```python
import torch

def _softmax(x, axis=-1):
    return torch.softmax(x, dim=axis)

def _gelu(x):
    return torch.nn.functional.gelu(x, approximate='tanh')

def _silu(x):
    return torch.nn.functional.silu(x)

def _sigmoid(x):
    return torch.sigmoid(x)

def _layernorm(x, axis=-1, eps=1e-05):
    m = x.mean(dim=axis, keepdim=True)
    v = x.var(dim=axis, keepdim=True, unbiased=False)
    return (x - m) / torch.sqrt(v + eps)

def _scatter_add(tgt, idx, src, axis=0):
    return tgt.clone().index_add_(axis, idx, src)

def _segment_sum(src, seg, n):
    out = torch.zeros((n,) + src.shape[1:], dtype=src.dtype)
    return out.index_add_(0, seg, src)

def _pad(x, pw):
    flat = tuple((v for pair in reversed(pw) for v in pair))
    return torch.nn.functional.pad(x, flat)
kernel_name = 'adaLN_cond__compressed_kv_cla__mixer_gmlp__prompt'

def setup_inputs():

    _w = lambda a: (lambda t: t.to(torch.bfloat16) if t.is_floating_point() else t)(torch.as_tensor(a))

    def _A_setup():
        B, H, Sq, Sk, D, M = (1, 32, 2048, 2048, 128, 512)
        Dc = 4 * D
        return {'x': _w((lambda *s: torch.randn(*s, dtype=torch.bfloat16) * 0.05)(B, Sq, M)), 'c_kv': _w((lambda *s: torch.randn(*s, dtype=torch.bfloat16) * 1.6)(B, Sk, Dc)), 'w_q': _w((lambda *s: torch.randn(*s, dtype=torch.bfloat16) * 0.8)(M, H, D) * M ** (-0.5)), 'w_uk': _w((lambda *s: torch.randn(*s, dtype=torch.bfloat16) * 0.8)(Dc, H, D) * Dc ** (-0.5)), 'w_uv': _w((lambda *s: torch.randn(*s, dtype=torch.bfloat16) * 1.6)(Dc, H, D) * Dc ** (-0.5)), 'w_o': _w((lambda *s: torch.randn(*s, dtype=torch.bfloat16) * 1.6)(H, D, M) * (H * D) ** (-0.5))}
    _A_in = _A_setup()

    def _B_setup():
        B, S, D, F = (1, 2048, 512, 1376)
        Fh = F // 2
        return {'x': _w((lambda *s: torch.randn(*s, dtype=torch.bfloat16) * 0.05)(B, S, D)), 'w_in': _w((lambda *s: torch.randn(*s, dtype=torch.bfloat16) * 0.4)(D, 2 * Fh)), 'w_sp': _w(0.01 * (lambda *s: torch.randn(*s, dtype=torch.bfloat16) * 0.4)(S, S)), 'b_sp': _w(1.0 + 0.01 * (lambda *s: torch.randn(*s, dtype=torch.bfloat16) * 0.05)(S)), 'w_out': _w((lambda *s: torch.randn(*s, dtype=torch.bfloat16) * 0.05)(Fh, D))}
    _B_in = _B_setup()
    return {'A_x': _A_in['x'], 'A_c_kv': _A_in['c_kv'], 'A_w_q': _A_in['w_q'], 'A_w_uk': _A_in['w_uk'], 'A_w_uv': _A_in['w_uv'], 'A_w_o': _A_in['w_o'], 'B_x': _B_in['x'], 'B_w_in': _B_in['w_in'], 'B_w_sp': _B_in['w_sp'], 'B_b_sp': _B_in['b_sp'], 'B_w_out': _B_in['w_out'], 'c': _w((lambda *s: torch.randn(*s, dtype=torch.bfloat16) * 0.1)(1, 512) * 8.0), 'w_mod': _w((lambda *s: torch.randn(*s, dtype=torch.bfloat16) * 0.1)(512, 6 * 512) * 512 ** (-0.5) * 8.0)}

def reference(A_x, A_c_kv, A_w_q, A_w_uk, A_w_uv, A_w_o, B_x, B_w_in, B_w_sp, B_b_sp, B_w_out, c, w_mod):

    def _A_ref(x, c_kv, w_q, w_uk, w_uv, w_o):
        B, Sq, M = (x.shape[0], x.shape[1], x.shape[2])
        Sk = c_kv.shape[1]
        H, D = (w_q.shape[1], w_q.shape[2])
        q = torch.einsum('bqm,mhd->bhqd', x, w_q)
        k = torch.einsum('bkc,chd->bhkd', c_kv, w_uk)
        v = torch.einsum('bkc,chd->bhkd', c_kv, w_uv)
        scores = torch.einsum('bhqd,bhkd->bhqk', q, k) * D ** (-0.5)
        off = Sk - Sq
        qi = torch.arange(Sq)[:, None]
        kj = torch.arange(Sk)[None, :]
        cmask = kj <= qi + off
        scores = torch.where(cmask[None, None], scores, -1000000000.0)
        p = _softmax(scores, axis=-1)
        ctx = torch.einsum('bhqk,bhkd->bhqd', p, v)
        return torch.einsum('bhqd,hdm->bqm', ctx, w_o)

    def _B_ref(x, w_in, w_sp, b_sp, w_out):
        B, S, D = x.shape
        F = w_in.shape[-1]
        Fh = F // 2
        z = _gelu(torch.einsum('bsd,df->bsf', x, w_in))
        z1 = z[..., :Fh].clone()
        z2 = _layernorm(z[..., Fh:], axis=-1)
        g = torch.einsum('ts,bsf->btf', w_sp, z2) + b_sp[None, :, None]
        return torch.einsum('bsf,fd->bsd', z1 * g, w_out)
    x = A_x
    mod = (_silu(c) @ w_mod).reshape(c.shape[0], 6, 1, -1)
    sa, ca, ga, sb, cb, gb = (mod[:, 0].clone(), mod[:, 1].clone(), mod[:, 2].clone(), mod[:, 3].clone(), mod[:, 4].clone(), mod[:, 5].clone())
    h = _layernorm(x, axis=-1) * (1 + ca) + sa
    x = x + ga * _A_ref(h, A_c_kv, A_w_q, A_w_uk, A_w_uv, A_w_o)
    h = _layernorm(x, axis=-1) * (1 + cb) + sb
    x = x + gb * _B_ref(h, B_w_in, B_w_sp, B_b_sp, B_w_out)
    return x
```

```asm
; @launch kernel=attn_kernel grid=(256,1,1) block=(256,1,1) lds=163840
.amdgcn_target "amdgcn-amd-amdhsa--gfx950"
.text
.globl attn_kernel
.p2align 8
.type attn_kernel,@function
attn_kernel:
    s_load_dwordx2 s[92:93], s[0:1], 112
    s_load_dwordx2 s[88:89], s[0:1], 96
    s_load_dwordx2 s[84:85], s[0:1], 88
    s_load_dwordx2 s[60:61], s[0:1], 8
    s_load_dwordx2 s[64:65], s[0:1], 24
    s_load_dwordx2 s[76:77], s[0:1], 32
    s_load_dwordx2 s[8:9], s[0:1], 120
    s_load_dwordx2 s[80:81], s[0:1], 0
    s_load_dwordx2 s[16:17], s[0:1], 16
    s_load_dwordx2 s[68:69], s[0:1], 40
    s_load_dwordx2 s[20:21], s[0:1], 56
    s_load_dwordx2 s[24:25], s[0:1], 80
    s_getreg_b32 s5, hwreg(HW_REG_XCC_ID, 0, 4)
    s_getreg_b32 s6, hwreg(HW_REG_HW_ID, 13, 2)
    s_getreg_b32 s7, hwreg(HW_REG_HW_ID, 8, 4)
    v_lshrrev_b32 v1, 6, v0
    s_cmp_ge_u32 s2, 256
    s_cbranch_scc1 AT_END
    v_readfirstlane_b32 s55, v1
    s_and_b32 s5, s5, 7
    s_and_b32 s10, s6, 1
    s_sub_u32 s10, s7, s10
    s_lshl_b32 s59, s6, 3
    s_and_b32 s7, s7, 7
    s_or_b32 s6, s59, s7
    s_lshl_b32 s2, s6, 3
    s_or_b32 s2, s2, s5
    s_mov_b32 s35, 0
    s_mov_b32 s58, 0
    v_and_b32 v1, 63, v0
    v_lshlrev_b32 v17, 4, v1
    v_mov_b32 v57, 163776
    s_mov_b32 s94, 256
    s_mov_b32 s95, 0x00020000
    s_mov_b32 s90, 3145728
    s_mov_b32 s91, 0x00020000
    s_mov_b32 s86, 1024
    s_mov_b32 s87, 0x00020000
    s_mov_b32 s62, 2097152
    s_mov_b32 s63, 0x00020000
    s_mov_b32 s66, 4194304
    s_mov_b32 s67, 0x00020000
    s_mov_b32 s78, 4194304
    s_mov_b32 s79, 0x00020000
    s_mov_b32 s74, 0x10000000
    s_mov_b32 s75, 0x00020000
    s_mov_b32 s15, 0x00020000
    s_cmp_ge_u32 s10, 8
    s_cbranch_scc1 FR_AL
FR_RE:
    s_nop 0
    s_and_b32 s5, s2, 7
    s_lshr_b32 s4, s2, 3
    s_lshl_b32 s96, 1, s4
    v_mov_b32 v60, 0
    s_mov_b32 s49, 1073741824
    s_cmp_eq_u32 s55, 1
    s_cbranch_scc1 FR_M
    s_or_b32 s97, s55, s35
    s_cbranch_scc1 FR_CM
    s_lshl_b32 s97, s5, 4
    s_lshl_b32 s98, s5, 2
    v_mov_b32 v60, s96
    v_mov_b32 v56, s96
    s_mov_b64 exec, 1
    s_waitcnt lgkmcnt(0)
    buffer_atomic_or v60, off, s[92:95], s97 sc0
    buffer_atomic_or v56, off, s[92:95], s98 offset:160 sc1
    s_mov_b64 exec, -1
    s_branch FR_CM
FR_M:
    v_lshrrev_b32 v4, 1, v1
    v_lshlrev_b32 v5, 3, v4
    v_mul_u32_u24 v4, 24576, v4
    v_and_b32 v6, 1, v1
    v_lshl_add_u32 v4, v6, 4, v4
    s_lshr_b32 s7, s4, 3
    s_lshl_b32 s49, s7, 12
    s_lshl_b32 s7, s7, 8
    s_mul_i32 s6, s7, 3072
    s_and_b32 s10, s4, 7
    s_lshl_b32 s11, s5, 3
    s_add_u32 s10, s10, s11
    s_lshl_b32 s10, s10, 5
    s_add_u32 s6, s6, s10
    s_waitcnt lgkmcnt(0)
    buffer_load_dwordx2 v[58:59], v5, s[84:87], s7 offen
    buffer_load_dwordx4 v[240:243], v4, s[88:91], s6 offen
    s_add_u32 s6, s6, 6144
    buffer_load_dwordx4 v[244:247], v4, s[88:91], s6 offen
    s_add_u32 s6, s6, 6144
    buffer_load_dwordx4 v[248:251], v4, s[88:91], s6 offen
    s_add_u32 s6, s6, 6144
    buffer_load_dwordx4 v[252:255], v4, s[88:91], s6 offen
    s_lshl_b32 s10, s10, 1
    s_add_u32 s49, s49, s10
    s_add_u32 s49, s49, 16384
FR_CM:
    s_nop 0
    v_and_b32 v2, 31, v1
    v_lshrrev_b32 v3, 5, v1
    v_and_b32 v6, 7, v1
    s_lshl_b32 s6, s4, 16
    s_lshl_b32 s7, s55, 15
    s_add_u32 s6, s6, s7
    v_lshlrev_b32 v16, 7, v3
    v_lshl_add_u32 v16, v2, 10, v16
    v_bfe_u32 v4, v1, 3, 1
    v_lshl_add_u32 v4, v3, 6, v4
    v_lshlrev_b32 v4, 13, v4
    v_lshl_add_u32 v4, v6, 7, v4
    v_bfe_u32 v7, v1, 4, 1
    v_lshl_add_u32 v4, v7, 30, v4
    s_lshl_b32 s7, s4, 14
    s_lshl_b32 s10, s5, 10
    s_add_u32 s7, s7, s10
    s_movk_i32 s38, 128
    s_cmp_lt_u32 s55, 2
    s_cselect_b32 s31, s6, s7
    s_cselect_b32 s38, s38, 0x80000
    s_cselect_b32 s14, 2097152, s66
    s_cselect_b64 vcc, -1, 0
    v_cndmask_b32 v16, v4, v16, vcc
    s_waitcnt lgkmcnt(0)
    s_cselect_b32 s12, s60, s64
    s_cselect_b32 s13, s61, s65
    s_cmp_eq_u32 s55, 3
    s_cselect_b32 s12, s76, s12
    s_cselect_b32 s13, s77, s13
    s_mov_b32 s72, s8
    s_mov_b32 s73, s9
    s_mov_b64 exec, 0xffffffff
    buffer_load_dword v8, v16, s[12:15], s31 offen
    s_mov_b64 exec, -1
    s_add_u32 s31, s31, s38
    s_and_b32 s42, s4, 3
    s_lshl_b32 s40, s5, 2
    s_add_u32 s40, s40, s42
    s_lshr_b32 s56, s4, 2
    v_lshrrev_b32 v4, 3, v1
    v_xor_b32 v5, v4, v6
    s_and_b32 s3, s55, 1
    v_xor_b32 v5, s3, v5
    s_lshl_b32 s6, s55, 3
    s_lshl_b32 s45, s56, 8
    s_add_u32 s6, s6, s45
    v_add_u32 v7, s6, v4
    v_lshlrev_b32 v7, 10, v7
    v_lshl_add_u32 v10, v5, 4, v7
    v_lshrrev_b32 v20, 4, v1
    v_and_b32 v21, 15, v1
    v_lshlrev_b32 v22, 2, v20
    v_xor_b32 v22, v22, v21
    s_lshl_b32 s6, s55, 2
    v_add_u32 v23, s6, v20
    v_lshlrev_b32 v18, 13, v23
    v_lshl_add_u32 v19, v22, 4, v18
    s_lshl_b32 s45, s40, 8
    v_add_u32 v19, s45, v19
    s_lshl_b32 s36, s55, 12
    s_lshl_b32 s37, s55, 10
    s_add_u32 m0, s37, 32768
    s_mov_b32 s39, 0
    buffer_load_dwordx4 v10, s[60:63], s39 offen lds
    s_add_u32 m0, s37, 36864
    s_mov_b32 s39, 32768
    buffer_load_dwordx4 v10, s[60:63], s39 offen lds
    s_add_u32 m0, s37, 40960
    s_mov_b32 s39, 65536
    buffer_load_dwordx4 v10, s[60:63], s39 offen lds
    s_add_u32 m0, s37, 45056
    s_mov_b32 s39, 98304
    buffer_load_dwordx4 v10, s[60:63], s39 offen lds
    s_add_u32 m0, s37, 49152
    s_mov_b32 s39, 131072
    buffer_load_dwordx4 v10, s[60:63], s39 offen lds
    s_add_u32 m0, s37, 53248
    s_mov_b32 s39, 163840
    buffer_load_dwordx4 v10, s[60:63], s39 offen lds
    s_add_u32 m0, s37, 57344
    s_mov_b32 s39, 196608
    buffer_load_dwordx4 v10, s[60:63], s39 offen lds
    s_add_u32 m0, s37, 61440
    s_mov_b32 s39, 229376
    buffer_load_dwordx4 v10, s[60:63], s39 offen lds
    s_add_u32 m0, s37, 98304
    s_mov_b32 s39, 0
    buffer_load_dwordx4 v19, s[64:67], s39 offen nt lds
    s_add_u32 m0, s37, 106496
    s_nop 0
    buffer_load_dwordx4 v19, s[76:79], s39 offen nt lds
    s_add_u32 m0, s37, 102400
    s_mov_b32 s39, 131072
    buffer_load_dwordx4 v19, s[64:67], s39 offen nt lds
    s_add_u32 m0, s37, 110592
    s_nop 0
    buffer_load_dwordx4 v19, s[76:79], s39 offen nt lds
    s_add_u32 m0, s37, 114688
    s_mov_b32 s39, 262144
    buffer_load_dwordx4 v19, s[64:67], s39 offen nt lds
    s_add_u32 m0, s37, 122880
    s_nop 0
    buffer_load_dwordx4 v19, s[76:79], s39 offen nt lds
    s_add_u32 m0, s37, 118784
    s_mov_b32 s39, 393216
    buffer_load_dwordx4 v19, s[64:67], s39 offen nt lds
    s_add_u32 m0, s37, 126976
    s_nop 0
    buffer_load_dwordx4 v19, s[76:79], s39 offen nt lds
    s_lshl_b32 s6, s55, 2
    v_add_u32 v61, s6, v57
    v_lshlrev_b32 v11, 4, v4
    v_lshl_add_u32 v11, v6, 10, v11
    v_lshlrev_b32 v18, 5, v4
    s_lshl_b32 s45, s55, 9
    s_add_u32 s45, s45, 147456
    v_add_u32 v18, s45, v18
    v_lshlrev_b32 v63, 3, v6
    v_add_u32 v63, 153088, v63
    v_lshlrev_b32 v6, 4, v6
    v_lshl_add_u32 v6, v4, 9, v6
    v_bfe_u32 v5, v1, 2, 2
    s_lshl_b32 s45, s55, 6
    v_add_u32 v4, s45, v2
    v_lshlrev_b32 v4, 7, v4
    v_bfe_u32 v7, v1, 3, 1
    v_xor_b32 v7, v7, v1
    v_and_b32 v7, 7, v7
    v_xor_b32 v7, v7, v3
    v_xor_b32 v9, 0, v7
    v_lshl_add_u32 v12, v9, 4, v4
    v_xor_b32 v9, 2, v7
    v_lshl_add_u32 v13, v9, 4, v4
    v_xor_b32 v9, 4, v7
    v_lshl_add_u32 v14, v9, 4, v4
    v_xor_b32 v9, 6, v7
    v_lshl_add_u32 v15, v9, 4, v4
    v_and_b32 v4, 3, v1
    v_bfe_u32 v7, v1, 4, 1
    v_lshlrev_b32 v9, 3, v3
    v_add_u32 v9, v9, v5
    v_lshlrev_b32 v9, 8, v9
    v_lshl_add_u32 v9, v7, 5, v9
    v_lshl_add_u32 v9, v4, 3, v9
    v_xor_b32 v0, 0, v5
    v_lshl_add_u32 v20, v0, 6, v9
    v_add_u32 v24, 98304, v20
    v_xor_b32 v0, 1, v5
    v_lshl_add_u32 v21, v0, 6, v9
    v_add_u32 v25, 98304, v21
    v_xor_b32 v0, 2, v5
    v_lshl_add_u32 v22, v0, 6, v9
    v_add_u32 v26, 98304, v22
    v_xor_b32 v0, 3, v5
    v_lshl_add_u32 v23, v0, 6, v9
    v_add_u32 v27, 98304, v23
    s_mov_b32 s82, 2097152
    s_mov_b32 s83, 0x00020000
    s_mov_b32 s18, 4194304
    s_mov_b32 s19, 0x00020000
    v_lshl_or_b32 v5, v4, 2, v5
    v_and_b32 v9, 0x30, v1
    v_or_b32 v5, v5, v9
    v_and_b32 v4, 1, v1
    v_lshlrev_b32 v4, 5, v4
    v_lshl_add_u32 v4, v3, 4, v4
    v_lshl_add_u32 v4, v7, 3, v4
    v_lshlrev_b32 v7, 4, v5
    v_mov_b32 v32, 0
    v_mov_b32 v33, 0
    v_mov_b32 v34, 0
    v_mov_b32 v35, 0
    s_lshl_b32 s6, s2, 10
    s_add_u32 s6, s6, 262144
    s_cmp_eq_u32 s55, 1
    s_cselect_b32 s6, s6, 1073741824
    s_cselect_b32 s10, 128, s6
    buffer_store_dwordx4 v[32:35], v17, s[72:75], s6 offen sc0 sc1
    s_cbranch_scc0 FR_DW
    s_waitcnt vmcnt(22)
    v_lshlrev_b32 v28, 16, v58
    v_and_b32 v29, 0xffff0000, v58
    v_lshlrev_b32 v30, 16, v59
    v_and_b32 v31, 0xffff0000, v59
    v_mul_f32 v36, 0xbfb8aa3b, v28
    v_mul_f32 v37, 0xbfb8aa3b, v29
    v_mul_f32 v38, 0xbfb8aa3b, v30
    v_mul_f32 v39, 0xbfb8aa3b, v31
    v_exp_f32 v36, v36
    v_exp_f32 v37, v37
    v_exp_f32 v38, v38
    v_exp_f32 v39, v39
    v_add_f32 v36, 1.0, v36
    v_add_f32 v37, 1.0, v37
    v_add_f32 v38, 1.0, v38
    v_add_f32 v39, 1.0, v39
    v_rcp_f32 v36, v36
    v_rcp_f32 v37, v37
    v_rcp_f32 v38, v38
    v_rcp_f32 v39, v39
    v_mul_f32 v28, v28, v36
    v_mul_f32 v29, v29, v37
    v_mul_f32 v30, v30, v38
    v_mul_f32 v31, v31, v39
    v_cvt_pk_bf16_f32 v28, v28, v28
    v_cvt_pk_bf16_f32 v29, v29, v29
    v_cvt_pk_bf16_f32 v30, v30, v30
    v_cvt_pk_bf16_f32 v31, v31, v31
    v_lshlrev_b32 v28, 16, v28
    v_lshlrev_b32 v29, 16, v29
    v_lshlrev_b32 v30, 16, v30
    v_lshlrev_b32 v31, 16, v31
    s_waitcnt vmcnt(21)
    v_lshlrev_b32 v144, 16, v240
    v_and_b32 v145, 0xffff0000, v240
    v_lshlrev_b32 v146, 16, v241
    v_and_b32 v147, 0xffff0000, v241
    v_lshlrev_b32 v148, 16, v242
    v_and_b32 v149, 0xffff0000, v242
    v_lshlrev_b32 v150, 16, v243
    v_and_b32 v151, 0xffff0000, v243
    v_mul_f32 v44, v144, v28
    v_mul_f32 v45, v145, v28
    v_mul_f32 v46, v146, v28
    v_mul_f32 v47, v147, v28
    v_mul_f32 v48, v148, v28
    v_mul_f32 v49, v149, v28
    v_mul_f32 v50, v150, v28
    v_mul_f32 v51, v151, v28
    s_waitcnt vmcnt(20)
    v_lshlrev_b32 v144, 16, v244
    v_and_b32 v145, 0xffff0000, v244
    v_lshlrev_b32 v146, 16, v245
    v_and_b32 v147, 0xffff0000, v245
    v_lshlrev_b32 v148, 16, v246
    v_and_b32 v149, 0xffff0000, v246
    v_lshlrev_b32 v150, 16, v247
    v_and_b32 v151, 0xffff0000, v247
    v_fmac_f32 v44, v144, v29
    v_fmac_f32 v45, v145, v29
    v_fmac_f32 v46, v146, v29
    v_fmac_f32 v47, v147, v29
    v_fmac_f32 v48, v148, v29
    v_fmac_f32 v49, v149, v29
    v_fmac_f32 v50, v150, v29
    v_fmac_f32 v51, v151, v29
    s_waitcnt vmcnt(19)
    v_lshlrev_b32 v144, 16, v248
    v_and_b32 v145, 0xffff0000, v248
    v_lshlrev_b32 v146, 16, v249
    v_and_b32 v147, 0xffff0000, v249
    v_lshlrev_b32 v148, 16, v250
    v_and_b32 v149, 0xffff0000, v250
    v_lshlrev_b32 v150, 16, v251
    v_and_b32 v151, 0xffff0000, v251
    v_fmac_f32 v44, v144, v30
    v_fmac_f32 v45, v145, v30
    v_fmac_f32 v46, v146, v30
    v_fmac_f32 v47, v147, v30
    v_fmac_f32 v48, v148, v30
    v_fmac_f32 v49, v149, v30
    v_fmac_f32 v50, v150, v30
    v_fmac_f32 v51, v151, v30
    s_waitcnt vmcnt(18)
    v_lshlrev_b32 v144, 16, v252
    v_and_b32 v145, 0xffff0000, v252
    v_lshlrev_b32 v146, 16, v253
    v_and_b32 v147, 0xffff0000, v253
    v_lshlrev_b32 v148, 16, v254
    v_and_b32 v149, 0xffff0000, v254
    v_lshlrev_b32 v150, 16, v255
    v_and_b32 v151, 0xffff0000, v255
    v_fmac_f32 v44, v144, v31
    v_fmac_f32 v45, v145, v31
    v_fmac_f32 v46, v146, v31
    v_fmac_f32 v47, v147, v31
    v_fmac_f32 v48, v148, v31
    v_fmac_f32 v49, v149, v31
    v_fmac_f32 v50, v150, v31
    v_fmac_f32 v51, v151, v31
    v_permlane32_swap_b32 v44, v48
    v_permlane32_swap_b32 v45, v49
    v_permlane32_swap_b32 v46, v50
    v_permlane32_swap_b32 v47, v51
    v_add_f32 v44, v44, v48
    v_add_f32 v45, v45, v49
    v_add_f32 v46, v46, v50
    v_add_f32 v47, v47, v51
    s_nop 0
    v_permlane16_swap_b32 v44, v46
    v_permlane16_swap_b32 v45, v47
    v_add_f32 v44, v44, v46
    v_add_f32 v45, v45, v47
    s_nop 0
    v_add_f32_dpp v46, v44, v44 row_ror:8 row_mask:0xf bank_mask:0xf
    v_add_f32_dpp v47, v45, v45 row_ror:8 row_mask:0xf bank_mask:0xf
    s_nop 0
    v_add_f32_dpp v48, v46, v46 row_ror:4 row_mask:0xf bank_mask:0xf
    v_add_f32_dpp v49, v47, v47 row_ror:4 row_mask:0xf bank_mask:0xf
    s_nop 0
    v_add_f32_dpp v50, v48, v48 row_ror:2 row_mask:0xf bank_mask:0xf
    v_add_f32_dpp v51, v49, v49 row_ror:2 row_mask:0xf bank_mask:0xf
FR_DW:
    s_nop 4
    buffer_store_dwordx2 v[50:51], v4, s[72:75], s49 offen sc1
    s_add_u32 m0, s37, 65536
    s_mov_b32 s39, 128
    buffer_load_dwordx4 v10, s[60:63], s39 offen lds
    s_add_u32 m0, s37, 69632
    s_mov_b32 s39, 32896
    buffer_load_dwordx4 v10, s[60:63], s39 offen lds
    s_add_u32 m0, s37, 73728
    s_mov_b32 s39, 65664
    buffer_load_dwordx4 v10, s[60:63], s39 offen lds
    s_add_u32 m0, s37, 77824
    s_mov_b32 s39, 98432
    buffer_load_dwordx4 v10, s[60:63], s39 offen lds
    s_add_u32 m0, s37, 81920
    s_mov_b32 s39, 131200
    buffer_load_dwordx4 v10, s[60:63], s39 offen lds
    s_add_u32 m0, s37, 86016
    s_mov_b32 s39, 163968
    buffer_load_dwordx4 v10, s[60:63], s39 offen lds
    s_add_u32 m0, s37, 90112
    s_mov_b32 s39, 196736
    buffer_load_dwordx4 v10, s[60:63], s39 offen lds
    s_add_u32 m0, s37, 94208
    s_mov_b32 s39, 229504
    buffer_load_dwordx4 v10, s[60:63], s39 offen lds
    s_add_u32 m0, s37, 131072
    s_mov_b32 s39, 524288
    buffer_load_dwordx4 v19, s[64:67], s39 offen nt lds
    s_add_u32 m0, s37, 139264
    s_nop 0
    buffer_load_dwordx4 v19, s[76:79], s39 offen nt lds
    s_add_u32 m0, s37, 135168
    s_mov_b32 s39, 655360
    buffer_load_dwordx4 v19, s[64:67], s39 offen nt lds
    s_add_u32 m0, s37, 143360
    s_nop 0
    buffer_load_dwordx4 v19, s[76:79], s39 offen nt lds
    buffer_load_dword v8, v16, s[12:15], s31 offen
    s_add_u32 s31, s31, s38
    s_add_u32 s31, s31, s38
    s_waitcnt vmcnt(19)
    v_readfirstlane_b32 s98, v60
    s_nop 0
    s_and_b32 s98, s98, s96
    v_mov_b32 v60, s98
    ds_write_b32 v61, v60
    v_mov_b32 v9, 1
    s_waitcnt lgkmcnt(0)
    s_barrier
    ds_read_b32 v60, v57
    ds_read_b128 v[64:67], v12 offset:32768
    ds_read_b128 v[68:71], v12 offset:36864
    ds_read_b64_tr_b16 v[80:81], v24 offset:0
    ds_read_b64_tr_b16 v[82:83], v24 offset:1024
    ds_read_b64_tr_b16 v[84:85], v25 offset:0
    ds_read_b64_tr_b16 v[86:87], v25 offset:1024
    ds_read_b64_tr_b16 v[88:89], v26 offset:0
    ds_read_b64_tr_b16 v[90:91], v26 offset:1024
    ds_read_b64_tr_b16 v[92:93], v27 offset:0
    ds_read_b64_tr_b16 v[94:95], v27 offset:1024
    ds_read_b64_tr_b16 v[96:97], v24 offset:8192
    ds_read_b64_tr_b16 v[98:99], v24 offset:9216
    ds_read_b64_tr_b16 v[100:101], v25 offset:8192
    ds_read_b64_tr_b16 v[102:103], v25 offset:9216
    ds_read_b64_tr_b16 v[104:105], v26 offset:8192
    ds_read_b64_tr_b16 v[106:107], v26 offset:9216
    ds_read_b64_tr_b16 v[108:109], v27 offset:8192
    ds_read_b64_tr_b16 v[110:111], v27 offset:9216
    s_waitcnt lgkmcnt(0)
    v_readfirstlane_b32 s98, v60
    s_nop 0
    s_cmp_lg_u32 s98, 0
    s_cbranch_scc1 FR_AL
    v_mfma_f32_32x32x16_bf16 a[0:15], v[80:83], v[64:67], 0
    ds_read_b128 v[72:75], v13 offset:32768
    ds_read_b128 v[76:79], v13 offset:36864
    ds_read_b64_tr_b16 v[112:113], v24 offset:4096
    s_sub_u32 s71, 15, s56
    s_cmp_lt_u32 s40, 16
    s_cselect_b32 s71, s71, s56
    s_lshl_b32 s71, s71, 7
    s_and_b32 s45, s40, 15
    s_lshl_b32 s45, s45, 3
    v_mfma_f32_32x32x16_bf16 a[16:31], v[84:87], v[64:67], 0
    ds_read_b64_tr_b16 v[114:115], v24 offset:5120
    ds_read_b64_tr_b16 v[116:117], v25 offset:4096
    ds_read_b64_tr_b16 v[118:119], v25 offset:5120
    s_add_u32 s71, s71, s45
    s_lshl_b32 s70, s71, 10
    s_lshl_b32 s45, s55, 8
    s_add_u32 s70, s70, s45
    v_mfma_f32_32x32x16_bf16 a[32:47], v[88:91], v[64:67], 0
    ds_read_b64_tr_b16 v[120:121], v26 offset:4096
    ds_read_b64_tr_b16 v[122:123], v26 offset:5120
    ds_read_b64_tr_b16 v[124:125], v27 offset:4096
    buffer_load_dwordx4 v[192:195], v11, s[80:83], s70 offen offset:0
    v_mfma_f32_32x32x16_bf16 a[48:63], v[92:95], v[64:67], 0
    ds_read_b64_tr_b16 v[126:127], v27 offset:5120
    ds_read_b64_tr_b16 v[128:129], v24 offset:12288
    ds_read_b64_tr_b16 v[130:131], v24 offset:13312
    buffer_load_dwordx4 v[196:199], v11, s[80:83], s70 offen offset:128
    s_sub_u32 s43, 15, s56
    v_mfma_f32_32x32x16_bf16 a[64:79], v[80:83], v[68:71], 0
    ds_read_b64_tr_b16 v[132:133], v25 offset:12288
    ds_read_b64_tr_b16 v[134:135], v25 offset:13312
    ds_read_b64_tr_b16 v[136:137], v26 offset:12288
    s_cmp_lt_u32 s55, 2
    s_cselect_b32 s41, s43, s56
    s_cmp_lt_u32 s42, 2
    s_cselect_b32 s43, s43, s56
    s_lshl_b32 s43, s43, 7
    s_and_b32 s45, s42, 1
    v_mfma_f32_32x32x16_bf16 a[80:95], v[84:87], v[68:71], 0
    ds_read_b64_tr_b16 v[138:139], v26 offset:13312
    ds_read_b64_tr_b16 v[140:141], v27 offset:12288
    ds_read_b64_tr_b16 v[142:143], v27 offset:13312
    s_lshl_b32 s45, s45, 6
    s_add_u32 s43, s43, s45
    s_lshl_b32 s45, s55, 4
    s_add_u32 s43, s43, s45
    s_lshr_b32 s45, s71, 5
    s_lshl_b32 s45, s45, 15
    v_mfma_f32_32x32x16_bf16 a[96:111], v[88:91], v[68:71], 0
    s_and_b32 s46, s71, 31
    s_lshl_b32 s46, s46, 4
    s_add_u32 s45, s45, s46
    s_lshl_b32 s46, s55, 13
    s_add_u32 s45, s45, s46
    s_add_u32 s54, s45, 83886080
    v_mfma_f32_32x32x16_bf16 a[112:127], v[92:95], v[68:71], 0
    v_mfma_f32_32x32x16_bf16 a[128:143], v[64:67], v[96:99], 0
    v_mfma_f32_32x32x16_bf16 a[144:159], v[68:71], v[96:99], 0
    v_mfma_f32_32x32x16_bf16 a[160:175], v[64:67], v[100:103], 0
    v_mfma_f32_32x32x16_bf16 a[176:191], v[68:71], v[100:103], 0
    v_mfma_f32_32x32x16_bf16 a[192:207], v[64:67], v[104:107], 0
    v_mfma_f32_32x32x16_bf16 a[208:223], v[68:71], v[104:107], 0
    v_mfma_f32_32x32x16_bf16 a[224:239], v[64:67], v[108:111], 0
    v_mfma_f32_32x32x16_bf16 a[240:255], v[68:71], v[108:111], 0
    s_waitcnt lgkmcnt(0)
    v_mfma_f32_32x32x16_bf16 a[0:15], v[112:115], v[72:75], a[0:15]
    s_waitcnt vmcnt(17)
    s_barrier
    v_mfma_f32_32x32x16_bf16 a[16:31], v[116:119], v[72:75], a[16:31]
    ds_read_b128 v[64:67], v14 offset:32768
    ds_read_b128 v[68:71], v14 offset:36864
    ds_read_b64_tr_b16 v[80:81], v24 offset:16384
    v_mfma_f32_32x32x16_bf16 a[32:47], v[120:123], v[72:75], a[32:47]
    ds_read_b64_tr_b16 v[82:83], v24 offset:17408
    ds_read_b64_tr_b16 v[84:85], v25 offset:16384
    ds_read_b64_tr_b16 v[86:87], v25 offset:17408
    v_mfma_f32_32x32x16_bf16 a[48:63], v[124:127], v[72:75], a[48:63]
    ds_read_b64_tr_b16 v[88:89], v26 offset:16384
    ds_read_b64_tr_b16 v[90:91], v26 offset:17408
    ds_read_b64_tr_b16 v[92:93], v27 offset:16384
    v_mfma_f32_32x32x16_bf16 a[64:79], v[112:115], v[76:79], a[64:79]
    ds_read_b64_tr_b16 v[94:95], v27 offset:17408
    ds_read_b64_tr_b16 v[96:97], v24 offset:24576
    ds_read_b64_tr_b16 v[98:99], v24 offset:25600
    s_waitcnt vmcnt(15)
    v_mfma_f32_32x32x16_bf16 a[80:95], v[116:119], v[76:79], a[80:95]
    ds_read_b64_tr_b16 v[100:101], v25 offset:24576
    ds_read_b64_tr_b16 v[102:103], v25 offset:25600
    ds_read_b64_tr_b16 v[104:105], v26 offset:24576
    s_mov_b64 exec, 1
    buffer_atomic_add v9, off, s[92:95], s10 sc1
    s_mov_b64 exec, -1
    v_mfma_f32_32x32x16_bf16 a[96:111], v[120:123], v[76:79], a[96:111]
    ds_read_b64_tr_b16 v[106:107], v26 offset:25600
    ds_read_b64_tr_b16 v[108:109], v27 offset:24576
    ds_read_b64_tr_b16 v[110:111], v27 offset:25600
    v_mfma_f32_32x32x16_bf16 a[112:127], v[124:127], v[76:79], a[112:127]
    s_add_u32 m0, s37, 98304
    s_mov_b32 s39, 786432
    buffer_load_dwordx4 v19, s[64:67], s39 offen nt lds
    s_add_u32 m0, s37, 106496
    s_nop 0
    buffer_load_dwordx4 v19, s[76:79], s39 offen nt lds
    v_mfma_f32_32x32x16_bf16 a[128:143], v[72:75], v[128:131], a[128:143]
    s_add_u32 m0, s37, 102400
    s_mov_b32 s39, 917504
    buffer_load_dwordx4 v19, s[64:67], s39 offen nt lds
    s_add_u32 m0, s37, 110592
    s_nop 0
    buffer_load_dwordx4 v19, s[76:79], s39 offen nt lds
    v_mfma_f32_32x32x16_bf16 a[144:159], v[76:79], v[128:131], a[144:159]
    s_add_u32 m0, s37, 0
    s_mov_b32 s39, 256
    buffer_load_dwordx4 v10, s[60:63], s39 offen lds
    buffer_load_dword v8, v16, s[12:15], s31 offen
    s_add_u32 s31, s31, s38
    s_add_u32 s31, s31, s38
    v_mfma_f32_32x32x16_bf16 a[160:175], v[72:75], v[132:135], a[160:175]
    s_add_u32 m0, s37, 4096
    s_mov_b32 s39, 33024
    buffer_load_dwordx4 v10, s[60:63], s39 offen lds
    v_mfma_f32_32x32x16_bf16 a[176:191], v[76:79], v[132:135], a[176:191]
    s_add_u32 m0, s37, 8192
    s_mov_b32 s39, 65792
    buffer_load_dwordx4 v10, s[60:63], s39 offen lds
    v_mfma_f32_32x32x16_bf16 a[192:207], v[72:75], v[136:139], a[192:207]
    s_add_u32 m0, s37, 12288
    s_mov_b32 s39, 98560
    buffer_load_dwordx4 v10, s[60:63], s39 offen lds
    v_mfma_f32_32x32x16_bf16 a[208:223], v[76:79], v[136:139], a[208:223]
    s_add_u32 m0, s37, 16384
    s_mov_b32 s39, 131328
    buffer_load_dwordx4 v10, s[60:63], s39 offen lds
    v_mfma_f32_32x32x16_bf16 a[224:239], v[72:75], v[140:143], a[224:239]
    s_add_u32 m0, s37, 20480
    s_mov_b32 s39, 164096
    buffer_load_dwordx4 v10, s[60:63], s39 offen lds
    v_mfma_f32_32x32x16_bf16 a[240:255], v[76:79], v[140:143], a[240:255]
    s_add_u32 m0, s37, 24576
    s_mov_b32 s39, 196864
    buffer_load_dwordx4 v10, s[60:63], s39 offen lds
    s_waitcnt lgkmcnt(0)
    v_mfma_f32_32x32x16_bf16 a[0:15], v[80:83], v[64:67], a[0:15]
    s_add_u32 m0, s37, 28672
    s_mov_b32 s39, 229632
    buffer_load_dwordx4 v10, s[60:63], s39 offen lds
    ds_read_b128 v[72:75], v15 offset:32768
    ds_read_b128 v[76:79], v15 offset:36864
    ds_read_b64_tr_b16 v[112:113], v24 offset:20480
    v_mfma_f32_32x32x16_bf16 a[16:31], v[84:87], v[64:67], a[16:31]
    ds_read_b64_tr_b16 v[114:115], v24 offset:21504
    ds_read_b64_tr_b16 v[116:117], v25 offset:20480
    ds_read_b64_tr_b16 v[118:119], v25 offset:21504
    s_waitcnt vmcnt(14)
    v_lshlrev_b32 v52, 16, v192
    v_and_b32 v53, 0xffff0000, v192
    v_mfma_f32_32x32x16_bf16 a[32:47], v[88:91], v[64:67], a[32:47]
    ds_read_b64_tr_b16 v[120:121], v26 offset:20480
    ds_read_b64_tr_b16 v[122:123], v26 offset:21504
    ds_read_b64_tr_b16 v[124:125], v27 offset:20480
    v_lshlrev_b32 v54, 16, v193
    v_and_b32 v55, 0xffff0000, v193
    v_lshlrev_b32 v56, 16, v194
    v_mfma_f32_32x32x16_bf16 a[48:63], v[92:95], v[64:67], a[48:63]
    ds_read_b64_tr_b16 v[126:127], v27 offset:21504
    ds_read_b64_tr_b16 v[128:129], v24 offset:28672
    ds_read_b64_tr_b16 v[130:131], v24 offset:29696
    v_and_b32 v57, 0xffff0000, v194
    v_lshlrev_b32 v58, 16, v195
    v_and_b32 v59, 0xffff0000, v195
    v_mfma_f32_32x32x16_bf16 a[64:79], v[80:83], v[68:71], a[64:79]
    ds_read_b64_tr_b16 v[132:133], v25 offset:28672
    ds_read_b64_tr_b16 v[134:135], v25 offset:29696
    ds_read_b64_tr_b16 v[136:137], v26 offset:28672
    v_mov_b32 v44, v52
    v_mul_f32 v45, v52, v52
    v_mov_b32 v46, v53
    v_mfma_f32_32x32x16_bf16 a[80:95], v[84:87], v[68:71], a[80:95]
    ds_read_b64_tr_b16 v[138:139], v26 offset:29696
    ds_read_b64_tr_b16 v[140:141], v27 offset:28672
    ds_read_b64_tr_b16 v[142:143], v27 offset:29696
    v_mul_f32 v47, v53, v53
    v_add_f32 v44, v44, v54
    v_fmac_f32 v45, v54, v54
    v_mfma_f32_32x32x16_bf16 a[96:111], v[88:91], v[68:71], a[96:111]
    v_add_f32 v46, v46, v55
    v_fmac_f32 v47, v55, v55
    v_add_f32 v44, v44, v56
    v_fmac_f32 v45, v56, v56
    v_add_f32 v46, v46, v57
    v_fmac_f32 v47, v57, v57
    v_mfma_f32_32x32x16_bf16 a[112:127], v[92:95], v[68:71], a[112:127]
    v_add_f32 v44, v44, v58
    v_fmac_f32 v45, v58, v58
    v_add_f32 v46, v46, v59
    v_fmac_f32 v47, v59, v59
    v_lshlrev_b32 v52, 16, v196
    v_and_b32 v53, 0xffff0000, v196
    v_mfma_f32_32x32x16_bf16 a[128:143], v[64:67], v[96:99], a[128:143]
    v_lshlrev_b32 v54, 16, v197
    v_and_b32 v55, 0xffff0000, v197
    v_lshlrev_b32 v56, 16, v198
    v_and_b32 v57, 0xffff0000, v198
    v_lshlrev_b32 v58, 16, v199
    v_and_b32 v59, 0xffff0000, v199
    v_mfma_f32_32x32x16_bf16 a[144:159], v[68:71], v[96:99], a[144:159]
    v_add_f32 v44, v44, v52
    v_fmac_f32 v45, v52, v52
    v_add_f32 v46, v46, v53
    v_fmac_f32 v47, v53, v53
    v_add_f32 v44, v44, v54
    v_fmac_f32 v45, v54, v54
    v_mfma_f32_32x32x16_bf16 a[160:175], v[64:67], v[100:103], a[160:175]
    v_add_f32 v46, v46, v55
    v_fmac_f32 v47, v55, v55
    v_add_f32 v44, v44, v56
    v_fmac_f32 v45, v56, v56
    v_add_f32 v46, v46, v57
    v_fmac_f32 v47, v57, v57
    v_mfma_f32_32x32x16_bf16 a[176:191], v[68:71], v[100:103], a[176:191]
    v_add_f32 v44, v44, v58
    v_fmac_f32 v45, v58, v58
    v_add_f32 v46, v46, v59
    v_fmac_f32 v47, v59, v59
    v_add_f32 v44, v44, v46
    v_add_f32 v45, v45, v47
    v_mfma_f32_32x32x16_bf16 a[192:207], v[64:67], v[104:107], a[192:207]
    s_lshl_b32 s45, s55, 6
    v_add_f32_dpp v46, v44, v44 row_ror:8 row_mask:0xf bank_mask:0xf
    v_add_f32_dpp v47, v45, v45 row_ror:8 row_mask:0xf bank_mask:0xf
    v_mov_b32 v44, v46
    v_mov_b32 v45, v47
    v_add_u32 v48, s45, v63
    v_mfma_f32_32x32x16_bf16 a[208:223], v[68:71], v[104:107], a[208:223]
    v_permlane16_swap_b32 v44, v46
    v_permlane16_swap_b32 v45, v47
    v_add_f32 v44, v44, v46
    v_add_f32 v45, v45, v47
    v_mov_b32 v46, v44
    v_mov_b32 v47, v45
    v_mfma_f32_32x32x16_bf16 a[224:239], v[64:67], v[108:111], a[224:239]
    v_permlane32_swap_b32 v44, v46
    v_permlane32_swap_b32 v45, v47
    v_add_f32 v44, v44, v46
    v_add_f32 v45, v45, v47
    ds_write_b64 v48, v[44:45]
    s_waitcnt lgkmcnt(0)
    v_mfma_f32_32x32x16_bf16 a[240:255], v[68:71], v[108:111], a[240:255]
    s_getpc_b64 s[32:33]
PF_1:
    s_sub_u32 s32, s32, PF_1-attn_kernel
    s_subb_u32 s33, s33, 0
    v_lshrrev_b32 v190, 3, s2
    v_lshl_add_u32 v190, v190, 12, v17
    v_add_u32 v190, s37, v190
    v_min_u32 v190, CODE_END-attn_kernel-4, v190
    global_load_dword v190, v190, s[32:33]
    v_mfma_f32_32x32x16_bf16 a[0:15], v[112:115], v[72:75], a[0:15]
    s_barrier
    s_mov_b32 s22, 1409024
    s_mov_b32 s23, 0x00020000
    s_mov_b32 s26, 704512
    s_mov_b32 s27, 0x00020000
    s_lshl_b32 s48, s4, 2
    s_add_u32 s48, s48, s55
    v_lshrrev_b32 v0, 2, v1
    v_mfma_f32_32x32x16_bf16 a[16:31], v[116:119], v[72:75], a[16:31]
    v_add_u32 v12, 32768, v12
    ds_read_b128 v[64:67], v12 offset:32768
    ds_read_b128 v[68:71], v12 offset:36864
    ds_read_b64_tr_b16 v[80:81], v24 offset:32768
    v_mul_u32_u24 v0, 6144, v0
    v_and_b32 v4, 3, v1
    v_mfma_f32_32x32x16_bf16 a[32:47], v[120:123], v[72:75], a[32:47]
    ds_read_b64_tr_b16 v[82:83], v24 offset:33792
    ds_read_b64_tr_b16 v[84:85], v25 offset:32768
    ds_read_b64_tr_b16 v[86:87], v25 offset:33792
    v_lshl_add_u32 v0, v4, 7, v0
    v_lshlrev_b32 v4, 7, v1
    s_mul_i32 s28, s48, 24576
    s_lshl_b32 s29, s5, 9
    v_mfma_f32_32x32x16_bf16 a[48:63], v[124:127], v[72:75], a[48:63]
    ds_read_b64_tr_b16 v[88:89], v26 offset:32768
    ds_read_b64_tr_b16 v[90:91], v26 offset:33792
    ds_read_b64_tr_b16 v[92:93], v27 offset:32768
    s_add_u32 s28, s28, s29
    s_mul_i32 s29, s5, 176128
    s_mul_i32 s30, s48, 1408
    s_add_u32 s29, s29, s30
    v_lshlrev_b32 v11, 10, v1
    v_mfma_f32_32x32x16_bf16 a[64:79], v[112:115], v[76:79], a[64:79]
    ds_read_b64_tr_b16 v[94:95], v27 offset:33792
    ds_read_b64_tr_b16 v[96:97], v24 offset:40960
    ds_read_b64_tr_b16 v[98:99], v24 offset:41984
    s_mul_i32 s30, s48, 48
    s_add_u32 s30, s30, s5
    s_lshl_b32 s30, s30, 7
    v_mfma_f32_32x32x16_bf16 a[80:95], v[116:119], v[76:79], a[80:95]
    ds_read_b64_tr_b16 v[100:101], v25 offset:40960
    ds_read_b64_tr_b16 v[102:103], v25 offset:41984
    ds_read_b64_tr_b16 v[104:105], v26 offset:40960
    v_mfma_f32_32x32x16_bf16 a[96:111], v[120:123], v[76:79], a[96:111]
    ds_read_b64_tr_b16 v[106:107], v26 offset:41984
    ds_read_b64_tr_b16 v[108:109], v27 offset:40960
    ds_read_b64_tr_b16 v[110:111], v27 offset:41984
    v_mfma_f32_32x32x16_bf16 a[112:127], v[124:127], v[76:79], a[112:127]
    s_add_u32 m0, s37, 114688
    s_mov_b32 s39, 1048576
    buffer_load_dwordx4 v19, s[64:67], s39 offen nt lds
    s_add_u32 m0, s37, 122880
    s_nop 0
    buffer_load_dwordx4 v19, s[76:79], s39 offen nt lds
    v_mfma_f32_32x32x16_bf16 a[128:143], v[72:75], v[128:131], a[128:143]
    s_add_u32 m0, s37, 118784
    s_mov_b32 s39, 1179648
    buffer_load_dwordx4 v19, s[64:67], s39 offen nt lds
    s_add_u32 m0, s37, 126976
    s_nop 0
    buffer_load_dwordx4 v19, s[76:79], s39 offen nt lds
    v_mfma_f32_32x32x16_bf16 a[144:159], v[76:79], v[128:131], a[144:159]
    s_add_u32 m0, s37, 32768
    s_mov_b32 s39, 384
    buffer_load_dwordx4 v10, s[60:63], s39 offen lds
    v_mfma_f32_32x32x16_bf16 a[160:175], v[72:75], v[132:135], a[160:175]
    s_add_u32 m0, s37, 36864
    s_mov_b32 s39, 33152
    buffer_load_dwordx4 v10, s[60:63], s39 offen lds
    v_mfma_f32_32x32x16_bf16 a[176:191], v[76:79], v[132:135], a[176:191]
    s_add_u32 m0, s37, 40960
    s_mov_b32 s39, 65920
    buffer_load_dwordx4 v10, s[60:63], s39 offen lds
    v_mfma_f32_32x32x16_bf16 a[192:207], v[72:75], v[136:139], a[192:207]
    s_add_u32 m0, s37, 45056
    s_mov_b32 s39, 98688
    buffer_load_dwordx4 v10, s[60:63], s39 offen lds
    v_mfma_f32_32x32x16_bf16 a[208:223], v[76:79], v[136:139], a[208:223]
    v_mfma_f32_32x32x16_bf16 a[224:239], v[72:75], v[140:143], a[224:239]
    v_mfma_f32_32x32x16_bf16 a[240:255], v[76:79], v[140:143], a[240:255]
    s_waitcnt lgkmcnt(0)
    v_mfma_f32_32x32x16_bf16 a[0:15], v[80:83], v[64:67], a[0:15]
    v_add_u32 v13, 32768, v13
    ds_read_b128 v[72:75], v13 offset:32768
    ds_read_b128 v[76:79], v13 offset:36864
    ds_read_b64_tr_b16 v[112:113], v24 offset:36864
    v_mfma_f32_32x32x16_bf16 a[16:31], v[84:87], v[64:67], a[16:31]
    ds_read_b64_tr_b16 v[114:115], v24 offset:37888
    ds_read_b64_tr_b16 v[116:117], v25 offset:36864
    ds_read_b64_tr_b16 v[118:119], v25 offset:37888
    v_mfma_f32_32x32x16_bf16 a[32:47], v[88:91], v[64:67], a[32:47]
    ds_read_b64_tr_b16 v[120:121], v26 offset:36864
    ds_read_b64_tr_b16 v[122:123], v26 offset:37888
    ds_read_b64_tr_b16 v[124:125], v27 offset:36864
    v_mfma_f32_32x32x16_bf16 a[48:63], v[92:95], v[64:67], a[48:63]
    ds_read_b64_tr_b16 v[126:127], v27 offset:37888
    ds_read_b64_tr_b16 v[128:129], v24 offset:45056
    ds_read_b64_tr_b16 v[130:131], v24 offset:46080
    v_mfma_f32_32x32x16_bf16 a[64:79], v[80:83], v[68:71], a[64:79]
    ds_read_b64_tr_b16 v[132:133], v25 offset:45056
    ds_read_b64_tr_b16 v[134:135], v25 offset:46080
    ds_read_b64_tr_b16 v[136:137], v26 offset:45056
    v_mfma_f32_32x32x16_bf16 a[80:95], v[84:87], v[68:71], a[80:95]
    ds_read_b64_tr_b16 v[138:139], v26 offset:46080
    ds_read_b64_tr_b16 v[140:141], v27 offset:45056
    ds_read_b64_tr_b16 v[142:143], v27 offset:46080
    v_mfma_f32_32x32x16_bf16 a[96:111], v[88:91], v[68:71], a[96:111]
    v_mfma_f32_32x32x16_bf16 a[112:127], v[92:95], v[68:71], a[112:127]
    v_mfma_f32_32x32x16_bf16 a[128:143], v[64:67], v[96:99], a[128:143]
    v_mfma_f32_32x32x16_bf16 a[144:159], v[68:71], v[96:99], a[144:159]
    v_mfma_f32_32x32x16_bf16 a[160:175], v[64:67], v[100:103], a[160:175]
    v_mfma_f32_32x32x16_bf16 a[176:191], v[68:71], v[100:103], a[176:191]
    v_mfma_f32_32x32x16_bf16 a[192:207], v[64:67], v[104:107], a[192:207]
    v_mfma_f32_32x32x16_bf16 a[208:223], v[68:71], v[104:107], a[208:223]
    v_mfma_f32_32x32x16_bf16 a[224:239], v[64:67], v[108:111], a[224:239]
    v_mfma_f32_32x32x16_bf16 a[240:255], v[68:71], v[108:111], a[240:255]
    s_waitcnt lgkmcnt(0)
    v_mfma_f32_32x32x16_bf16 a[0:15], v[112:115], v[72:75], a[0:15]
    s_waitcnt vmcnt(18)
    s_barrier
    v_mfma_f32_32x32x16_bf16 a[16:31], v[116:119], v[72:75], a[16:31]
    v_add_u32 v14, 32768, v14
    ds_read_b128 v[64:67], v14 offset:32768
    ds_read_b128 v[68:71], v14 offset:36864
    ds_read_b64_tr_b16 v[80:81], v24 offset:0
    ds_read_b64 v[44:45], v63 offset:0
    ds_read_b64 v[46:47], v63 offset:64
    v_mfma_f32_32x32x16_bf16 a[32:47], v[120:123], v[72:75], a[32:47]
    ds_read_b64_tr_b16 v[82:83], v24 offset:1024
    ds_read_b64_tr_b16 v[84:85], v25 offset:0
    ds_read_b64_tr_b16 v[86:87], v25 offset:1024
    ds_read_b64 v[48:49], v63 offset:128
    ds_read_b64 v[50:51], v63 offset:192
    v_mfma_f32_32x32x16_bf16 a[48:63], v[124:127], v[72:75], a[48:63]
    ds_read_b64_tr_b16 v[88:89], v26 offset:0
    ds_read_b64_tr_b16 v[90:91], v26 offset:1024
    ds_read_b64_tr_b16 v[92:93], v27 offset:0
    v_mfma_f32_32x32x16_bf16 a[64:79], v[112:115], v[76:79], a[64:79]
    ds_read_b64_tr_b16 v[94:95], v27 offset:1024
    ds_read_b64_tr_b16 v[96:97], v24 offset:8192
    ds_read_b64_tr_b16 v[98:99], v24 offset:9216
    v_mfma_f32_32x32x16_bf16 a[80:95], v[116:119], v[76:79], a[80:95]
    ds_read_b64_tr_b16 v[100:101], v25 offset:8192
    ds_read_b64_tr_b16 v[102:103], v25 offset:9216
    ds_read_b64_tr_b16 v[104:105], v26 offset:8192
    s_waitcnt lgkmcnt(9)
    v_add_f32 v44, v44, v46
    v_add_f32 v45, v45, v47
    v_mfma_f32_32x32x16_bf16 a[96:111], v[120:123], v[76:79], a[96:111]
    ds_read_b64_tr_b16 v[106:107], v26 offset:9216
    ds_read_b64_tr_b16 v[108:109], v27 offset:8192
    ds_read_b64_tr_b16 v[110:111], v27 offset:9216
    v_add_f32 v48, v48, v50
    v_add_f32 v49, v49, v51
    v_add_f32 v44, v44, v48
    v_mfma_f32_32x32x16_bf16 a[112:127], v[124:127], v[76:79], a[112:127]
    s_add_u32 m0, s37, 131072
    s_mov_b32 s39, 1310720
    buffer_load_dwordx4 v19, s[64:67], s39 offen nt lds
    s_add_u32 m0, s37, 139264
    s_nop 0
    buffer_load_dwordx4 v19, s[76:79], s39 offen nt lds
    v_mfma_f32_32x32x16_bf16 a[128:143], v[72:75], v[128:131], a[128:143]
    s_add_u32 m0, s37, 135168
    s_mov_b32 s39, 1441792
    buffer_load_dwordx4 v19, s[64:67], s39 offen nt lds
    s_add_u32 m0, s37, 143360
    s_nop 0
    buffer_load_dwordx4 v19, s[76:79], s39 offen nt lds
    v_mfma_f32_32x32x16_bf16 a[144:159], v[76:79], v[128:131], a[144:159]
    s_add_u32 m0, s37, 49152
    s_mov_b32 s39, 131456
    buffer_load_dwordx4 v10, s[60:63], s39 offen lds
    buffer_load_dword v8, v16, s[12:15], s31 offen
    s_add_u32 s31, s31, s38
    s_add_u32 s31, s31, s38
    v_mfma_f32_32x32x16_bf16 a[160:175], v[72:75], v[132:135], a[160:175]
    s_add_u32 m0, s37, 53248
    s_mov_b32 s39, 164224
    buffer_load_dwordx4 v10, s[60:63], s39 offen lds
    v_add_f32 v45, v45, v49
    v_mul_f32 v44, 0xbb000000, v44
    v_mul_f32 v45, 0x3b000000, v45
    v_mfma_f32_32x32x16_bf16 a[176:191], v[76:79], v[132:135], a[176:191]
    s_add_u32 m0, s37, 57344
    s_mov_b32 s39, 196992
    buffer_load_dwordx4 v10, s[60:63], s39 offen lds
    v_fma_f32 v45, -v44, v44, v45
    v_max_f32 v45, 0, v45
    v_add_f32 v45, 0x3727c5ac, v45
    v_mfma_f32_32x32x16_bf16 a[192:207], v[72:75], v[136:139], a[192:207]
    s_add_u32 m0, s37, 61440
    s_mov_b32 s39, 229760
    buffer_load_dwordx4 v10, s[60:63], s39 offen lds
    v_rsq_f32 v45, v45
    s_nop 0
    v_mul_f32 v44, v44, v45
    v_mfma_f32_32x32x16_bf16 a[208:223], v[76:79], v[136:139], a[208:223]
    s_and_b32 s46, s2, 7
    s_mul_i32 s46, s46, 20480
    s_add_u32 s46, s46, 262144
    s_lshl_b32 s47, s56, 9
    s_add_u32 s47, s47, 458752
    s_lshl_b32 s50, s40, 4
    s_lshl_b32 s51, s55, 2
    s_add_u32 s50, s50, s51
    s_add_u32 s50, s50, s47
    s_lshl_b32 s51, s42, 7
    s_add_u32 s46, s46, s51
    s_add_u32 s46, s46, 17408
    v_mfma_f32_32x32x16_bf16 a[224:239], v[72:75], v[140:143], a[224:239]
    s_lshl_b32 s51, s56, 4
    s_add_u32 s51, s51, s46
    s_lshl_b32 s52, s55, 2
    s_add_u32 s51, s51, s52
    s_lshl_b32 s44, s41, 7
    s_lshr_b32 s52, s55, 1
    s_xor_b32 s52, s52, s3
    s_lshl_b32 s52, s52, 6
    s_add_u32 s44, s44, s52
    s_lshl_b32 s52, s44, 10
    v_add_u32 v5, s52, v17
    v_mfma_f32_32x32x16_bf16 a[240:255], v[76:79], v[140:143], a[240:255]
    s_lshr_b32 s45, s43, 5
    s_lshl_b32 s45, s45, 15
    s_bfe_u32 s52, s43, 0x10004
    s_lshl_b32 s52, s52, 12
    s_add_u32 s45, s45, s52
    v_lshlrev_b32 v52, 16, v192
    v_and_b32 v53, 0xffff0000, v192
    v_lshlrev_b32 v54, 16, v193
    s_waitcnt lgkmcnt(0)
    v_mfma_f32_32x32x16_bf16 a[0:15], v[80:83], v[64:67], a[0:15]
    v_add_u32 v15, 32768, v15
    ds_read_b128 v[72:75], v15 offset:32768
    ds_read_b128 v[76:79], v15 offset:36864
    ds_read_b64_tr_b16 v[112:113], v24 offset:4096
    buffer_load_dwordx2 v[236:237], off, s[92:95], 0 offset:128 sc0 sc1
    v_mfma_f32_32x32x16_bf16 a[16:31], v[84:87], v[64:67], a[16:31]
    ds_read_b64_tr_b16 v[114:115], v24 offset:5120
    ds_read_b64_tr_b16 v[116:117], v25 offset:4096
    ds_read_b64_tr_b16 v[118:119], v25 offset:5120
    v_and_b32 v55, 0xffff0000, v193
    v_lshlrev_b32 v56, 16, v194
    v_and_b32 v57, 0xffff0000, v194
    v_mfma_f32_32x32x16_bf16 a[32:47], v[88:91], v[64:67], a[32:47]
    ds_read_b64_tr_b16 v[120:121], v26 offset:4096
    ds_read_b64_tr_b16 v[122:123], v26 offset:5120
    ds_read_b64_tr_b16 v[124:125], v27 offset:4096
    v_lshlrev_b32 v58, 16, v195
    v_and_b32 v59, 0xffff0000, v195
    v_fma_f32 v52, v52, v45, v44
    v_mfma_f32_32x32x16_bf16 a[48:63], v[92:95], v[64:67], a[48:63]
    ds_read_b64_tr_b16 v[126:127], v27 offset:5120
    ds_read_b64_tr_b16 v[128:129], v24 offset:12288
    ds_read_b64_tr_b16 v[130:131], v24 offset:13312
    v_fma_f32 v53, v53, v45, v44
    v_fma_f32 v54, v54, v45, v44
    v_fma_f32 v55, v55, v45, v44
    v_mfma_f32_32x32x16_bf16 a[64:79], v[80:83], v[68:71], a[64:79]
    ds_read_b64_tr_b16 v[132:133], v25 offset:12288
    ds_read_b64_tr_b16 v[134:135], v25 offset:13312
    ds_read_b64_tr_b16 v[136:137], v26 offset:12288
    v_fma_f32 v56, v56, v45, v44
    v_fma_f32 v57, v57, v45, v44
    v_fma_f32 v58, v58, v45, v44
    v_mfma_f32_32x32x16_bf16 a[80:95], v[84:87], v[68:71], a[80:95]
    ds_read_b64_tr_b16 v[138:139], v26 offset:13312
    ds_read_b64_tr_b16 v[140:141], v27 offset:12288
    ds_read_b64_tr_b16 v[142:143], v27 offset:13312
    v_fma_f32 v59, v59, v45, v44
    v_lshlrev_b32 v168, 16, v196
    v_and_b32 v169, 0xffff0000, v196
    v_mfma_f32_32x32x16_bf16 a[96:111], v[88:91], v[68:71], a[96:111]
    v_lshlrev_b32 v170, 16, v197
    v_and_b32 v171, 0xffff0000, v197
    v_lshlrev_b32 v172, 16, v198
    v_and_b32 v173, 0xffff0000, v198
    v_lshlrev_b32 v174, 16, v199
    v_and_b32 v175, 0xffff0000, v199
    v_mfma_f32_32x32x16_bf16 a[112:127], v[92:95], v[68:71], a[112:127]
    v_fma_f32 v168, v168, v45, v44
    v_fma_f32 v169, v169, v45, v44
    v_fma_f32 v170, v170, v45, v44
    v_fma_f32 v171, v171, v45, v44
    v_fma_f32 v172, v172, v45, v44
    v_fma_f32 v173, v173, v45, v44
    v_mfma_f32_32x32x16_bf16 a[128:143], v[64:67], v[96:99], a[128:143]
    v_fma_f32 v174, v174, v45, v44
    v_fma_f32 v175, v175, v45, v44
    v_mfma_f32_32x32x16_bf16 a[144:159], v[68:71], v[96:99], a[144:159]
    s_mov_b64 exec, 0xffff
    buffer_load_dword v8, v0, s[88:91], s28 offen offset:2048
    s_mov_b64 exec, 0x7ff
    buffer_load_dword v8, v4, s[20:23], s29 offen
    s_mov_b64 exec, -1
    v_mfma_f32_32x32x16_bf16 a[160:175], v[64:67], v[100:103], a[160:175]
    v_mfma_f32_32x32x16_bf16 a[176:191], v[68:71], v[100:103], a[176:191]
    v_mfma_f32_32x32x16_bf16 a[192:207], v[64:67], v[104:107], a[192:207]
    v_mfma_f32_32x32x16_bf16 a[208:223], v[68:71], v[104:107], a[208:223]
    v_mfma_f32_32x32x16_bf16 a[224:239], v[64:67], v[108:111], a[224:239]
    v_mfma_f32_32x32x16_bf16 a[240:255], v[68:71], v[108:111], a[240:255]
    s_waitcnt lgkmcnt(0)
    v_mfma_f32_32x32x16_bf16 a[0:15], v[112:115], v[72:75], a[0:15]
    s_waitcnt vmcnt(16)
    s_barrier
    v_mfma_f32_32x32x16_bf16 a[16:31], v[116:119], v[72:75], a[16:31]
    v_add_u32 v12, 4294934528, v12
    ds_read_b128 v[64:67], v12 offset:0
    ds_read_b128 v[68:71], v12 offset:4096
    ds_read_b64_tr_b16 v[80:81], v24 offset:16384
    v_mfma_f32_32x32x16_bf16 a[32:47], v[120:123], v[72:75], a[32:47]
    ds_read_b64_tr_b16 v[82:83], v24 offset:17408
    ds_read_b64_tr_b16 v[84:85], v25 offset:16384
    ds_read_b64_tr_b16 v[86:87], v25 offset:17408
    v_mfma_f32_32x32x16_bf16 a[48:63], v[124:127], v[72:75], a[48:63]
    ds_read_b64_tr_b16 v[88:89], v26 offset:16384
    ds_read_b64_tr_b16 v[90:91], v26 offset:17408
    ds_read_b64_tr_b16 v[92:93], v27 offset:16384
    v_mfma_f32_32x32x16_bf16 a[64:79], v[112:115], v[76:79], a[64:79]
    ds_read_b64_tr_b16 v[94:95], v27 offset:17408
    ds_read_b64_tr_b16 v[96:97], v24 offset:24576
    ds_read_b64_tr_b16 v[98:99], v24 offset:25600
    v_mfma_f32_32x32x16_bf16 a[80:95], v[116:119], v[76:79], a[80:95]
    ds_read_b64_tr_b16 v[100:101], v25 offset:24576
    ds_read_b64_tr_b16 v[102:103], v25 offset:25600
    ds_read_b64_tr_b16 v[104:105], v26 offset:24576
    v_mfma_f32_32x32x16_bf16 a[96:111], v[120:123], v[76:79], a[96:111]
    ds_read_b64_tr_b16 v[106:107], v26 offset:25600
    ds_read_b64_tr_b16 v[108:109], v27 offset:24576
    ds_read_b64_tr_b16 v[110:111], v27 offset:25600
    v_mfma_f32_32x32x16_bf16 a[112:127], v[124:127], v[76:79], a[112:127]
    s_add_u32 m0, s37, 98304
    s_mov_b32 s39, 1572864
    buffer_load_dwordx4 v19, s[64:67], s39 offen nt lds
    s_add_u32 m0, s37, 106496
    s_nop 0
    buffer_load_dwordx4 v19, s[76:79], s39 offen nt lds
    v_mfma_f32_32x32x16_bf16 a[128:143], v[72:75], v[128:131], a[128:143]
    s_add_u32 m0, s37, 102400
    s_mov_b32 s39, 1703936
    buffer_load_dwordx4 v19, s[64:67], s39 offen nt lds
    s_add_u32 m0, s37, 110592
    s_nop 0
    buffer_load_dwordx4 v19, s[76:79], s39 offen nt lds
    v_mfma_f32_32x32x16_bf16 a[144:159], v[76:79], v[128:131], a[144:159]
    s_add_u32 m0, s37, 65536
    s_mov_b32 s39, 512
    buffer_load_dwordx4 v10, s[60:63], s39 offen lds
    v_mfma_f32_32x32x16_bf16 a[160:175], v[72:75], v[132:135], a[160:175]
    s_add_u32 m0, s37, 69632
    s_mov_b32 s39, 33280
    buffer_load_dwordx4 v10, s[60:63], s39 offen lds
    v_mfma_f32_32x32x16_bf16 a[176:191], v[76:79], v[132:135], a[176:191]
    s_add_u32 m0, s37, 73728
    s_mov_b32 s39, 66048
    buffer_load_dwordx4 v10, s[60:63], s39 offen lds
    v_mfma_f32_32x32x16_bf16 a[192:207], v[72:75], v[136:139], a[192:207]
    s_add_u32 m0, s37, 77824
    s_mov_b32 s39, 98816
    buffer_load_dwordx4 v10, s[60:63], s39 offen lds
    v_mfma_f32_32x32x16_bf16 a[208:223], v[76:79], v[136:139], a[208:223]
    s_waitcnt vmcnt(10)
    v_cmp_eq_u32 vcc, 0x100, v236
    s_nop 0
    s_cmp_eq_u64 vcc, -1
    s_cbranch_scc0 FR_CS
FR_CR:
    v_cmp_eq_u32 vcc, 0, v237
    s_nop 0
    s_cmp_eq_u64 vcc, -1
    s_cselect_b32 s10, 1, 0
    s_add_u32 s39, s37, 16384
    buffer_load_dwordx4 v[144:147], v17, s[72:75], s39 offen
    s_add_u32 s39, s39, 4096
    buffer_load_dwordx4 v[148:151], v17, s[72:75], s39 offen
    s_add_u32 s39, s39, 4096
    buffer_load_dwordx4 v[152:155], v17, s[72:75], s39 offen
    s_add_u32 s39, s39, 4096
    buffer_load_dwordx4 v[156:159], v17, s[72:75], s39 offen
    v_mfma_f32_32x32x16_bf16 a[224:239], v[72:75], v[140:143], a[224:239]
    s_cmp_ge_u32 s55, 2
    s_cselect_b32 s11, 1.0, 0
    s_mov_b32 s49, 1040356334
    s_add_u32 s6, s37, 147456
    v_add_u32 v9, s6, v17
    v_mfma_f32_32x32x16_bf16 a[240:255], v[76:79], v[140:143], a[240:255]
    s_waitcnt lgkmcnt(0)
    v_mfma_f32_32x32x16_bf16 a[0:15], v[80:83], v[64:67], a[0:15]
    v_add_u32 v13, 4294934528, v13
    ds_read_b128 v[72:75], v13 offset:0
    ds_read_b128 v[76:79], v13 offset:4096
    ds_read_b64_tr_b16 v[112:113], v24 offset:20480
    v_mfma_f32_32x32x16_bf16 a[16:31], v[84:87], v[64:67], a[16:31]
    ds_read_b64_tr_b16 v[114:115], v24 offset:21504
    ds_read_b64_tr_b16 v[116:117], v25 offset:20480
    ds_read_b64_tr_b16 v[118:119], v25 offset:21504
    v_mfma_f32_32x32x16_bf16 a[32:47], v[88:91], v[64:67], a[32:47]
    ds_read_b64_tr_b16 v[120:121], v26 offset:20480
    ds_read_b64_tr_b16 v[122:123], v26 offset:21504
    ds_read_b64_tr_b16 v[124:125], v27 offset:20480
    v_mfma_f32_32x32x16_bf16 a[48:63], v[92:95], v[64:67], a[48:63]
    ds_read_b64_tr_b16 v[126:127], v27 offset:21504
    ds_read_b64_tr_b16 v[128:129], v24 offset:28672
    ds_read_b64_tr_b16 v[130:131], v24 offset:29696
    v_mfma_f32_32x32x16_bf16 a[64:79], v[80:83], v[68:71], a[64:79]
    ds_read_b64_tr_b16 v[132:133], v25 offset:28672
    ds_read_b64_tr_b16 v[134:135], v25 offset:29696
    ds_read_b64_tr_b16 v[136:137], v26 offset:28672
    v_mfma_f32_32x32x16_bf16 a[80:95], v[84:87], v[68:71], a[80:95]
    ds_read_b64_tr_b16 v[138:139], v26 offset:29696
    ds_read_b64_tr_b16 v[140:141], v27 offset:28672
    ds_read_b64_tr_b16 v[142:143], v27 offset:29696
    v_mfma_f32_32x32x16_bf16 a[96:111], v[88:91], v[68:71], a[96:111]
    v_mfma_f32_32x32x16_bf16 a[112:127], v[92:95], v[68:71], a[112:127]
    v_mfma_f32_32x32x16_bf16 a[128:143], v[64:67], v[96:99], a[128:143]
    v_mfma_f32_32x32x16_bf16 a[144:159], v[68:71], v[96:99], a[144:159]
    v_mfma_f32_32x32x16_bf16 a[160:175], v[64:67], v[100:103], a[160:175]
    v_mfma_f32_32x32x16_bf16 a[176:191], v[68:71], v[100:103], a[176:191]
    v_mfma_f32_32x32x16_bf16 a[192:207], v[64:67], v[104:107], a[192:207]
    v_mfma_f32_32x32x16_bf16 a[208:223], v[68:71], v[104:107], a[208:223]
    v_mfma_f32_32x32x16_bf16 a[224:239], v[64:67], v[108:111], a[224:239]
    v_mfma_f32_32x32x16_bf16 a[240:255], v[68:71], v[108:111], a[240:255]
    s_waitcnt lgkmcnt(0)
    v_mfma_f32_32x32x16_bf16 a[0:15], v[112:115], v[72:75], a[0:15]
    s_barrier
    v_mfma_f32_32x32x16_bf16 a[16:31], v[116:119], v[72:75], a[16:31]
    v_add_u32 v14, 4294934528, v14
    ds_read_b128 v[64:67], v14 offset:0
    ds_read_b128 v[68:71], v14 offset:4096
    ds_read_b64_tr_b16 v[80:81], v24 offset:32768
    v_mfma_f32_32x32x16_bf16 a[32:47], v[120:123], v[72:75], a[32:47]
    ds_read_b64_tr_b16 v[82:83], v24 offset:33792
    ds_read_b64_tr_b16 v[84:85], v25 offset:32768
    ds_read_b64_tr_b16 v[86:87], v25 offset:33792
    v_mfma_f32_32x32x16_bf16 a[48:63], v[124:127], v[72:75], a[48:63]
    ds_read_b64_tr_b16 v[88:89], v26 offset:32768
    ds_read_b64_tr_b16 v[90:91], v26 offset:33792
    ds_read_b64_tr_b16 v[92:93], v27 offset:32768
    v_mfma_f32_32x32x16_bf16 a[64:79], v[112:115], v[76:79], a[64:79]
    ds_read_b64_tr_b16 v[94:95], v27 offset:33792
    ds_read_b64_tr_b16 v[96:97], v24 offset:40960
    ds_read_b64_tr_b16 v[98:99], v24 offset:41984
    v_mfma_f32_32x32x16_bf16 a[80:95], v[116:119], v[76:79], a[80:95]
    ds_read_b64_tr_b16 v[100:101], v25 offset:40960
    ds_read_b64_tr_b16 v[102:103], v25 offset:41984
    ds_read_b64_tr_b16 v[104:105], v26 offset:40960
    v_mfma_f32_32x32x16_bf16 a[96:111], v[120:123], v[76:79], a[96:111]
    ds_read_b64_tr_b16 v[106:107], v26 offset:41984
    ds_read_b64_tr_b16 v[108:109], v27 offset:40960
    ds_read_b64_tr_b16 v[110:111], v27 offset:41984
    v_mfma_f32_32x32x16_bf16 a[112:127], v[124:127], v[76:79], a[112:127]
    s_add_u32 m0, s37, 114688
    s_mov_b32 s39, 1835008
    buffer_load_dwordx4 v19, s[64:67], s39 offen nt lds
    s_add_u32 m0, s37, 122880
    s_nop 0
    buffer_load_dwordx4 v19, s[76:79], s39 offen nt lds
    v_mfma_f32_32x32x16_bf16 a[128:143], v[72:75], v[128:131], a[128:143]
    s_add_u32 m0, s37, 118784
    s_mov_b32 s39, 1966080
    buffer_load_dwordx4 v19, s[64:67], s39 offen nt lds
    s_add_u32 m0, s37, 126976
    s_nop 0
    buffer_load_dwordx4 v19, s[76:79], s39 offen nt lds
    v_mfma_f32_32x32x16_bf16 a[144:159], v[76:79], v[128:131], a[144:159]
    s_add_u32 m0, s37, 81920
    s_mov_b32 s39, 131584
    buffer_load_dwordx4 v10, s[60:63], s39 offen lds
    v_mfma_f32_32x32x16_bf16 a[160:175], v[72:75], v[132:135], a[160:175]
    s_add_u32 m0, s37, 86016
    s_mov_b32 s39, 164352
    buffer_load_dwordx4 v10, s[60:63], s39 offen lds
    v_mfma_f32_32x32x16_bf16 a[176:191], v[76:79], v[132:135], a[176:191]
    s_add_u32 m0, s37, 90112
    s_mov_b32 s39, 197120
    buffer_load_dwordx4 v10, s[60:63], s39 offen lds
    v_mfma_f32_32x32x16_bf16 a[192:207], v[72:75], v[136:139], a[192:207]
    s_add_u32 m0, s37, 94208
    s_mov_b32 s39, 229888
    buffer_load_dwordx4 v10, s[60:63], s39 offen lds
    v_mfma_f32_32x32x16_bf16 a[208:223], v[76:79], v[136:139], a[208:223]
    s_mov_b64 exec, 0xffffffff
    buffer_load_dword v8, v16, s[12:15], s31 offen
    s_mov_b64 exec, -1
    s_add_u32 s31, s31, s38
    s_sub_u32 s31, s31, 4194304
    s_and_b32 s38, s55, 1
    s_lshl_b32 s38, s38, 20
    s_add_u32 s31, s31, s38
    v_mfma_f32_32x32x16_bf16 a[224:239], v[72:75], v[140:143], a[224:239]
    s_cmp_lt_u32 s55, 2
    s_cselect_b32 s31, 1073741824, s31
    v_mfma_f32_32x32x16_bf16 a[240:255], v[76:79], v[140:143], a[240:255]
    s_waitcnt lgkmcnt(0)
    v_mfma_f32_32x32x16_bf16 a[0:15], v[80:83], v[64:67], a[0:15]
    v_add_u32 v15, 4294934528, v15
    ds_read_b128 v[72:75], v15 offset:0
    ds_read_b128 v[76:79], v15 offset:4096
    ds_read_b64_tr_b16 v[112:113], v24 offset:36864
    s_lshl_b32 s34, s5, 3
    s_add_u32 s34, s34, s4
    s_cmp_lt_u32 s4, 8
    s_cselect_b32 s7, s34, 0xff
    v_mfma_f32_32x32x16_bf16 a[16:31], v[84:87], v[64:67], a[16:31]
    ds_read_b64_tr_b16 v[114:115], v24 offset:37888
    ds_read_b64_tr_b16 v[116:117], v25 offset:36864
    ds_read_b64_tr_b16 v[118:119], v25 offset:37888
    s_lshl_b32 s34, s55, 4
    v_lshrrev_b32 v248, 2, v1
    v_add_u32 v248, s34, v248
    s_sub_u32 s32, s48, 32
    v_mfma_f32_32x32x16_bf16 a[32:47], v[88:91], v[64:67], a[32:47]
    ds_read_b64_tr_b16 v[120:121], v26 offset:36864
    ds_read_b64_tr_b16 v[122:123], v26 offset:37888
    ds_read_b64_tr_b16 v[124:125], v27 offset:36864
    s_waitcnt vmcnt(9)
    v_add_f32 v144, v144, v148
    v_add_f32 v152, v152, v156
    v_mfma_f32_32x32x16_bf16 a[48:63], v[92:95], v[64:67], a[48:63]
    ds_read_b64_tr_b16 v[126:127], v27 offset:37888
    ds_read_b64_tr_b16 v[128:129], v24 offset:45056
    ds_read_b64_tr_b16 v[130:131], v24 offset:46080
    v_add_f32 v145, v145, v149
    v_add_f32 v153, v153, v157
    v_add_f32 v146, v146, v150
    v_mfma_f32_32x32x16_bf16 a[64:79], v[80:83], v[68:71], a[64:79]
    ds_read_b64_tr_b16 v[132:133], v25 offset:45056
    ds_read_b64_tr_b16 v[134:135], v25 offset:46080
    ds_read_b64_tr_b16 v[136:137], v26 offset:45056
    v_add_f32 v154, v154, v158
    v_add_f32 v147, v147, v151
    v_add_f32 v155, v155, v159
    v_mfma_f32_32x32x16_bf16 a[80:95], v[84:87], v[68:71], a[80:95]
    ds_read_b64_tr_b16 v[138:139], v26 offset:46080
    ds_read_b64_tr_b16 v[140:141], v27 offset:45056
    ds_read_b64_tr_b16 v[142:143], v27 offset:46080
    v_add_f32 v144, v144, v152
    v_add_f32 v145, v145, v153
    v_add_f32 v146, v146, v154
    v_mfma_f32_32x32x16_bf16 a[96:111], v[88:91], v[68:71], a[96:111]
    v_add_f32 v147, v147, v155
    v_cvt_pk_bf16_f32 v144, v144, v144
    v_cvt_pk_bf16_f32 v145, v145, v145
    v_cvt_pk_bf16_f32 v146, v146, v146
    v_cvt_pk_bf16_f32 v147, v147, v147
    v_lshlrev_b32 v144, 16, v144
    v_mfma_f32_32x32x16_bf16 a[112:127], v[92:95], v[68:71], a[112:127]
    v_lshlrev_b32 v145, 16, v145
    v_lshlrev_b32 v146, 16, v146
    v_lshlrev_b32 v147, 16, v147
    v_add_f32 v144, s11, v144
    v_add_f32 v145, s11, v145
    v_add_f32 v146, s11, v146
    v_mfma_f32_32x32x16_bf16 a[128:143], v[64:67], v[96:99], a[128:143]
    v_add_f32 v147, s11, v147
    v_mul_f32 v144, s49, v144
    v_mul_f32 v145, s49, v145
    v_mul_f32 v146, s49, v146
    v_mul_f32 v147, s49, v147
    ds_write_b128 v9, v[144:147]
    v_mfma_f32_32x32x16_bf16 a[144:159], v[68:71], v[96:99], a[144:159]
    s_waitcnt lgkmcnt(0)
    v_mul_u32_u24 v250, 49152, v248
    v_lshlrev_b32 v248, 4, v248
    v_and_b32 v249, 3, v1
    v_lshl_add_u32 v249, v249, 4, v250
    s_lshl_b32 s34, s7, 6
    s_add_u32 s34, s34, 2048
    v_mfma_f32_32x32x16_bf16 a[160:175], v[64:67], v[100:103], a[160:175]
    s_cmp_lt_u32 s7, 64
    s_cselect_b32 s34, s34, 1073741824
    buffer_load_dwordx4 v[200:203], v249, s[88:91], s34 offen nt
    s_add_u32 s34, s34, 6144
    buffer_load_dwordx4 v[204:207], v249, s[88:91], s34 offen nt
    s_add_u32 s34, s34, 6144
    v_mfma_f32_32x32x16_bf16 a[176:191], v[68:71], v[100:103], a[176:191]
    buffer_load_dwordx4 v[208:211], v249, s[88:91], s34 offen nt
    s_add_u32 s34, s34, 6144
    buffer_load_dwordx4 v[212:215], v249, s[88:91], s34 offen nt
    s_add_u32 s34, s34, 6144
    s_sub_u32 s28, s48, 80
    v_mfma_f32_32x32x16_bf16 a[192:207], v[64:67], v[104:107], a[192:207]
    buffer_load_dwordx4 v[216:219], v249, s[88:91], s34 offen nt
    s_add_u32 s34, s34, 6144
    v_bfe_u32 v0, v1, 1, 3
    v_bfe_u32 v11, v1, 4, 1
    v_lshlrev_b32 v11, 2, v11
    v_mfma_f32_32x32x16_bf16 a[208:223], v[68:71], v[104:107], a[208:223]
    v_lshl_add_u32 v11, v3, 4, v11
    v_and_b32 v4, 1, v1
    v_lshl_add_u32 v11, v4, 5, v11
    v_mul_u32_u24 v11, 2752, v11
    v_lshl_add_u32 v11, v0, 2, v11
    s_mul_i32 s33, s32, 43691
    s_lshr_b32 s33, s33, 19
    v_mfma_f32_32x32x16_bf16 a[224:239], v[64:67], v[108:111], a[224:239]
    buffer_load_dwordx4 v[220:223], v249, s[88:91], s34 offen nt
    s_add_u32 s34, s34, 6144
    s_mul_i32 s30, s33, 12
    s_sub_u32 s30, s32, s30
    s_lshl_b32 s30, s30, 2
    s_mov_b32 s96, 740008088
    s_mov_b32 s97, 21715
    s_lshr_b64 s[96:97], s[96:97], s30
    s_and_b32 s30, s96, 7
    v_mfma_f32_32x32x16_bf16 a[240:255], v[68:71], v[108:111], a[240:255]
    s_lshl_b32 s30, s30, 4
    s_mul_i32 s33, s33, 88
    s_add_u32 s33, s33, s30
    s_bitcmp1_b32 s96, 3
    s_cselect_b32 s30, 688, 0
    s_add_u32 s33, s33, s30
    s_lshl_b32 s33, s33, 1
    s_mul_i32 s30, s5, 176128
    s_add_u32 s29, s33, s30
    s_lshl_b32 s48, s32, 3
    s_add_u32 s48, s48, s5
    s_lshl_b32 s48, s48, 11
    v_mfma_f32_32x32x16_bf16 a[0:15], v[112:115], v[72:75], a[0:15]
    s_barrier
    buffer_load_dwordx4 v[224:227], v249, s[88:91], s34 offen nt
    s_add_u32 s34, s34, 6144
    s_add_u32 s48, s48, 104857600
    s_cmp_lt_u32 s4, 8
    s_cselect_b32 s29, 1073741824, s29
    s_cselect_b32 s48, 1073741824, s48
    v_mfma_f32_32x32x16_bf16 a[16:31], v[116:119], v[72:75], a[16:31]
    ds_read_b128 v[64:67], v12 offset:32768
    ds_read_b128 v[68:71], v12 offset:36864
    ds_read_b64_tr_b16 v[80:81], v24 offset:0
    ds_read_b128 v[144:147], v18 offset:0
    ds_read_b128 v[148:151], v18 offset:16
    ds_read_b128 v[152:155], v18 offset:2048
    v_mfma_f32_32x32x16_bf16 a[32:47], v[120:123], v[72:75], a[32:47]
    ds_read_b64_tr_b16 v[82:83], v24 offset:1024
    ds_read_b64_tr_b16 v[84:85], v25 offset:0
    ds_read_b64_tr_b16 v[86:87], v25 offset:1024
    ds_read_b128 v[156:159], v18 offset:2064
    ds_read_b128 v[44:47], v18 offset:256
    ds_read_b128 v[48:51], v18 offset:272
    v_mfma_f32_32x32x16_bf16 a[48:63], v[124:127], v[72:75], a[48:63]
    ds_read_b64_tr_b16 v[88:89], v26 offset:0
    ds_read_b64_tr_b16 v[90:91], v26 offset:1024
    ds_read_b64_tr_b16 v[92:93], v27 offset:0
    ds_read_b128 v[160:163], v18 offset:2304
    ds_read_b128 v[164:167], v18 offset:2320
    v_mfma_f32_32x32x16_bf16 a[64:79], v[112:115], v[76:79], a[64:79]
    ds_read_b64_tr_b16 v[94:95], v27 offset:1024
    ds_read_b64_tr_b16 v[96:97], v24 offset:8192
    ds_read_b64_tr_b16 v[98:99], v24 offset:9216
    buffer_load_dwordx4 v[228:231], v249, s[88:91], s34 offen nt
    v_mfma_f32_32x32x16_bf16 a[80:95], v[116:119], v[76:79], a[80:95]
    ds_read_b64_tr_b16 v[100:101], v25 offset:8192
    ds_read_b64_tr_b16 v[102:103], v25 offset:9216
    ds_read_b64_tr_b16 v[104:105], v26 offset:8192
    s_waitcnt lgkmcnt(13)
    v_fma_f32 v52, v52, v152, v144
    v_fma_f32 v53, v53, v153, v145
    v_mfma_f32_32x32x16_bf16 a[96:111], v[120:123], v[76:79], a[96:111]
    ds_read_b64_tr_b16 v[106:107], v26 offset:9216
    ds_read_b64_tr_b16 v[108:109], v27 offset:8192
    ds_read_b64_tr_b16 v[110:111], v27 offset:9216
    v_fma_f32 v54, v54, v154, v146
    v_fma_f32 v55, v55, v155, v147
    v_fma_f32 v56, v56, v156, v148
    v_mfma_f32_32x32x16_bf16 a[112:127], v[124:127], v[76:79], a[112:127]
    s_add_u32 m0, s37, 131072
    s_mov_b32 s39, 2097152
    buffer_load_dwordx4 v19, s[64:67], s39 offen nt lds
    s_add_u32 m0, s37, 139264
    s_nop 0
    buffer_load_dwordx4 v19, s[76:79], s39 offen nt lds
    v_mfma_f32_32x32x16_bf16 a[128:143], v[72:75], v[128:131], a[128:143]
    s_add_u32 m0, s37, 135168
    s_mov_b32 s39, 2228224
    buffer_load_dwordx4 v19, s[64:67], s39 offen nt lds
    s_add_u32 m0, s37, 143360
    s_nop 0
    buffer_load_dwordx4 v19, s[76:79], s39 offen nt lds
    v_mfma_f32_32x32x16_bf16 a[144:159], v[76:79], v[128:131], a[144:159]
    s_add_u32 m0, s37, 0
    s_mov_b32 s39, 640
    buffer_load_dwordx4 v10, s[60:63], s39 offen lds
    v_fma_f32 v57, v57, v157, v149
    v_fma_f32 v58, v58, v158, v150
    v_fma_f32 v59, v59, v159, v151
    v_mfma_f32_32x32x16_bf16 a[160:175], v[72:75], v[132:135], a[160:175]
    s_add_u32 m0, s37, 4096
    s_mov_b32 s39, 33408
    buffer_load_dwordx4 v10, s[60:63], s39 offen lds
    v_cvt_pk_bf16_f32 v192, v52, v53
    v_cvt_pk_bf16_f32 v193, v54, v55
    v_cvt_pk_bf16_f32 v194, v56, v57
    v_mfma_f32_32x32x16_bf16 a[176:191], v[76:79], v[132:135], a[176:191]
    s_add_u32 m0, s37, 8192
    s_mov_b32 s39, 66176
    buffer_load_dwordx4 v10, s[60:63], s39 offen lds
    v_cvt_pk_bf16_f32 v195, v58, v59
    buffer_store_dwordx4 v[192:195], v6, s[72:75], s54 offen sc0 sc1
    v_mfma_f32_32x32x16_bf16 a[192:207], v[72:75], v[136:139], a[192:207]
    s_add_u32 m0, s37, 12288
    s_mov_b32 s39, 98944
    buffer_load_dwordx4 v10, s[60:63], s39 offen lds
    s_add_u32 s54, s54, 4096
    s_waitcnt lgkmcnt(9)
    v_fma_f32 v168, v168, v160, v44
    v_mfma_f32_32x32x16_bf16 a[208:223], v[76:79], v[136:139], a[208:223]
    v_fma_f32 v169, v169, v161, v45
    v_fma_f32 v170, v170, v162, v46
    v_fma_f32 v171, v171, v163, v47
    v_fma_f32 v172, v172, v164, v48
    v_fma_f32 v173, v173, v165, v49
    v_fma_f32 v174, v174, v166, v50
    v_mfma_f32_32x32x16_bf16 a[224:239], v[72:75], v[140:143], a[224:239]
    v_fma_f32 v175, v175, v167, v51
    v_cvt_pk_bf16_f32 v196, v168, v169
    v_cvt_pk_bf16_f32 v197, v170, v171
    v_cvt_pk_bf16_f32 v198, v172, v173
    v_cvt_pk_bf16_f32 v199, v174, v175
    v_mfma_f32_32x32x16_bf16 a[240:255], v[76:79], v[140:143], a[240:255]
    buffer_store_dwordx4 v[196:199], v6, s[72:75], s54 offen sc0 sc1
    buffer_load_dwordx4 v[232:235], v248, s[84:87], 0 offen
    s_waitcnt lgkmcnt(0)
    v_mfma_f32_32x32x16_bf16 a[0:15], v[80:83], v[64:67], a[0:15]
    ds_read_b128 v[72:75], v13 offset:32768
    ds_read_b128 v[76:79], v13 offset:36864
    ds_read_b64_tr_b16 v[112:113], v24 offset:4096
    buffer_load_dword v176, v11, s[20:23], s29 offen
    s_add_u32 s29, s29, 2752
    v_mfma_f32_32x32x16_bf16 a[16:31], v[84:87], v[64:67], a[16:31]
    ds_read_b64_tr_b16 v[114:115], v24 offset:5120
    ds_read_b64_tr_b16 v[116:117], v25 offset:4096
    ds_read_b64_tr_b16 v[118:119], v25 offset:5120
    buffer_load_dword v177, v11, s[20:23], s29 offen
    s_add_u32 s29, s29, 2752
    v_mfma_f32_32x32x16_bf16 a[32:47], v[88:91], v[64:67], a[32:47]
    ds_read_b64_tr_b16 v[120:121], v26 offset:4096
    ds_read_b64_tr_b16 v[122:123], v26 offset:5120
    ds_read_b64_tr_b16 v[124:125], v27 offset:4096
    buffer_load_dword v178, v11, s[20:23], s29 offen
    s_add_u32 s29, s29, 2752
    v_mfma_f32_32x32x16_bf16 a[48:63], v[92:95], v[64:67], a[48:63]
    ds_read_b64_tr_b16 v[126:127], v27 offset:5120
    ds_read_b64_tr_b16 v[128:129], v24 offset:12288
    ds_read_b64_tr_b16 v[130:131], v24 offset:13312
    buffer_load_dword v179, v11, s[20:23], s29 offen
    s_add_u32 s29, s29, 13760
    v_mfma_f32_32x32x16_bf16 a[64:79], v[80:83], v[68:71], a[64:79]
    ds_read_b64_tr_b16 v[132:133], v25 offset:12288
    ds_read_b64_tr_b16 v[134:135], v25 offset:13312
    ds_read_b64_tr_b16 v[136:137], v26 offset:12288
    buffer_load_dword v180, v11, s[20:23], s29 offen
    s_add_u32 s29, s29, 2752
    v_mfma_f32_32x32x16_bf16 a[80:95], v[84:87], v[68:71], a[80:95]
    ds_read_b64_tr_b16 v[138:139], v26 offset:13312
    ds_read_b64_tr_b16 v[140:141], v27 offset:12288
    ds_read_b64_tr_b16 v[142:143], v27 offset:13312
    buffer_load_dword v181, v11, s[20:23], s29 offen
    s_add_u32 s29, s29, 2752
    v_mfma_f32_32x32x16_bf16 a[96:111], v[88:91], v[68:71], a[96:111]
    buffer_load_dword v182, v11, s[20:23], s29 offen
    s_add_u32 s29, s29, 2752
    buffer_load_dword v183, v11, s[20:23], s29 offen
    s_mul_i32 s32, s28, 43691
    s_lshr_b32 s32, s32, 18
    s_mul_i32 s96, s32, 6
    v_mfma_f32_32x32x16_bf16 a[112:127], v[92:95], v[68:71], a[112:127]
    s_sub_u32 s96, s28, s96
    s_lshl_b32 s96, s96, 4
    s_cmp_eq_u32 s32, 7
    s_cselect_b32 s97, 9, 11
    s_lshl_b32 s97, s97, 3
    s_mul_i32 s32, s32, 88
    s_add_u32 s32, s32, s96
    s_lshl_b32 s32, s32, 10
    s_lshl_b32 s33, s5, 7
    s_add_u32 s33, s33, s32
    s_cmp_lt_u32 s96, s97
    s_cselect_b32 s29, s33, 1073741824
    v_mfma_f32_32x32x16_bf16 a[128:143], v[64:67], v[96:99], a[128:143]
    s_add_u32 s96, s96, 8
    s_movk_i32 s58, 5120
    s_cmp_lt_u32 s96, s97
    s_cselect_b32 s58, s58, 1073741824
    s_mul_i32 s57, s5, 48
    s_add_u32 s57, s57, s28
    s_lshl_b32 s57, s57, 11
    s_add_u32 s57, s57, 106954752
    v_bfe_u32 v0, v1, 1, 4
    v_and_b32 v4, 1, v1
    v_mfma_f32_32x32x16_bf16 a[144:159], v[68:71], v[96:99], a[144:159]
    v_lshlrev_b32 v4, 6, v4
    v_lshl_add_u32 v4, v3, 12, v4
    v_lshl_add_u32 v4, v0, 2, v4
    s_cmp_lt_u32 s4, 20
    s_cselect_b32 s29, 1073741824, s29
    s_cselect_b32 s57, 1073741824, s57
    v_mfma_f32_32x32x16_bf16 a[160:175], v[64:67], v[100:103], a[160:175]
    buffer_load_dword v184, v4, s[24:27], s29 offen nt
    s_add_u32 s29, s29, 1024
    buffer_load_dword v185, v4, s[24:27], s29 offen nt
    s_add_u32 s29, s29, 1024
    v_mfma_f32_32x32x16_bf16 a[176:191], v[68:71], v[100:103], a[176:191]
    buffer_load_dword v186, v4, s[24:27], s29 offen nt
    s_add_u32 s29, s29, 1024
    buffer_load_dword v187, v4, s[24:27], s29 offen nt
    s_add_u32 s29, s29, s58
    v_mfma_f32_32x32x16_bf16 a[192:207], v[64:67], v[104:107], a[192:207]
    buffer_load_dword v188, v4, s[24:27], s29 offen nt
    s_add_u32 s29, s29, 1024
    buffer_load_dword v189, v4, s[24:27], s29 offen nt
    s_add_u32 s29, s29, 1024
    v_mfma_f32_32x32x16_bf16 a[208:223], v[68:71], v[104:107], a[208:223]
    buffer_load_dword v190, v4, s[24:27], s29 offen nt
    s_add_u32 s29, s29, 1024
    buffer_load_dword v191, v4, s[24:27], s29 offen nt
    s_mov_b32 s32, 0x05040100
    s_mov_b32 s33, 0x07060302
    v_mfma_f32_32x32x16_bf16 a[224:239], v[64:67], v[108:111], a[224:239]
    v_mfma_f32_32x32x16_bf16 a[240:255], v[68:71], v[108:111], a[240:255]
    s_waitcnt lgkmcnt(0)
    v_mfma_f32_32x32x16_bf16 a[0:15], v[112:115], v[72:75], a[0:15]
    s_waitcnt vmcnt(40)
    s_barrier
    v_mfma_f32_32x32x16_bf16 a[16:31], v[116:119], v[72:75], a[16:31]
    ds_read_b128 v[64:67], v14 offset:32768
    ds_read_b128 v[68:71], v14 offset:36864
    ds_read_b64_tr_b16 v[80:81], v24 offset:16384
    v_mfma_f32_32x32x16_bf16 a[32:47], v[120:123], v[72:75], a[32:47]
    ds_read_b64_tr_b16 v[82:83], v24 offset:17408
    ds_read_b64_tr_b16 v[84:85], v25 offset:16384
    ds_read_b64_tr_b16 v[86:87], v25 offset:17408
    v_mfma_f32_32x32x16_bf16 a[48:63], v[124:127], v[72:75], a[48:63]
    ds_read_b64_tr_b16 v[88:89], v26 offset:16384
    ds_read_b64_tr_b16 v[90:91], v26 offset:17408
    ds_read_b64_tr_b16 v[92:93], v27 offset:16384
    v_mfma_f32_32x32x16_bf16 a[64:79], v[112:115], v[76:79], a[64:79]
    ds_read_b64_tr_b16 v[94:95], v27 offset:17408
    ds_read_b64_tr_b16 v[96:97], v24 offset:24576
    ds_read_b64_tr_b16 v[98:99], v24 offset:25600
    v_mfma_f32_32x32x16_bf16 a[80:95], v[116:119], v[76:79], a[80:95]
    ds_read_b64_tr_b16 v[100:101], v25 offset:24576
    ds_read_b64_tr_b16 v[102:103], v25 offset:25600
    ds_read_b64_tr_b16 v[104:105], v26 offset:24576
    v_mfma_f32_32x32x16_bf16 a[96:111], v[120:123], v[76:79], a[96:111]
    ds_read_b64_tr_b16 v[106:107], v26 offset:25600
    ds_read_b64_tr_b16 v[108:109], v27 offset:24576
    ds_read_b64_tr_b16 v[110:111], v27 offset:25600
    v_mfma_f32_32x32x16_bf16 a[112:127], v[124:127], v[76:79], a[112:127]
    s_add_u32 m0, s37, 98304
    s_mov_b32 s39, 2359296
    buffer_load_dwordx4 v19, s[64:67], s39 offen nt lds
    s_add_u32 m0, s37, 106496
    s_nop 0
    buffer_load_dwordx4 v19, s[76:79], s39 offen nt lds
    v_mfma_f32_32x32x16_bf16 a[128:143], v[72:75], v[128:131], a[128:143]
    s_add_u32 m0, s37, 102400
    s_mov_b32 s39, 2490368
    buffer_load_dwordx4 v19, s[64:67], s39 offen nt lds
    s_add_u32 m0, s37, 110592
    s_nop 0
    buffer_load_dwordx4 v19, s[76:79], s39 offen nt lds
    v_mfma_f32_32x32x16_bf16 a[144:159], v[76:79], v[128:131], a[144:159]
    s_add_u32 m0, s37, 16384
    s_mov_b32 s39, 131712
    buffer_load_dwordx4 v10, s[60:63], s39 offen lds
    buffer_load_dword v8, v16, s[16:19], s31 offen
    s_add_u32 s31, s31, 0x200000
    v_mfma_f32_32x32x16_bf16 a[160:175], v[72:75], v[132:135], a[160:175]
    s_add_u32 m0, s37, 20480
    s_mov_b32 s39, 164480
    buffer_load_dwordx4 v10, s[60:63], s39 offen lds
    v_mfma_f32_32x32x16_bf16 a[176:191], v[76:79], v[132:135], a[176:191]
    s_add_u32 m0, s37, 24576
    s_mov_b32 s39, 197248
    buffer_load_dwordx4 v10, s[60:63], s39 offen lds
    v_mfma_f32_32x32x16_bf16 a[192:207], v[72:75], v[136:139], a[192:207]
    s_add_u32 m0, s37, 28672
    s_mov_b32 s39, 230016
    buffer_load_dwordx4 v10, s[60:63], s39 offen lds
    v_mfma_f32_32x32x16_bf16 a[208:223], v[76:79], v[136:139], a[208:223]
    v_mfma_f32_32x32x16_bf16 a[224:239], v[72:75], v[140:143], a[224:239]
    v_mfma_f32_32x32x16_bf16 a[240:255], v[76:79], v[140:143], a[240:255]
    s_waitcnt lgkmcnt(0)
    v_mfma_f32_32x32x16_bf16 a[0:15], v[80:83], v[64:67], a[0:15]
    ds_read_b128 v[72:75], v15 offset:32768
    ds_read_b128 v[76:79], v15 offset:36864
    ds_read_b64_tr_b16 v[112:113], v24 offset:20480
    s_waitcnt vmcnt(26)
    s_waitcnt vmcnt(25)
    v_lshlrev_b32 v28, 16, v232
    v_mfma_f32_32x32x16_bf16 a[16:31], v[84:87], v[64:67], a[16:31]
    ds_read_b64_tr_b16 v[114:115], v24 offset:21504
    ds_read_b64_tr_b16 v[116:117], v25 offset:20480
    ds_read_b64_tr_b16 v[118:119], v25 offset:21504
    v_and_b32 v29, 0xffff0000, v232
    v_lshlrev_b32 v30, 16, v233
    v_and_b32 v31, 0xffff0000, v233
    v_mfma_f32_32x32x16_bf16 a[32:47], v[88:91], v[64:67], a[32:47]
    ds_read_b64_tr_b16 v[120:121], v26 offset:20480
    ds_read_b64_tr_b16 v[122:123], v26 offset:21504
    ds_read_b64_tr_b16 v[124:125], v27 offset:20480
    v_lshlrev_b32 v32, 16, v234
    v_and_b32 v33, 0xffff0000, v234
    v_lshlrev_b32 v34, 16, v235
    v_mfma_f32_32x32x16_bf16 a[48:63], v[92:95], v[64:67], a[48:63]
    ds_read_b64_tr_b16 v[126:127], v27 offset:21504
    ds_read_b64_tr_b16 v[128:129], v24 offset:28672
    ds_read_b64_tr_b16 v[130:131], v24 offset:29696
    v_and_b32 v35, 0xffff0000, v235
    v_mul_f32 v36, 0xbfb8aa3b, v28
    v_mul_f32 v37, 0xbfb8aa3b, v29
    v_mfma_f32_32x32x16_bf16 a[64:79], v[80:83], v[68:71], a[64:79]
    ds_read_b64_tr_b16 v[132:133], v25 offset:28672
    ds_read_b64_tr_b16 v[134:135], v25 offset:29696
    ds_read_b64_tr_b16 v[136:137], v26 offset:28672
    v_mul_f32 v38, 0xbfb8aa3b, v30
    v_mul_f32 v39, 0xbfb8aa3b, v31
    v_mul_f32 v40, 0xbfb8aa3b, v32
    v_mfma_f32_32x32x16_bf16 a[80:95], v[84:87], v[68:71], a[80:95]
    ds_read_b64_tr_b16 v[138:139], v26 offset:29696
    ds_read_b64_tr_b16 v[140:141], v27 offset:28672
    ds_read_b64_tr_b16 v[142:143], v27 offset:29696
    v_mul_f32 v41, 0xbfb8aa3b, v33
    v_mul_f32 v42, 0xbfb8aa3b, v34
    v_mul_f32 v43, 0xbfb8aa3b, v35
    v_mfma_f32_32x32x16_bf16 a[96:111], v[88:91], v[68:71], a[96:111]
    v_mov_b32 v60, 1
    s_mov_b64 exec, 1
    buffer_store_dword v60, off, s[72:75], s50 sc0 sc1
    s_mov_b64 exec, -1
    v_lshlrev_b32 v61, 3, v1
    v_mfma_f32_32x32x16_bf16 a[112:127], v[92:95], v[68:71], a[112:127]
    v_lshlrev_b32 v63, 7, v1
    v_exp_f32 v36, v36
    v_exp_f32 v37, v37
    v_mfma_f32_32x32x16_bf16 a[128:143], v[64:67], v[96:99], a[128:143]
    v_exp_f32 v38, v38
    v_exp_f32 v39, v39
    v_exp_f32 v40, v40
    v_mfma_f32_32x32x16_bf16 a[144:159], v[68:71], v[96:99], a[144:159]
    v_exp_f32 v41, v41
    v_exp_f32 v42, v42
    v_exp_f32 v43, v43
    v_mfma_f32_32x32x16_bf16 a[160:175], v[64:67], v[100:103], a[160:175]
    v_add_f32 v36, 1.0, v36
    v_add_f32 v37, 1.0, v37
    v_add_f32 v38, 1.0, v38
    v_add_f32 v39, 1.0, v39
    v_add_f32 v40, 1.0, v40
    v_add_f32 v41, 1.0, v41
    v_mfma_f32_32x32x16_bf16 a[176:191], v[68:71], v[100:103], a[176:191]
    v_add_f32 v42, 1.0, v42
    v_add_f32 v43, 1.0, v43
    v_rcp_f32 v36, v36
    v_rcp_f32 v37, v37
    v_mfma_f32_32x32x16_bf16 a[192:207], v[64:67], v[104:107], a[192:207]
    v_rcp_f32 v38, v38
    v_rcp_f32 v39, v39
    v_rcp_f32 v40, v40
    v_mfma_f32_32x32x16_bf16 a[208:223], v[68:71], v[104:107], a[208:223]
    v_rcp_f32 v41, v41
    v_rcp_f32 v42, v42
    v_rcp_f32 v43, v43
    v_mfma_f32_32x32x16_bf16 a[224:239], v[64:67], v[108:111], a[224:239]
    v_mul_f32 v28, v28, v36
    v_mul_f32 v29, v29, v37
    v_mul_f32 v30, v30, v38
    v_mul_f32 v31, v31, v39
    v_mul_f32 v32, v32, v40
    v_mul_f32 v33, v33, v41
    v_mfma_f32_32x32x16_bf16 a[240:255], v[68:71], v[108:111], a[240:255]
    v_mul_f32 v34, v34, v42
    v_mul_f32 v35, v35, v43
    v_cvt_pk_bf16_f32 v28, v28, v28
    v_cvt_pk_bf16_f32 v29, v29, v29
    v_cvt_pk_bf16_f32 v30, v30, v30
    v_cvt_pk_bf16_f32 v31, v31, v31
    s_waitcnt lgkmcnt(0)
    v_mfma_f32_32x32x16_bf16 a[0:15], v[112:115], v[72:75], a[0:15]
    s_barrier
    v_cvt_pk_bf16_f32 v32, v32, v32
    v_cvt_pk_bf16_f32 v33, v33, v33
    v_cvt_pk_bf16_f32 v34, v34, v34
    v_cvt_pk_bf16_f32 v35, v35, v35
    v_mfma_f32_32x32x16_bf16 a[16:31], v[116:119], v[72:75], a[16:31]
    v_add_u32 v12, 32768, v12
    ds_read_b128 v[64:67], v12 offset:32768
    ds_read_b128 v[68:71], v12 offset:36864
    ds_read_b64_tr_b16 v[80:81], v24 offset:32768
    v_lshlrev_b32 v28, 16, v28
    v_lshlrev_b32 v29, 16, v29
    v_mfma_f32_32x32x16_bf16 a[32:47], v[120:123], v[72:75], a[32:47]
    ds_read_b64_tr_b16 v[82:83], v24 offset:33792
    ds_read_b64_tr_b16 v[84:85], v25 offset:32768
    ds_read_b64_tr_b16 v[86:87], v25 offset:33792
    v_lshlrev_b32 v30, 16, v30
    v_lshlrev_b32 v31, 16, v31
    v_lshlrev_b32 v32, 16, v32
    v_mfma_f32_32x32x16_bf16 a[48:63], v[124:127], v[72:75], a[48:63]
    ds_read_b64_tr_b16 v[88:89], v26 offset:32768
    ds_read_b64_tr_b16 v[90:91], v26 offset:33792
    ds_read_b64_tr_b16 v[92:93], v27 offset:32768
    v_lshlrev_b32 v33, 16, v33
    v_lshlrev_b32 v34, 16, v34
    v_lshlrev_b32 v35, 16, v35
    v_mfma_f32_32x32x16_bf16 a[64:79], v[112:115], v[76:79], a[64:79]
    ds_read_b64_tr_b16 v[94:95], v27 offset:33792
    ds_read_b64_tr_b16 v[96:97], v24 offset:40960
    ds_read_b64_tr_b16 v[98:99], v24 offset:41984
    v_lshlrev_b32 v36, 16, v200
    v_and_b32 v37, 0xffff0000, v200
    v_lshlrev_b32 v38, 16, v201
    v_mfma_f32_32x32x16_bf16 a[80:95], v[116:119], v[76:79], a[80:95]
    ds_read_b64_tr_b16 v[100:101], v25 offset:40960
    ds_read_b64_tr_b16 v[102:103], v25 offset:41984
    ds_read_b64_tr_b16 v[104:105], v26 offset:40960
    v_and_b32 v39, 0xffff0000, v201
    v_lshlrev_b32 v40, 16, v202
    v_and_b32 v41, 0xffff0000, v202
    v_mfma_f32_32x32x16_bf16 a[96:111], v[120:123], v[76:79], a[96:111]
    ds_read_b64_tr_b16 v[106:107], v26 offset:41984
    ds_read_b64_tr_b16 v[108:109], v27 offset:40960
    ds_read_b64_tr_b16 v[110:111], v27 offset:41984
    v_lshlrev_b32 v42, 16, v203
    v_and_b32 v43, 0xffff0000, v203
    v_mul_f32 v240, v36, v28
    v_mfma_f32_32x32x16_bf16 a[112:127], v[124:127], v[76:79], a[112:127]
    s_add_u32 m0, s37, 114688
    s_mov_b32 s39, 2621440
    buffer_load_dwordx4 v19, s[64:67], s39 offen nt lds
    s_add_u32 m0, s37, 122880
    s_nop 0
    buffer_load_dwordx4 v19, s[76:79], s39 offen nt lds
    v_mfma_f32_32x32x16_bf16 a[128:143], v[72:75], v[128:131], a[128:143]
    s_add_u32 m0, s37, 118784
    s_mov_b32 s39, 2752512
    buffer_load_dwordx4 v19, s[64:67], s39 offen nt lds
    s_add_u32 m0, s37, 126976
    s_nop 0
    buffer_load_dwordx4 v19, s[76:79], s39 offen nt lds
    v_mfma_f32_32x32x16_bf16 a[144:159], v[76:79], v[128:131], a[144:159]
    s_add_u32 m0, s37, 32768
    s_mov_b32 s39, 768
    buffer_load_dwordx4 v10, s[60:63], s39 offen lds
    v_mul_f32 v241, v37, v28
    v_mul_f32 v242, v38, v28
    v_mul_f32 v243, v39, v28
    v_mfma_f32_32x32x16_bf16 a[160:175], v[72:75], v[132:135], a[160:175]
    s_add_u32 m0, s37, 36864
    s_mov_b32 s39, 33536
    buffer_load_dwordx4 v10, s[60:63], s39 offen lds
    v_mul_f32 v244, v40, v28
    v_mul_f32 v245, v41, v28
    v_mul_f32 v246, v42, v28
    v_mfma_f32_32x32x16_bf16 a[176:191], v[76:79], v[132:135], a[176:191]
    s_add_u32 m0, s37, 40960
    s_mov_b32 s39, 66304
    buffer_load_dwordx4 v10, s[60:63], s39 offen lds
    v_mul_f32 v247, v43, v28
    v_lshlrev_b32 v36, 16, v204
    v_and_b32 v37, 0xffff0000, v204
    v_mfma_f32_32x32x16_bf16 a[192:207], v[72:75], v[136:139], a[192:207]
    s_add_u32 m0, s37, 45056
    s_mov_b32 s39, 99072
    buffer_load_dwordx4 v10, s[60:63], s39 offen lds
    v_lshlrev_b32 v38, 16, v205
    v_and_b32 v39, 0xffff0000, v205
    v_lshlrev_b32 v40, 16, v206
    v_mfma_f32_32x32x16_bf16 a[208:223], v[76:79], v[136:139], a[208:223]
    v_and_b32 v41, 0xffff0000, v206
    v_lshlrev_b32 v42, 16, v207
    v_and_b32 v43, 0xffff0000, v207
    v_fmac_f32 v240, v36, v29
    v_fmac_f32 v241, v37, v29
    v_fmac_f32 v242, v38, v29
    v_mfma_f32_32x32x16_bf16 a[224:239], v[72:75], v[140:143], a[224:239]
    v_fmac_f32 v243, v39, v29
    v_fmac_f32 v244, v40, v29
    v_fmac_f32 v245, v41, v29
    v_fmac_f32 v246, v42, v29
    v_fmac_f32 v247, v43, v29
    v_lshlrev_b32 v36, 16, v208
    v_mfma_f32_32x32x16_bf16 a[240:255], v[76:79], v[140:143], a[240:255]
    v_and_b32 v37, 0xffff0000, v208
    v_lshlrev_b32 v38, 16, v209
    v_and_b32 v39, 0xffff0000, v209
    v_lshlrev_b32 v40, 16, v210
    v_and_b32 v41, 0xffff0000, v210
    v_lshlrev_b32 v42, 16, v211
    s_waitcnt lgkmcnt(0)
    v_mfma_f32_32x32x16_bf16 a[0:15], v[80:83], v[64:67], a[0:15]
    v_add_u32 v13, 32768, v13
    ds_read_b128 v[72:75], v13 offset:32768
    ds_read_b128 v[76:79], v13 offset:36864
    ds_read_b64_tr_b16 v[112:113], v24 offset:36864
    v_and_b32 v43, 0xffff0000, v211
    v_fmac_f32 v240, v36, v30
    v_mfma_f32_32x32x16_bf16 a[16:31], v[84:87], v[64:67], a[16:31]
    ds_read_b64_tr_b16 v[114:115], v24 offset:37888
    ds_read_b64_tr_b16 v[116:117], v25 offset:36864
    ds_read_b64_tr_b16 v[118:119], v25 offset:37888
    v_fmac_f32 v241, v37, v30
    v_fmac_f32 v242, v38, v30
    v_fmac_f32 v243, v39, v30
    v_mfma_f32_32x32x16_bf16 a[32:47], v[88:91], v[64:67], a[32:47]
    ds_read_b64_tr_b16 v[120:121], v26 offset:36864
    ds_read_b64_tr_b16 v[122:123], v26 offset:37888
    ds_read_b64_tr_b16 v[124:125], v27 offset:36864
    v_fmac_f32 v244, v40, v30
    v_fmac_f32 v245, v41, v30
    v_fmac_f32 v246, v42, v30
    v_mfma_f32_32x32x16_bf16 a[48:63], v[92:95], v[64:67], a[48:63]
    ds_read_b64_tr_b16 v[126:127], v27 offset:37888
    ds_read_b64_tr_b16 v[128:129], v24 offset:45056
    ds_read_b64_tr_b16 v[130:131], v24 offset:46080
    v_fmac_f32 v247, v43, v30
    v_lshlrev_b32 v36, 16, v212
    v_and_b32 v37, 0xffff0000, v212
    v_mfma_f32_32x32x16_bf16 a[64:79], v[80:83], v[68:71], a[64:79]
    ds_read_b64_tr_b16 v[132:133], v25 offset:45056
    ds_read_b64_tr_b16 v[134:135], v25 offset:46080
    ds_read_b64_tr_b16 v[136:137], v26 offset:45056
    v_lshlrev_b32 v38, 16, v213
    v_and_b32 v39, 0xffff0000, v213
    v_lshlrev_b32 v40, 16, v214
    v_mfma_f32_32x32x16_bf16 a[80:95], v[84:87], v[68:71], a[80:95]
    ds_read_b64_tr_b16 v[138:139], v26 offset:46080
    ds_read_b64_tr_b16 v[140:141], v27 offset:45056
    ds_read_b64_tr_b16 v[142:143], v27 offset:46080
    v_and_b32 v41, 0xffff0000, v214
    v_lshlrev_b32 v42, 16, v215
    v_and_b32 v43, 0xffff0000, v215
    v_mfma_f32_32x32x16_bf16 a[96:111], v[88:91], v[68:71], a[96:111]
    v_fmac_f32 v240, v36, v31
    v_fmac_f32 v241, v37, v31
    v_fmac_f32 v242, v38, v31
    v_fmac_f32 v243, v39, v31
    v_fmac_f32 v244, v40, v31
    v_fmac_f32 v245, v41, v31
    v_mfma_f32_32x32x16_bf16 a[112:127], v[92:95], v[68:71], a[112:127]
    v_fmac_f32 v246, v42, v31
    v_fmac_f32 v247, v43, v31
    v_lshlrev_b32 v36, 16, v216
    v_and_b32 v37, 0xffff0000, v216
    v_lshlrev_b32 v38, 16, v217
    v_and_b32 v39, 0xffff0000, v217
    v_mfma_f32_32x32x16_bf16 a[128:143], v[64:67], v[96:99], a[128:143]
    v_lshlrev_b32 v40, 16, v218
    v_and_b32 v41, 0xffff0000, v218
    v_lshlrev_b32 v42, 16, v219
    v_and_b32 v43, 0xffff0000, v219
    v_fmac_f32 v240, v36, v32
    v_fmac_f32 v241, v37, v32
    v_mfma_f32_32x32x16_bf16 a[144:159], v[68:71], v[96:99], a[144:159]
    v_fmac_f32 v242, v38, v32
    v_fmac_f32 v243, v39, v32
    v_fmac_f32 v244, v40, v32
    v_fmac_f32 v245, v41, v32
    v_fmac_f32 v246, v42, v32
    v_fmac_f32 v247, v43, v32
    v_mfma_f32_32x32x16_bf16 a[160:175], v[64:67], v[100:103], a[160:175]
    v_lshlrev_b32 v36, 16, v220
    v_and_b32 v37, 0xffff0000, v220
    v_lshlrev_b32 v38, 16, v221
    v_and_b32 v39, 0xffff0000, v221
    v_lshlrev_b32 v40, 16, v222
    v_and_b32 v41, 0xffff0000, v222
    v_mfma_f32_32x32x16_bf16 a[176:191], v[68:71], v[100:103], a[176:191]
    v_lshlrev_b32 v42, 16, v223
    v_and_b32 v43, 0xffff0000, v223
    v_fmac_f32 v240, v36, v33
    v_fmac_f32 v241, v37, v33
    v_fmac_f32 v242, v38, v33
    v_fmac_f32 v243, v39, v33
    v_mfma_f32_32x32x16_bf16 a[192:207], v[64:67], v[104:107], a[192:207]
    v_fmac_f32 v244, v40, v33
    v_fmac_f32 v245, v41, v33
    v_fmac_f32 v246, v42, v33
    v_fmac_f32 v247, v43, v33
    v_lshlrev_b32 v36, 16, v224
    v_and_b32 v37, 0xffff0000, v224
    v_mfma_f32_32x32x16_bf16 a[208:223], v[68:71], v[104:107], a[208:223]
    v_lshlrev_b32 v38, 16, v225
    v_and_b32 v39, 0xffff0000, v225
    v_lshlrev_b32 v40, 16, v226
    v_and_b32 v41, 0xffff0000, v226
    v_lshlrev_b32 v42, 16, v227
    v_and_b32 v43, 0xffff0000, v227
    v_mfma_f32_32x32x16_bf16 a[224:239], v[64:67], v[108:111], a[224:239]
    v_fmac_f32 v240, v36, v34
    v_fmac_f32 v241, v37, v34
    v_fmac_f32 v242, v38, v34
    v_fmac_f32 v243, v39, v34
    v_fmac_f32 v244, v40, v34
    v_fmac_f32 v245, v41, v34
    v_mfma_f32_32x32x16_bf16 a[240:255], v[68:71], v[108:111], a[240:255]
    v_fmac_f32 v246, v42, v34
    v_fmac_f32 v247, v43, v34
    v_lshlrev_b32 v36, 16, v228
    v_and_b32 v37, 0xffff0000, v228
    v_lshlrev_b32 v38, 16, v229
    v_and_b32 v39, 0xffff0000, v229
    s_waitcnt lgkmcnt(0)
    v_mfma_f32_32x32x16_bf16 a[0:15], v[112:115], v[72:75], a[0:15]
    s_waitcnt vmcnt(14)
    s_barrier
    v_lshlrev_b32 v40, 16, v230
    v_and_b32 v41, 0xffff0000, v230
    v_lshlrev_b32 v42, 16, v231
    v_and_b32 v43, 0xffff0000, v231
    v_mfma_f32_32x32x16_bf16 a[16:31], v[116:119], v[72:75], a[16:31]
    v_add_u32 v14, 32768, v14
    ds_read_b128 v[64:67], v14 offset:32768
    ds_read_b128 v[68:71], v14 offset:36864
    ds_read_b64_tr_b16 v[80:81], v24 offset:0
    v_fmac_f32 v240, v36, v35
    v_fmac_f32 v241, v37, v35
    v_mfma_f32_32x32x16_bf16 a[32:47], v[120:123], v[72:75], a[32:47]
    ds_read_b64_tr_b16 v[82:83], v24 offset:1024
    ds_read_b64_tr_b16 v[84:85], v25 offset:0
    ds_read_b64_tr_b16 v[86:87], v25 offset:1024
    v_fmac_f32 v242, v38, v35
    v_fmac_f32 v243, v39, v35
    v_fmac_f32 v244, v40, v35
    v_mfma_f32_32x32x16_bf16 a[48:63], v[124:127], v[72:75], a[48:63]
    ds_read_b64_tr_b16 v[88:89], v26 offset:0
    ds_read_b64_tr_b16 v[90:91], v26 offset:1024
    ds_read_b64_tr_b16 v[92:93], v27 offset:0
    v_fmac_f32 v245, v41, v35
    v_fmac_f32 v246, v42, v35
    v_fmac_f32 v247, v43, v35
    v_mfma_f32_32x32x16_bf16 a[64:79], v[112:115], v[76:79], a[64:79]
    ds_read_b64_tr_b16 v[94:95], v27 offset:1024
    ds_read_b64_tr_b16 v[96:97], v24 offset:8192
    ds_read_b64_tr_b16 v[98:99], v24 offset:9216
    v_add_f32_dpp v36, v240, v240 row_ror:4 row_mask:0xf bank_mask:0xf
    v_add_f32_dpp v37, v241, v241 row_ror:4 row_mask:0xf bank_mask:0xf
    v_add_f32_dpp v38, v242, v242 row_ror:4 row_mask:0xf bank_mask:0xf
    v_mfma_f32_32x32x16_bf16 a[80:95], v[116:119], v[76:79], a[80:95]
    ds_read_b64_tr_b16 v[100:101], v25 offset:8192
    ds_read_b64_tr_b16 v[102:103], v25 offset:9216
    ds_read_b64_tr_b16 v[104:105], v26 offset:8192
    v_add_f32_dpp v39, v243, v243 row_ror:4 row_mask:0xf bank_mask:0xf
    v_add_f32_dpp v40, v244, v244 row_ror:4 row_mask:0xf bank_mask:0xf
    v_add_f32_dpp v41, v245, v245 row_ror:4 row_mask:0xf bank_mask:0xf
    v_mfma_f32_32x32x16_bf16 a[96:111], v[120:123], v[76:79], a[96:111]
    ds_read_b64_tr_b16 v[106:107], v26 offset:9216
    ds_read_b64_tr_b16 v[108:109], v27 offset:8192
    ds_read_b64_tr_b16 v[110:111], v27 offset:9216
    v_add_f32_dpp v42, v246, v246 row_ror:4 row_mask:0xf bank_mask:0xf
    v_add_f32_dpp v43, v247, v247 row_ror:4 row_mask:0xf bank_mask:0xf
    v_add_f32_dpp v240, v36, v36 row_ror:8 row_mask:0xf bank_mask:0xf
    v_mfma_f32_32x32x16_bf16 a[112:127], v[124:127], v[76:79], a[112:127]
    s_add_u32 m0, s37, 131072
    s_mov_b32 s39, 2883584
    buffer_load_dwordx4 v19, s[64:67], s39 offen nt lds
    s_add_u32 m0, s37, 139264
    s_nop 0
    buffer_load_dwordx4 v19, s[76:79], s39 offen nt lds
    v_mfma_f32_32x32x16_bf16 a[128:143], v[72:75], v[128:131], a[128:143]
    s_add_u32 m0, s37, 135168
    s_mov_b32 s39, 3014656
    buffer_load_dwordx4 v19, s[64:67], s39 offen nt lds
    s_add_u32 m0, s37, 143360
    s_nop 0
    buffer_load_dwordx4 v19, s[76:79], s39 offen nt lds
    v_mfma_f32_32x32x16_bf16 a[144:159], v[76:79], v[128:131], a[144:159]
    s_add_u32 m0, s37, 49152
    s_mov_b32 s39, 131840
    buffer_load_dwordx4 v10, s[60:63], s39 offen lds
    buffer_load_dword v8, v16, s[16:19], s31 offen
    v_add_f32_dpp v241, v37, v37 row_ror:8 row_mask:0xf bank_mask:0xf
    v_mfma_f32_32x32x16_bf16 a[160:175], v[72:75], v[132:135], a[160:175]
    s_add_u32 m0, s37, 53248
    s_mov_b32 s39, 164608
    buffer_load_dwordx4 v10, s[60:63], s39 offen lds
    v_add_f32_dpp v242, v38, v38 row_ror:8 row_mask:0xf bank_mask:0xf
    v_add_f32_dpp v243, v39, v39 row_ror:8 row_mask:0xf bank_mask:0xf
    v_add_f32_dpp v244, v40, v40 row_ror:8 row_mask:0xf bank_mask:0xf
    v_mfma_f32_32x32x16_bf16 a[176:191], v[76:79], v[132:135], a[176:191]
    s_add_u32 m0, s37, 57344
    s_mov_b32 s39, 197376
    buffer_load_dwordx4 v10, s[60:63], s39 offen lds
    v_add_f32_dpp v245, v41, v41 row_ror:8 row_mask:0xf bank_mask:0xf
    v_add_f32_dpp v246, v42, v42 row_ror:8 row_mask:0xf bank_mask:0xf
    v_add_f32_dpp v247, v43, v43 row_ror:8 row_mask:0xf bank_mask:0xf
    v_mfma_f32_32x32x16_bf16 a[192:207], v[72:75], v[136:139], a[192:207]
    s_add_u32 m0, s37, 61440
    s_mov_b32 s39, 230144
    buffer_load_dwordx4 v10, s[60:63], s39 offen lds
    v_permlane16_swap_b32 v240, v244
    v_permlane16_swap_b32 v241, v245
    v_permlane16_swap_b32 v242, v246
    v_mfma_f32_32x32x16_bf16 a[208:223], v[76:79], v[136:139], a[208:223]
    v_permlane16_swap_b32 v243, v247
    v_add_f32 v240, v240, v244
    v_add_f32 v241, v241, v245
    v_add_f32 v242, v242, v246
    v_add_f32 v243, v243, v247
    s_nop 0
    v_permlane32_swap_b32 v240, v242
    v_mfma_f32_32x32x16_bf16 a[224:239], v[72:75], v[140:143], a[224:239]
    v_permlane32_swap_b32 v241, v243
    v_add_f32 v240, v240, v242
    v_add_f32 v241, v241, v243
    v_bfe_u32 v248, v1, 4, 1
    v_lshlrev_b32 v248, 4, v248
    v_lshl_add_u32 v248, v3, 3, v248
    v_mfma_f32_32x32x16_bf16 a[240:255], v[76:79], v[140:143], a[240:255]
    v_and_b32 v249, 3, v1
    v_lshl_add_u32 v248, v249, 5, v248
    s_lshl_b32 s34, s55, 7
    s_add_u32 s34, s34, 152576
    v_add_u32 v248, s34, v248
    ds_write_b64 v248, v[240:241]
    s_waitcnt lgkmcnt(0)
    v_mfma_f32_32x32x16_bf16 a[0:15], v[80:83], v[64:67], a[0:15]
    v_add_u32 v15, 32768, v15
    ds_read_b128 v[72:75], v15 offset:32768
    ds_read_b128 v[76:79], v15 offset:36864
    ds_read_b64_tr_b16 v[112:113], v24 offset:4096
    v_mfma_f32_32x32x16_bf16 a[16:31], v[84:87], v[64:67], a[16:31]
    ds_read_b64_tr_b16 v[114:115], v24 offset:5120
    ds_read_b64_tr_b16 v[116:117], v25 offset:4096
    ds_read_b64_tr_b16 v[118:119], v25 offset:5120
    v_mfma_f32_32x32x16_bf16 a[32:47], v[88:91], v[64:67], a[32:47]
    ds_read_b64_tr_b16 v[120:121], v26 offset:4096
    ds_read_b64_tr_b16 v[122:123], v26 offset:5120
    ds_read_b64_tr_b16 v[124:125], v27 offset:4096
    v_mfma_f32_32x32x16_bf16 a[48:63], v[92:95], v[64:67], a[48:63]
    ds_read_b64_tr_b16 v[126:127], v27 offset:5120
    ds_read_b64_tr_b16 v[128:129], v24 offset:12288
    ds_read_b64_tr_b16 v[130:131], v24 offset:13312
    v_mfma_f32_32x32x16_bf16 a[64:79], v[80:83], v[68:71], a[64:79]
    ds_read_b64_tr_b16 v[132:133], v25 offset:12288
    ds_read_b64_tr_b16 v[134:135], v25 offset:13312
    ds_read_b64_tr_b16 v[136:137], v26 offset:12288
    v_mfma_f32_32x32x16_bf16 a[80:95], v[84:87], v[68:71], a[80:95]
    ds_read_b64_tr_b16 v[138:139], v26 offset:13312
    ds_read_b64_tr_b16 v[140:141], v27 offset:12288
    ds_read_b64_tr_b16 v[142:143], v27 offset:13312
    v_mfma_f32_32x32x16_bf16 a[96:111], v[88:91], v[68:71], a[96:111]
    v_mfma_f32_32x32x16_bf16 a[112:127], v[92:95], v[68:71], a[112:127]
    v_mfma_f32_32x32x16_bf16 a[128:143], v[64:67], v[96:99], a[128:143]
    v_mfma_f32_32x32x16_bf16 a[144:159], v[68:71], v[96:99], a[144:159]
    v_mfma_f32_32x32x16_bf16 a[160:175], v[64:67], v[100:103], a[160:175]
    v_mfma_f32_32x32x16_bf16 a[176:191], v[68:71], v[100:103], a[176:191]
    v_mfma_f32_32x32x16_bf16 a[192:207], v[64:67], v[104:107], a[192:207]
    v_mfma_f32_32x32x16_bf16 a[208:223], v[68:71], v[104:107], a[208:223]
    v_mfma_f32_32x32x16_bf16 a[224:239], v[64:67], v[108:111], a[224:239]
    v_mfma_f32_32x32x16_bf16 a[240:255], v[68:71], v[108:111], a[240:255]
    s_waitcnt lgkmcnt(0)
    v_mfma_f32_32x32x16_bf16 a[0:15], v[112:115], v[72:75], a[0:15]
    s_waitcnt vmcnt(13)
    s_barrier
    v_mfma_f32_32x32x16_bf16 a[16:31], v[116:119], v[72:75], a[16:31]
    v_add_u32 v12, 4294934528, v12
    ds_read_b128 v[64:67], v12 offset:0
    ds_read_b128 v[68:71], v12 offset:4096
    ds_read_b64_tr_b16 v[80:81], v24 offset:16384
    v_lshlrev_b32 v249, 2, v2
    v_add_u32 v248, 152576, v249
    v_mfma_f32_32x32x16_bf16 a[32:47], v[120:123], v[72:75], a[32:47]
    ds_read_b64_tr_b16 v[82:83], v24 offset:17408
    ds_read_b64_tr_b16 v[84:85], v25 offset:16384
    ds_read_b64_tr_b16 v[86:87], v25 offset:17408
    ds_read_b32 v36, v248
    ds_read_b32 v37, v248 offset:128
    ds_read_b32 v38, v248 offset:256
    v_mfma_f32_32x32x16_bf16 a[48:63], v[124:127], v[72:75], a[48:63]
    ds_read_b64_tr_b16 v[88:89], v26 offset:16384
    ds_read_b64_tr_b16 v[90:91], v26 offset:17408
    ds_read_b64_tr_b16 v[92:93], v27 offset:16384
    ds_read_b32 v39, v248 offset:384
    s_lshl_b32 s35, s7, 7
    s_add_u32 s35, s35, 4096
    s_cmp_lt_u32 s7, 64
    s_cselect_b32 s35, s35, 1073741824
    v_mfma_f32_32x32x16_bf16 a[64:79], v[112:115], v[76:79], a[64:79]
    ds_read_b64_tr_b16 v[94:95], v27 offset:17408
    ds_read_b64_tr_b16 v[96:97], v24 offset:24576
    ds_read_b64_tr_b16 v[98:99], v24 offset:25600
    s_cmp_eq_u32 s55, 0
    s_cselect_b32 s35, s35, 1073741824
    s_cmp_ge_u32 s7, 32
    s_cselect_b32 s70, 1.0, 0
    s_cselect_b32 s71, 0, 16
    s_and_b32 s34, s7, 15
    v_mfma_f32_32x32x16_bf16 a[80:95], v[116:119], v[76:79], a[80:95]
    ds_read_b64_tr_b16 v[100:101], v25 offset:24576
    ds_read_b64_tr_b16 v[102:103], v25 offset:25600
    ds_read_b64_tr_b16 v[104:105], v26 offset:24576
    s_lshl_b32 s34, s34, 10
    s_add_u32 s34, s34, s71
    s_lshl_b32 s71, s55, 6
    s_add_u32 s34, s34, s71
    s_add_u32 s34, s34, 108003328
    s_sub_u32 s71, s7, 16
    v_mfma_f32_32x32x16_bf16 a[96:111], v[120:123], v[76:79], a[96:111]
    ds_read_b64_tr_b16 v[106:107], v26 offset:25600
    ds_read_b64_tr_b16 v[108:109], v27 offset:24576
    ds_read_b64_tr_b16 v[110:111], v27 offset:25600
    s_cmp_lt_u32 s71, 32
    s_cselect_b32 s34, s34, 1073741824
    v_bfe_u32 v40, v1, 4, 1
    v_lshlrev_b32 v40, 9, v40
    v_mfma_f32_32x32x16_bf16 a[112:127], v[124:127], v[76:79], a[112:127]
    s_add_u32 m0, s37, 98304
    s_mov_b32 s39, 3145728
    buffer_load_dwordx4 v19, s[64:67], s39 offen nt lds
    s_add_u32 m0, s37, 106496
    s_nop 0
    buffer_load_dwordx4 v19, s[76:79], s39 offen nt lds
    v_mfma_f32_32x32x16_bf16 a[128:143], v[72:75], v[128:131], a[128:143]
    s_add_u32 m0, s37, 102400
    s_mov_b32 s39, 3276800
    buffer_load_dwordx4 v19, s[64:67], s39 offen nt lds
    s_add_u32 m0, s37, 110592
    s_nop 0
    buffer_load_dwordx4 v19, s[76:79], s39 offen nt lds
    v_mfma_f32_32x32x16_bf16 a[144:159], v[76:79], v[128:131], a[144:159]
    s_add_u32 m0, s37, 65536
    s_mov_b32 s39, 896
    buffer_load_dwordx4 v10, s[60:63], s39 offen lds
    v_bfe_u32 v248, v1, 2, 1
    v_lshl_add_u32 v40, v248, 8, v40
    v_and_b32 v248, 3, v1
    v_mfma_f32_32x32x16_bf16 a[160:175], v[72:75], v[132:135], a[160:175]
    s_add_u32 m0, s37, 69632
    s_mov_b32 s39, 33664
    buffer_load_dwordx4 v10, s[60:63], s39 offen lds
    v_lshl_add_u32 v40, v248, 1, v40
    v_bfe_u32 v248, v1, 3, 1
    v_lshl_add_u32 v40, v248, 3, v40
    v_mfma_f32_32x32x16_bf16 a[176:191], v[76:79], v[132:135], a[176:191]
    s_add_u32 m0, s37, 73728
    s_mov_b32 s39, 66432
    buffer_load_dwordx4 v10, s[60:63], s39 offen lds
    s_waitcnt lgkmcnt(9)
    v_add_f32 v36, v36, v37
    v_add_f32 v38, v38, v39
    v_mfma_f32_32x32x16_bf16 a[192:207], v[72:75], v[136:139], a[192:207]
    s_add_u32 m0, s37, 77824
    s_mov_b32 s39, 99200
    buffer_load_dwordx4 v10, s[60:63], s39 offen lds
    v_add_f32 v36, v36, v38
    v_cvt_pk_bf16_f32 v36, v36, v36
    v_lshlrev_b32 v36, 16, v36
    v_mfma_f32_32x32x16_bf16 a[208:223], v[76:79], v[136:139], a[208:223]
    buffer_store_dword v36, v249, s[72:75], s35 offen sc1
    v_add_f32 v38, s70, v36
    v_cvt_pk_bf16_f32 v38, v38, v38
    buffer_store_short v38, v40, s[72:75], s34 offen sc1
    v_mfma_f32_32x32x16_bf16 a[224:239], v[72:75], v[140:143], a[224:239]
    v_perm_b32 v28, v177, v176, s32
    v_perm_b32 v32, v177, v176, s33
    v_perm_b32 v29, v179, v178, s32
    v_perm_b32 v33, v179, v178, s33
    v_perm_b32 v30, v181, v180, s32
    v_mfma_f32_32x32x16_bf16 a[240:255], v[76:79], v[140:143], a[240:255]
    v_perm_b32 v34, v181, v180, s33
    v_perm_b32 v31, v183, v182, s32
    v_perm_b32 v35, v183, v182, s33
    s_waitcnt lgkmcnt(0)
    v_mfma_f32_32x32x16_bf16 a[0:15], v[80:83], v[64:67], a[0:15]
    v_add_u32 v13, 4294934528, v13
    ds_read_b128 v[72:75], v13 offset:0
    ds_read_b128 v[76:79], v13 offset:4096
    ds_read_b64_tr_b16 v[112:113], v24 offset:20480
    buffer_load_dwordx2 v[236:237], v61, s[72:75], s47 offen sc0 sc1
    v_mfma_f32_32x32x16_bf16 a[16:31], v[84:87], v[64:67], a[16:31]
    ds_read_b64_tr_b16 v[114:115], v24 offset:21504
    ds_read_b64_tr_b16 v[116:117], v25 offset:20480
    ds_read_b64_tr_b16 v[118:119], v25 offset:21504
    s_add_u32 s12, s8, 83886080
    s_addc_u32 s13, s9, 0
    s_mov_b32 s14, 2097152
    s_mov_b32 s15, 0x00020000
    v_add_u32 v16, s36, v17
    v_mfma_f32_32x32x16_bf16 a[32:47], v[88:91], v[64:67], a[32:47]
    ds_read_b64_tr_b16 v[120:121], v26 offset:20480
    ds_read_b64_tr_b16 v[122:123], v26 offset:21504
    ds_read_b64_tr_b16 v[124:125], v27 offset:20480
    v_mfma_f32_32x32x16_bf16 a[48:63], v[92:95], v[64:67], a[48:63]
    ds_read_b64_tr_b16 v[126:127], v27 offset:21504
    ds_read_b64_tr_b16 v[128:129], v24 offset:28672
    ds_read_b64_tr_b16 v[130:131], v24 offset:29696
    v_mfma_f32_32x32x16_bf16 a[64:79], v[80:83], v[68:71], a[64:79]
    ds_read_b64_tr_b16 v[132:133], v25 offset:28672
    ds_read_b64_tr_b16 v[134:135], v25 offset:29696
    ds_read_b64_tr_b16 v[136:137], v26 offset:28672
    v_mfma_f32_32x32x16_bf16 a[80:95], v[84:87], v[68:71], a[80:95]
    ds_read_b64_tr_b16 v[138:139], v26 offset:29696
    ds_read_b64_tr_b16 v[140:141], v27 offset:28672
    ds_read_b64_tr_b16 v[142:143], v27 offset:29696
    v_mfma_f32_32x32x16_bf16 a[96:111], v[88:91], v[68:71], a[96:111]
    s_mov_b32 vcc_lo, 0x55555555
    s_mov_b32 vcc_hi, 0x55555555
    v_cndmask_b32_dpp v176, v32, v28, vcc quad_perm:[1,0,3,2] row_mask:0xf bank_mask:0xf
    v_cndmask_b32_dpp v177, v33, v29, vcc quad_perm:[1,0,3,2] row_mask:0xf bank_mask:0xf
    v_cndmask_b32_dpp v178, v34, v30, vcc quad_perm:[1,0,3,2] row_mask:0xf bank_mask:0xf
    v_cndmask_b32_dpp v179, v35, v31, vcc quad_perm:[1,0,3,2] row_mask:0xf bank_mask:0xf
    v_mfma_f32_32x32x16_bf16 a[112:127], v[92:95], v[68:71], a[112:127]
    s_mov_b32 vcc_lo, 0xaaaaaaaa
    s_mov_b32 vcc_hi, 0xaaaaaaaa
    v_cndmask_b32_dpp v180, v28, v32, vcc quad_perm:[1,0,3,2] row_mask:0xf bank_mask:0xf
    v_cndmask_b32_dpp v181, v29, v33, vcc quad_perm:[1,0,3,2] row_mask:0xf bank_mask:0xf
    v_cndmask_b32_dpp v182, v30, v34, vcc quad_perm:[1,0,3,2] row_mask:0xf bank_mask:0xf
    v_cndmask_b32_dpp v183, v31, v35, vcc quad_perm:[1,0,3,2] row_mask:0xf bank_mask:0xf
    v_mfma_f32_32x32x16_bf16 a[128:143], v[64:67], v[96:99], a[128:143]
    v_perm_b32 v36, v185, v184, s32
    v_perm_b32 v40, v185, v184, s33
    v_perm_b32 v37, v187, v186, s32
    v_perm_b32 v41, v187, v186, s33
    v_perm_b32 v38, v189, v188, s32
    v_perm_b32 v42, v189, v188, s33
    v_mfma_f32_32x32x16_bf16 a[144:159], v[68:71], v[96:99], a[144:159]
    v_perm_b32 v39, v191, v190, s32
    v_perm_b32 v43, v191, v190, s33
    v_mfma_f32_32x32x16_bf16 a[160:175], v[64:67], v[100:103], a[160:175]
    s_mov_b32 vcc_lo, 0x55555555
    s_mov_b32 vcc_hi, 0x55555555
    v_cndmask_b32_dpp v184, v40, v36, vcc quad_perm:[1,0,3,2] row_mask:0xf bank_mask:0xf
    v_cndmask_b32_dpp v185, v41, v37, vcc quad_perm:[1,0,3,2] row_mask:0xf bank_mask:0xf
    v_cndmask_b32_dpp v186, v42, v38, vcc quad_perm:[1,0,3,2] row_mask:0xf bank_mask:0xf
    v_cndmask_b32_dpp v187, v43, v39, vcc quad_perm:[1,0,3,2] row_mask:0xf bank_mask:0xf
    v_mfma_f32_32x32x16_bf16 a[176:191], v[68:71], v[100:103], a[176:191]
    s_mov_b32 vcc_lo, 0xaaaaaaaa
    s_mov_b32 vcc_hi, 0xaaaaaaaa
    v_cndmask_b32_dpp v188, v36, v40, vcc quad_perm:[1,0,3,2] row_mask:0xf bank_mask:0xf
    v_cndmask_b32_dpp v189, v37, v41, vcc quad_perm:[1,0,3,2] row_mask:0xf bank_mask:0xf
    v_cndmask_b32_dpp v190, v38, v42, vcc quad_perm:[1,0,3,2] row_mask:0xf bank_mask:0xf
    v_cndmask_b32_dpp v191, v39, v43, vcc quad_perm:[1,0,3,2] row_mask:0xf bank_mask:0xf
    v_mfma_f32_32x32x16_bf16 a[192:207], v[64:67], v[104:107], a[192:207]
    buffer_store_dwordx4 v[176:179], v17, s[72:75], s48 offen sc1
    buffer_store_dwordx4 v[180:183], v17, s[72:75], s48 offen offset:1024 sc1
    buffer_store_dwordx4 v[184:187], v17, s[72:75], s57 offen sc1
    v_mfma_f32_32x32x16_bf16 a[208:223], v[68:71], v[104:107], a[208:223]
    buffer_store_dwordx4 v[188:191], v17, s[72:75], s57 offen offset:1024 sc1
    v_mfma_f32_32x32x16_bf16 a[224:239], v[64:67], v[108:111], a[224:239]
    v_mfma_f32_32x32x16_bf16 a[240:255], v[68:71], v[108:111], a[240:255]
    s_waitcnt lgkmcnt(0)
    v_mfma_f32_32x32x16_bf16 a[0:15], v[112:115], v[72:75], a[0:15]
    s_waitcnt vmcnt(20)
    s_barrier
    v_mfma_f32_32x32x16_bf16 a[16:31], v[116:119], v[72:75], a[16:31]
    v_add_u32 v14, 4294934528, v14
    ds_read_b128 v[64:67], v14 offset:0
    ds_read_b128 v[68:71], v14 offset:4096
    ds_read_b64_tr_b16 v[80:81], v24 offset:32768
    v_mfma_f32_32x32x16_bf16 a[32:47], v[120:123], v[72:75], a[32:47]
    ds_read_b64_tr_b16 v[82:83], v24 offset:33792
    ds_read_b64_tr_b16 v[84:85], v25 offset:32768
    ds_read_b64_tr_b16 v[86:87], v25 offset:33792
    v_mfma_f32_32x32x16_bf16 a[48:63], v[124:127], v[72:75], a[48:63]
    ds_read_b64_tr_b16 v[88:89], v26 offset:32768
    ds_read_b64_tr_b16 v[90:91], v26 offset:33792
    ds_read_b64_tr_b16 v[92:93], v27 offset:32768
    v_mfma_f32_32x32x16_bf16 a[64:79], v[112:115], v[76:79], a[64:79]
    ds_read_b64_tr_b16 v[94:95], v27 offset:33792
    ds_read_b64_tr_b16 v[96:97], v24 offset:40960
    ds_read_b64_tr_b16 v[98:99], v24 offset:41984
    v_mfma_f32_32x32x16_bf16 a[80:95], v[116:119], v[76:79], a[80:95]
    ds_read_b64_tr_b16 v[100:101], v25 offset:40960
    ds_read_b64_tr_b16 v[102:103], v25 offset:41984
    ds_read_b64_tr_b16 v[104:105], v26 offset:40960
    v_mfma_f32_32x32x16_bf16 a[96:111], v[120:123], v[76:79], a[96:111]
    ds_read_b64_tr_b16 v[106:107], v26 offset:41984
    ds_read_b64_tr_b16 v[108:109], v27 offset:40960
    ds_read_b64_tr_b16 v[110:111], v27 offset:41984
    v_mfma_f32_32x32x16_bf16 a[112:127], v[124:127], v[76:79], a[112:127]
    s_add_u32 m0, s37, 114688
    s_mov_b32 s39, 3407872
    buffer_load_dwordx4 v19, s[64:67], s39 offen nt lds
    s_add_u32 m0, s37, 122880
    s_nop 0
    buffer_load_dwordx4 v19, s[76:79], s39 offen nt lds
    v_mfma_f32_32x32x16_bf16 a[128:143], v[72:75], v[128:131], a[128:143]
    s_add_u32 m0, s37, 118784
    s_mov_b32 s39, 3538944
    buffer_load_dwordx4 v19, s[64:67], s39 offen nt lds
    s_add_u32 m0, s37, 126976
    s_nop 0
    buffer_load_dwordx4 v19, s[76:79], s39 offen nt lds
    v_mfma_f32_32x32x16_bf16 a[144:159], v[76:79], v[128:131], a[144:159]
    s_add_u32 m0, s37, 81920
    s_mov_b32 s39, 131968
    buffer_load_dwordx4 v10, s[60:63], s39 offen lds
    v_mfma_f32_32x32x16_bf16 a[160:175], v[72:75], v[132:135], a[160:175]
    s_add_u32 m0, s37, 86016
    s_mov_b32 s39, 164736
    buffer_load_dwordx4 v10, s[60:63], s39 offen lds
    v_mfma_f32_32x32x16_bf16 a[176:191], v[76:79], v[132:135], a[176:191]
    s_add_u32 m0, s37, 90112
    s_mov_b32 s39, 197504
    buffer_load_dwordx4 v10, s[60:63], s39 offen lds
    v_mfma_f32_32x32x16_bf16 a[192:207], v[72:75], v[136:139], a[192:207]
    s_add_u32 m0, s37, 94208
    s_mov_b32 s39, 230272
    buffer_load_dwordx4 v10, s[60:63], s39 offen lds
    v_mfma_f32_32x32x16_bf16 a[208:223], v[76:79], v[136:139], a[208:223]
    v_mfma_f32_32x32x16_bf16 a[224:239], v[72:75], v[140:143], a[224:239]
    v_mfma_f32_32x32x16_bf16 a[240:255], v[76:79], v[140:143], a[240:255]
    s_waitcnt lgkmcnt(0)
    v_mfma_f32_32x32x16_bf16 a[0:15], v[80:83], v[64:67], a[0:15]
    v_add_u32 v15, 4294934528, v15
    ds_read_b128 v[72:75], v15 offset:0
    ds_read_b128 v[76:79], v15 offset:4096
    ds_read_b64_tr_b16 v[112:113], v24 offset:36864
    v_mfma_f32_32x32x16_bf16 a[16:31], v[84:87], v[64:67], a[16:31]
    ds_read_b64_tr_b16 v[114:115], v24 offset:37888
    ds_read_b64_tr_b16 v[116:117], v25 offset:36864
    ds_read_b64_tr_b16 v[118:119], v25 offset:37888
    s_waitcnt vmcnt(12)
    v_min_u32 v236, v236, v237
    v_cmp_ne_u32 vcc, 0, v236
    s_nop 0
    s_cmp_eq_u64 vcc, -1
    s_cbranch_scc0 FR_H_S
FR_H_R:
    v_mfma_f32_32x32x16_bf16 a[32:47], v[88:91], v[64:67], a[32:47]
    ds_read_b64_tr_b16 v[120:121], v26 offset:36864
    ds_read_b64_tr_b16 v[122:123], v26 offset:37888
    ds_read_b64_tr_b16 v[124:125], v27 offset:36864
    s_lshl_b32 s42, s40, 19
    s_add_u32 s43, s42, 16777216
    s_add_u32 s20, s8, s43
    s_addc_u32 s21, s9, 0
    v_mfma_f32_32x32x16_bf16 a[48:63], v[92:95], v[64:67], a[48:63]
    ds_read_b64_tr_b16 v[126:127], v27 offset:37888
    ds_read_b64_tr_b16 v[128:129], v24 offset:45056
    ds_read_b64_tr_b16 v[130:131], v24 offset:46080
    s_mov_b32 s22, 524288
    s_mov_b32 s23, 0x00020000
    s_add_u32 s43, s42, 33554432
    s_add_u32 s24, s8, s43
    s_addc_u32 s25, s9, 0
    s_mov_b32 s26, 524288
    v_mfma_f32_32x32x16_bf16 a[64:79], v[80:83], v[68:71], a[64:79]
    ds_read_b64_tr_b16 v[132:133], v25 offset:45056
    ds_read_b64_tr_b16 v[134:135], v25 offset:46080
    ds_read_b64_tr_b16 v[136:137], v26 offset:45056
    s_mov_b32 s27, 0x00020000
    s_add_u32 s28, s8, 50331648
    s_addc_u32 s29, s9, 0
    s_mov_b32 s30, 16777216
    s_mov_b32 s31, 0x00020000
    s_lshl_b32 s52, s56, 2
    v_mfma_f32_32x32x16_bf16 a[80:95], v[84:87], v[68:71], a[80:95]
    ds_read_b64_tr_b16 v[138:139], v26 offset:46080
    ds_read_b64_tr_b16 v[140:141], v27 offset:45056
    ds_read_b64_tr_b16 v[142:143], v27 offset:46080
    s_add_u32 s52, s52, s55
    s_lshl_b32 s52, s52, 14
    s_mov_b32 s53, s52
    s_mov_b32 s38, 0
    s_mov_b32 s54, 32768
    v_mfma_f32_32x32x16_bf16 a[96:111], v[88:91], v[68:71], a[96:111]
    v_mfma_f32_32x32x16_bf16 a[112:127], v[92:95], v[68:71], a[112:127]
    v_mfma_f32_32x32x16_bf16 a[128:143], v[64:67], v[96:99], a[128:143]
    v_mfma_f32_32x32x16_bf16 a[144:159], v[68:71], v[96:99], a[144:159]
    v_mfma_f32_32x32x16_bf16 a[160:175], v[64:67], v[100:103], a[160:175]
    v_mfma_f32_32x32x16_bf16 a[176:191], v[68:71], v[100:103], a[176:191]
    v_mfma_f32_32x32x16_bf16 a[192:207], v[64:67], v[104:107], a[192:207]
    v_mfma_f32_32x32x16_bf16 a[208:223], v[68:71], v[104:107], a[208:223]
    v_mfma_f32_32x32x16_bf16 a[224:239], v[64:67], v[108:111], a[224:239]
    v_mfma_f32_32x32x16_bf16 a[240:255], v[68:71], v[108:111], a[240:255]
    s_waitcnt lgkmcnt(0)
    v_mfma_f32_32x32x16_bf16 a[0:15], v[112:115], v[72:75], a[0:15]
    s_barrier
    v_mfma_f32_32x32x16_bf16 a[16:31], v[116:119], v[72:75], a[16:31]
    ds_read_b128 v[64:67], v12 offset:32768
    ds_read_b128 v[68:71], v12 offset:36864
    ds_read_b64_tr_b16 v[80:81], v24 offset:0
    v_mfma_f32_32x32x16_bf16 a[32:47], v[120:123], v[72:75], a[32:47]
    ds_read_b64_tr_b16 v[82:83], v24 offset:1024
    ds_read_b64_tr_b16 v[84:85], v25 offset:0
    ds_read_b64_tr_b16 v[86:87], v25 offset:1024
    v_mfma_f32_32x32x16_bf16 a[48:63], v[124:127], v[72:75], a[48:63]
    ds_read_b64_tr_b16 v[88:89], v26 offset:0
    ds_read_b64_tr_b16 v[90:91], v26 offset:1024
    ds_read_b64_tr_b16 v[92:93], v27 offset:0
    v_mfma_f32_32x32x16_bf16 a[64:79], v[112:115], v[76:79], a[64:79]
    ds_read_b64_tr_b16 v[94:95], v27 offset:1024
    ds_read_b64_tr_b16 v[96:97], v24 offset:8192
    ds_read_b64_tr_b16 v[98:99], v24 offset:9216
    v_mfma_f32_32x32x16_bf16 a[80:95], v[116:119], v[76:79], a[80:95]
    ds_read_b64_tr_b16 v[100:101], v25 offset:8192
    ds_read_b64_tr_b16 v[102:103], v25 offset:9216
    ds_read_b64_tr_b16 v[104:105], v26 offset:8192
    v_mfma_f32_32x32x16_bf16 a[96:111], v[120:123], v[76:79], a[96:111]
    ds_read_b64_tr_b16 v[106:107], v26 offset:9216
    ds_read_b64_tr_b16 v[108:109], v27 offset:8192
    ds_read_b64_tr_b16 v[110:111], v27 offset:9216
    v_mfma_f32_32x32x16_bf16 a[112:127], v[124:127], v[76:79], a[112:127]
    s_add_u32 m0, s37, 131072
    s_mov_b32 s39, 3670016
    buffer_load_dwordx4 v19, s[64:67], s39 offen nt lds
    s_add_u32 m0, s37, 139264
    s_nop 0
    buffer_load_dwordx4 v19, s[76:79], s39 offen nt lds
    v_mfma_f32_32x32x16_bf16 a[128:143], v[72:75], v[128:131], a[128:143]
    s_add_u32 m0, s37, 135168
    s_mov_b32 s39, 3801088
    buffer_load_dwordx4 v19, s[64:67], s39 offen nt lds
    s_add_u32 m0, s37, 143360
    s_nop 0
    buffer_load_dwordx4 v19, s[76:79], s39 offen nt lds
    v_mfma_f32_32x32x16_bf16 a[144:159], v[76:79], v[128:131], a[144:159]
    s_add_u32 m0, s37, 0
    s_mov_b32 s39, 0
    buffer_load_dwordx4 v19, s[16:19], s39 offen nt lds
    v_mfma_f32_32x32x16_bf16 a[160:175], v[72:75], v[132:135], a[160:175]
    s_add_u32 m0, s37, 4096
    s_mov_b32 s39, 131072
    buffer_load_dwordx4 v19, s[16:19], s39 offen nt lds
    v_mfma_f32_32x32x16_bf16 a[176:191], v[76:79], v[132:135], a[176:191]
    s_add_u32 m0, s37, 8192
    s_mov_b32 s39, 262144
    buffer_load_dwordx4 v19, s[16:19], s39 offen nt lds
    v_mfma_f32_32x32x16_bf16 a[192:207], v[72:75], v[136:139], a[192:207]
    s_add_u32 m0, s37, 12288
    s_mov_b32 s39, 393216
    buffer_load_dwordx4 v19, s[16:19], s39 offen nt lds
    v_mfma_f32_32x32x16_bf16 a[208:223], v[76:79], v[136:139], a[208:223]
    s_mov_b64 exec, 0xffffffff
    buffer_load_dword v8, v63, s[12:15], s45 offen
    s_mov_b64 exec, -1
    s_add_u32 s45, s45, 8192
    v_mfma_f32_32x32x16_bf16 a[224:239], v[72:75], v[140:143], a[224:239]
    v_mfma_f32_32x32x16_bf16 a[240:255], v[76:79], v[140:143], a[240:255]
    s_waitcnt lgkmcnt(0)
    v_mfma_f32_32x32x16_bf16 a[0:15], v[80:83], v[64:67], a[0:15]
    ds_read_b128 v[72:75], v13 offset:32768
    ds_read_b128 v[76:79], v13 offset:36864
    ds_read_b64_tr_b16 v[112:113], v24 offset:4096
    v_mfma_f32_32x32x16_bf16 a[16:31], v[84:87], v[64:67], a[16:31]
    ds_read_b64_tr_b16 v[114:115], v24 offset:5120
    ds_read_b64_tr_b16 v[116:117], v25 offset:4096
    ds_read_b64_tr_b16 v[118:119], v25 offset:5120
    v_mfma_f32_32x32x16_bf16 a[32:47], v[88:91], v[64:67], a[32:47]
    ds_read_b64_tr_b16 v[120:121], v26 offset:4096
    ds_read_b64_tr_b16 v[122:123], v26 offset:5120
    ds_read_b64_tr_b16 v[124:125], v27 offset:4096
    v_mfma_f32_32x32x16_bf16 a[48:63], v[92:95], v[64:67], a[48:63]
    ds_read_b64_tr_b16 v[126:127], v27 offset:5120
    ds_read_b64_tr_b16 v[128:129], v24 offset:12288
    ds_read_b64_tr_b16 v[130:131], v24 offset:13312
    v_mfma_f32_32x32x16_bf16 a[64:79], v[80:83], v[68:71], a[64:79]
    ds_read_b64_tr_b16 v[132:133], v25 offset:12288
    ds_read_b64_tr_b16 v[134:135], v25 offset:13312
    ds_read_b64_tr_b16 v[136:137], v26 offset:12288
    v_mfma_f32_32x32x16_bf16 a[80:95], v[84:87], v[68:71], a[80:95]
    ds_read_b64_tr_b16 v[138:139], v26 offset:13312
    ds_read_b64_tr_b16 v[140:141], v27 offset:12288
    ds_read_b64_tr_b16 v[142:143], v27 offset:13312
    v_mfma_f32_32x32x16_bf16 a[96:111], v[88:91], v[68:71], a[96:111]
    v_mfma_f32_32x32x16_bf16 a[112:127], v[92:95], v[68:71], a[112:127]
    v_mfma_f32_32x32x16_bf16 a[128:143], v[64:67], v[96:99], a[128:143]
    v_mfma_f32_32x32x16_bf16 a[144:159], v[68:71], v[96:99], a[144:159]
    v_mfma_f32_32x32x16_bf16 a[160:175], v[64:67], v[100:103], a[160:175]
    v_mfma_f32_32x32x16_bf16 a[176:191], v[68:71], v[100:103], a[176:191]
    v_mfma_f32_32x32x16_bf16 a[192:207], v[64:67], v[104:107], a[192:207]
    v_mfma_f32_32x32x16_bf16 a[208:223], v[68:71], v[104:107], a[208:223]
    v_mfma_f32_32x32x16_bf16 a[224:239], v[64:67], v[108:111], a[224:239]
    s_waitcnt vmcnt(17)
    v_mfma_f32_32x32x16_bf16 a[240:255], v[68:71], v[108:111], a[240:255]
    s_waitcnt lgkmcnt(0)
    v_mfma_f32_32x32x16_bf16 a[0:15], v[112:115], v[72:75], a[0:15]
    s_waitcnt vmcnt(13)
    s_barrier
    v_mfma_f32_32x32x16_bf16 a[16:31], v[116:119], v[72:75], a[16:31]
    ds_read_b128 v[64:67], v14 offset:32768
    ds_read_b128 v[68:71], v14 offset:36864
    ds_read_b64_tr_b16 v[80:81], v24 offset:16384
    v_mov_b32 v0, 1
    s_cmp_eq_u32 s55, 0
    s_cselect_b32 s49, 192, 1073741824
    v_mfma_f32_32x32x16_bf16 a[32:47], v[120:123], v[72:75], a[32:47]
    ds_read_b64_tr_b16 v[82:83], v24 offset:17408
    ds_read_b64_tr_b16 v[84:85], v25 offset:16384
    ds_read_b64_tr_b16 v[86:87], v25 offset:17408
    s_mov_b64 exec, 1
    buffer_atomic_add v0, off, s[92:95], s49 sc1
    s_mov_b64 exec, -1
    v_mfma_f32_32x32x16_bf16 a[48:63], v[124:127], v[72:75], a[48:63]
    ds_read_b64_tr_b16 v[88:89], v26 offset:16384
    ds_read_b64_tr_b16 v[90:91], v26 offset:17408
    ds_read_b64_tr_b16 v[92:93], v27 offset:16384
    v_mfma_f32_32x32x16_bf16 a[64:79], v[112:115], v[76:79], a[64:79]
    ds_read_b64_tr_b16 v[94:95], v27 offset:17408
    ds_read_b64_tr_b16 v[96:97], v24 offset:24576
    ds_read_b64_tr_b16 v[98:99], v24 offset:25600
    v_mfma_f32_32x32x16_bf16 a[80:95], v[116:119], v[76:79], a[80:95]
    ds_read_b64_tr_b16 v[100:101], v25 offset:24576
    ds_read_b64_tr_b16 v[102:103], v25 offset:25600
    ds_read_b64_tr_b16 v[104:105], v26 offset:24576
    v_mfma_f32_32x32x16_bf16 a[96:111], v[120:123], v[76:79], a[96:111]
    ds_read_b64_tr_b16 v[106:107], v26 offset:25600
    ds_read_b64_tr_b16 v[108:109], v27 offset:24576
    ds_read_b64_tr_b16 v[110:111], v27 offset:25600
    v_mfma_f32_32x32x16_bf16 a[112:127], v[124:127], v[76:79], a[112:127]
    s_add_u32 m0, s37, 98304
    s_mov_b32 s39, 3932160
    buffer_load_dwordx4 v19, s[64:67], s39 offen nt lds
    s_add_u32 m0, s37, 106496
    s_nop 0
    buffer_load_dwordx4 v19, s[76:79], s39 offen nt lds
    v_mfma_f32_32x32x16_bf16 a[128:143], v[72:75], v[128:131], a[128:143]
    s_add_u32 m0, s37, 102400
    s_mov_b32 s39, 4063232
    buffer_load_dwordx4 v19, s[64:67], s39 offen nt lds
    s_add_u32 m0, s37, 110592
    s_nop 0
    buffer_load_dwordx4 v19, s[76:79], s39 offen nt lds
    v_mfma_f32_32x32x16_bf16 a[144:159], v[76:79], v[128:131], a[144:159]
    s_add_u32 m0, s37, 16384
    s_mov_b32 s39, 524288
    buffer_load_dwordx4 v19, s[16:19], s39 offen nt lds
    v_mfma_f32_32x32x16_bf16 a[160:175], v[72:75], v[132:135], a[160:175]
    s_add_u32 m0, s37, 20480
    s_mov_b32 s39, 655360
    buffer_load_dwordx4 v19, s[16:19], s39 offen nt lds
    v_mfma_f32_32x32x16_bf16 a[176:191], v[76:79], v[132:135], a[176:191]
    s_add_u32 m0, s37, 24576
    s_mov_b32 s39, 786432
    buffer_load_dwordx4 v19, s[16:19], s39 offen nt lds
    v_mfma_f32_32x32x16_bf16 a[192:207], v[72:75], v[136:139], a[192:207]
    s_add_u32 m0, s37, 28672
    s_mov_b32 s39, 917504
    buffer_load_dwordx4 v19, s[16:19], s39 offen nt lds
    v_mfma_f32_32x32x16_bf16 a[208:223], v[76:79], v[136:139], a[208:223]
    s_mov_b64 exec, 0xffffffff
    buffer_load_dword v8, v63, s[12:15], s45 offen
    s_mov_b64 exec, -1
    s_add_u32 s45, s45, 8192
    v_mfma_f32_32x32x16_bf16 a[224:239], v[72:75], v[140:143], a[224:239]
    v_mfma_f32_32x32x16_bf16 a[240:255], v[76:79], v[140:143], a[240:255]
    s_waitcnt lgkmcnt(0)
    v_mfma_f32_32x32x16_bf16 a[0:15], v[80:83], v[64:67], a[0:15]
    ds_read_b128 v[72:75], v15 offset:32768
    ds_read_b128 v[76:79], v15 offset:36864
    ds_read_b64_tr_b16 v[112:113], v24 offset:20480
    v_mfma_f32_32x32x16_bf16 a[16:31], v[84:87], v[64:67], a[16:31]
    ds_read_b64_tr_b16 v[114:115], v24 offset:21504
    ds_read_b64_tr_b16 v[116:117], v25 offset:20480
    ds_read_b64_tr_b16 v[118:119], v25 offset:21504
    v_mfma_f32_32x32x16_bf16 a[32:47], v[88:91], v[64:67], a[32:47]
    ds_read_b64_tr_b16 v[120:121], v26 offset:20480
    ds_read_b64_tr_b16 v[122:123], v26 offset:21504
    ds_read_b64_tr_b16 v[124:125], v27 offset:20480
    v_mfma_f32_32x32x16_bf16 a[48:63], v[92:95], v[64:67], a[48:63]
    ds_read_b64_tr_b16 v[126:127], v27 offset:21504
    ds_read_b64_tr_b16 v[128:129], v24 offset:28672
    ds_read_b64_tr_b16 v[130:131], v24 offset:29696
    v_mfma_f32_32x32x16_bf16 a[64:79], v[80:83], v[68:71], a[64:79]
    ds_read_b64_tr_b16 v[132:133], v25 offset:28672
    ds_read_b64_tr_b16 v[134:135], v25 offset:29696
    ds_read_b64_tr_b16 v[136:137], v26 offset:28672
    v_mfma_f32_32x32x16_bf16 a[80:95], v[84:87], v[68:71], a[80:95]
    ds_read_b64_tr_b16 v[138:139], v26 offset:29696
    ds_read_b64_tr_b16 v[140:141], v27 offset:28672
    ds_read_b64_tr_b16 v[142:143], v27 offset:29696
    v_mfma_f32_32x32x16_bf16 a[96:111], v[88:91], v[68:71], a[96:111]
    v_mfma_f32_32x32x16_bf16 a[112:127], v[92:95], v[68:71], a[112:127]
    v_mfma_f32_32x32x16_bf16 a[128:143], v[64:67], v[96:99], a[128:143]
    v_mfma_f32_32x32x16_bf16 a[144:159], v[68:71], v[96:99], a[144:159]
    v_mfma_f32_32x32x16_bf16 a[160:175], v[64:67], v[100:103], a[160:175]
    v_mfma_f32_32x32x16_bf16 a[176:191], v[68:71], v[100:103], a[176:191]
    v_mfma_f32_32x32x16_bf16 a[192:207], v[64:67], v[104:107], a[192:207]
    v_mfma_f32_32x32x16_bf16 a[208:223], v[68:71], v[104:107], a[208:223]
    v_mfma_f32_32x32x16_bf16 a[224:239], v[64:67], v[108:111], a[224:239]
    v_mfma_f32_32x32x16_bf16 a[240:255], v[68:71], v[108:111], a[240:255]
    s_waitcnt lgkmcnt(0)
    v_mfma_f32_32x32x16_bf16 a[0:15], v[112:115], v[72:75], a[0:15]
    s_waitcnt vmcnt(15)
    s_barrier
    v_mfma_f32_32x32x16_bf16 a[16:31], v[116:119], v[72:75], a[16:31]
    v_add_u32 v12, 32768, v12
    ds_read_b128 v[64:67], v12 offset:32768
    ds_read_b128 v[68:71], v12 offset:36864
    ds_read_b64_tr_b16 v[80:81], v24 offset:32768
    v_mfma_f32_32x32x16_bf16 a[32:47], v[120:123], v[72:75], a[32:47]
    ds_read_b64_tr_b16 v[82:83], v24 offset:33792
    ds_read_b64_tr_b16 v[84:85], v25 offset:32768
    ds_read_b64_tr_b16 v[86:87], v25 offset:33792
    v_mfma_f32_32x32x16_bf16 a[48:63], v[124:127], v[72:75], a[48:63]
    ds_read_b64_tr_b16 v[88:89], v26 offset:32768
    ds_read_b64_tr_b16 v[90:91], v26 offset:33792
    ds_read_b64_tr_b16 v[92:93], v27 offset:32768
    v_mfma_f32_32x32x16_bf16 a[64:79], v[112:115], v[76:79], a[64:79]
    ds_read_b64_tr_b16 v[94:95], v27 offset:33792
    ds_read_b64_tr_b16 v[96:97], v24 offset:40960
    ds_read_b64_tr_b16 v[98:99], v24 offset:41984
    v_mfma_f32_32x32x16_bf16 a[80:95], v[116:119], v[76:79], a[80:95]
    ds_read_b64_tr_b16 v[100:101], v25 offset:40960
    ds_read_b64_tr_b16 v[102:103], v25 offset:41984
    ds_read_b64_tr_b16 v[104:105], v26 offset:40960
    v_mfma_f32_32x32x16_bf16 a[96:111], v[120:123], v[76:79], a[96:111]
    ds_read_b64_tr_b16 v[106:107], v26 offset:41984
    ds_read_b64_tr_b16 v[108:109], v27 offset:40960
    ds_read_b64_tr_b16 v[110:111], v27 offset:41984
    v_mfma_f32_32x32x16_bf16 a[112:127], v[124:127], v[76:79], a[112:127]
    s_add_u32 m0, s37, 32768
    s_mov_b32 s39, 1048576
    buffer_load_dwordx4 v19, s[16:19], s39 offen nt lds
    v_mfma_f32_32x32x16_bf16 a[128:143], v[72:75], v[128:131], a[128:143]
    s_add_u32 m0, s37, 36864
    s_mov_b32 s39, 1179648
    buffer_load_dwordx4 v19, s[16:19], s39 offen nt lds
    v_mfma_f32_32x32x16_bf16 a[144:159], v[76:79], v[128:131], a[144:159]
    s_add_u32 m0, s37, 40960
    s_mov_b32 s39, 1310720
    buffer_load_dwordx4 v19, s[16:19], s39 offen nt lds
    v_mfma_f32_32x32x16_bf16 a[160:175], v[72:75], v[132:135], a[160:175]
    s_add_u32 m0, s37, 45056
    s_mov_b32 s39, 1441792
    buffer_load_dwordx4 v19, s[16:19], s39 offen nt lds
    v_mfma_f32_32x32x16_bf16 a[176:191], v[76:79], v[132:135], a[176:191]
    s_add_u32 m0, s37, 49152
    s_mov_b32 s39, 1572864
    buffer_load_dwordx4 v19, s[16:19], s39 offen nt lds
    v_mfma_f32_32x32x16_bf16 a[192:207], v[72:75], v[136:139], a[192:207]
    s_add_u32 m0, s37, 53248
    s_mov_b32 s39, 1703936
    buffer_load_dwordx4 v19, s[16:19], s39 offen nt lds
    v_mfma_f32_32x32x16_bf16 a[208:223], v[76:79], v[136:139], a[208:223]
    s_add_u32 m0, s37, 57344
    s_mov_b32 s39, 1835008
    buffer_load_dwordx4 v19, s[16:19], s39 offen nt lds
    v_mfma_f32_32x32x16_bf16 a[224:239], v[72:75], v[140:143], a[224:239]
    s_add_u32 m0, s37, 61440
    s_mov_b32 s39, 1966080
    buffer_load_dwordx4 v19, s[16:19], s39 offen nt lds
    v_mfma_f32_32x32x16_bf16 a[240:255], v[76:79], v[140:143], a[240:255]
    s_mov_b64 exec, 0xffffffff
    buffer_load_dword v8, v63, s[12:15], s45 offen
    s_mov_b64 exec, -1
    s_add_u32 s45, s45, 8192
    s_waitcnt lgkmcnt(0)
    v_mfma_f32_32x32x16_bf16 a[0:15], v[80:83], v[64:67], a[0:15]
    v_add_u32 v13, 32768, v13
    ds_read_b128 v[72:75], v13 offset:32768
    ds_read_b128 v[76:79], v13 offset:36864
    ds_read_b64_tr_b16 v[112:113], v24 offset:36864
    v_mfma_f32_32x32x16_bf16 a[16:31], v[84:87], v[64:67], a[16:31]
    ds_read_b64_tr_b16 v[114:115], v24 offset:37888
    ds_read_b64_tr_b16 v[116:117], v25 offset:36864
    ds_read_b64_tr_b16 v[118:119], v25 offset:37888
    v_mfma_f32_32x32x16_bf16 a[32:47], v[88:91], v[64:67], a[32:47]
    ds_read_b64_tr_b16 v[120:121], v26 offset:36864
    ds_read_b64_tr_b16 v[122:123], v26 offset:37888
    ds_read_b64_tr_b16 v[124:125], v27 offset:36864
    v_mfma_f32_32x32x16_bf16 a[48:63], v[92:95], v[64:67], a[48:63]
    ds_read_b64_tr_b16 v[126:127], v27 offset:37888
    ds_read_b64_tr_b16 v[128:129], v24 offset:45056
    ds_read_b64_tr_b16 v[130:131], v24 offset:46080
    v_mfma_f32_32x32x16_bf16 a[64:79], v[80:83], v[68:71], a[64:79]
    ds_read_b64_tr_b16 v[132:133], v25 offset:45056
    ds_read_b64_tr_b16 v[134:135], v25 offset:46080
    ds_read_b64_tr_b16 v[136:137], v26 offset:45056
    v_mfma_f32_32x32x16_bf16 a[80:95], v[84:87], v[68:71], a[80:95]
    ds_read_b64_tr_b16 v[138:139], v26 offset:46080
    ds_read_b64_tr_b16 v[140:141], v27 offset:45056
    ds_read_b64_tr_b16 v[142:143], v27 offset:46080
    v_mfma_f32_32x32x16_bf16 a[96:111], v[88:91], v[68:71], a[96:111]
    buffer_load_dwordx4 v[224:227], v5, s[12:15], s38 offen offset:0
    buffer_load_dwordx4 v[228:231], v5, s[12:15], s54 offen offset:0
    v_mfma_f32_32x32x16_bf16 a[112:127], v[92:95], v[68:71], a[112:127]
    buffer_load_dwordx4 v[232:235], v5, s[12:15], s38 offen offset:1024
    buffer_load_dwordx4 v[236:239], v5, s[12:15], s54 offen offset:1024
    v_mfma_f32_32x32x16_bf16 a[128:143], v[64:67], v[96:99], a[128:143]
    buffer_load_dwordx4 v[240:243], v5, s[12:15], s38 offen offset:2048
    buffer_load_dwordx4 v[244:247], v5, s[12:15], s54 offen offset:2048
    v_mfma_f32_32x32x16_bf16 a[144:159], v[68:71], v[96:99], a[144:159]
    buffer_load_dwordx4 v[248:251], v5, s[12:15], s38 offen offset:3072
    buffer_load_dwordx4 v[252:255], v5, s[12:15], s54 offen offset:3072
    s_add_u32 s38, s38, 4096
    s_add_u32 s54, s54, 4096
    v_lshlrev_b32 v61, 2, v2
    v_mfma_f32_32x32x16_bf16 a[160:175], v[64:67], v[100:103], a[160:175]
    v_mfma_f32_32x32x16_bf16 a[176:191], v[68:71], v[100:103], a[176:191]
    v_mfma_f32_32x32x16_bf16 a[192:207], v[64:67], v[104:107], a[192:207]
    v_mfma_f32_32x32x16_bf16 a[208:223], v[68:71], v[104:107], a[208:223]
    v_mfma_f32_32x32x16_bf16 a[224:239], v[64:67], v[108:111], a[224:239]
    v_mfma_f32_32x32x16_bf16 a[240:255], v[68:71], v[108:111], a[240:255]
    s_waitcnt lgkmcnt(0)
    v_mfma_f32_32x32x16_bf16 a[0:15], v[112:115], v[72:75], a[0:15]
    s_waitcnt vmcnt(22)
    s_barrier
    v_mfma_f32_32x32x16_bf16 a[16:31], v[116:119], v[72:75], a[16:31]
    v_add_u32 v14, 32768, v14
    ds_read_b128 v[64:67], v14 offset:32768
    ds_read_b128 v[68:71], v14 offset:36864
    ds_read_b64_tr_b16 v[80:81], v24 offset:0
    v_mfma_f32_32x32x16_bf16 a[32:47], v[120:123], v[72:75], a[32:47]
    ds_read_b64_tr_b16 v[82:83], v24 offset:1024
    ds_read_b64_tr_b16 v[84:85], v25 offset:0
    ds_read_b64_tr_b16 v[86:87], v25 offset:1024
    v_mfma_f32_32x32x16_bf16 a[48:63], v[124:127], v[72:75], a[48:63]
    ds_read_b64_tr_b16 v[88:89], v26 offset:0
    ds_read_b64_tr_b16 v[90:91], v26 offset:1024
    ds_read_b64_tr_b16 v[92:93], v27 offset:0
    v_mfma_f32_32x32x16_bf16 a[64:79], v[112:115], v[76:79], a[64:79]
    ds_read_b64_tr_b16 v[94:95], v27 offset:1024
    ds_read_b64_tr_b16 v[96:97], v24 offset:8192
    ds_read_b64_tr_b16 v[98:99], v24 offset:9216
    v_mfma_f32_32x32x16_bf16 a[80:95], v[116:119], v[76:79], a[80:95]
    ds_read_b64_tr_b16 v[100:101], v25 offset:8192
    ds_read_b64_tr_b16 v[102:103], v25 offset:9216
    ds_read_b64_tr_b16 v[104:105], v26 offset:8192
    v_mfma_f32_32x32x16_bf16 a[96:111], v[120:123], v[76:79], a[96:111]
    ds_read_b64_tr_b16 v[106:107], v26 offset:9216
    ds_read_b64_tr_b16 v[108:109], v27 offset:8192
    ds_read_b64_tr_b16 v[110:111], v27 offset:9216
    v_mfma_f32_32x32x16_bf16 a[112:127], v[124:127], v[76:79], a[112:127]
    s_add_u32 m0, s37, 114688
    s_mov_b32 s39, 2097152
    buffer_load_dwordx4 v19, s[16:19], s39 offen nt lds
    v_mfma_f32_32x32x16_bf16 a[128:143], v[72:75], v[128:131], a[128:143]
    s_add_u32 m0, s37, 118784
    s_mov_b32 s39, 2228224
    buffer_load_dwordx4 v19, s[16:19], s39 offen nt lds
    v_mfma_f32_32x32x16_bf16 a[144:159], v[76:79], v[128:131], a[144:159]
    s_add_u32 m0, s37, 122880
    s_mov_b32 s39, 2359296
    buffer_load_dwordx4 v19, s[16:19], s39 offen nt lds
    v_mfma_f32_32x32x16_bf16 a[160:175], v[72:75], v[132:135], a[160:175]
    s_add_u32 m0, s37, 126976
    s_mov_b32 s39, 2490368
    buffer_load_dwordx4 v19, s[16:19], s39 offen nt lds
    v_mfma_f32_32x32x16_bf16 a[176:191], v[76:79], v[132:135], a[176:191]
    s_add_u32 m0, s37, 131072
    s_mov_b32 s39, 2621440
    buffer_load_dwordx4 v19, s[16:19], s39 offen nt lds
    v_mfma_f32_32x32x16_bf16 a[192:207], v[72:75], v[136:139], a[192:207]
    s_add_u32 m0, s37, 135168
    s_mov_b32 s39, 2752512
    buffer_load_dwordx4 v19, s[16:19], s39 offen nt lds
    s_mov_b64 exec, 0xffffffff
    buffer_load_dword v8, v63, s[12:15], s45 offen
    s_mov_b64 exec, -1
    v_mfma_f32_32x32x16_bf16 a[208:223], v[76:79], v[136:139], a[208:223]
    s_add_u32 m0, s37, 139264
    s_mov_b32 s39, 2883584
    buffer_load_dwordx4 v19, s[16:19], s39 offen nt lds
    v_mfma_f32_32x32x16_bf16 a[224:239], v[72:75], v[140:143], a[224:239]
    s_add_u32 m0, s37, 143360
    s_mov_b32 s39, 3014656
    buffer_load_dwordx4 v19, s[16:19], s39 offen nt lds
    v_mfma_f32_32x32x16_bf16 a[240:255], v[76:79], v[140:143], a[240:255]
    s_waitcnt lgkmcnt(0)
    v_mfma_f32_32x32x16_bf16 a[0:15], v[80:83], v[64:67], a[0:15]
    v_add_u32 v15, 32768, v15
    ds_read_b128 v[72:75], v15 offset:32768
    ds_read_b128 v[76:79], v15 offset:36864
    ds_read_b64_tr_b16 v[112:113], v24 offset:4096
    v_mfma_f32_32x32x16_bf16 a[16:31], v[84:87], v[64:67], a[16:31]
    ds_read_b64_tr_b16 v[114:115], v24 offset:5120
    ds_read_b64_tr_b16 v[116:117], v25 offset:4096
    ds_read_b64_tr_b16 v[118:119], v25 offset:5120
    v_mfma_f32_32x32x16_bf16 a[32:47], v[88:91], v[64:67], a[32:47]
    ds_read_b64_tr_b16 v[120:121], v26 offset:4096
    ds_read_b64_tr_b16 v[122:123], v26 offset:5120
    ds_read_b64_tr_b16 v[124:125], v27 offset:4096
    v_mfma_f32_32x32x16_bf16 a[48:63], v[92:95], v[64:67], a[48:63]
    ds_read_b64_tr_b16 v[126:127], v27 offset:5120
    ds_read_b64_tr_b16 v[128:129], v24 offset:12288
    ds_read_b64_tr_b16 v[130:131], v24 offset:13312
    v_mfma_f32_32x32x16_bf16 a[64:79], v[80:83], v[68:71], a[64:79]
    ds_read_b64_tr_b16 v[132:133], v25 offset:12288
    ds_read_b64_tr_b16 v[134:135], v25 offset:13312
    ds_read_b64_tr_b16 v[136:137], v26 offset:12288
    v_mfma_f32_32x32x16_bf16 a[80:95], v[84:87], v[68:71], a[80:95]
    ds_read_b64_tr_b16 v[138:139], v26 offset:13312
    ds_read_b64_tr_b16 v[140:141], v27 offset:12288
    ds_read_b64_tr_b16 v[142:143], v27 offset:13312
    v_mfma_f32_32x32x16_bf16 a[96:111], v[88:91], v[68:71], a[96:111]
    v_mfma_f32_32x32x16_bf16 a[112:127], v[92:95], v[68:71], a[112:127]
    v_mfma_f32_32x32x16_bf16 a[128:143], v[64:67], v[96:99], a[128:143]
    v_mfma_f32_32x32x16_bf16 a[144:159], v[68:71], v[96:99], a[144:159]
    v_mfma_f32_32x32x16_bf16 a[160:175], v[64:67], v[100:103], a[160:175]
    v_mfma_f32_32x32x16_bf16 a[176:191], v[68:71], v[100:103], a[176:191]
    v_mfma_f32_32x32x16_bf16 a[192:207], v[64:67], v[104:107], a[192:207]
    v_mfma_f32_32x32x16_bf16 a[208:223], v[68:71], v[104:107], a[208:223]
    v_mfma_f32_32x32x16_bf16 a[224:239], v[64:67], v[108:111], a[224:239]
    v_mfma_f32_32x32x16_bf16 a[240:255], v[68:71], v[108:111], a[240:255]
    s_waitcnt lgkmcnt(0)
    v_mfma_f32_32x32x16_bf16 a[0:15], v[112:115], v[72:75], a[0:15]
    s_waitcnt vmcnt(27)
    s_barrier
    v_mfma_f32_32x32x16_bf16 a[16:31], v[116:119], v[72:75], a[16:31]
    ds_read_b64_tr_b16 v[28:29], v20 offset:0
    ds_read_b64_tr_b16 v[30:31], v20 offset:1024
    ds_read_b64_tr_b16 v[32:33], v21 offset:0
    v_mfma_f32_32x32x16_bf16 a[32:47], v[120:123], v[72:75], a[32:47]
    ds_read_b64_tr_b16 v[34:35], v21 offset:1024
    ds_read_b64_tr_b16 v[36:37], v22 offset:0
    ds_read_b64_tr_b16 v[38:39], v22 offset:1024
    s_nop 1
    v_accvgpr_read_b32 v192, a0
    v_accvgpr_read_b32 v193, a1
    v_accvgpr_read_b32 v194, a2
    v_mfma_f32_32x32x16_bf16 a[48:63], v[124:127], v[72:75], a[48:63]
    ds_read_b64_tr_b16 v[40:41], v23 offset:0
    ds_read_b64_tr_b16 v[42:43], v23 offset:1024
    v_accvgpr_read_b32 v195, a3
    v_accvgpr_read_b32 v196, a4
    v_accvgpr_read_b32 v197, a5
    v_accvgpr_read_b32 v198, a6
    v_mfma_f32_32x32x16_bf16 a[64:79], v[112:115], v[76:79], a[64:79]
    v_accvgpr_read_b32 v199, a7
    v_accvgpr_read_b32 v200, a8
    v_accvgpr_read_b32 v201, a9
    v_accvgpr_read_b32 v202, a10
    v_accvgpr_read_b32 v203, a11
    v_accvgpr_read_b32 v204, a12
    v_mfma_f32_32x32x16_bf16 a[80:95], v[116:119], v[76:79], a[80:95]
    v_accvgpr_read_b32 v205, a13
    v_accvgpr_read_b32 v206, a14
    v_accvgpr_read_b32 v207, a15
    v_mfma_f32_32x32x16_bf16 a[96:111], v[120:123], v[76:79], a[96:111]
    buffer_load_dwordx4 a[0:3], v5, s[12:15], s38 offen offset:0
    buffer_load_dwordx4 a[4:7], v5, s[12:15], s54 offen offset:0
    v_mfma_f32_32x32x16_bf16 a[112:127], v[124:127], v[76:79], a[112:127]
    s_add_u32 m0, s37, 65536
    s_mov_b32 s39, 3145728
    buffer_load_dwordx4 v19, s[16:19], s39 offen nt lds
    v_mfma_f32_32x32x16_bf16 a[128:143], v[72:75], v[128:131], a[128:143]
    s_add_u32 m0, s37, 69632
    s_mov_b32 s39, 3276800
    buffer_load_dwordx4 v19, s[16:19], s39 offen nt lds
    v_mfma_f32_32x32x16_bf16 a[144:159], v[76:79], v[128:131], a[144:159]
    s_add_u32 m0, s37, 73728
    s_mov_b32 s39, 3407872
    buffer_load_dwordx4 v19, s[16:19], s39 offen nt lds
    v_mfma_f32_32x32x16_bf16 a[160:175], v[72:75], v[132:135], a[160:175]
    s_add_u32 m0, s37, 77824
    s_mov_b32 s39, 3538944
    buffer_load_dwordx4 v19, s[16:19], s39 offen nt lds
    v_mfma_f32_32x32x16_bf16 a[176:191], v[76:79], v[132:135], a[176:191]
    s_add_u32 m0, s37, 81920
    s_mov_b32 s39, 3670016
    buffer_load_dwordx4 v19, s[16:19], s39 offen nt lds
    v_mfma_f32_32x32x16_bf16 a[192:207], v[72:75], v[136:139], a[192:207]
    s_add_u32 m0, s37, 86016
    s_mov_b32 s39, 3801088
    buffer_load_dwordx4 v19, s[16:19], s39 offen nt lds
    v_mfma_f32_32x32x16_bf16 a[208:223], v[76:79], v[136:139], a[208:223]
    s_add_u32 m0, s37, 90112
    s_mov_b32 s39, 3932160
    buffer_load_dwordx4 v19, s[16:19], s39 offen nt lds
    v_mfma_f32_32x32x16_bf16 a[224:239], v[72:75], v[140:143], a[224:239]
    s_add_u32 m0, s37, 94208
    s_mov_b32 s39, 4063232
    buffer_load_dwordx4 v19, s[16:19], s39 offen nt lds
    v_mfma_f32_32x32x16_bf16 a[240:255], v[76:79], v[140:143], a[240:255]
    buffer_load_dwordx4 a[8:11], v5, s[12:15], s38 offen offset:1024
    buffer_load_dwordx4 a[12:15], v5, s[12:15], s54 offen offset:1024
    v_cvt_pk_bf16_f32 v192, v192, v193
    v_cvt_pk_bf16_f32 v193, v194, v195
    s_waitcnt vmcnt(27) lgkmcnt(0)
    v_mfma_f32_32x32x16_bf16 v[64:79], v[28:31], v[224:227], 0
    ds_read_b64_tr_b16 v[44:45], v20 offset:4096
    ds_read_b64_tr_b16 v[46:47], v20 offset:5120
    ds_read_b64_tr_b16 v[48:49], v21 offset:4096
    v_cvt_pk_bf16_f32 v194, v196, v197
    v_cvt_pk_bf16_f32 v195, v198, v199
    v_mfma_f32_32x32x16_bf16 v[128:143], v[28:31], v[228:231], 0
    ds_read_b64_tr_b16 v[50:51], v21 offset:5120
    ds_read_b64_tr_b16 v[52:53], v22 offset:4096
    ds_read_b64_tr_b16 v[54:55], v22 offset:5120
    buffer_store_dwordx4 v[192:195], v17, s[20:23], s52 offen offset:0
    v_cvt_pk_bf16_f32 v200, v200, v201
    v_mfma_f32_32x32x16_bf16 v[80:95], v[32:35], v[224:227], 0
    ds_read_b64_tr_b16 v[56:57], v23 offset:4096
    ds_read_b64_tr_b16 v[58:59], v23 offset:5120
    v_cvt_pk_bf16_f32 v201, v202, v203
    v_cvt_pk_bf16_f32 v202, v204, v205
    v_cvt_pk_bf16_f32 v203, v206, v207
    v_mfma_f32_32x32x16_bf16 v[144:159], v[32:35], v[228:231], 0
    buffer_store_dwordx4 v[200:203], v17, s[20:23], s52 offen offset:1024
    v_accvgpr_read_b32 v208, a16
    v_accvgpr_read_b32 v209, a17
    v_accvgpr_read_b32 v210, a18
    v_accvgpr_read_b32 v211, a19
    v_mfma_f32_32x32x16_bf16 v[96:111], v[36:39], v[224:227], 0
    v_accvgpr_read_b32 v212, a20
    v_accvgpr_read_b32 v213, a21
    v_accvgpr_read_b32 v214, a22
    v_accvgpr_read_b32 v215, a23
    v_accvgpr_read_b32 v216, a24
    v_accvgpr_read_b32 v217, a25
    v_mfma_f32_32x32x16_bf16 v[160:175], v[36:39], v[228:231], 0
    v_accvgpr_read_b32 v218, a26
    v_accvgpr_read_b32 v219, a27
    v_accvgpr_read_b32 v220, a28
    v_accvgpr_read_b32 v221, a29
    v_accvgpr_read_b32 v222, a30
    v_accvgpr_read_b32 v223, a31
    v_mfma_f32_32x32x16_bf16 v[112:127], v[40:43], v[224:227], 0
    buffer_load_dwordx4 a[16:19], v5, s[12:15], s38 offen offset:2048
    buffer_load_dwordx4 a[20:23], v5, s[12:15], s54 offen offset:2048
    v_mfma_f32_32x32x16_bf16 v[176:191], v[40:43], v[228:231], 0
    buffer_load_dwordx4 a[24:27], v5, s[12:15], s38 offen offset:3072
    buffer_load_dwordx4 a[28:31], v5, s[12:15], s54 offen offset:3072
    s_add_u32 s38, s38, 4096
    s_add_u32 s54, s54, 4096
    v_cvt_pk_bf16_f32 v208, v208, v209
    s_waitcnt vmcnt(31) lgkmcnt(0)
    v_mfma_f32_32x32x16_bf16 v[64:79], v[44:47], v[232:235], v[64:79]
    ds_read_b64_tr_b16 v[28:29], v20 offset:8192
    ds_read_b64_tr_b16 v[30:31], v20 offset:9216
    ds_read_b64_tr_b16 v[32:33], v21 offset:8192
    v_cvt_pk_bf16_f32 v209, v210, v211
    v_cvt_pk_bf16_f32 v210, v212, v213
    v_cvt_pk_bf16_f32 v211, v214, v215
    v_mfma_f32_32x32x16_bf16 v[128:143], v[44:47], v[236:239], v[128:143]
    ds_read_b64_tr_b16 v[34:35], v21 offset:9216
    ds_read_b64_tr_b16 v[36:37], v22 offset:8192
    ds_read_b64_tr_b16 v[38:39], v22 offset:9216
    buffer_store_dwordx4 v[208:211], v17, s[20:23], s52 offen offset:2048
    v_cvt_pk_bf16_f32 v216, v216, v217
    v_mfma_f32_32x32x16_bf16 v[80:95], v[48:51], v[232:235], v[80:95]
    ds_read_b64_tr_b16 v[40:41], v23 offset:8192
    ds_read_b64_tr_b16 v[42:43], v23 offset:9216
    v_cvt_pk_bf16_f32 v217, v218, v219
    v_cvt_pk_bf16_f32 v218, v220, v221
    v_cvt_pk_bf16_f32 v219, v222, v223
    v_mfma_f32_32x32x16_bf16 v[144:159], v[48:51], v[236:239], v[144:159]
    buffer_store_dwordx4 v[216:219], v17, s[20:23], s52 offen offset:3072
    s_add_u32 s52, s52, 4096
    v_accvgpr_read_b32 v192, a32
    v_accvgpr_read_b32 v193, a33
    v_accvgpr_read_b32 v194, a34
    v_mfma_f32_32x32x16_bf16 v[96:111], v[52:55], v[232:235], v[96:111]
    v_accvgpr_read_b32 v195, a35
    v_accvgpr_read_b32 v196, a36
    v_accvgpr_read_b32 v197, a37
    v_accvgpr_read_b32 v198, a38
    v_accvgpr_read_b32 v199, a39
    v_accvgpr_read_b32 v200, a40
    v_mfma_f32_32x32x16_bf16 v[160:175], v[52:55], v[236:239], v[160:175]
    v_accvgpr_read_b32 v201, a41
    v_accvgpr_read_b32 v202, a42
    v_accvgpr_read_b32 v203, a43
    v_accvgpr_read_b32 v204, a44
    v_accvgpr_read_b32 v205, a45
    v_accvgpr_read_b32 v206, a46
    v_mfma_f32_32x32x16_bf16 v[112:127], v[56:59], v[232:235], v[112:127]
    v_accvgpr_read_b32 v207, a47
    buffer_load_dwordx4 a[32:35], v5, s[12:15], s38 offen offset:0
    buffer_load_dwordx4 a[36:39], v5, s[12:15], s54 offen offset:0
    v_mfma_f32_32x32x16_bf16 v[176:191], v[56:59], v[236:239], v[176:191]
    buffer_load_dwordx4 a[40:43], v5, s[12:15], s38 offen offset:1024
    buffer_load_dwordx4 a[44:47], v5, s[12:15], s54 offen offset:1024
    v_cvt_pk_bf16_f32 v192, v192, v193
    v_cvt_pk_bf16_f32 v193, v194, v195
    s_waitcnt vmcnt(35) lgkmcnt(0)
    v_mfma_f32_32x32x16_bf16 v[64:79], v[28:31], v[240:243], v[64:79]
    ds_read_b64_tr_b16 v[44:45], v20 offset:12288
    ds_read_b64_tr_b16 v[46:47], v20 offset:13312
    ds_read_b64_tr_b16 v[48:49], v21 offset:12288
    v_cvt_pk_bf16_f32 v194, v196, v197
    v_cvt_pk_bf16_f32 v195, v198, v199
    v_mfma_f32_32x32x16_bf16 v[128:143], v[28:31], v[244:247], v[128:143]
    ds_read_b64_tr_b16 v[50:51], v21 offset:13312
    ds_read_b64_tr_b16 v[52:53], v22 offset:12288
    ds_read_b64_tr_b16 v[54:55], v22 offset:13312
    buffer_store_dwordx4 v[192:195], v17, s[20:23], s52 offen offset:0
    v_cvt_pk_bf16_f32 v200, v200, v201
    v_mfma_f32_32x32x16_bf16 v[80:95], v[32:35], v[240:243], v[80:95]
    ds_read_b64_tr_b16 v[56:57], v23 offset:12288
    ds_read_b64_tr_b16 v[58:59], v23 offset:13312
    v_cvt_pk_bf16_f32 v201, v202, v203
    v_cvt_pk_bf16_f32 v202, v204, v205
    v_cvt_pk_bf16_f32 v203, v206, v207
    v_mfma_f32_32x32x16_bf16 v[144:159], v[32:35], v[244:247], v[144:159]
    buffer_store_dwordx4 v[200:203], v17, s[20:23], s52 offen offset:1024
    v_mfma_f32_32x32x16_bf16 v[96:111], v[36:39], v[240:243], v[96:111]
    v_accvgpr_read_b32 v208, a48
    v_accvgpr_read_b32 v209, a49
    v_accvgpr_read_b32 v210, a50
    v_accvgpr_read_b32 v211, a51
    v_accvgpr_read_b32 v212, a52
    v_accvgpr_read_b32 v213, a53
    v_mfma_f32_32x32x16_bf16 v[160:175], v[36:39], v[244:247], v[160:175]
    v_accvgpr_read_b32 v214, a54
    v_accvgpr_read_b32 v215, a55
    v_accvgpr_read_b32 v216, a56
    v_accvgpr_read_b32 v217, a57
    v_accvgpr_read_b32 v218, a58
    v_accvgpr_read_b32 v219, a59
    v_mfma_f32_32x32x16_bf16 v[112:127], v[40:43], v[240:243], v[112:127]
    v_accvgpr_read_b32 v220, a60
    v_accvgpr_read_b32 v221, a61
    v_accvgpr_read_b32 v222, a62
    v_accvgpr_read_b32 v223, a63
    v_mfma_f32_32x32x16_bf16 v[176:191], v[40:43], v[244:247], v[176:191]
    buffer_load_dwordx4 a[48:51], v5, s[12:15], s38 offen offset:2048
    buffer_load_dwordx4 a[52:55], v5, s[12:15], s54 offen offset:2048
    s_waitcnt vmcnt(37) lgkmcnt(0)
    v_mfma_f32_32x32x16_bf16 v[64:79], v[44:47], v[248:251], v[64:79]
    ds_read_b64_tr_b16 v[28:29], v20 offset:16384
    ds_read_b64_tr_b16 v[30:31], v20 offset:17408
    ds_read_b64_tr_b16 v[32:33], v21 offset:16384
    v_mfma_f32_32x32x16_bf16 v[128:143], v[44:47], v[252:255], v[128:143]
    ds_read_b64_tr_b16 v[34:35], v21 offset:17408
    ds_read_b64_tr_b16 v[36:37], v22 offset:16384
    ds_read_b64_tr_b16 v[38:39], v22 offset:17408
    v_mfma_f32_32x32x16_bf16 v[80:95], v[48:51], v[248:251], v[80:95]
    ds_read_b64_tr_b16 v[40:41], v23 offset:16384
    ds_read_b64_tr_b16 v[42:43], v23 offset:17408
    v_mfma_f32_32x32x16_bf16 v[144:159], v[48:51], v[252:255], v[144:159]
    buffer_load_dwordx4 a[56:59], v5, s[12:15], s38 offen offset:3072
    buffer_load_dwordx4 a[60:63], v5, s[12:15], s54 offen offset:3072
    s_add_u32 s38, s38, 4096
    s_add_u32 s54, s54, 4096
    v_cvt_pk_bf16_f32 v208, v208, v209
    v_mfma_f32_32x32x16_bf16 v[96:111], v[52:55], v[248:251], v[96:111]
    v_cvt_pk_bf16_f32 v209, v210, v211
    v_cvt_pk_bf16_f32 v210, v212, v213
    v_cvt_pk_bf16_f32 v211, v214, v215
    buffer_store_dwordx4 v[208:211], v17, s[20:23], s52 offen offset:2048
    v_cvt_pk_bf16_f32 v216, v216, v217
    v_mfma_f32_32x32x16_bf16 v[160:175], v[52:55], v[252:255], v[160:175]
    v_cvt_pk_bf16_f32 v217, v218, v219
    v_cvt_pk_bf16_f32 v218, v220, v221
    v_cvt_pk_bf16_f32 v219, v222, v223
    buffer_store_dwordx4 v[216:219], v17, s[20:23], s52 offen offset:3072
    s_add_u32 s52, s52, 4096
    v_mfma_f32_32x32x16_bf16 v[112:127], v[56:59], v[248:251], v[112:127]
    v_mfma_f32_32x32x16_bf16 v[176:191], v[56:59], v[252:255], v[176:191]
    s_waitcnt vmcnt(30) lgkmcnt(0)
    v_mfma_f32_32x32x16_bf16 v[64:79], v[28:31], a[0:3], v[64:79]
    ds_read_b64_tr_b16 v[44:45], v20 offset:20480
    ds_read_b64_tr_b16 v[46:47], v20 offset:21504
    ds_read_b64_tr_b16 v[48:49], v21 offset:20480
    v_accvgpr_read_b32 v192, a64
    v_accvgpr_read_b32 v193, a65
    v_accvgpr_read_b32 v194, a66
    v_mfma_f32_32x32x16_bf16 v[128:143], v[28:31], a[4:7], v[128:143]
    ds_read_b64_tr_b16 v[50:51], v21 offset:21504
    ds_read_b64_tr_b16 v[52:53], v22 offset:20480
    ds_read_b64_tr_b16 v[54:55], v22 offset:21504
    v_accvgpr_read_b32 v195, a67
    v_accvgpr_read_b32 v196, a68
    v_accvgpr_read_b32 v197, a69
    v_mfma_f32_32x32x16_bf16 v[80:95], v[32:35], a[0:3], v[80:95]
    ds_read_b64_tr_b16 v[56:57], v23 offset:20480
    ds_read_b64_tr_b16 v[58:59], v23 offset:21504
    v_accvgpr_read_b32 v198, a70
    v_accvgpr_read_b32 v199, a71
    v_accvgpr_read_b32 v200, a72
    v_accvgpr_read_b32 v201, a73
    v_mfma_f32_32x32x16_bf16 v[144:159], v[32:35], a[4:7], v[144:159]
    v_accvgpr_read_b32 v202, a74
    v_accvgpr_read_b32 v203, a75
    v_accvgpr_read_b32 v204, a76
    v_accvgpr_read_b32 v205, a77
    v_accvgpr_read_b32 v206, a78
    v_accvgpr_read_b32 v207, a79
    v_mfma_f32_32x32x16_bf16 v[96:111], v[36:39], a[0:3], v[96:111]
    buffer_load_dwordx4 a[64:67], v5, s[12:15], s38 offen offset:0
    buffer_load_dwordx4 a[68:71], v5, s[12:15], s54 offen offset:0
    v_mfma_f32_32x32x16_bf16 v[160:175], v[36:39], a[4:7], v[160:175]
    buffer_load_dwordx4 a[72:75], v5, s[12:15], s38 offen offset:1024
    buffer_load_dwordx4 a[76:79], v5, s[12:15], s54 offen offset:1024
    v_cvt_pk_bf16_f32 v192, v192, v193
    v_cvt_pk_bf16_f32 v193, v194, v195
    v_mfma_f32_32x32x16_bf16 v[112:127], v[40:43], a[0:3], v[112:127]
    v_cvt_pk_bf16_f32 v194, v196, v197
    v_cvt_pk_bf16_f32 v195, v198, v199
    buffer_store_dwordx4 v[192:195], v17, s[20:23], s52 offen offset:0
    v_cvt_pk_bf16_f32 v200, v200, v201
    v_cvt_pk_bf16_f32 v201, v202, v203
    v_mfma_f32_32x32x16_bf16 v[176:191], v[40:43], a[4:7], v[176:191]
    v_cvt_pk_bf16_f32 v202, v204, v205
    v_cvt_pk_bf16_f32 v203, v206, v207
    buffer_store_dwordx4 v[200:203], v17, s[20:23], s52 offen offset:1024
    s_waitcnt vmcnt(26) lgkmcnt(0)
    v_mfma_f32_32x32x16_bf16 v[64:79], v[44:47], a[8:11], v[64:79]
    ds_read_b64_tr_b16 v[28:29], v20 offset:24576
    ds_read_b64_tr_b16 v[30:31], v20 offset:25600
    ds_read_b64_tr_b16 v[32:33], v21 offset:24576
    v_mfma_f32_32x32x16_bf16 v[128:143], v[44:47], a[12:15], v[128:143]
    ds_read_b64_tr_b16 v[34:35], v21 offset:25600
    ds_read_b64_tr_b16 v[36:37], v22 offset:24576
    ds_read_b64_tr_b16 v[38:39], v22 offset:25600
    v_mfma_f32_32x32x16_bf16 v[80:95], v[48:51], a[8:11], v[80:95]
    ds_read_b64_tr_b16 v[40:41], v23 offset:24576
    ds_read_b64_tr_b16 v[42:43], v23 offset:25600
    v_mfma_f32_32x32x16_bf16 v[144:159], v[48:51], a[12:15], v[144:159]
    v_mfma_f32_32x32x16_bf16 v[96:111], v[52:55], a[8:11], v[96:111]
    v_accvgpr_read_b32 v208, a80
    v_accvgpr_read_b32 v209, a81
    v_accvgpr_read_b32 v210, a82
    v_accvgpr_read_b32 v211, a83
    v_accvgpr_read_b32 v212, a84
    v_accvgpr_read_b32 v213, a85
    v_mfma_f32_32x32x16_bf16 v[160:175], v[52:55], a[12:15], v[160:175]
    v_accvgpr_read_b32 v214, a86
    v_accvgpr_read_b32 v215, a87
    v_accvgpr_read_b32 v216, a88
    v_accvgpr_read_b32 v217, a89
    v_accvgpr_read_b32 v218, a90
    v_accvgpr_read_b32 v219, a91
    v_mfma_f32_32x32x16_bf16 v[112:127], v[56:59], a[8:11], v[112:127]
    v_accvgpr_read_b32 v220, a92
    v_accvgpr_read_b32 v221, a93
    v_accvgpr_read_b32 v222, a94
    v_accvgpr_read_b32 v223, a95
    v_mfma_f32_32x32x16_bf16 v[176:191], v[56:59], a[12:15], v[176:191]
    buffer_load_dwordx4 a[80:83], v5, s[12:15], s38 offen offset:2048
    buffer_load_dwordx4 a[84:87], v5, s[12:15], s54 offen offset:2048
    s_waitcnt vmcnt(24) lgkmcnt(0)
    v_mfma_f32_32x32x16_bf16 v[64:79], v[28:31], a[16:19], v[64:79]
    ds_read_b64_tr_b16 v[44:45], v20 offset:28672
    ds_read_b64_tr_b16 v[46:47], v20 offset:29696
    ds_read_b64_tr_b16 v[48:49], v21 offset:28672
    v_mfma_f32_32x32x16_bf16 v[128:143], v[28:31], a[20:23], v[128:143]
    ds_read_b64_tr_b16 v[50:51], v21 offset:29696
    ds_read_b64_tr_b16 v[52:53], v22 offset:28672
    ds_read_b64_tr_b16 v[54:55], v22 offset:29696
    v_mfma_f32_32x32x16_bf16 v[80:95], v[32:35], a[16:19], v[80:95]
    ds_read_b64_tr_b16 v[56:57], v23 offset:28672
    ds_read_b64_tr_b16 v[58:59], v23 offset:29696
    v_mfma_f32_32x32x16_bf16 v[144:159], v[32:35], a[20:23], v[144:159]
    buffer_load_dwordx4 a[88:91], v5, s[12:15], s38 offen offset:3072
    buffer_load_dwordx4 a[92:95], v5, s[12:15], s54 offen offset:3072
    s_add_u32 s38, s38, 4096
    s_add_u32 s54, s54, 4096
    v_cvt_pk_bf16_f32 v208, v208, v209
    v_mfma_f32_32x32x16_bf16 v[96:111], v[36:39], a[16:19], v[96:111]
    v_cvt_pk_bf16_f32 v209, v210, v211
    v_cvt_pk_bf16_f32 v210, v212, v213
    v_cvt_pk_bf16_f32 v211, v214, v215
    buffer_store_dwordx4 v[208:211], v17, s[20:23], s52 offen offset:2048
    v_cvt_pk_bf16_f32 v216, v216, v217
    v_mfma_f32_32x32x16_bf16 v[160:175], v[36:39], a[20:23], v[160:175]
    v_cvt_pk_bf16_f32 v217, v218, v219
    v_cvt_pk_bf16_f32 v218, v220, v221
    v_cvt_pk_bf16_f32 v219, v222, v223
    buffer_store_dwordx4 v[216:219], v17, s[20:23], s52 offen offset:3072
    s_add_u32 s52, s52, 4096
    v_mfma_f32_32x32x16_bf16 v[112:127], v[40:43], a[16:19], v[112:127]
    v_mfma_f32_32x32x16_bf16 v[176:191], v[40:43], a[20:23], v[176:191]
    s_waitcnt vmcnt(26) lgkmcnt(0)
    v_mfma_f32_32x32x16_bf16 v[64:79], v[44:47], a[24:27], v[64:79]
    s_barrier
    v_accvgpr_read_b32 v192, a96
    v_accvgpr_read_b32 v193, a97
    v_accvgpr_read_b32 v194, a98
    v_accvgpr_read_b32 v195, a99
    v_mfma_f32_32x32x16_bf16 v[128:143], v[44:47], a[28:31], v[128:143]
    ds_read_b64_tr_b16 v[28:29], v20 offset:32768
    ds_read_b64_tr_b16 v[30:31], v20 offset:33792
    ds_read_b64_tr_b16 v[32:33], v21 offset:32768
    v_accvgpr_read_b32 v196, a100
    v_accvgpr_read_b32 v197, a101
    v_accvgpr_read_b32 v198, a102
    v_mfma_f32_32x32x16_bf16 v[80:95], v[48:51], a[24:27], v[80:95]
    ds_read_b64_tr_b16 v[34:35], v21 offset:33792
    ds_read_b64_tr_b16 v[36:37], v22 offset:32768
    ds_read_b64_tr_b16 v[38:39], v22 offset:33792
    v_accvgpr_read_b32 v199, a103
    v_accvgpr_read_b32 v200, a104
    v_accvgpr_read_b32 v201, a105
    v_mfma_f32_32x32x16_bf16 v[144:159], v[48:51], a[28:31], v[144:159]
    ds_read_b64_tr_b16 v[40:41], v23 offset:32768
    ds_read_b64_tr_b16 v[42:43], v23 offset:33792
    v_accvgpr_read_b32 v202, a106
    v_accvgpr_read_b32 v203, a107
    v_accvgpr_read_b32 v204, a108
    v_accvgpr_read_b32 v205, a109
    v_mfma_f32_32x32x16_bf16 v[96:111], v[52:55], a[24:27], v[96:111]
    v_accvgpr_read_b32 v206, a110
    v_accvgpr_read_b32 v207, a111
    buffer_load_dwordx4 a[96:99], v5, s[12:15], s38 offen offset:0
    buffer_load_dwordx4 a[100:103], v5, s[12:15], s54 offen offset:0
    v_mfma_f32_32x32x16_bf16 v[160:175], v[52:55], a[28:31], v[160:175]
    buffer_load_dwordx4 a[104:107], v5, s[12:15], s38 offen offset:1024
    buffer_load_dwordx4 a[108:111], v5, s[12:15], s54 offen offset:1024
    v_cvt_pk_bf16_f32 v192, v192, v193
    v_cvt_pk_bf16_f32 v193, v194, v195
    v_mfma_f32_32x32x16_bf16 v[112:127], v[56:59], a[24:27], v[112:127]
    v_cvt_pk_bf16_f32 v194, v196, v197
    v_cvt_pk_bf16_f32 v195, v198, v199
    buffer_store_dwordx4 v[192:195], v17, s[20:23], s52 offen offset:0
    v_cvt_pk_bf16_f32 v200, v200, v201
    v_cvt_pk_bf16_f32 v201, v202, v203
    v_mfma_f32_32x32x16_bf16 v[176:191], v[56:59], a[28:31], v[176:191]
    v_cvt_pk_bf16_f32 v202, v204, v205
    v_cvt_pk_bf16_f32 v203, v206, v207
    buffer_store_dwordx4 v[200:203], v17, s[20:23], s52 offen offset:1024
    s_waitcnt vmcnt(28) lgkmcnt(0)
    v_mfma_f32_32x32x16_bf16 v[64:79], v[28:31], a[32:35], v[64:79]
    ds_read_b64_tr_b16 v[44:45], v20 offset:36864
    ds_read_b64_tr_b16 v[46:47], v20 offset:37888
    ds_read_b64_tr_b16 v[48:49], v21 offset:36864
    v_mfma_f32_32x32x16_bf16 v[128:143], v[28:31], a[36:39], v[128:143]
    ds_read_b64_tr_b16 v[50:51], v21 offset:37888
    ds_read_b64_tr_b16 v[52:53], v22 offset:36864
    ds_read_b64_tr_b16 v[54:55], v22 offset:37888
    v_mfma_f32_32x32x16_bf16 v[80:95], v[32:35], a[32:35], v[80:95]
    ds_read_b64_tr_b16 v[56:57], v23 offset:36864
    ds_read_b64_tr_b16 v[58:59], v23 offset:37888
    v_mfma_f32_32x32x16_bf16 v[144:159], v[32:35], a[36:39], v[144:159]
    v_mfma_f32_32x32x16_bf16 v[96:111], v[36:39], a[32:35], v[96:111]
    v_accvgpr_read_b32 v208, a112
    v_accvgpr_read_b32 v209, a113
    v_accvgpr_read_b32 v210, a114
    v_accvgpr_read_b32 v211, a115
    v_accvgpr_read_b32 v212, a116
    v_accvgpr_read_b32 v213, a117
    v_mfma_f32_32x32x16_bf16 v[160:175], v[36:39], a[36:39], v[160:175]
    v_accvgpr_read_b32 v214, a118
    v_accvgpr_read_b32 v215, a119
    v_accvgpr_read_b32 v216, a120
    v_accvgpr_read_b32 v217, a121
    v_accvgpr_read_b32 v218, a122
    v_accvgpr_read_b32 v219, a123
    v_mfma_f32_32x32x16_bf16 v[112:127], v[40:43], a[32:35], v[112:127]
    v_accvgpr_read_b32 v220, a124
    v_accvgpr_read_b32 v221, a125
    v_accvgpr_read_b32 v222, a126
    v_accvgpr_read_b32 v223, a127
    v_mfma_f32_32x32x16_bf16 v[176:191], v[40:43], a[36:39], v[176:191]
    buffer_load_dwordx4 a[112:115], v5, s[12:15], s38 offen offset:2048
    buffer_load_dwordx4 a[116:119], v5, s[12:15], s54 offen offset:2048
    s_waitcnt vmcnt(28) lgkmcnt(0)
    v_mfma_f32_32x32x16_bf16 v[64:79], v[44:47], a[40:43], v[64:79]
    ds_read_b64_tr_b16 v[28:29], v20 offset:40960
    ds_read_b64_tr_b16 v[30:31], v20 offset:41984
    ds_read_b64_tr_b16 v[32:33], v21 offset:40960
    v_mfma_f32_32x32x16_bf16 v[128:143], v[44:47], a[44:47], v[128:143]
    ds_read_b64_tr_b16 v[34:35], v21 offset:41984
    ds_read_b64_tr_b16 v[36:37], v22 offset:40960
    ds_read_b64_tr_b16 v[38:39], v22 offset:41984
    v_mfma_f32_32x32x16_bf16 v[80:95], v[48:51], a[40:43], v[80:95]
    ds_read_b64_tr_b16 v[40:41], v23 offset:40960
    ds_read_b64_tr_b16 v[42:43], v23 offset:41984
    v_mfma_f32_32x32x16_bf16 v[144:159], v[48:51], a[44:47], v[144:159]
    buffer_load_dwordx4 a[120:123], v5, s[12:15], s38 offen offset:3072
    buffer_load_dwordx4 a[124:127], v5, s[12:15], s54 offen offset:3072
    s_add_u32 s38, s38, 4096
    s_add_u32 s54, s54, 4096
    v_cvt_pk_bf16_f32 v208, v208, v209
    v_mfma_f32_32x32x16_bf16 v[96:111], v[52:55], a[40:43], v[96:111]
    v_cvt_pk_bf16_f32 v209, v210, v211
    v_cvt_pk_bf16_f32 v210, v212, v213
    v_cvt_pk_bf16_f32 v211, v214, v215
    buffer_store_dwordx4 v[208:211], v17, s[20:23], s52 offen offset:2048
    v_cvt_pk_bf16_f32 v216, v216, v217
    v_mfma_f32_32x32x16_bf16 v[160:175], v[52:55], a[44:47], v[160:175]
    v_cvt_pk_bf16_f32 v217, v218, v219
    v_cvt_pk_bf16_f32 v218, v220, v221
    v_cvt_pk_bf16_f32 v219, v222, v223
    buffer_store_dwordx4 v[216:219], v17, s[20:23], s52 offen offset:3072
    s_add_u32 s52, s52, 4096
    v_mfma_f32_32x32x16_bf16 v[112:127], v[56:59], a[40:43], v[112:127]
    v_mfma_f32_32x32x16_bf16 v[176:191], v[56:59], a[44:47], v[176:191]
    s_waitcnt vmcnt(28) lgkmcnt(0)
    v_mfma_f32_32x32x16_bf16 v[64:79], v[28:31], a[48:51], v[64:79]
    ds_read_b64_tr_b16 v[44:45], v20 offset:45056
    ds_read_b64_tr_b16 v[46:47], v20 offset:46080
    ds_read_b64_tr_b16 v[48:49], v21 offset:45056
    v_accvgpr_read_b32 v192, a128
    v_accvgpr_read_b32 v193, a129
    v_accvgpr_read_b32 v194, a130
    v_mfma_f32_32x32x16_bf16 v[128:143], v[28:31], a[52:55], v[128:143]
    ds_read_b64_tr_b16 v[50:51], v21 offset:46080
    ds_read_b64_tr_b16 v[52:53], v22 offset:45056
    ds_read_b64_tr_b16 v[54:55], v22 offset:46080
    v_accvgpr_read_b32 v195, a131
    v_accvgpr_read_b32 v196, a132
    v_accvgpr_read_b32 v197, a133
    v_mfma_f32_32x32x16_bf16 v[80:95], v[32:35], a[48:51], v[80:95]
    ds_read_b64_tr_b16 v[56:57], v23 offset:45056
    ds_read_b64_tr_b16 v[58:59], v23 offset:46080
    v_accvgpr_read_b32 v198, a134
    v_accvgpr_read_b32 v199, a135
    v_accvgpr_read_b32 v200, a136
    v_accvgpr_read_b32 v201, a137
    v_mfma_f32_32x32x16_bf16 v[144:159], v[32:35], a[52:55], v[144:159]
    v_accvgpr_read_b32 v202, a138
    v_accvgpr_read_b32 v203, a139
    v_accvgpr_read_b32 v204, a140
    v_accvgpr_read_b32 v205, a141
    v_accvgpr_read_b32 v206, a142
    v_accvgpr_read_b32 v207, a143
    v_mfma_f32_32x32x16_bf16 v[96:111], v[36:39], a[48:51], v[96:111]
    buffer_load_dwordx4 a[128:131], v5, s[12:15], s38 offen offset:0
    buffer_load_dwordx4 a[132:135], v5, s[12:15], s54 offen offset:0
    v_mfma_f32_32x32x16_bf16 v[160:175], v[36:39], a[52:55], v[160:175]
    buffer_load_dwordx4 a[136:139], v5, s[12:15], s38 offen offset:1024
    buffer_load_dwordx4 a[140:143], v5, s[12:15], s54 offen offset:1024
    v_cvt_pk_bf16_f32 v192, v192, v193
    v_cvt_pk_bf16_f32 v193, v194, v195
    v_mfma_f32_32x32x16_bf16 v[112:127], v[40:43], a[48:51], v[112:127]
    v_cvt_pk_bf16_f32 v194, v196, v197
    v_cvt_pk_bf16_f32 v195, v198, v199
    buffer_store_dwordx4 v[192:195], v7, s[24:27], s53 offen offset:0
    v_cvt_pk_bf16_f32 v200, v200, v201
    v_cvt_pk_bf16_f32 v201, v202, v203
    v_mfma_f32_32x32x16_bf16 v[176:191], v[40:43], a[52:55], v[176:191]
    v_cvt_pk_bf16_f32 v202, v204, v205
    v_cvt_pk_bf16_f32 v203, v206, v207
    buffer_store_dwordx4 v[200:203], v7, s[24:27], s53 offen offset:1024
    s_waitcnt vmcnt(32) lgkmcnt(0)
    v_mfma_f32_32x32x16_bf16 v[64:79], v[44:47], a[56:59], v[64:79]
    ds_read_b64_tr_b16 v[28:29], v20 offset:49152
    ds_read_b64_tr_b16 v[30:31], v20 offset:50176
    ds_read_b64_tr_b16 v[32:33], v21 offset:49152
    v_mfma_f32_32x32x16_bf16 v[128:143], v[44:47], a[60:63], v[128:143]
    ds_read_b64_tr_b16 v[34:35], v21 offset:50176
    ds_read_b64_tr_b16 v[36:37], v22 offset:49152
    ds_read_b64_tr_b16 v[38:39], v22 offset:50176
    v_mfma_f32_32x32x16_bf16 v[80:95], v[48:51], a[56:59], v[80:95]
    ds_read_b64_tr_b16 v[40:41], v23 offset:49152
    ds_read_b64_tr_b16 v[42:43], v23 offset:50176
    v_mfma_f32_32x32x16_bf16 v[144:159], v[48:51], a[60:63], v[144:159]
    v_mfma_f32_32x32x16_bf16 v[96:111], v[52:55], a[56:59], v[96:111]
    v_accvgpr_read_b32 v208, a144
    v_accvgpr_read_b32 v209, a145
    v_accvgpr_read_b32 v210, a146
    v_accvgpr_read_b32 v211, a147
    v_accvgpr_read_b32 v212, a148
    v_accvgpr_read_b32 v213, a149
    v_mfma_f32_32x32x16_bf16 v[160:175], v[52:55], a[60:63], v[160:175]
    v_accvgpr_read_b32 v214, a150
    v_accvgpr_read_b32 v215, a151
    v_accvgpr_read_b32 v216, a152
    v_accvgpr_read_b32 v217, a153
    v_accvgpr_read_b32 v218, a154
    v_accvgpr_read_b32 v219, a155
    v_mfma_f32_32x32x16_bf16 v[112:127], v[56:59], a[56:59], v[112:127]
    v_accvgpr_read_b32 v220, a156
    v_accvgpr_read_b32 v221, a157
    v_accvgpr_read_b32 v222, a158
    v_accvgpr_read_b32 v223, a159
    v_mfma_f32_32x32x16_bf16 v[176:191], v[56:59], a[60:63], v[176:191]
    buffer_load_dwordx4 a[144:147], v5, s[12:15], s38 offen offset:2048
    buffer_load_dwordx4 a[148:151], v5, s[12:15], s54 offen offset:2048
    s_waitcnt vmcnt(30) lgkmcnt(0)
    v_mfma_f32_32x32x16_bf16 v[64:79], v[28:31], a[64:67], v[64:79]
    ds_read_b64_tr_b16 v[44:45], v20 offset:53248
    ds_read_b64_tr_b16 v[46:47], v20 offset:54272
    ds_read_b64_tr_b16 v[48:49], v21 offset:53248
    v_mfma_f32_32x32x16_bf16 v[128:143], v[28:31], a[68:71], v[128:143]
    ds_read_b64_tr_b16 v[50:51], v21 offset:54272
    ds_read_b64_tr_b16 v[52:53], v22 offset:53248
    ds_read_b64_tr_b16 v[54:55], v22 offset:54272
    v_mfma_f32_32x32x16_bf16 v[80:95], v[32:35], a[64:67], v[80:95]
    ds_read_b64_tr_b16 v[56:57], v23 offset:53248
    ds_read_b64_tr_b16 v[58:59], v23 offset:54272
    v_mfma_f32_32x32x16_bf16 v[144:159], v[32:35], a[68:71], v[144:159]
    buffer_load_dwordx4 a[152:155], v5, s[12:15], s38 offen offset:3072
    buffer_load_dwordx4 a[156:159], v5, s[12:15], s54 offen offset:3072
    s_add_u32 s38, s38, 4096
    s_add_u32 s54, s54, 4096
    v_cvt_pk_bf16_f32 v208, v208, v209
    v_mfma_f32_32x32x16_bf16 v[96:111], v[36:39], a[64:67], v[96:111]
    v_cvt_pk_bf16_f32 v209, v210, v211
    v_cvt_pk_bf16_f32 v210, v212, v213
    v_cvt_pk_bf16_f32 v211, v214, v215
    buffer_store_dwordx4 v[208:211], v7, s[24:27], s53 offen offset:2048
    v_cvt_pk_bf16_f32 v216, v216, v217
    v_mfma_f32_32x32x16_bf16 v[160:175], v[36:39], a[68:71], v[160:175]
    v_cvt_pk_bf16_f32 v217, v218, v219
    v_cvt_pk_bf16_f32 v218, v220, v221
    v_cvt_pk_bf16_f32 v219, v222, v223
    buffer_store_dwordx4 v[216:219], v7, s[24:27], s53 offen offset:3072
    s_add_u32 s53, s53, 4096
    v_mfma_f32_32x32x16_bf16 v[112:127], v[40:43], a[64:67], v[112:127]
    v_mfma_f32_32x32x16_bf16 v[176:191], v[40:43], a[68:71], v[176:191]
    s_waitcnt vmcnt(32) lgkmcnt(0)
    v_mfma_f32_32x32x16_bf16 v[64:79], v[44:47], a[72:75], v[64:79]
    ds_read_b64_tr_b16 v[28:29], v20 offset:57344
    ds_read_b64_tr_b16 v[30:31], v20 offset:58368
    ds_read_b64_tr_b16 v[32:33], v21 offset:57344
    v_accvgpr_read_b32 v192, a160
    v_accvgpr_read_b32 v193, a161
    v_accvgpr_read_b32 v194, a162
    v_mfma_f32_32x32x16_bf16 v[128:143], v[44:47], a[76:79], v[128:143]
    ds_read_b64_tr_b16 v[34:35], v21 offset:58368
    ds_read_b64_tr_b16 v[36:37], v22 offset:57344
    ds_read_b64_tr_b16 v[38:39], v22 offset:58368
    v_accvgpr_read_b32 v195, a163
    v_accvgpr_read_b32 v196, a164
    v_accvgpr_read_b32 v197, a165
    v_mfma_f32_32x32x16_bf16 v[80:95], v[48:51], a[72:75], v[80:95]
    ds_read_b64_tr_b16 v[40:41], v23 offset:57344
    ds_read_b64_tr_b16 v[42:43], v23 offset:58368
    v_accvgpr_read_b32 v198, a166
    v_accvgpr_read_b32 v199, a167
    v_accvgpr_read_b32 v200, a168
    v_accvgpr_read_b32 v201, a169
    v_mfma_f32_32x32x16_bf16 v[144:159], v[48:51], a[76:79], v[144:159]
    v_accvgpr_read_b32 v202, a170
    v_accvgpr_read_b32 v203, a171
    v_accvgpr_read_b32 v204, a172
    v_accvgpr_read_b32 v205, a173
    v_accvgpr_read_b32 v206, a174
    v_accvgpr_read_b32 v207, a175
    v_mfma_f32_32x32x16_bf16 v[96:111], v[52:55], a[72:75], v[96:111]
    buffer_load_dwordx4 a[160:163], v5, s[12:15], s38 offen offset:0
    buffer_load_dwordx4 a[164:167], v5, s[12:15], s54 offen offset:0
    v_mfma_f32_32x32x16_bf16 v[160:175], v[52:55], a[76:79], v[160:175]
    buffer_load_dwordx4 a[168:171], v5, s[12:15], s38 offen offset:1024
    buffer_load_dwordx4 a[172:175], v5, s[12:15], s54 offen offset:1024
    v_cvt_pk_bf16_f32 v192, v192, v193
    v_cvt_pk_bf16_f32 v193, v194, v195
    v_mfma_f32_32x32x16_bf16 v[112:127], v[56:59], a[72:75], v[112:127]
    v_cvt_pk_bf16_f32 v194, v196, v197
    v_cvt_pk_bf16_f32 v195, v198, v199
    buffer_store_dwordx4 v[192:195], v7, s[24:27], s53 offen offset:0
    v_cvt_pk_bf16_f32 v200, v200, v201
    v_cvt_pk_bf16_f32 v201, v202, v203
    v_mfma_f32_32x32x16_bf16 v[176:191], v[56:59], a[76:79], v[176:191]
    v_cvt_pk_bf16_f32 v202, v204, v205
    v_cvt_pk_bf16_f32 v203, v206, v207
    buffer_store_dwordx4 v[200:203], v7, s[24:27], s53 offen offset:1024
    s_waitcnt vmcnt(34) lgkmcnt(0)
    v_mfma_f32_32x32x16_bf16 v[64:79], v[28:31], a[80:83], v[64:79]
    ds_read_b64_tr_b16 v[44:45], v20 offset:61440
    ds_read_b64_tr_b16 v[46:47], v20 offset:62464
    ds_read_b64_tr_b16 v[48:49], v21 offset:61440
    v_mfma_f32_32x32x16_bf16 v[128:143], v[28:31], a[84:87], v[128:143]
    ds_read_b64_tr_b16 v[50:51], v21 offset:62464
    ds_read_b64_tr_b16 v[52:53], v22 offset:61440
    ds_read_b64_tr_b16 v[54:55], v22 offset:62464
    v_mfma_f32_32x32x16_bf16 v[80:95], v[32:35], a[80:83], v[80:95]
    ds_read_b64_tr_b16 v[56:57], v23 offset:61440
    ds_read_b64_tr_b16 v[58:59], v23 offset:62464
    v_mfma_f32_32x32x16_bf16 v[144:159], v[32:35], a[84:87], v[144:159]
    v_mfma_f32_32x32x16_bf16 v[96:111], v[36:39], a[80:83], v[96:111]
    v_accvgpr_read_b32 v208, a176
    v_accvgpr_read_b32 v209, a177
    v_accvgpr_read_b32 v210, a178
    v_accvgpr_read_b32 v211, a179
    v_accvgpr_read_b32 v212, a180
    v_accvgpr_read_b32 v213, a181
    v_mfma_f32_32x32x16_bf16 v[160:175], v[36:39], a[84:87], v[160:175]
    v_accvgpr_read_b32 v214, a182
    v_accvgpr_read_b32 v215, a183
    v_accvgpr_read_b32 v216, a184
    v_accvgpr_read_b32 v217, a185
    v_accvgpr_read_b32 v218, a186
    v_accvgpr_read_b32 v219, a187
    v_mfma_f32_32x32x16_bf16 v[112:127], v[40:43], a[80:83], v[112:127]
    v_accvgpr_read_b32 v220, a188
    v_accvgpr_read_b32 v221, a189
    v_accvgpr_read_b32 v222, a190
    v_accvgpr_read_b32 v223, a191
    v_mfma_f32_32x32x16_bf16 v[176:191], v[40:43], a[84:87], v[176:191]
    buffer_load_dwordx4 a[176:179], v5, s[12:15], s38 offen offset:2048
    buffer_load_dwordx4 a[180:183], v5, s[12:15], s54 offen offset:2048
    s_waitcnt vmcnt(34) lgkmcnt(0)
    v_mfma_f32_32x32x16_bf16 v[64:79], v[44:47], a[88:91], v[64:79]
    s_barrier
    v_mfma_f32_32x32x16_bf16 v[128:143], v[44:47], a[92:95], v[128:143]
    ds_read_b64_tr_b16 v[28:29], v24 offset:16384
    ds_read_b64_tr_b16 v[30:31], v24 offset:17408
    ds_read_b64_tr_b16 v[32:33], v25 offset:16384
    v_mfma_f32_32x32x16_bf16 v[80:95], v[48:51], a[88:91], v[80:95]
    ds_read_b64_tr_b16 v[34:35], v25 offset:17408
    ds_read_b64_tr_b16 v[36:37], v26 offset:16384
    ds_read_b64_tr_b16 v[38:39], v26 offset:17408
    v_mfma_f32_32x32x16_bf16 v[144:159], v[48:51], a[92:95], v[144:159]
    ds_read_b64_tr_b16 v[40:41], v27 offset:16384
    ds_read_b64_tr_b16 v[42:43], v27 offset:17408
    v_mfma_f32_32x32x16_bf16 v[96:111], v[52:55], a[88:91], v[96:111]
    buffer_load_dwordx4 a[184:187], v5, s[12:15], s38 offen offset:3072
    buffer_load_dwordx4 a[188:191], v5, s[12:15], s54 offen offset:3072
    s_add_u32 s38, s38, 4096
    s_add_u32 s54, s54, 4096
    v_cvt_pk_bf16_f32 v208, v208, v209
    v_mfma_f32_32x32x16_bf16 v[160:175], v[52:55], a[92:95], v[160:175]
    v_cvt_pk_bf16_f32 v209, v210, v211
    v_cvt_pk_bf16_f32 v210, v212, v213
    v_cvt_pk_bf16_f32 v211, v214, v215
    buffer_store_dwordx4 v[208:211], v7, s[24:27], s53 offen offset:2048
    v_cvt_pk_bf16_f32 v216, v216, v217
    v_mfma_f32_32x32x16_bf16 v[112:127], v[56:59], a[88:91], v[112:127]
    v_cvt_pk_bf16_f32 v217, v218, v219
    v_cvt_pk_bf16_f32 v218, v220, v221
    v_cvt_pk_bf16_f32 v219, v222, v223
    buffer_store_dwordx4 v[216:219], v7, s[24:27], s53 offen offset:3072
    s_add_u32 s53, s53, 4096
    v_mfma_f32_32x32x16_bf16 v[176:191], v[56:59], a[92:95], v[176:191]
    s_waitcnt vmcnt(34) lgkmcnt(0)
    v_mfma_f32_32x32x16_bf16 v[64:79], v[28:31], a[96:99], v[64:79]
    ds_read_b64_tr_b16 v[44:45], v24 offset:20480
    ds_read_b64_tr_b16 v[46:47], v24 offset:21504
    ds_read_b64_tr_b16 v[48:49], v25 offset:20480
    v_accvgpr_read_b32 v192, a192
    v_accvgpr_read_b32 v193, a193
    v_accvgpr_read_b32 v194, a194
    v_mfma_f32_32x32x16_bf16 v[128:143], v[28:31], a[100:103], v[128:143]
    ds_read_b64_tr_b16 v[50:51], v25 offset:21504
    ds_read_b64_tr_b16 v[52:53], v26 offset:20480
    ds_read_b64_tr_b16 v[54:55], v26 offset:21504
    v_accvgpr_read_b32 v195, a195
    v_accvgpr_read_b32 v196, a196
    v_accvgpr_read_b32 v197, a197
    v_mfma_f32_32x32x16_bf16 v[80:95], v[32:35], a[96:99], v[80:95]
    ds_read_b64_tr_b16 v[56:57], v27 offset:20480
    ds_read_b64_tr_b16 v[58:59], v27 offset:21504
    v_accvgpr_read_b32 v198, a198
    v_accvgpr_read_b32 v199, a199
    v_accvgpr_read_b32 v200, a200
    v_accvgpr_read_b32 v201, a201
    v_mfma_f32_32x32x16_bf16 v[144:159], v[32:35], a[100:103], v[144:159]
    v_accvgpr_read_b32 v202, a202
    v_accvgpr_read_b32 v203, a203
    v_accvgpr_read_b32 v204, a204
    v_accvgpr_read_b32 v205, a205
    v_accvgpr_read_b32 v206, a206
    v_accvgpr_read_b32 v207, a207
    v_mfma_f32_32x32x16_bf16 v[96:111], v[36:39], a[96:99], v[96:111]
    buffer_load_dwordx4 a[192:195], v5, s[12:15], s38 offen offset:0
    buffer_load_dwordx4 a[196:199], v5, s[12:15], s54 offen offset:0
    v_mfma_f32_32x32x16_bf16 v[160:175], v[36:39], a[100:103], v[160:175]
    buffer_load_dwordx4 a[200:203], v5, s[12:15], s38 offen offset:1024
    buffer_load_dwordx4 a[204:207], v5, s[12:15], s54 offen offset:1024
    v_cvt_pk_bf16_f32 v192, v192, v193
    v_cvt_pk_bf16_f32 v193, v194, v195
    v_mfma_f32_32x32x16_bf16 v[112:127], v[40:43], a[96:99], v[112:127]
    v_cvt_pk_bf16_f32 v194, v196, v197
    v_cvt_pk_bf16_f32 v195, v198, v199
    buffer_store_dwordx4 v[192:195], v7, s[24:27], s53 offen offset:0
    v_cvt_pk_bf16_f32 v200, v200, v201
    v_cvt_pk_bf16_f32 v201, v202, v203
    v_mfma_f32_32x32x16_bf16 v[176:191], v[40:43], a[100:103], v[176:191]
    v_cvt_pk_bf16_f32 v202, v204, v205
    v_cvt_pk_bf16_f32 v203, v206, v207
    buffer_store_dwordx4 v[200:203], v7, s[24:27], s53 offen offset:1024
    s_waitcnt vmcnt(38) lgkmcnt(0)
    v_mfma_f32_32x32x16_bf16 v[64:79], v[44:47], a[104:107], v[64:79]
    ds_read_b64_tr_b16 v[28:29], v24 offset:24576
    ds_read_b64_tr_b16 v[30:31], v24 offset:25600
    ds_read_b64_tr_b16 v[32:33], v25 offset:24576
    v_mfma_f32_32x32x16_bf16 v[128:143], v[44:47], a[108:111], v[128:143]
    ds_read_b64_tr_b16 v[34:35], v25 offset:25600
    ds_read_b64_tr_b16 v[36:37], v26 offset:24576
    ds_read_b64_tr_b16 v[38:39], v26 offset:25600
    v_mfma_f32_32x32x16_bf16 v[80:95], v[48:51], a[104:107], v[80:95]
    ds_read_b64_tr_b16 v[40:41], v27 offset:24576
    ds_read_b64_tr_b16 v[42:43], v27 offset:25600
    v_mfma_f32_32x32x16_bf16 v[144:159], v[48:51], a[108:111], v[144:159]
    v_mfma_f32_32x32x16_bf16 v[96:111], v[52:55], a[104:107], v[96:111]
    v_accvgpr_read_b32 v208, a208
    v_accvgpr_read_b32 v209, a209
    v_accvgpr_read_b32 v210, a210
    v_accvgpr_read_b32 v211, a211
    v_accvgpr_read_b32 v212, a212
    v_accvgpr_read_b32 v213, a213
    v_mfma_f32_32x32x16_bf16 v[160:175], v[52:55], a[108:111], v[160:175]
    v_accvgpr_read_b32 v214, a214
    v_accvgpr_read_b32 v215, a215
    v_accvgpr_read_b32 v216, a216
    v_accvgpr_read_b32 v217, a217
    v_accvgpr_read_b32 v218, a218
    v_accvgpr_read_b32 v219, a219
    v_mfma_f32_32x32x16_bf16 v[112:127], v[56:59], a[104:107], v[112:127]
    v_accvgpr_read_b32 v220, a220
    v_accvgpr_read_b32 v221, a221
    v_accvgpr_read_b32 v222, a222
    v_accvgpr_read_b32 v223, a223
    v_mfma_f32_32x32x16_bf16 v[176:191], v[56:59], a[108:111], v[176:191]
    buffer_load_dwordx4 a[208:211], v5, s[12:15], s38 offen offset:2048
    buffer_load_dwordx4 a[212:215], v5, s[12:15], s54 offen offset:2048
    s_waitcnt vmcnt(36) lgkmcnt(0)
    v_mfma_f32_32x32x16_bf16 v[64:79], v[28:31], a[112:115], v[64:79]
    ds_read_b64_tr_b16 v[44:45], v24 offset:28672
    ds_read_b64_tr_b16 v[46:47], v24 offset:29696
    ds_read_b64_tr_b16 v[48:49], v25 offset:28672
    v_mfma_f32_32x32x16_bf16 v[128:143], v[28:31], a[116:119], v[128:143]
    ds_read_b64_tr_b16 v[50:51], v25 offset:29696
    ds_read_b64_tr_b16 v[52:53], v26 offset:28672
    ds_read_b64_tr_b16 v[54:55], v26 offset:29696
    v_mfma_f32_32x32x16_bf16 v[80:95], v[32:35], a[112:115], v[80:95]
    ds_read_b64_tr_b16 v[56:57], v27 offset:28672
    ds_read_b64_tr_b16 v[58:59], v27 offset:29696
    v_mfma_f32_32x32x16_bf16 v[144:159], v[32:35], a[116:119], v[144:159]
    buffer_load_dwordx4 a[216:219], v5, s[12:15], s38 offen offset:3072
    buffer_load_dwordx4 a[220:223], v5, s[12:15], s54 offen offset:3072
    s_add_u32 s38, s38, 4096
    s_add_u32 s54, s54, 4096
    v_cvt_pk_bf16_f32 v208, v208, v209
    v_mfma_f32_32x32x16_bf16 v[96:111], v[36:39], a[112:115], v[96:111]
    v_cvt_pk_bf16_f32 v209, v210, v211
    v_cvt_pk_bf16_f32 v210, v212, v213
    v_cvt_pk_bf16_f32 v211, v214, v215
    buffer_store_dwordx4 v[208:211], v7, s[24:27], s53 offen offset:2048
    v_cvt_pk_bf16_f32 v216, v216, v217
    v_mfma_f32_32x32x16_bf16 v[160:175], v[36:39], a[116:119], v[160:175]
    v_cvt_pk_bf16_f32 v217, v218, v219
    v_cvt_pk_bf16_f32 v218, v220, v221
    v_cvt_pk_bf16_f32 v219, v222, v223
    buffer_store_dwordx4 v[216:219], v7, s[24:27], s53 offen offset:3072
    s_add_u32 s53, s53, 4096
    v_mfma_f32_32x32x16_bf16 v[112:127], v[40:43], a[112:115], v[112:127]
    v_mfma_f32_32x32x16_bf16 v[176:191], v[40:43], a[116:119], v[176:191]
    s_waitcnt vmcnt(38) lgkmcnt(0)
    v_mfma_f32_32x32x16_bf16 v[64:79], v[44:47], a[120:123], v[64:79]
    ds_read_b64_tr_b16 v[28:29], v24 offset:32768
    ds_read_b64_tr_b16 v[30:31], v24 offset:33792
    ds_read_b64_tr_b16 v[32:33], v25 offset:32768
    v_accvgpr_read_b32 v192, a224
    v_accvgpr_read_b32 v193, a225
    v_accvgpr_read_b32 v194, a226
    v_mfma_f32_32x32x16_bf16 v[128:143], v[44:47], a[124:127], v[128:143]
    ds_read_b64_tr_b16 v[34:35], v25 offset:33792
    ds_read_b64_tr_b16 v[36:37], v26 offset:32768
    ds_read_b64_tr_b16 v[38:39], v26 offset:33792
    v_accvgpr_read_b32 v195, a227
    v_accvgpr_read_b32 v196, a228
    v_accvgpr_read_b32 v197, a229
    v_mfma_f32_32x32x16_bf16 v[80:95], v[48:51], a[120:123], v[80:95]
    ds_read_b64_tr_b16 v[40:41], v27 offset:32768
    ds_read_b64_tr_b16 v[42:43], v27 offset:33792
    v_accvgpr_read_b32 v198, a230
    v_accvgpr_read_b32 v199, a231
    v_accvgpr_read_b32 v200, a232
    v_accvgpr_read_b32 v201, a233
    v_mfma_f32_32x32x16_bf16 v[144:159], v[48:51], a[124:127], v[144:159]
    v_accvgpr_read_b32 v202, a234
    v_accvgpr_read_b32 v203, a235
    v_accvgpr_read_b32 v204, a236
    v_accvgpr_read_b32 v205, a237
    v_accvgpr_read_b32 v206, a238
    v_accvgpr_read_b32 v207, a239
    v_mfma_f32_32x32x16_bf16 v[96:111], v[52:55], a[120:123], v[96:111]
    v_cvt_pk_bf16_f32 v192, v192, v193
    v_cvt_pk_bf16_f32 v193, v194, v195
    v_cvt_pk_bf16_f32 v194, v196, v197
    v_cvt_pk_bf16_f32 v195, v198, v199
    buffer_store_dwordx4 v[192:195], v7, s[24:27], s53 offen offset:0
    v_mfma_f32_32x32x16_bf16 v[160:175], v[52:55], a[124:127], v[160:175]
    v_cvt_pk_bf16_f32 v200, v200, v201
    v_cvt_pk_bf16_f32 v201, v202, v203
    v_cvt_pk_bf16_f32 v202, v204, v205
    v_cvt_pk_bf16_f32 v203, v206, v207
    buffer_store_dwordx4 v[200:203], v7, s[24:27], s53 offen offset:1024
    v_mfma_f32_32x32x16_bf16 v[112:127], v[56:59], a[120:123], v[112:127]
    v_mfma_f32_32x32x16_bf16 v[176:191], v[56:59], a[124:127], v[176:191]
    s_waitcnt vmcnt(36) lgkmcnt(0)
    v_mfma_f32_32x32x16_bf16 v[64:79], v[28:31], a[128:131], v[64:79]
    ds_read_b64_tr_b16 v[44:45], v24 offset:36864
    ds_read_b64_tr_b16 v[46:47], v24 offset:37888
    ds_read_b64_tr_b16 v[48:49], v25 offset:36864
    v_mfma_f32_32x32x16_bf16 v[128:143], v[28:31], a[132:135], v[128:143]
    ds_read_b64_tr_b16 v[50:51], v25 offset:37888
    ds_read_b64_tr_b16 v[52:53], v26 offset:36864
    ds_read_b64_tr_b16 v[54:55], v26 offset:37888
    v_mfma_f32_32x32x16_bf16 v[80:95], v[32:35], a[128:131], v[80:95]
    ds_read_b64_tr_b16 v[56:57], v27 offset:36864
    ds_read_b64_tr_b16 v[58:59], v27 offset:37888
    v_mfma_f32_32x32x16_bf16 v[144:159], v[32:35], a[132:135], v[144:159]
    v_mfma_f32_32x32x16_bf16 v[96:111], v[36:39], a[128:131], v[96:111]
    v_accvgpr_read_b32 v208, a240
    v_accvgpr_read_b32 v209, a241
    v_accvgpr_read_b32 v210, a242
    v_accvgpr_read_b32 v211, a243
    v_accvgpr_read_b32 v212, a244
    v_accvgpr_read_b32 v213, a245
    v_mfma_f32_32x32x16_bf16 v[160:175], v[36:39], a[132:135], v[160:175]
    v_accvgpr_read_b32 v214, a246
    v_accvgpr_read_b32 v215, a247
    v_accvgpr_read_b32 v216, a248
    v_accvgpr_read_b32 v217, a249
    v_accvgpr_read_b32 v218, a250
    v_accvgpr_read_b32 v219, a251
    v_mfma_f32_32x32x16_bf16 v[112:127], v[40:43], a[128:131], v[112:127]
    v_accvgpr_read_b32 v220, a252
    v_accvgpr_read_b32 v221, a253
    v_accvgpr_read_b32 v222, a254
    v_accvgpr_read_b32 v223, a255
    v_cvt_pk_bf16_f32 v208, v208, v209
    v_cvt_pk_bf16_f32 v209, v210, v211
    v_mfma_f32_32x32x16_bf16 v[176:191], v[40:43], a[132:135], v[176:191]
    v_cvt_pk_bf16_f32 v210, v212, v213
    v_cvt_pk_bf16_f32 v211, v214, v215
    buffer_store_dwordx4 v[208:211], v7, s[24:27], s53 offen offset:2048
    v_cvt_pk_bf16_f32 v216, v216, v217
    v_cvt_pk_bf16_f32 v217, v218, v219
    s_waitcnt vmcnt(35) lgkmcnt(0)
    v_mfma_f32_32x32x16_bf16 v[64:79], v[44:47], a[136:139], v[64:79]
    ds_read_b64_tr_b16 v[28:29], v24 offset:40960
    ds_read_b64_tr_b16 v[30:31], v24 offset:41984
    ds_read_b64_tr_b16 v[32:33], v25 offset:40960
    v_cvt_pk_bf16_f32 v218, v220, v221
    v_cvt_pk_bf16_f32 v219, v222, v223
    v_mfma_f32_32x32x16_bf16 v[128:143], v[44:47], a[140:143], v[128:143]
    ds_read_b64_tr_b16 v[34:35], v25 offset:41984
    ds_read_b64_tr_b16 v[36:37], v26 offset:40960
    ds_read_b64_tr_b16 v[38:39], v26 offset:41984
    buffer_store_dwordx4 v[216:219], v7, s[24:27], s53 offen offset:3072
    s_add_u32 s53, s53, 4096
    v_mfma_f32_32x32x16_bf16 v[80:95], v[48:51], a[136:139], v[80:95]
    ds_read_b64_tr_b16 v[40:41], v27 offset:40960
    ds_read_b64_tr_b16 v[42:43], v27 offset:41984
    v_mfma_f32_32x32x16_bf16 v[144:159], v[48:51], a[140:143], v[144:159]
    v_mfma_f32_32x32x16_bf16 v[96:111], v[52:55], a[136:139], v[96:111]
    v_mfma_f32_32x32x16_bf16 v[160:175], v[52:55], a[140:143], v[160:175]
    v_mfma_f32_32x32x16_bf16 v[112:127], v[56:59], a[136:139], v[112:127]
    v_mfma_f32_32x32x16_bf16 v[176:191], v[56:59], a[140:143], v[176:191]
    s_waitcnt vmcnt(32) lgkmcnt(0)
    v_mfma_f32_32x32x16_bf16 v[64:79], v[28:31], a[144:147], v[64:79]
    ds_read_b64_tr_b16 v[44:45], v24 offset:45056
    ds_read_b64_tr_b16 v[46:47], v24 offset:46080
    ds_read_b64_tr_b16 v[48:49], v25 offset:45056
    v_mfma_f32_32x32x16_bf16 v[128:143], v[28:31], a[148:151], v[128:143]
    ds_read_b64_tr_b16 v[50:51], v25 offset:46080
    ds_read_b64_tr_b16 v[52:53], v26 offset:45056
    ds_read_b64_tr_b16 v[54:55], v26 offset:46080
    v_mfma_f32_32x32x16_bf16 v[80:95], v[32:35], a[144:147], v[80:95]
    ds_read_b64_tr_b16 v[56:57], v27 offset:45056
    ds_read_b64_tr_b16 v[58:59], v27 offset:46080
    v_mfma_f32_32x32x16_bf16 v[144:159], v[32:35], a[148:151], v[144:159]
    v_mfma_f32_32x32x16_bf16 v[96:111], v[36:39], a[144:147], v[96:111]
    v_mfma_f32_32x32x16_bf16 v[160:175], v[36:39], a[148:151], v[160:175]
    v_mfma_f32_32x32x16_bf16 v[112:127], v[40:43], a[144:147], v[112:127]
    v_mfma_f32_32x32x16_bf16 v[176:191], v[40:43], a[148:151], v[176:191]
    s_waitcnt vmcnt(30) lgkmcnt(0)
    v_mfma_f32_32x32x16_bf16 v[64:79], v[44:47], a[152:155], v[64:79]
    s_barrier
    v_mfma_f32_32x32x16_bf16 v[128:143], v[44:47], a[156:159], v[128:143]
    v_add_u32 v20, 0x10000, v20
    ds_read_b64_tr_b16 v[28:29], v20 offset:0
    ds_read_b64_tr_b16 v[30:31], v20 offset:1024
    v_add_u32 v21, 0x10000, v21
    ds_read_b64_tr_b16 v[32:33], v21 offset:0
    v_mfma_f32_32x32x16_bf16 v[80:95], v[48:51], a[152:155], v[80:95]
    ds_read_b64_tr_b16 v[34:35], v21 offset:1024
    v_add_u32 v22, 0x10000, v22
    ds_read_b64_tr_b16 v[36:37], v22 offset:0
    ds_read_b64_tr_b16 v[38:39], v22 offset:1024
    v_mfma_f32_32x32x16_bf16 v[144:159], v[48:51], a[156:159], v[144:159]
    v_add_u32 v23, 0x10000, v23
    ds_read_b64_tr_b16 v[40:41], v23 offset:0
    ds_read_b64_tr_b16 v[42:43], v23 offset:1024
    v_mfma_f32_32x32x16_bf16 v[96:111], v[52:55], a[152:155], v[96:111]
    v_mfma_f32_32x32x16_bf16 v[160:175], v[52:55], a[156:159], v[160:175]
    v_mfma_f32_32x32x16_bf16 v[112:127], v[56:59], a[152:155], v[112:127]
    v_mfma_f32_32x32x16_bf16 v[176:191], v[56:59], a[156:159], v[176:191]
    s_waitcnt vmcnt(26) lgkmcnt(0)
    v_mfma_f32_32x32x16_bf16 v[64:79], v[28:31], a[160:163], v[64:79]
    ds_read_b64_tr_b16 v[44:45], v20 offset:4096
    ds_read_b64_tr_b16 v[46:47], v20 offset:5120
    ds_read_b64_tr_b16 v[48:49], v21 offset:4096
    v_mfma_f32_32x32x16_bf16 v[128:143], v[28:31], a[164:167], v[128:143]
    ds_read_b64_tr_b16 v[50:51], v21 offset:5120
    ds_read_b64_tr_b16 v[52:53], v22 offset:4096
    ds_read_b64_tr_b16 v[54:55], v22 offset:5120
    v_mfma_f32_32x32x16_bf16 v[80:95], v[32:35], a[160:163], v[80:95]
    ds_read_b64_tr_b16 v[56:57], v23 offset:4096
    ds_read_b64_tr_b16 v[58:59], v23 offset:5120
    v_mfma_f32_32x32x16_bf16 v[144:159], v[32:35], a[164:167], v[144:159]
    v_mfma_f32_32x32x16_bf16 v[96:111], v[36:39], a[160:163], v[96:111]
    v_mfma_f32_32x32x16_bf16 v[160:175], v[36:39], a[164:167], v[160:175]
    v_mfma_f32_32x32x16_bf16 v[112:127], v[40:43], a[160:163], v[112:127]
    v_mfma_f32_32x32x16_bf16 v[176:191], v[40:43], a[164:167], v[176:191]
    s_waitcnt vmcnt(24) lgkmcnt(0)
    v_mfma_f32_32x32x16_bf16 v[64:79], v[44:47], a[168:171], v[64:79]
    ds_read_b64_tr_b16 v[28:29], v20 offset:8192
    ds_read_b64_tr_b16 v[30:31], v20 offset:9216
    ds_read_b64_tr_b16 v[32:33], v21 offset:8192
    s_waitcnt vmcnt(0)
    v_mfma_f32_32x32x16_bf16 v[128:143], v[44:47], a[172:175], v[128:143]
    ds_read_b64_tr_b16 v[34:35], v21 offset:9216
    ds_read_b64_tr_b16 v[36:37], v22 offset:8192
    ds_read_b64_tr_b16 v[38:39], v22 offset:9216
    v_mfma_f32_32x32x16_bf16 v[80:95], v[48:51], a[168:171], v[80:95]
    ds_read_b64_tr_b16 v[40:41], v23 offset:8192
    ds_read_b64_tr_b16 v[42:43], v23 offset:9216
    v_mfma_f32_32x32x16_bf16 v[144:159], v[48:51], a[172:175], v[144:159]
    s_cmp_eq_u32 s10, 0
    s_cbranch_scc1 FR_LF_2
    v_mov_b32 v60, 1
    s_mov_b64 exec, 1
    buffer_store_dword v60, off, s[72:75], s51
    s_mov_b64 exec, -1
FR_LF_2_R:
    v_mfma_f32_32x32x16_bf16 v[96:111], v[52:55], a[168:171], v[96:111]
    v_mfma_f32_32x32x16_bf16 v[160:175], v[52:55], a[172:175], v[160:175]
    v_mfma_f32_32x32x16_bf16 v[112:127], v[56:59], a[168:171], v[112:127]
    v_mfma_f32_32x32x16_bf16 v[176:191], v[56:59], a[172:175], v[176:191]
    s_waitcnt lgkmcnt(0)
    v_mfma_f32_32x32x16_bf16 v[64:79], v[28:31], a[176:179], v[64:79]
    ds_read_b64_tr_b16 v[44:45], v20 offset:12288
    ds_read_b64_tr_b16 v[46:47], v20 offset:13312
    ds_read_b64_tr_b16 v[48:49], v21 offset:12288
    v_mfma_f32_32x32x16_bf16 v[128:143], v[28:31], a[180:183], v[128:143]
    ds_read_b64_tr_b16 v[50:51], v21 offset:13312
    ds_read_b64_tr_b16 v[52:53], v22 offset:12288
    ds_read_b64_tr_b16 v[54:55], v22 offset:13312
    v_mfma_f32_32x32x16_bf16 v[80:95], v[32:35], a[176:179], v[80:95]
    ds_read_b64_tr_b16 v[56:57], v23 offset:12288
    ds_read_b64_tr_b16 v[58:59], v23 offset:13312
    v_mfma_f32_32x32x16_bf16 v[144:159], v[32:35], a[180:183], v[144:159]
    v_mfma_f32_32x32x16_bf16 v[96:111], v[36:39], a[176:179], v[96:111]
    v_mfma_f32_32x32x16_bf16 v[160:175], v[36:39], a[180:183], v[160:175]
    v_mfma_f32_32x32x16_bf16 v[112:127], v[40:43], a[176:179], v[112:127]
    v_mfma_f32_32x32x16_bf16 v[176:191], v[40:43], a[180:183], v[176:191]
    s_waitcnt lgkmcnt(0)
    v_mfma_f32_32x32x16_bf16 v[64:79], v[44:47], a[184:187], v[64:79]
    ds_read_b64_tr_b16 v[28:29], v20 offset:16384
    ds_read_b64_tr_b16 v[30:31], v20 offset:17408
    ds_read_b64_tr_b16 v[32:33], v21 offset:16384
    buffer_load_dword v63, v61, s[72:75], s46 offen sc1
    v_mfma_f32_32x32x16_bf16 v[128:143], v[44:47], a[188:191], v[128:143]
    ds_read_b64_tr_b16 v[34:35], v21 offset:17408
    ds_read_b64_tr_b16 v[36:37], v22 offset:16384
    ds_read_b64_tr_b16 v[38:39], v22 offset:17408
    v_mfma_f32_32x32x16_bf16 v[80:95], v[48:51], a[184:187], v[80:95]
    ds_read_b64_tr_b16 v[40:41], v23 offset:16384
    ds_read_b64_tr_b16 v[42:43], v23 offset:17408
    v_mfma_f32_32x32x16_bf16 v[144:159], v[48:51], a[188:191], v[144:159]
    v_mfma_f32_32x32x16_bf16 v[96:111], v[52:55], a[184:187], v[96:111]
    v_mfma_f32_32x32x16_bf16 v[160:175], v[52:55], a[188:191], v[160:175]
    v_mfma_f32_32x32x16_bf16 v[112:127], v[56:59], a[184:187], v[112:127]
    v_mfma_f32_32x32x16_bf16 v[176:191], v[56:59], a[188:191], v[176:191]
    s_waitcnt lgkmcnt(0)
    v_mfma_f32_32x32x16_bf16 v[64:79], v[28:31], a[192:195], v[64:79]
    ds_read_b64_tr_b16 v[44:45], v20 offset:20480
    ds_read_b64_tr_b16 v[46:47], v20 offset:21504
    ds_read_b64_tr_b16 v[48:49], v21 offset:20480
    v_mfma_f32_32x32x16_bf16 v[128:143], v[28:31], a[196:199], v[128:143]
    ds_read_b64_tr_b16 v[50:51], v21 offset:21504
    ds_read_b64_tr_b16 v[52:53], v22 offset:20480
    ds_read_b64_tr_b16 v[54:55], v22 offset:21504
    v_mfma_f32_32x32x16_bf16 v[80:95], v[32:35], a[192:195], v[80:95]
    ds_read_b64_tr_b16 v[56:57], v23 offset:20480
    ds_read_b64_tr_b16 v[58:59], v23 offset:21504
    v_mfma_f32_32x32x16_bf16 v[144:159], v[32:35], a[196:199], v[144:159]
    v_mfma_f32_32x32x16_bf16 v[96:111], v[36:39], a[192:195], v[96:111]
    v_mfma_f32_32x32x16_bf16 v[160:175], v[36:39], a[196:199], v[160:175]
    v_mfma_f32_32x32x16_bf16 v[112:127], v[40:43], a[192:195], v[112:127]
    v_mfma_f32_32x32x16_bf16 v[176:191], v[40:43], a[196:199], v[176:191]
    s_waitcnt lgkmcnt(0)
    v_mfma_f32_32x32x16_bf16 v[64:79], v[44:47], a[200:203], v[64:79]
    ds_read_b64_tr_b16 v[28:29], v20 offset:24576
    ds_read_b64_tr_b16 v[30:31], v20 offset:25600
    ds_read_b64_tr_b16 v[32:33], v21 offset:24576
    s_waitcnt vmcnt(0)
    v_cmp_ne_u32 vcc, 0, v63
    s_nop 0
    s_cmp_eq_u64 vcc, -1
    s_cbranch_scc0 FR_K_S
FR_K_R:
    v_mfma_f32_32x32x16_bf16 v[128:143], v[44:47], a[204:207], v[128:143]
    ds_read_b64_tr_b16 v[34:35], v21 offset:25600
    ds_read_b64_tr_b16 v[36:37], v22 offset:24576
    ds_read_b64_tr_b16 v[38:39], v22 offset:25600
    v_mfma_f32_32x32x16_bf16 v[80:95], v[48:51], a[200:203], v[80:95]
    ds_read_b64_tr_b16 v[40:41], v23 offset:24576
    ds_read_b64_tr_b16 v[42:43], v23 offset:25600
    v_mfma_f32_32x32x16_bf16 v[144:159], v[48:51], a[204:207], v[144:159]
    s_add_u32 m0, s36, 0
    s_mov_b32 s50, 0
    buffer_load_dwordx4 v16, s[20:23], s50 offen offset:0 lds
    buffer_load_dwordx4 v16, s[20:23], s50 offen offset:1024 lds
    v_mfma_f32_32x32x16_bf16 v[96:111], v[52:55], a[200:203], v[96:111]
    s_add_u32 m0, s36, 0
    s_mov_b32 s50, 0
    buffer_load_dwordx4 v16, s[20:23], s50 offen offset:2048 lds
    buffer_load_dwordx4 v16, s[20:23], s50 offen offset:3072 lds
    v_mfma_f32_32x32x16_bf16 v[160:175], v[52:55], a[204:207], v[160:175]
    s_add_u32 m0, s36, 32768
    s_mov_b32 s50, 16384
    buffer_load_dwordx4 v16, s[20:23], s50 offen offset:0 lds
    buffer_load_dwordx4 v16, s[20:23], s50 offen offset:1024 lds
    v_mfma_f32_32x32x16_bf16 v[112:127], v[56:59], a[200:203], v[112:127]
    s_add_u32 m0, s36, 32768
    s_mov_b32 s50, 16384
    buffer_load_dwordx4 v16, s[20:23], s50 offen offset:2048 lds
    buffer_load_dwordx4 v16, s[20:23], s50 offen offset:3072 lds
    v_mfma_f32_32x32x16_bf16 v[176:191], v[56:59], a[204:207], v[176:191]
    s_add_u32 m0, s36, 16384
    s_mov_b32 s50, 0
    buffer_load_dwordx4 v16, s[24:27], s50 offen offset:0 lds
    buffer_load_dwordx4 v16, s[24:27], s50 offen offset:1024 lds
    s_waitcnt lgkmcnt(0)
    v_mfma_f32_32x32x16_bf16 v[64:79], v[28:31], a[208:211], v[64:79]
    ds_read_b64_tr_b16 v[44:45], v20 offset:28672
    ds_read_b64_tr_b16 v[46:47], v20 offset:29696
    ds_read_b64_tr_b16 v[48:49], v21 offset:28672
    v_mfma_f32_32x32x16_bf16 v[128:143], v[28:31], a[212:215], v[128:143]
    ds_read_b64_tr_b16 v[50:51], v21 offset:29696
    ds_read_b64_tr_b16 v[52:53], v22 offset:28672
    ds_read_b64_tr_b16 v[54:55], v22 offset:29696
    v_mfma_f32_32x32x16_bf16 v[80:95], v[32:35], a[208:211], v[80:95]
    ds_read_b64_tr_b16 v[56:57], v23 offset:28672
    ds_read_b64_tr_b16 v[58:59], v23 offset:29696
    v_mfma_f32_32x32x16_bf16 v[144:159], v[32:35], a[212:215], v[144:159]
    s_add_u32 m0, s36, 16384
    s_mov_b32 s50, 0
    buffer_load_dwordx4 v16, s[24:27], s50 offen offset:2048 lds
    buffer_load_dwordx4 v16, s[24:27], s50 offen offset:3072 lds
    v_mfma_f32_32x32x16_bf16 v[96:111], v[36:39], a[208:211], v[96:111]
    s_add_u32 m0, s36, 49152
    s_mov_b32 s50, 16384
    buffer_load_dwordx4 v16, s[24:27], s50 offen offset:0 lds
    buffer_load_dwordx4 v16, s[24:27], s50 offen offset:1024 lds
    v_mfma_f32_32x32x16_bf16 v[160:175], v[36:39], a[212:215], v[160:175]
    s_add_u32 m0, s36, 49152
    s_mov_b32 s50, 16384
    buffer_load_dwordx4 v16, s[24:27], s50 offen offset:2048 lds
    buffer_load_dwordx4 v16, s[24:27], s50 offen offset:3072 lds
    v_mfma_f32_32x32x16_bf16 v[112:127], v[40:43], a[208:211], v[112:127]
    v_mfma_f32_32x32x16_bf16 v[176:191], v[40:43], a[212:215], v[176:191]
    s_waitcnt lgkmcnt(0)
    v_mfma_f32_32x32x16_bf16 v[64:79], v[44:47], a[216:219], v[64:79]
    v_mfma_f32_32x32x16_bf16 v[128:143], v[44:47], a[220:223], v[128:143]
    v_mfma_f32_32x32x16_bf16 v[80:95], v[48:51], a[216:219], v[80:95]
    v_mfma_f32_32x32x16_bf16 v[144:159], v[48:51], a[220:223], v[144:159]
    v_mfma_f32_32x32x16_bf16 v[96:111], v[52:55], a[216:219], v[96:111]
    v_mfma_f32_32x32x16_bf16 v[160:175], v[52:55], a[220:223], v[160:175]
    v_mfma_f32_32x32x16_bf16 v[112:127], v[56:59], a[216:219], v[112:127]
    v_mfma_f32_32x32x16_bf16 v[176:191], v[56:59], a[220:223], v[176:191]
    s_load_dwordx2 s[16:17], s[0:1], 64
    s_mov_b32 s18, 8388608
    s_mov_b32 s19, 0x00020000
    buffer_load_dword v59, off, s[92:95], 0 offset:192 sc0 sc1
    s_mov_b64 s[4:5], s[92:93]
    s_mov_b64 s[6:7], s[94:95]
    s_lshl_b32 s45, s3, 14
    s_add_u32 s45, s45, 131072
    v_add_u32 v6, s45, v17
    v_cvt_pk_bf16_f32 v224, v64, v65
    v_cvt_pk_bf16_f32 v225, v66, v67
    v_cvt_pk_bf16_f32 v226, v68, v69
    v_cvt_pk_bf16_f32 v227, v70, v71
    v_cvt_pk_bf16_f32 v228, v72, v73
    v_cvt_pk_bf16_f32 v229, v74, v75
    v_cvt_pk_bf16_f32 v230, v76, v77
    v_cvt_pk_bf16_f32 v231, v78, v79
    v_cvt_pk_bf16_f32 v232, v80, v81
    v_cvt_pk_bf16_f32 v233, v82, v83
    v_cvt_pk_bf16_f32 v234, v84, v85
    v_cvt_pk_bf16_f32 v235, v86, v87
    v_cvt_pk_bf16_f32 v236, v88, v89
    v_cvt_pk_bf16_f32 v237, v90, v91
    v_cvt_pk_bf16_f32 v238, v92, v93
    v_cvt_pk_bf16_f32 v239, v94, v95
    v_cvt_pk_bf16_f32 v240, v96, v97
    v_cvt_pk_bf16_f32 v241, v98, v99
    v_cvt_pk_bf16_f32 v242, v100, v101
    v_cvt_pk_bf16_f32 v243, v102, v103
    v_cvt_pk_bf16_f32 v244, v104, v105
    v_cvt_pk_bf16_f32 v245, v106, v107
    v_cvt_pk_bf16_f32 v246, v108, v109
    v_cvt_pk_bf16_f32 v247, v110, v111
    v_cvt_pk_bf16_f32 v248, v112, v113
    v_cvt_pk_bf16_f32 v249, v114, v115
    v_cvt_pk_bf16_f32 v250, v116, v117
    v_cvt_pk_bf16_f32 v251, v118, v119
    v_cvt_pk_bf16_f32 v252, v120, v121
    v_cvt_pk_bf16_f32 v253, v122, v123
    v_cvt_pk_bf16_f32 v254, v124, v125
    v_cvt_pk_bf16_f32 v255, v126, v127
    v_accvgpr_write_b32 a128, v224
    v_accvgpr_write_b32 a129, v225
    v_accvgpr_write_b32 a130, v226
    v_accvgpr_write_b32 a131, v227
    v_accvgpr_write_b32 a132, v228
    v_accvgpr_write_b32 a133, v229
    v_accvgpr_write_b32 a134, v230
    v_accvgpr_write_b32 a135, v231
    v_accvgpr_write_b32 a136, v232
    v_accvgpr_write_b32 a137, v233
    v_accvgpr_write_b32 a138, v234
    v_accvgpr_write_b32 a139, v235
    v_accvgpr_write_b32 a140, v236
    v_accvgpr_write_b32 a141, v237
    v_accvgpr_write_b32 a142, v238
    v_accvgpr_write_b32 a143, v239
    v_accvgpr_write_b32 a144, v240
    v_accvgpr_write_b32 a145, v241
    v_accvgpr_write_b32 a146, v242
    v_accvgpr_write_b32 a147, v243
    v_accvgpr_write_b32 a148, v244
    v_accvgpr_write_b32 a149, v245
    v_accvgpr_write_b32 a150, v246
    v_accvgpr_write_b32 a151, v247
    v_accvgpr_write_b32 a152, v248
    v_accvgpr_write_b32 a153, v249
    v_accvgpr_write_b32 a154, v250
    v_accvgpr_write_b32 a155, v251
    v_accvgpr_write_b32 a156, v252
    v_accvgpr_write_b32 a157, v253
    v_accvgpr_write_b32 a158, v254
    v_accvgpr_write_b32 a159, v255
    v_cvt_pk_bf16_f32 v224, v128, v129
    v_cvt_pk_bf16_f32 v225, v130, v131
    v_cvt_pk_bf16_f32 v226, v132, v133
    v_cvt_pk_bf16_f32 v227, v134, v135
    v_cvt_pk_bf16_f32 v228, v136, v137
    v_cvt_pk_bf16_f32 v229, v138, v139
    v_cvt_pk_bf16_f32 v230, v140, v141
    v_cvt_pk_bf16_f32 v231, v142, v143
    v_cvt_pk_bf16_f32 v232, v144, v145
    v_cvt_pk_bf16_f32 v233, v146, v147
    v_cvt_pk_bf16_f32 v234, v148, v149
    v_cvt_pk_bf16_f32 v235, v150, v151
    v_cvt_pk_bf16_f32 v236, v152, v153
    v_cvt_pk_bf16_f32 v237, v154, v155
    v_cvt_pk_bf16_f32 v238, v156, v157
    v_cvt_pk_bf16_f32 v239, v158, v159
    v_cvt_pk_bf16_f32 v240, v160, v161
    v_cvt_pk_bf16_f32 v241, v162, v163
    v_cvt_pk_bf16_f32 v242, v164, v165
    v_cvt_pk_bf16_f32 v243, v166, v167
    v_cvt_pk_bf16_f32 v244, v168, v169
    v_cvt_pk_bf16_f32 v245, v170, v171
    v_cvt_pk_bf16_f32 v246, v172, v173
    v_cvt_pk_bf16_f32 v247, v174, v175
    v_cvt_pk_bf16_f32 v248, v176, v177
    v_cvt_pk_bf16_f32 v249, v178, v179
    v_cvt_pk_bf16_f32 v250, v180, v181
    v_cvt_pk_bf16_f32 v251, v182, v183
    v_cvt_pk_bf16_f32 v252, v184, v185
    v_cvt_pk_bf16_f32 v253, v186, v187
    v_cvt_pk_bf16_f32 v254, v188, v189
    v_cvt_pk_bf16_f32 v255, v190, v191
    v_accvgpr_write_b32 a160, v224
    v_accvgpr_write_b32 a161, v225
    v_accvgpr_write_b32 a162, v226
    v_accvgpr_write_b32 a163, v227
    v_accvgpr_write_b32 a164, v228
    v_accvgpr_write_b32 a165, v229
    v_accvgpr_write_b32 a166, v230
    v_accvgpr_write_b32 a167, v231
    v_accvgpr_write_b32 a168, v232
    v_accvgpr_write_b32 a169, v233
    v_accvgpr_write_b32 a170, v234
    v_accvgpr_write_b32 a171, v235
    v_accvgpr_write_b32 a172, v236
    v_accvgpr_write_b32 a173, v237
    v_accvgpr_write_b32 a174, v238
    v_accvgpr_write_b32 a175, v239
    v_accvgpr_write_b32 a176, v240
    v_accvgpr_write_b32 a177, v241
    v_accvgpr_write_b32 a178, v242
    v_accvgpr_write_b32 a179, v243
    v_accvgpr_write_b32 a180, v244
    v_accvgpr_write_b32 a181, v245
    v_accvgpr_write_b32 a182, v246
    v_accvgpr_write_b32 a183, v247
    v_accvgpr_write_b32 a184, v248
    v_accvgpr_write_b32 a185, v249
    v_accvgpr_write_b32 a186, v250
    v_accvgpr_write_b32 a187, v251
    v_accvgpr_write_b32 a188, v252
    v_accvgpr_write_b32 a189, v253
    v_accvgpr_write_b32 a190, v254
    v_accvgpr_write_b32 a191, v255
    v_add_u32 v28, s44, v2
    v_lshlrev_b32 v24, 2, v3
    v_sub_u32 v28, v28, v24
    v_add_u32 v29, 32, v28
    s_lshr_b32 s53, s44, 6
    s_mov_b32 s88, s53
    v_mov_b32 v19, 0
    v_mov_b32 v21, 0
    v_mov_b32 v18, 0xf149f2ca
    v_mov_b32 v20, 0xf149f2ca
    s_lshl_b32 s59, s56, 1
    s_mov_b32 s47, 0
    s_mov_b32 s80, 0
    s_mov_b32 s54, 0x41000000
    s_add_u32 s45, s59, 1
    s_bfm_b32 s45, s45, 0
    s_and_b32 s60, s45, 0x5555
    s_andn2_b32 s45, 0x7fff, s45
    s_or_b32 s60, s60, s45
    s_add_u32 s45, s59, 2
    s_bfm_b32 s45, s45, 0
    s_and_b32 s61, s45, 0xaaaa
    s_andn2_b32 s45, 0xffff, s45
    s_or_b32 s61, s61, s45
    s_add_u32 s62, s36, 65536
    s_mov_b32 s63, 32768
    s_add_u32 s64, s36, 81920
    s_mov_b32 s65, 32768
    s_or_b32 s60, s60, 0x18000
    s_or_b32 s61, s61, 0x10000
    s_sub_u32 s89, s59, s3
    s_add_u32 s89, s89, 3
    s_cmp_lt_u32 s55, 2
    s_cselect_b32 s89, 0, s89
    s_lshl_b32 s45, s59, 15
    s_sub_u32 s45, 475136, s45
    s_add_u32 s50, s59, 1
    v_mov_b32 v52, 0xffffc000
    v_mov_b32 v53, s45
    v_mov_b32 v33, 16384
    v_mov_b32 v51, 16384
    v_cmp_lt_u32 vcc, s59, v1
    s_nop 1
    v_cndmask_b32 v33, v33, v52, vcc
    v_cmp_lt_u32 vcc, s50, v1
    s_nop 1
    v_cndmask_b32 v51, v51, v52, vcc
    v_cmp_eq_u32 vcc, s59, v1
    s_nop 1
    v_cndmask_b32 v33, v33, v53, vcc
    v_cmp_eq_u32 vcc, s50, v1
    s_nop 1
    v_cndmask_b32 v51, v51, v53, vcc
    v_mov_b32 v52, 0x20000
    v_cmp_lt_u32 vcc, 14, v1
    s_nop 1
    v_cndmask_b32 v33, v33, v52, vcc
    v_cmp_lt_u32 vcc, 15, v1
    s_nop 1
    v_cndmask_b32 v51, v51, v52, vcc
    v_mov_b32 v5, v17
    v_mov_b32 v50, v16
    v_lshrrev_b32 v53, 4, v1
    v_lshlrev_b32 v52, 2, v53
    v_xor_b32 v52, v52, v1
    v_and_b32 v52, 15, v52
    v_lshlrev_b32 v52, 4, v52
    v_lshl_add_u32 v52, v53, 12, v52
    s_lshl_b32 s45, s3, 14
    s_lshr_b32 s50, s55, 1
    s_lshl_b32 s50, s50, 16
    s_add_u32 s45, s45, s50
    v_add_u32 v52, s45, v52
    v_add_u32 v53, 0x20000, v52
    s_and_b32 s90, s2, 7
    s_mul_i32 s94, s90, 20480
    s_add_u32 s94, s94, 282368
    s_lshl_b32 s45, s90, 19
    s_and_b32 s50, s40, 3
    s_lshl_b32 s50, s50, 8
    s_add_u32 s45, s45, s50
    s_add_u32 s68, s68, s45
    s_addc_u32 s69, s69, 0
    s_lshl_b32 s35, s56, 1
    s_lshr_b32 s34, s55, 1
    s_add_u32 s35, s35, s34
    s_lshl_b32 s37, s35, 5
    s_lshl_b32 s35, s35, 7
    s_lshl_b32 s34, s90, 4
    s_add_u32 s35, s35, s34
    s_add_u32 s35, s35, 425984
    s_add_u32 s37, s37, s94
    s_sub_u32 s37, s37, 3840
    v_and_b32 v56, 3, v1
    v_lshlrev_b32 v56, 2, v56
    s_add_u32 s66, s89, 1
    s_cmp_lt_u32 s55, 2
    s_cselect_b32 s66, 99, s66
    s_lshl_b32 s67, s56, 1
    s_add_u32 s67, s67, s3
    s_xor_b32 s67, s67, 1
    s_lshl_b32 s67, s67, 5
    s_add_u32 s67, s67, s40
    s_lshl_b32 s67, s67, 2
    s_add_u32 s67, s67, 425984
    s_mov_b32 s70, 1073741824
    s_mov_b32 s71, 1073741824
    s_mov_b32 s81, 1073741824
    v_mov_b32 v7, 1073741824
    v_mov_b32 v34, 1073741824
    s_lshl_b32 s50, s55, 13
    v_lshlrev_b32 v35, 7, v1
    v_add_u32 v35, s50, v35
    s_lshr_b32 s91, s2, 3
    s_and_b32 s92, s91, 7
    s_lshr_b32 s93, s91, 3
    v_lshlrev_b32 v8, 12, v2
    v_lshl_add_u32 v8, v3, 5, v8
    s_lshl_b32 s33, s90, 2
    s_add_u32 s34, s33, s93
    s_sub_u32 s45, 60, s33
    s_add_u32 s45, s45, s93
    s_lshl_b32 s49, s34, 18
    s_lshl_b32 s34, s34, 17
    s_lshl_b32 s45, s45, 17
    s_bfe_u32 s32, s2, 0x20004
    s_lshl_b32 s32, s32, 3
    s_lshl_b32 s33, s55, 1
    s_add_u32 s32, s32, s33
    s_bfe_u32 s33, s2, 0x10003
    s_lshl_b32 s33, s33, 5
    s_add_u32 s32, s32, s33
    s_lshl_b32 s32, s32, 6
    s_add_u32 s34, s34, s32
    s_add_u32 s45, s45, s32
    s_lshl_b32 s32, s92, 15
    s_add_u32 s49, s49, s32
    s_lshl_b32 s32, s55, 13
    s_add_u32 s49, s49, s32
    s_add_u32 s49, s49, 109051904
    v_subrev_u32 v58, 2, v1
    v_and_b32 v57, 1, v58
    v_cmp_eq_u32 vcc, 0, v57
    v_mov_b32 v57, s45
    v_mov_b32 v9, s34
    v_cndmask_b32 v57, v57, v9, vcc
    v_bfe_u32 v9, v58, 1, 1
    v_lshl_add_u32 v57, v9, 4, v57
    v_bfe_u32 v9, v58, 2, 1
    v_lshl_add_u32 v57, v9, 6, v57
    v_cmp_gt_u32 vcc, 8, v58
    s_nop 1
    v_cndmask_b32 v7, v7, v57, vcc
    v_subrev_u32 v58, 4, v1
    v_lshlrev_b32 v57, 10, v58
    v_add_u32 v57, s49, v57
    v_mov_b32 v9, 1073741824
    v_cmp_gt_u32 vcc, 8, v58
    s_nop 1
    v_cndmask_b32 v9, v9, v57, vcc
    s_mov_b32 s11, 1073741824
    s_lshr_b32 s50, s56, 1
    s_lshl_b32 s50, s50, 17
    s_and_b32 s94, s56, 1
    s_lshl_b32 s94, s94, 11
    s_add_u32 s50, s50, s94
    s_lshr_b32 s94, s55, 1
    s_lshl_b32 s94, s94, 10
    s_add_u32 s50, s50, s94
    s_lshl_b32 s94, s3, 7
    s_add_u32 s50, s50, s94
    v_writelane_b32 v7, s50, 11
    s_lshl_b32 s50, s40, 19
    s_and_b32 s94, s56, 3
    s_lshl_b32 s94, s94, 15
    s_add_u32 s50, s50, s94
    s_lshr_b32 s94, s56, 2
    s_lshl_b32 s94, s94, 24
    s_add_u32 s50, s50, s94
    s_add_u32 s50, s50, 16908288
    v_writelane_b32 v34, s50, 12
    s_mul_i32 s50, s90, 20480
    s_add_u32 s50, s50, 262144
    v_writelane_b32 v34, s50, 13
    s_waitcnt vmcnt(13)
    s_waitcnt lgkmcnt(0)
    s_barrier
    s_cmp_ge_u32 s55, 2
    s_cbranch_scc1 AT_NOSTASH
    ds_write_b128 v6, a[128:131] offset:0
    ds_write_b128 v6, a[132:135] offset:1024
    ds_write_b128 v6, a[136:139] offset:2048
    ds_write_b128 v6, a[140:143] offset:3072
    ds_write_b128 v6, a[144:147] offset:4096
    ds_write_b128 v6, a[148:151] offset:5120
    ds_write_b128 v6, a[152:155] offset:6144
    ds_write_b128 v6, a[156:159] offset:7168
    ds_write_b128 v6, a[160:163] offset:8192
    ds_write_b128 v6, a[164:167] offset:9216
    ds_write_b128 v6, a[168:171] offset:10240
    ds_write_b128 v6, a[172:175] offset:11264
    ds_write_b128 v6, a[176:179] offset:12288
    ds_write_b128 v6, a[180:183] offset:13312
    ds_write_b128 v6, a[184:187] offset:14336
    ds_write_b128 v6, a[188:191] offset:15360
    s_waitcnt lgkmcnt(0)
AT_NOSTASH:
    s_nop 0
    ds_read_b128 a[192:195], v5 offset:0
    ds_read_b128 a[196:199], v5 offset:8192
    ds_read_b128 a[200:203], v5 offset:1024
    ds_read_b128 a[204:207], v5 offset:9216
    ds_read_b128 a[208:211], v5 offset:2048
    ds_read_b128 a[212:215], v5 offset:10240
    ds_read_b128 a[216:219], v5 offset:3072
    ds_read_b128 a[220:223], v5 offset:11264
    v_accvgpr_write_b32 a0, 0
    v_accvgpr_write_b32 a1, 0
    v_accvgpr_write_b32 a2, 0
    v_accvgpr_write_b32 a3, 0
    v_accvgpr_write_b32 a4, 0
    v_accvgpr_write_b32 a5, 0
    v_accvgpr_write_b32 a6, 0
    v_accvgpr_write_b32 a7, 0
    v_accvgpr_write_b32 a8, 0
    v_accvgpr_write_b32 a9, 0
    v_accvgpr_write_b32 a10, 0
    v_accvgpr_write_b32 a11, 0
    v_accvgpr_write_b32 a12, 0
    v_accvgpr_write_b32 a13, 0
    v_accvgpr_write_b32 a14, 0
    v_accvgpr_write_b32 a15, 0
    v_accvgpr_write_b32 a16, 0
    v_accvgpr_write_b32 a17, 0
    v_accvgpr_write_b32 a18, 0
    v_accvgpr_write_b32 a19, 0
    v_accvgpr_write_b32 a20, 0
    v_accvgpr_write_b32 a21, 0
    v_accvgpr_write_b32 a22, 0
    v_accvgpr_write_b32 a23, 0
    s_waitcnt lgkmcnt(4)
    v_mfma_f32_32x32x16_bf16 v[64:79], a[192:195], a[128:131], 0
    ds_read_b128 a[224:227], v5 offset:4096
    v_accvgpr_write_b32 a24, 0
    v_accvgpr_write_b32 a25, 0
    v_accvgpr_write_b32 a26, 0
    v_accvgpr_write_b32 a27, 0
    v_accvgpr_write_b32 a28, 0
    v_mfma_f32_32x32x16_bf16 v[96:111], a[192:195], a[160:163], 0
    ds_read_b128 a[228:231], v5 offset:12288
    v_accvgpr_write_b32 a29, 0
    v_accvgpr_write_b32 a30, 0
    v_accvgpr_write_b32 a31, 0
    v_accvgpr_write_b32 a32, 0
    v_accvgpr_write_b32 a33, 0
    v_mfma_f32_32x32x16_bf16 v[80:95], a[196:199], a[128:131], 0
    ds_read_b128 a[232:235], v5 offset:5120
    v_accvgpr_write_b32 a34, 0
    v_accvgpr_write_b32 a35, 0
    v_accvgpr_write_b32 a36, 0
    v_accvgpr_write_b32 a37, 0
    v_accvgpr_write_b32 a38, 0
    v_mfma_f32_32x32x16_bf16 v[112:127], a[196:199], a[160:163], 0
    ds_read_b128 a[236:239], v5 offset:13312
    v_accvgpr_write_b32 a39, 0
    v_accvgpr_write_b32 a40, 0
    v_accvgpr_write_b32 a41, 0
    v_accvgpr_write_b32 a42, 0
    v_accvgpr_write_b32 a43, 0
    v_mfma_f32_32x32x16_bf16 v[64:79], a[200:203], a[132:135], v[64:79]
    v_accvgpr_write_b32 a44, 0
    v_accvgpr_write_b32 a45, 0
    v_accvgpr_write_b32 a46, 0
    v_accvgpr_write_b32 a47, 0
    v_accvgpr_write_b32 a48, 0
    v_accvgpr_write_b32 a49, 0
    v_mfma_f32_32x32x16_bf16 v[96:111], a[200:203], a[164:167], v[96:111]
    v_accvgpr_write_b32 a50, 0
    v_accvgpr_write_b32 a51, 0
    v_accvgpr_write_b32 a52, 0
    v_accvgpr_write_b32 a53, 0
    v_accvgpr_write_b32 a54, 0
    v_accvgpr_write_b32 a55, 0
    v_mfma_f32_32x32x16_bf16 v[80:95], a[204:207], a[132:135], v[80:95]
    v_accvgpr_write_b32 a56, 0
    v_accvgpr_write_b32 a57, 0
    v_accvgpr_write_b32 a58, 0
    v_accvgpr_write_b32 a59, 0
    v_accvgpr_write_b32 a60, 0
    v_accvgpr_write_b32 a61, 0
    v_mfma_f32_32x32x16_bf16 v[112:127], a[204:207], a[164:167], v[112:127]
    s_waitcnt lgkmcnt(4)
    v_accvgpr_write_b32 a62, 0
    v_accvgpr_write_b32 a63, 0
    v_accvgpr_write_b32 a64, 0
    v_accvgpr_write_b32 a65, 0
    v_accvgpr_write_b32 a66, 0
    v_accvgpr_write_b32 a67, 0
    v_mfma_f32_32x32x16_bf16 v[64:79], a[208:211], a[136:139], v[64:79]
    ds_read_b128 a[240:243], v5 offset:6144
    v_accvgpr_write_b32 a68, 0
    v_accvgpr_write_b32 a69, 0
    v_accvgpr_write_b32 a70, 0
    v_accvgpr_write_b32 a71, 0
    v_accvgpr_write_b32 a72, 0
    v_mfma_f32_32x32x16_bf16 v[96:111], a[208:211], a[168:171], v[96:111]
    ds_read_b128 a[244:247], v5 offset:14336
    v_accvgpr_write_b32 a73, 0
    v_accvgpr_write_b32 a74, 0
    v_accvgpr_write_b32 a75, 0
    v_accvgpr_write_b32 a76, 0
    v_accvgpr_write_b32 a77, 0
    v_mfma_f32_32x32x16_bf16 v[80:95], a[212:215], a[136:139], v[80:95]
    ds_read_b128 a[248:251], v5 offset:7168
    v_accvgpr_write_b32 a78, 0
    v_accvgpr_write_b32 a79, 0
    v_accvgpr_write_b32 a80, 0
    v_accvgpr_write_b32 a81, 0
    v_accvgpr_write_b32 a82, 0
    v_mfma_f32_32x32x16_bf16 v[112:127], a[212:215], a[168:171], v[112:127]
    ds_read_b128 a[252:255], v5 offset:15360
    v_accvgpr_write_b32 a83, 0
    v_accvgpr_write_b32 a84, 0
    v_accvgpr_write_b32 a85, 0
    v_accvgpr_write_b32 a86, 0
    v_accvgpr_write_b32 a87, 0
    v_mfma_f32_32x32x16_bf16 v[64:79], a[216:219], a[140:143], v[64:79]
    v_accvgpr_write_b32 a88, 0
    v_accvgpr_write_b32 a89, 0
    v_accvgpr_write_b32 a90, 0
    v_accvgpr_write_b32 a91, 0
    v_accvgpr_write_b32 a92, 0
    v_accvgpr_write_b32 a93, 0
    v_mfma_f32_32x32x16_bf16 v[96:111], a[216:219], a[172:175], v[96:111]
    v_accvgpr_write_b32 a94, 0
    v_accvgpr_write_b32 a95, 0
    v_accvgpr_write_b32 a96, 0
    v_accvgpr_write_b32 a97, 0
    v_accvgpr_write_b32 a98, 0
    v_accvgpr_write_b32 a99, 0
    v_mfma_f32_32x32x16_bf16 v[80:95], a[220:223], a[140:143], v[80:95]
    v_accvgpr_write_b32 a100, 0
    v_accvgpr_write_b32 a101, 0
    v_accvgpr_write_b32 a102, 0
    v_accvgpr_write_b32 a103, 0
    v_accvgpr_write_b32 a104, 0
    v_accvgpr_write_b32 a105, 0
    v_mfma_f32_32x32x16_bf16 v[112:127], a[220:223], a[172:175], v[112:127]
    s_waitcnt lgkmcnt(4)
    v_accvgpr_write_b32 a106, 0
    v_accvgpr_write_b32 a107, 0
    v_accvgpr_write_b32 a108, 0
    v_accvgpr_write_b32 a109, 0
    v_accvgpr_write_b32 a110, 0
    v_accvgpr_write_b32 a111, 0
    v_mfma_f32_32x32x16_bf16 v[64:79], a[224:227], a[144:147], v[64:79]
    v_accvgpr_write_b32 a112, 0
    v_accvgpr_write_b32 a113, 0
    v_accvgpr_write_b32 a114, 0
    v_accvgpr_write_b32 a115, 0
    v_accvgpr_write_b32 a116, 0
    v_accvgpr_write_b32 a117, 0
    v_mfma_f32_32x32x16_bf16 v[96:111], a[224:227], a[176:179], v[96:111]
    v_accvgpr_write_b32 a118, 0
    v_accvgpr_write_b32 a119, 0
    v_accvgpr_write_b32 a120, 0
    v_accvgpr_write_b32 a121, 0
    v_accvgpr_write_b32 a122, 0
    v_accvgpr_write_b32 a123, 0
    v_mfma_f32_32x32x16_bf16 v[80:95], a[228:231], a[144:147], v[80:95]
    v_accvgpr_write_b32 a124, 0
    v_accvgpr_write_b32 a125, 0
    v_accvgpr_write_b32 a126, 0
    v_accvgpr_write_b32 a127, 0
    v_mfma_f32_32x32x16_bf16 v[112:127], a[228:231], a[176:179], v[112:127]
    v_mfma_f32_32x32x16_bf16 v[64:79], a[232:235], a[148:151], v[64:79]
    v_mfma_f32_32x32x16_bf16 v[96:111], a[232:235], a[180:183], v[96:111]
    v_mfma_f32_32x32x16_bf16 v[80:95], a[236:239], a[148:151], v[80:95]
    v_mfma_f32_32x32x16_bf16 v[112:127], a[236:239], a[180:183], v[112:127]
    s_waitcnt lgkmcnt(0)
    v_mfma_f32_32x32x16_bf16 v[64:79], a[240:243], a[152:155], v[64:79]
    v_mfma_f32_32x32x16_bf16 v[96:111], a[240:243], a[184:187], v[96:111]
    v_mfma_f32_32x32x16_bf16 v[80:95], a[244:247], a[152:155], v[80:95]
    v_mfma_f32_32x32x16_bf16 v[112:127], a[244:247], a[184:187], v[112:127]
    v_mfma_f32_32x32x16_bf16 v[64:79], a[248:251], a[156:159], v[64:79]
    v_mfma_f32_32x32x16_bf16 v[96:111], a[248:251], a[188:191], v[96:111]
    v_mfma_f32_32x32x16_bf16 v[80:95], a[252:255], a[156:159], v[80:95]
    v_mfma_f32_32x32x16_bf16 v[112:127], a[252:255], a[188:191], v[112:127]
    s_cmp_lg_u32 s80, s88
    s_cbranch_scc1 AT_NOMASK_3
    s_lshl_b32 s51, s53, 6
    v_subrev_u32 v24, s51, v28
    v_mov_b32 v26, 0xf149f2ca
    v_mov_b32 v27, 0xf149f2ca
    s_nop 4
    v_pk_mov_b32 v[80:81], v[26:27], v[26:27]
    v_pk_mov_b32 v[82:83], v[26:27], v[26:27]
    v_pk_mov_b32 v[84:85], v[26:27], v[26:27]
    v_pk_mov_b32 v[86:87], v[26:27], v[26:27]
    v_pk_mov_b32 v[88:89], v[26:27], v[26:27]
    v_pk_mov_b32 v[90:91], v[26:27], v[26:27]
    v_pk_mov_b32 v[92:93], v[26:27], v[26:27]
    v_pk_mov_b32 v[94:95], v[26:27], v[26:27]
    v_cmpx_gt_i32 vcc, 27, v24
    v_mov_b32 v79, v26
    v_mov_b32 v127, v26
    v_cmpx_gt_i32 vcc, 26, v24
    v_mov_b32 v78, v26
    v_mov_b32 v126, v26
    v_cmpx_gt_i32 vcc, 25, v24
    v_mov_b32 v77, v26
    v_mov_b32 v125, v26
    v_cmpx_gt_i32 vcc, 24, v24
    v_mov_b32 v76, v26
    v_mov_b32 v124, v26
    v_cmpx_gt_i32 vcc, 19, v24
    v_mov_b32 v75, v26
    v_mov_b32 v123, v26
    v_cmpx_gt_i32 vcc, 18, v24
    v_mov_b32 v74, v26
    v_mov_b32 v122, v26
    v_cmpx_gt_i32 vcc, 17, v24
    v_mov_b32 v73, v26
    v_mov_b32 v121, v26
    v_cmpx_gt_i32 vcc, 16, v24
    v_mov_b32 v72, v26
    v_mov_b32 v120, v26
    v_cmpx_gt_i32 vcc, 11, v24
    v_mov_b32 v71, v26
    v_mov_b32 v119, v26
    v_cmpx_gt_i32 vcc, 10, v24
    v_mov_b32 v70, v26
    v_mov_b32 v118, v26
    v_cmpx_gt_i32 vcc, 9, v24
    v_mov_b32 v69, v26
    v_mov_b32 v117, v26
    v_cmpx_gt_i32 vcc, 8, v24
    v_mov_b32 v68, v26
    v_mov_b32 v116, v26
    v_cmpx_gt_i32 vcc, 3, v24
    v_mov_b32 v67, v26
    v_mov_b32 v115, v26
    v_cmpx_gt_i32 vcc, 2, v24
    v_mov_b32 v66, v26
    v_mov_b32 v114, v26
    v_cmpx_gt_i32 vcc, 1, v24
    v_mov_b32 v65, v26
    v_mov_b32 v113, v26
    v_cmpx_gt_i32 vcc, 0, v24
    v_mov_b32 v64, v26
    v_mov_b32 v112, v26
    s_mov_b64 exec, -1
AT_NOMASK_3:
    s_nop 3
    v_max3_f32 v24, v64, v65, v66
    v_max3_f32 v24, v24, v67, v68
    v_max3_f32 v24, v24, v69, v70
    v_max3_f32 v24, v24, v71, v72
    v_max3_f32 v24, v24, v73, v74
    v_max3_f32 v24, v24, v75, v76
    v_max3_f32 v24, v24, v77, v78
    v_max3_f32 v24, v24, v79, v80
    v_max3_f32 v24, v24, v81, v82
    v_max3_f32 v24, v24, v83, v84
    v_max3_f32 v24, v24, v85, v86
    v_max3_f32 v24, v24, v87, v88
    v_max3_f32 v24, v24, v89, v90
    v_max3_f32 v24, v24, v91, v92
    v_max3_f32 v24, v24, v93, v94
    v_max_f32 v24, v24, v95
    v_max3_f32 v25, v96, v97, v98
    v_max3_f32 v25, v25, v99, v100
    v_max3_f32 v25, v25, v101, v102
    v_max3_f32 v25, v25, v103, v104
    v_max3_f32 v25, v25, v105, v106
    v_max3_f32 v25, v25, v107, v108
    v_max3_f32 v25, v25, v109, v110
    v_max3_f32 v25, v25, v111, v112
    v_max3_f32 v25, v25, v113, v114
    v_max3_f32 v25, v25, v115, v116
    v_max3_f32 v25, v25, v117, v118
    v_max3_f32 v25, v25, v119, v120
    v_max3_f32 v25, v25, v121, v122
    v_max3_f32 v25, v25, v123, v124
    v_max3_f32 v25, v25, v125, v126
    v_max_f32 v25, v25, v127
    v_mov_b32 v26, v24
    s_nop 1
    v_permlane32_swap_b32 v24, v26
    v_max_f32 v24, v24, v26
    v_mov_b32 v18, v24
    v_sub_f32 v26, 0, v18
    v_pk_add_f32 v[64:65], v[64:65], v[24:25] op_sel:[0,0] op_sel_hi:[1,0] neg_lo:[0,1] neg_hi:[0,1]
    v_pk_add_f32 v[66:67], v[66:67], v[24:25] op_sel:[0,0] op_sel_hi:[1,0] neg_lo:[0,1] neg_hi:[0,1]
    v_pk_add_f32 v[68:69], v[68:69], v[24:25] op_sel:[0,0] op_sel_hi:[1,0] neg_lo:[0,1] neg_hi:[0,1]
    v_pk_add_f32 v[70:71], v[70:71], v[24:25] op_sel:[0,0] op_sel_hi:[1,0] neg_lo:[0,1] neg_hi:[0,1]
    v_pk_add_f32 v[72:73], v[72:73], v[24:25] op_sel:[0,0] op_sel_hi:[1,0] neg_lo:[0,1] neg_hi:[0,1]
    v_pk_add_f32 v[74:75], v[74:75], v[24:25] op_sel:[0,0] op_sel_hi:[1,0] neg_lo:[0,1] neg_hi:[0,1]
    v_pk_add_f32 v[76:77], v[76:77], v[24:25] op_sel:[0,0] op_sel_hi:[1,0] neg_lo:[0,1] neg_hi:[0,1]
    v_pk_add_f32 v[78:79], v[78:79], v[24:25] op_sel:[0,0] op_sel_hi:[1,0] neg_lo:[0,1] neg_hi:[0,1]
    v_pk_add_f32 v[80:81], v[80:81], v[24:25] op_sel:[0,0] op_sel_hi:[1,0] neg_lo:[0,1] neg_hi:[0,1]
    v_pk_add_f32 v[82:83], v[82:83], v[24:25] op_sel:[0,0] op_sel_hi:[1,0] neg_lo:[0,1] neg_hi:[0,1]
    v_pk_add_f32 v[84:85], v[84:85], v[24:25] op_sel:[0,0] op_sel_hi:[1,0] neg_lo:[0,1] neg_hi:[0,1]
    v_pk_add_f32 v[86:87], v[86:87], v[24:25] op_sel:[0,0] op_sel_hi:[1,0] neg_lo:[0,1] neg_hi:[0,1]
    v_pk_add_f32 v[88:89], v[88:89], v[24:25] op_sel:[0,0] op_sel_hi:[1,0] neg_lo:[0,1] neg_hi:[0,1]
    v_pk_add_f32 v[90:91], v[90:91], v[24:25] op_sel:[0,0] op_sel_hi:[1,0] neg_lo:[0,1] neg_hi:[0,1]
    v_pk_add_f32 v[92:93], v[92:93], v[24:25] op_sel:[0,0] op_sel_hi:[1,0] neg_lo:[0,1] neg_hi:[0,1]
    v_pk_add_f32 v[94:95], v[94:95], v[24:25] op_sel:[0,0] op_sel_hi:[1,0] neg_lo:[0,1] neg_hi:[0,1]
    v_pk_mov_b32 v[224:225], v[26:27], v[26:27] op_sel:[0,0]
    v_pk_mov_b32 v[226:227], v[26:27], v[26:27] op_sel:[0,0]
    v_pk_mov_b32 v[228:229], v[26:27], v[26:27] op_sel:[0,0]
    v_pk_mov_b32 v[230:231], v[26:27], v[26:27] op_sel:[0,0]
    v_pk_mov_b32 v[232:233], v[26:27], v[26:27] op_sel:[0,0]
    v_pk_mov_b32 v[234:235], v[26:27], v[26:27] op_sel:[0,0]
    v_pk_mov_b32 v[236:237], v[26:27], v[26:27] op_sel:[0,0]
    v_pk_mov_b32 v[238:239], v[26:27], v[26:27] op_sel:[0,0]
    s_mov_b64 s[76:77], 0
    v_mov_b32 v27, v25
    s_nop 1
    v_permlane32_swap_b32 v25, v27
    v_max_f32 v25, v25, v27
    v_mov_b32 v20, v25
    v_sub_f32 v27, 0, v20
    v_pk_add_f32 v[96:97], v[96:97], v[24:25] op_sel:[0,1] op_sel_hi:[1,1] neg_lo:[0,1] neg_hi:[0,1]
    v_pk_add_f32 v[98:99], v[98:99], v[24:25] op_sel:[0,1] op_sel_hi:[1,1] neg_lo:[0,1] neg_hi:[0,1]
    v_pk_add_f32 v[100:101], v[100:101], v[24:25] op_sel:[0,1] op_sel_hi:[1,1] neg_lo:[0,1] neg_hi:[0,1]
    v_pk_add_f32 v[102:103], v[102:103], v[24:25] op_sel:[0,1] op_sel_hi:[1,1] neg_lo:[0,1] neg_hi:[0,1]
    v_pk_add_f32 v[104:105], v[104:105], v[24:25] op_sel:[0,1] op_sel_hi:[1,1] neg_lo:[0,1] neg_hi:[0,1]
    v_pk_add_f32 v[106:107], v[106:107], v[24:25] op_sel:[0,1] op_sel_hi:[1,1] neg_lo:[0,1] neg_hi:[0,1]
    v_pk_add_f32 v[108:109], v[108:109], v[24:25] op_sel:[0,1] op_sel_hi:[1,1] neg_lo:[0,1] neg_hi:[0,1]
    v_pk_add_f32 v[110:111], v[110:111], v[24:25] op_sel:[0,1] op_sel_hi:[1,1] neg_lo:[0,1] neg_hi:[0,1]
    v_pk_add_f32 v[112:113], v[112:113], v[24:25] op_sel:[0,1] op_sel_hi:[1,1] neg_lo:[0,1] neg_hi:[0,1]
    v_pk_add_f32 v[114:115], v[114:115], v[24:25] op_sel:[0,1] op_sel_hi:[1,1] neg_lo:[0,1] neg_hi:[0,1]
    v_pk_add_f32 v[116:117], v[116:117], v[24:25] op_sel:[0,1] op_sel_hi:[1,1] neg_lo:[0,1] neg_hi:[0,1]
    v_pk_add_f32 v[118:119], v[118:119], v[24:25] op_sel:[0,1] op_sel_hi:[1,1] neg_lo:[0,1] neg_hi:[0,1]
    v_pk_add_f32 v[120:121], v[120:121], v[24:25] op_sel:[0,1] op_sel_hi:[1,1] neg_lo:[0,1] neg_hi:[0,1]
    v_pk_add_f32 v[122:123], v[122:123], v[24:25] op_sel:[0,1] op_sel_hi:[1,1] neg_lo:[0,1] neg_hi:[0,1]
    v_pk_add_f32 v[124:125], v[124:125], v[24:25] op_sel:[0,1] op_sel_hi:[1,1] neg_lo:[0,1] neg_hi:[0,1]
    v_pk_add_f32 v[126:127], v[126:127], v[24:25] op_sel:[0,1] op_sel_hi:[1,1] neg_lo:[0,1] neg_hi:[0,1]
    v_pk_mov_b32 v[240:241], v[26:27], v[26:27] op_sel:[1,1]
    v_pk_mov_b32 v[242:243], v[26:27], v[26:27] op_sel:[1,1]
    v_pk_mov_b32 v[244:245], v[26:27], v[26:27] op_sel:[1,1]
    v_pk_mov_b32 v[246:247], v[26:27], v[26:27] op_sel:[1,1]
    v_pk_mov_b32 v[248:249], v[26:27], v[26:27] op_sel:[1,1]
    v_pk_mov_b32 v[250:251], v[26:27], v[26:27] op_sel:[1,1]
    v_pk_mov_b32 v[252:253], v[26:27], v[26:27] op_sel:[1,1]
    v_pk_mov_b32 v[254:255], v[26:27], v[26:27] op_sel:[1,1]
    s_mov_b64 s[78:79], 0
    s_cmp_eq_u32 s47, 15
    s_cselect_b64 s[20:21], s[68:69], s[20:21]
    s_cselect_b32 s63, 0, s63
    s_cselect_b64 vcc, -1, 0
    v_cndmask_b32 v16, v16, v52, vcc
    v_readlane_b32 s86, v33, s47
    s_bitcmp1_b32 s60, s47
    s_cselect_b32 s90, s62, 0x28000
    s_cselect_b32 s92, s63, 0x80000
    s_cselect_b32 s96, 0x8000, 0
    s_add_u32 s63, s63, s96
    s_lshl_b32 s96, s96, 1
    s_xor_b32 s62, s62, s96
    s_add_u32 s91, s90, 32768
    s_add_u32 s86, s86, s92
    s_cmp_eq_u32 s47, 16
    s_cselect_b64 s[24:25], s[68:69], s[24:25]
    s_cselect_b32 s65, 262144, s65
    s_cselect_b64 vcc, -1, 0
    v_cndmask_b32 v50, v50, v52, vcc
    v_readlane_b32 s87, v51, s47
    s_bitcmp1_b32 s61, s47
    s_cselect_b32 s93, s64, 0x28000
    s_cselect_b32 s95, s65, 0x80000
    s_cselect_b32 s96, 0x8000, 0
    s_add_u32 s65, s65, s96
    s_lshl_b32 s96, s96, 1
    s_xor_b32 s64, s64, s96
    s_add_u32 s94, s93, 32768
    s_add_u32 s87, s87, s95
    s_cmp_eq_u32 s47, 11
    s_cselect_b64 s[16:17], s[68:69], s[16:17]
    s_waitcnt vmcnt(0)
    v_readfirstlane_b32 s45, v59
    s_nop 0
    s_cmp_eq_u32 s45, 256
    s_cbranch_scc0 TL_C2S
TL_C2R:
    s_mov_b32 s8, s10
    s_cmp_lg_u32 s10, 0
    s_cbranch_scc1 TL_HOME
    v_mov_b32 v34, 1073741824
TL_HOME:
    s_nop 4
    s_branch AT_BAR1
AT_FULL0:
    v_mfma_f32_32x32x16_bf16 v[128:143], a[192:195], a[128:131], v[224:239]
    ds_read_b128 a[224:227], v4 offset:4096
    v_exp_f32 v64, v64
    v_exp_f32 v65, v65
    v_mfma_f32_32x32x16_bf16 v[160:175], a[192:195], a[160:163], v[240:255]
    ds_read_b128 a[228:231], v4 offset:12288
    buffer_load_dwordx4 v16, s[20:23], s86 offen offset:2048 lds
    v_exp_f32 v66, v66
    v_add_f32 v19, v19, v64
    v_mfma_f32_32x32x16_bf16 v[144:159], a[196:199], a[128:131], v[224:239]
    ds_read_b128 a[232:235], v4 offset:5120
    v_exp_f32 v67, v67
    v_exp_f32 v68, v68
    v_mfma_f32_32x32x16_bf16 v[176:191], a[196:199], a[160:163], v[240:255]
    ds_read_b128 a[236:239], v4 offset:13312
    buffer_load_dwordx4 v16, s[20:23], s86 offen offset:3072 lds
    v_exp_f32 v69, v69
    v_add_f32 v19, v19, v65
    v_mfma_f32_32x32x16_bf16 v[128:143], a[200:203], a[132:135], v[128:143]
    s_mov_b32 m0, s93
    v_exp_f32 v70, v70
    v_exp_f32 v71, v71
    v_cvt_pk_bf16_f32 v192, v64, v65
    v_mfma_f32_32x32x16_bf16 v[160:175], a[200:203], a[164:167], v[160:175]
    buffer_load_dwordx4 v50, s[24:27], s95 offen offset:0 lds
    v_cvt_pk_bf16_f32 v193, v66, v67
    v_cvt_pk_bf16_f32 v194, v68, v69
    v_cvt_pk_bf16_f32 v195, v70, v71
    v_add_f32 v19, v19, v66
    v_mfma_f32_32x32x16_bf16 v[144:159], a[204:207], a[132:135], v[144:159]
    v_exp_f32 v96, v96
    v_exp_f32 v97, v97
    v_add_f32 v19, v19, v67
    v_mfma_f32_32x32x16_bf16 v[176:191], a[204:207], a[164:167], v[176:191]
    s_waitcnt lgkmcnt(4)
    buffer_load_dwordx4 v50, s[24:27], s95 offen offset:1024 lds
    v_exp_f32 v98, v98
    v_exp_f32 v99, v99
    v_mfma_f32_32x32x16_bf16 v[128:143], a[208:211], a[136:139], v[128:143]
    ds_read_b128 a[240:243], v4 offset:6144
    v_exp_f32 v100, v100
    v_exp_f32 v101, v101
    v_mfma_f32_32x32x16_bf16 v[160:175], a[208:211], a[168:171], v[160:175]
    ds_read_b128 a[244:247], v4 offset:14336
    buffer_load_dwordx4 v50, s[24:27], s95 offen offset:2048 lds
    v_exp_f32 v102, v102
    v_add_f32 v19, v19, v68
    v_mfma_f32_32x32x16_bf16 v[144:159], a[212:215], a[136:139], v[144:159]
    ds_read_b128 a[248:251], v4 offset:7168
    v_exp_f32 v103, v103
    v_cvt_pk_bf16_f32 v208, v96, v97
    v_cvt_pk_bf16_f32 v209, v98, v99
    v_mfma_f32_32x32x16_bf16 v[176:191], a[212:215], a[168:171], v[176:191]
    ds_read_b128 a[252:255], v4 offset:15360
    buffer_load_dwordx4 v50, s[24:27], s95 offen offset:3072 lds
    v_cvt_pk_bf16_f32 v210, v100, v101
    v_cvt_pk_bf16_f32 v211, v102, v103
    v_add_f32 v19, v19, v69
    v_mfma_f32_32x32x16_bf16 v[128:143], a[216:219], a[140:143], v[128:143]
    s_mov_b32 m0, s94
    v_exp_f32 v72, v72
    v_exp_f32 v73, v73
    v_add_f32 v19, v19, v70
    v_mfma_f32_32x32x16_bf16 v[160:175], a[216:219], a[172:175], v[160:175]
    buffer_load_dwordx4 v50, s[24:27], s87 offen offset:0 lds
    v_exp_f32 v74, v74
    v_exp_f32 v75, v75
    v_mfma_f32_32x32x16_bf16 v[144:159], a[220:223], a[140:143], v[144:159]
    v_exp_f32 v76, v76
    v_exp_f32 v77, v77
    v_add_f32 v19, v19, v71
    v_mfma_f32_32x32x16_bf16 v[176:191], a[220:223], a[172:175], v[176:191]
    s_waitcnt lgkmcnt(4)
    buffer_load_dwordx4 v50, s[24:27], s87 offen offset:1024 lds
    v_exp_f32 v78, v78
    v_exp_f32 v79, v79
    v_mfma_f32_32x32x16_bf16 v[128:143], a[224:227], a[144:147], v[128:143]
    ds_read_b128 a[192:195], v5 offset:16384
    v_cvt_pk_bf16_f32 v196, v72, v73
    v_cvt_pk_bf16_f32 v197, v74, v75
    v_cvt_pk_bf16_f32 v198, v76, v77
    v_cvt_pk_bf16_f32 v199, v78, v79
    v_mfma_f32_32x32x16_bf16 v[160:175], a[224:227], a[176:179], v[160:175]
    ds_read_b128 a[196:199], v5 offset:20480
    buffer_load_dwordx4 v50, s[24:27], s87 offen offset:2048 lds
    v_exp_f32 v104, v104
    v_add_f32 v21, v21, v96
    v_mfma_f32_32x32x16_bf16 v[144:159], a[228:231], a[144:147], v[144:159]
    ds_read_b128 a[200:203], v5 offset:24576
    v_exp_f32 v105, v105
    v_exp_f32 v106, v106
    v_mfma_f32_32x32x16_bf16 v[176:191], a[228:231], a[176:179], v[176:191]
    ds_read_b128 a[204:207], v5 offset:28672
    buffer_load_dwordx4 v50, s[24:27], s87 offen offset:3072 lds
    v_exp_f32 v107, v107
    v_add_f32 v21, v21, v97
    v_mfma_f32_32x32x16_bf16 v[128:143], a[232:235], a[148:151], v[128:143]
    s_add_u32 s47, s47, 1
    s_cmp_eq_u32 s47, 15
    s_cselect_b64 s[20:21], s[68:69], s[20:21]
    s_cselect_b32 s63, 0, s63
    s_cselect_b64 vcc, -1, 0
    v_cndmask_b32 v16, v16, v52, vcc
    v_readlane_b32 s86, v33, s47
    v_permlane32_swap_b32 v12, v14
    v_mfma_f32_32x32x16_bf16 v[160:175], a[232:235], a[180:183], v[160:175]
    s_bitcmp1_b32 s60, s47
    v_permlane32_swap_b32 v13, v15
    v_exp_f32 v108, v108
    v_exp_f32 v109, v109
    v_mfma_f32_32x32x16_bf16 v[144:159], a[236:239], a[148:151], v[144:159]
    s_cselect_b32 s90, s62, 0x28000
    buffer_store_dwordx4 v[12:15], v17, s[72:75], s11 offen
    v_exp_f32 v110, v110
    v_exp_f32 v111, v111
    v_mfma_f32_32x32x16_bf16 v[176:191], a[236:239], a[180:183], v[176:191]
    s_waitcnt lgkmcnt(4)
    buffer_load_dwordx4 v[12:15], v8, s[16:19], s70 offen
    v_cvt_pk_bf16_f32 v212, v104, v105
    v_cvt_pk_bf16_f32 v213, v106, v107
    v_cvt_pk_bf16_f32 v214, v108, v109
    v_cvt_pk_bf16_f32 v215, v110, v111
    v_mfma_f32_32x32x16_bf16 v[128:143], a[240:243], a[152:155], v[128:143]
    s_cselect_b32 s92, s63, 0x80000
    ds_read_b128 a[208:211], v5 offset:17408
    buffer_load_dword v36, v35, s[72:75], s71 offen
    v_exp_f32 v80, v80
    v_add_f32 v21, v21, v98
    v_mfma_f32_32x32x16_bf16 v[160:175], a[240:243], a[184:187], v[160:175]
    s_cselect_b32 s96, 0x8000, 0
    ds_read_b128 a[212:215], v5 offset:21504
    v_exp_f32 v81, v81
    v_exp_f32 v82, v82
    v_mfma_f32_32x32x16_bf16 v[144:159], a[244:247], a[152:155], v[144:159]
    s_add_u32 s63, s63, s96
    ds_read_b128 a[216:219], v5 offset:25600
    v_exp_f32 v83, v83
    v_exp_f32 v84, v84
    v_mfma_f32_32x32x16_bf16 v[176:191], a[244:247], a[184:187], v[176:191]
    s_lshl_b32 s96, s96, 1
    ds_read_b128 a[220:223], v5 offset:29696
    v_exp_f32 v85, v85
    v_exp_f32 v86, v86
    v_mfma_f32_32x32x16_bf16 v[128:143], a[248:251], a[156:159], v[128:143]
    s_xor_b32 s62, s62, s96
    v_exp_f32 v87, v87
    v_cvt_pk_bf16_f32 v200, v80, v81
    v_cvt_pk_bf16_f32 v201, v82, v83
    v_cvt_pk_bf16_f32 v202, v84, v85
    v_mfma_f32_32x32x16_bf16 v[160:175], a[248:251], a[188:191], v[160:175]
    s_add_u32 s91, s90, 32768
    v_cvt_pk_bf16_f32 v203, v86, v87
    v_exp_f32 v112, v112
    v_exp_f32 v113, v113
    v_mfma_f32_32x32x16_bf16 v[144:159], a[252:255], a[156:159], v[144:159]
    s_add_u32 s86, s86, s92
    v_exp_f32 v114, v114
    v_exp_f32 v115, v115
    v_readlane_b32 s70, v7, s47
    v_mfma_f32_32x32x16_bf16 v[176:191], a[252:255], a[188:191], v[176:191]
    s_waitcnt lgkmcnt(4)
    v_exp_f32 v116, v116
    v_exp_f32 v117, v117
    v_readlane_b32 s71, v34, s47
    v_mfma_f32_32x32x16_bf16 a[0:15], a[192:195], v[192:195], a[0:15]
    s_cmp_eq_u32 s80, s88
    s_cbranch_scc1 AT_MASK0
AT_MRET0:
    ds_read_b128 a[224:227], v5 offset:18432
    v_readlane_b32 s11, v9, s47
    v_mfma_f32_32x32x16_bf16 a[64:79], a[192:195], v[208:211], a[64:79]
    s_cmp_eq_u32 s47, 16
    s_cselect_b64 s[24:25], s[68:69], s[24:25]
    s_cselect_b32 s65, 262144, s65
    s_cselect_b64 vcc, -1, 0
    v_cndmask_b32 v50, v50, v52, vcc
    v_readlane_b32 s87, v51, s47
    s_bitcmp1_b32 s61, s47
    ds_read_b128 a[228:231], v5 offset:22528
    v_mfma_f32_32x32x16_bf16 a[16:31], a[196:199], v[192:195], a[16:31]
    s_cselect_b32 s93, s64, 0x28000
    ds_read_b128 a[232:235], v5 offset:26624
    v_exp_f32 v118, v118
    v_exp_f32 v119, v119
    v_mfma_f32_32x32x16_bf16 a[80:95], a[196:199], v[208:211], a[80:95]
    s_cselect_b32 s95, s65, 0x80000
    ds_read_b128 a[236:239], v5 offset:30720
    v_cvt_pk_bf16_f32 v216, v112, v113
    v_cvt_pk_bf16_f32 v217, v114, v115
    v_cvt_pk_bf16_f32 v218, v116, v117
    v_cvt_pk_bf16_f32 v219, v118, v119
    v_mfma_f32_32x32x16_bf16 a[32:47], a[200:203], v[192:195], a[32:47]
    s_cselect_b32 s96, 0x8000, 0
    v_exp_f32 v88, v88
    v_exp_f32 v89, v89
    v_max3_f32 v24, v128, v129, v130
    v_mfma_f32_32x32x16_bf16 a[96:111], a[200:203], v[208:211], a[96:111]
    s_add_u32 s65, s65, s96
    v_exp_f32 v90, v90
    v_exp_f32 v91, v91
    v_max3_f32 v24, v24, v131, v132
    v_mfma_f32_32x32x16_bf16 a[48:63], a[204:207], v[192:195], a[48:63]
    s_lshl_b32 s96, s96, 1
    v_exp_f32 v92, v92
    v_exp_f32 v93, v93
    v_max3_f32 v24, v24, v133, v134
    v_mfma_f32_32x32x16_bf16 a[112:127], a[204:207], v[208:211], a[112:127]
    s_waitcnt lgkmcnt(4)
    v_exp_f32 v94, v94
    v_exp_f32 v95, v95
    v_cvt_pk_bf16_f32 v204, v88, v89
    v_mfma_f32_32x32x16_bf16 a[0:15], a[208:211], v[196:199], a[0:15]
    s_xor_b32 s64, s64, s96
    ds_read_b128 a[240:243], v5 offset:19456
    v_cvt_pk_bf16_f32 v205, v90, v91
    v_cvt_pk_bf16_f32 v206, v92, v93
    v_cvt_pk_bf16_f32 v207, v94, v95
    v_max3_f32 v24, v24, v135, v136
    v_mfma_f32_32x32x16_bf16 a[64:79], a[208:211], v[212:215], a[64:79]
    s_add_u32 s94, s93, 32768
    ds_read_b128 a[244:247], v5 offset:23552
    v_exp_f32 v120, v120
    v_exp_f32 v121, v121
    v_mfma_f32_32x32x16_bf16 a[16:31], a[212:215], v[196:199], a[16:31]
    s_add_u32 s87, s87, s95
    ds_read_b128 a[248:251], v5 offset:27648
    v_exp_f32 v122, v122
    v_exp_f32 v123, v123
    v_mfma_f32_32x32x16_bf16 a[80:95], a[212:215], v[212:215], a[80:95]
    s_cmp_eq_u32 s47, 11
    ds_read_b128 a[252:255], v5 offset:31744
    v_exp_f32 v124, v124
    v_exp_f32 v125, v125
    v_mfma_f32_32x32x16_bf16 a[32:47], a[216:219], v[196:199], a[32:47]
    s_cselect_b64 s[16:17], s[68:69], s[16:17]
    v_exp_f32 v126, v126
    v_exp_f32 v127, v127
    v_cvt_pk_bf16_f32 v220, v120, v121
    v_mfma_f32_32x32x16_bf16 a[96:111], a[216:219], v[212:215], a[96:111]
    s_mov_b32 s57, s80
    v_cvt_pk_bf16_f32 v221, v122, v123
    v_cvt_pk_bf16_f32 v222, v124, v125
    v_cvt_pk_bf16_f32 v223, v126, v127
    v_max3_f32 v24, v24, v137, v138
    v_max3_f32 v24, v24, v139, v140
    v_mfma_f32_32x32x16_bf16 a[48:63], a[220:223], v[196:199], a[48:63]
    s_add_u32 s52, s59, 2
    v_max3_f32 v24, v24, v141, v142
    v_max3_f32 v24, v24, v143, v144
    v_max3_f32 v24, v24, v145, v146
    v_max3_f32 v24, v24, v147, v148
    v_max3_f32 v24, v24, v149, v150
    v_mfma_f32_32x32x16_bf16 a[112:127], a[220:223], v[212:215], a[112:127]
    s_waitcnt lgkmcnt(4)
    v_max3_f32 v24, v24, v151, v152
    v_max3_f32 v24, v24, v153, v154
    v_max3_f32 v24, v24, v155, v156
    v_max3_f32 v24, v24, v157, v158
    v_max_f32 v24, v24, v159
    v_mfma_f32_32x32x16_bf16 a[0:15], a[224:227], v[200:203], a[0:15]
    s_cmp_ge_u32 s47, s52
    v_cmp_lt_f32 s[76:77], s54, v24
    v_max3_f32 v25, v160, v161, v162
    v_max3_f32 v25, v25, v163, v164
    v_max3_f32 v25, v25, v165, v166
    v_max3_f32 v25, v25, v167, v168
    v_mfma_f32_32x32x16_bf16 a[64:79], a[224:227], v[216:219], a[64:79]
    s_addc_u32 s80, s57, 1
    v_max3_f32 v25, v25, v169, v170
    v_max3_f32 v25, v25, v171, v172
    v_max3_f32 v25, v25, v173, v174
    v_max3_f32 v25, v25, v175, v176
    v_max3_f32 v25, v25, v177, v178
    v_mfma_f32_32x32x16_bf16 a[16:31], a[228:231], v[200:203], a[16:31]
    s_and_b32 s50, s80, 3
    v_max3_f32 v25, v25, v179, v180
    v_max3_f32 v25, v25, v181, v182
    v_max3_f32 v25, v25, v183, v184
    v_max3_f32 v25, v25, v185, v186
    v_max3_f32 v25, v25, v187, v188
    v_mfma_f32_32x32x16_bf16 a[80:95], a[228:231], v[216:219], a[80:95]
    s_cmp_gt_u32 s80, s53
    v_max3_f32 v25, v25, v189, v190
    v_max_f32 v25, v25, v191
    v_cmp_lt_f32 s[78:79], s54, v25
    v_add_f32 v21, v21, v99
    v_add_f32 v21, v21, v100
    v_mfma_f32_32x32x16_bf16 a[32:47], a[232:235], v[200:203], a[32:47]
    s_cselect_b64 s[98:99], -1, 0
    v_add_f32 v21, v21, v101
    v_add_f32 v21, v21, v102
    v_add_f32 v21, v21, v103
    v_add_f32 v19, v19, v72
    v_add_f32 v19, v19, v73
    v_mfma_f32_32x32x16_bf16 a[96:111], a[232:235], v[216:219], a[96:111]
    s_cmp_eq_u32 s47, s66
    v_add_f32 v19, v19, v74
    v_add_f32 v19, v19, v75
    v_add_f32 v19, v19, v76
    v_add_f32 v19, v19, v77
    v_add_f32 v19, v19, v78
    v_mfma_f32_32x32x16_bf16 a[48:63], a[236:239], v[200:203], a[48:63]
    s_cselect_b32 s81, s67, 1073741824
    v_add_f32 v19, v19, v79
    v_add_f32 v21, v21, v104
    v_add_f32 v21, v21, v105
    v_add_f32 v21, v21, v106
    v_add_f32 v21, v21, v107
    v_mfma_f32_32x32x16_bf16 a[112:127], a[236:239], v[216:219], a[112:127]
    v_add_f32 v21, v21, v108
    v_add_f32 v21, v21, v109
    v_lshl_add_u32 v5, s50, 15, v17
    s_waitcnt vmcnt(3) lgkmcnt(0)
    s_barrier
    ds_read_b128 a[192:195], v5 offset:0
    ds_read_b128 a[196:199], v5 offset:8192
    buffer_store_dword v33, off, s[72:75], s81 sc1
    v_mfma_f32_32x32x16_bf16 a[0:15], a[240:243], v[204:207], a[0:15]
    s_mov_b32 m0, s90
    ds_read_b128 a[200:203], v5 offset:1024
    v_add_f32 v21, v21, v110
    v_add_f32 v21, v21, v111
    v_add_f32 v19, v19, v80
    v_add_f32 v19, v19, v81
    v_mfma_f32_32x32x16_bf16 a[64:79], a[240:243], v[220:223], a[64:79]
    ds_read_b128 a[204:207], v5 offset:9216
    buffer_load_dwordx4 v16, s[20:23], s92 offen offset:0 lds
    v_add_f32 v19, v19, v82
    v_add_f32 v19, v19, v83
    v_add_f32 v19, v19, v84
    v_mfma_f32_32x32x16_bf16 a[16:31], a[244:247], v[204:207], a[16:31]
    ds_read_b128 a[208:211], v5 offset:2048
    buffer_load_dwordx4 v16, s[20:23], s92 offen offset:1024 lds
    v_add_f32 v19, v19, v85
    v_add_f32 v19, v19, v86
    v_add_f32 v19, v19, v87
    v_mfma_f32_32x32x16_bf16 a[80:95], a[244:247], v[220:223], a[80:95]
    ds_read_b128 a[212:215], v5 offset:10240
    buffer_load_dwordx4 v16, s[20:23], s92 offen offset:2048 lds
    v_add_f32 v21, v21, v112
    v_add_f32 v21, v21, v113
    v_add_f32 v21, v21, v114
    v_mfma_f32_32x32x16_bf16 a[32:47], a[248:251], v[204:207], a[32:47]
    ds_read_b128 a[216:219], v5 offset:3072
    buffer_load_dwordx4 v16, s[20:23], s92 offen offset:3072 lds
    v_add_f32 v21, v21, v115
    v_add_f32 v21, v21, v116
    v_add_f32 v21, v21, v117
    v_mfma_f32_32x32x16_bf16 a[96:111], a[248:251], v[220:223], a[96:111]
    s_mov_b32 m0, s91
    ds_read_b128 a[220:223], v5 offset:11264
    buffer_load_dwordx4 v16, s[20:23], s86 offen offset:0 lds
    v_add_f32 v21, v21, v118
    v_add_f32 v21, v21, v119
    v_add_f32 v19, v19, v88
    v_mfma_f32_32x32x16_bf16 a[48:63], a[252:255], v[204:207], a[48:63]
    buffer_load_dwordx4 v16, s[20:23], s86 offen offset:1024 lds
    v_add_f32 v19, v19, v89
    v_add_f32 v19, v19, v90
    v_add_f32 v19, v19, v91
    v_mfma_f32_32x32x16_bf16 a[112:127], a[252:255], v[220:223], a[112:127]
    s_waitcnt lgkmcnt(4)
    v_add_f32 v19, v19, v92
    v_add_f32 v19, v19, v93
    v_add_f32 v19, v19, v94
    v_add_f32 v19, v19, v95
    v_add_f32 v21, v21, v120
    v_add_f32 v21, v21, v121
    v_add_f32 v21, v21, v122
    v_add_f32 v21, v21, v123
    v_add_f32 v21, v21, v124
    v_add_f32 v21, v21, v125
    v_add_f32 v21, v21, v126
    v_add_f32 v21, v21, v127
    s_or_b64 s[98:99], s[98:99], s[76:77]
    s_or_b64 s[98:99], s[98:99], s[78:79]
    s_cbranch_scc1 AT_EXC1
AT_FULL1:
    v_mfma_f32_32x32x16_bf16 v[64:79], a[192:195], a[128:131], v[224:239]
    ds_read_b128 a[224:227], v5 offset:4096
    v_exp_f32 v128, v128
    v_exp_f32 v129, v129
    v_mfma_f32_32x32x16_bf16 v[96:111], a[192:195], a[160:163], v[240:255]
    ds_read_b128 a[228:231], v5 offset:12288
    buffer_load_dwordx4 v16, s[20:23], s86 offen offset:2048 lds
    v_exp_f32 v130, v130
    v_add_f32 v19, v19, v128
    v_mfma_f32_32x32x16_bf16 v[80:95], a[196:199], a[128:131], v[224:239]
    ds_read_b128 a[232:235], v5 offset:5120
    v_exp_f32 v131, v131
    v_exp_f32 v132, v132
    v_mfma_f32_32x32x16_bf16 v[112:127], a[196:199], a[160:163], v[240:255]
    ds_read_b128 a[236:239], v5 offset:13312
    buffer_load_dwordx4 v16, s[20:23], s86 offen offset:3072 lds
    v_exp_f32 v133, v133
    v_add_f32 v19, v19, v129
    v_mfma_f32_32x32x16_bf16 v[64:79], a[200:203], a[132:135], v[64:79]
    s_mov_b32 m0, s93
    v_exp_f32 v134, v134
    v_exp_f32 v135, v135
    v_cvt_pk_bf16_f32 v192, v128, v129
    v_mfma_f32_32x32x16_bf16 v[96:111], a[200:203], a[164:167], v[96:111]
    buffer_load_dwordx4 v50, s[24:27], s95 offen offset:0 lds
    v_cvt_pk_bf16_f32 v193, v130, v131
    v_cvt_pk_bf16_f32 v194, v132, v133
    v_cvt_pk_bf16_f32 v195, v134, v135
    v_add_f32 v19, v19, v130
    v_mfma_f32_32x32x16_bf16 v[80:95], a[204:207], a[132:135], v[80:95]
    v_exp_f32 v160, v160
    v_exp_f32 v161, v161
    v_add_f32 v19, v19, v131
    v_mfma_f32_32x32x16_bf16 v[112:127], a[204:207], a[164:167], v[112:127]
    s_waitcnt lgkmcnt(4)
    buffer_load_dwordx4 v50, s[24:27], s95 offen offset:1024 lds
    v_exp_f32 v162, v162
    v_exp_f32 v163, v163
    v_mfma_f32_32x32x16_bf16 v[64:79], a[208:211], a[136:139], v[64:79]
    ds_read_b128 a[240:243], v5 offset:6144
    v_exp_f32 v164, v164
    v_exp_f32 v165, v165
    v_mfma_f32_32x32x16_bf16 v[96:111], a[208:211], a[168:171], v[96:111]
    ds_read_b128 a[244:247], v5 offset:14336
    buffer_load_dwordx4 v50, s[24:27], s95 offen offset:2048 lds
    v_exp_f32 v166, v166
    v_add_f32 v19, v19, v132
    v_mfma_f32_32x32x16_bf16 v[80:95], a[212:215], a[136:139], v[80:95]
    ds_read_b128 a[248:251], v5 offset:7168
    v_exp_f32 v167, v167
    v_cvt_pk_bf16_f32 v208, v160, v161
    v_cvt_pk_bf16_f32 v209, v162, v163
    v_mfma_f32_32x32x16_bf16 v[112:127], a[212:215], a[168:171], v[112:127]
    ds_read_b128 a[252:255], v5 offset:15360
    buffer_load_dwordx4 v50, s[24:27], s95 offen offset:3072 lds
    v_cvt_pk_bf16_f32 v210, v164, v165
    v_cvt_pk_bf16_f32 v211, v166, v167
    v_add_f32 v19, v19, v133
    v_mfma_f32_32x32x16_bf16 v[64:79], a[216:219], a[140:143], v[64:79]
    s_mov_b32 m0, s94
    v_exp_f32 v136, v136
    v_exp_f32 v137, v137
    v_add_f32 v19, v19, v134
    v_mfma_f32_32x32x16_bf16 v[96:111], a[216:219], a[172:175], v[96:111]
    buffer_load_dwordx4 v50, s[24:27], s87 offen offset:0 lds
    v_exp_f32 v138, v138
    v_exp_f32 v139, v139
    v_mfma_f32_32x32x16_bf16 v[80:95], a[220:223], a[140:143], v[80:95]
    v_exp_f32 v140, v140
    v_exp_f32 v141, v141
    v_add_f32 v19, v19, v135
    v_mfma_f32_32x32x16_bf16 v[112:127], a[220:223], a[172:175], v[112:127]
    s_waitcnt lgkmcnt(4)
    buffer_load_dwordx4 v50, s[24:27], s87 offen offset:1024 lds
    v_exp_f32 v142, v142
    v_exp_f32 v143, v143
    v_mfma_f32_32x32x16_bf16 v[64:79], a[224:227], a[144:147], v[64:79]
    ds_read_b128 a[192:195], v4 offset:16384
    v_cvt_pk_bf16_f32 v196, v136, v137
    v_cvt_pk_bf16_f32 v197, v138, v139
    v_cvt_pk_bf16_f32 v198, v140, v141
    v_cvt_pk_bf16_f32 v199, v142, v143
    v_mfma_f32_32x32x16_bf16 v[96:111], a[224:227], a[176:179], v[96:111]
    ds_read_b128 a[196:199], v4 offset:20480
    buffer_load_dwordx4 v50, s[24:27], s87 offen offset:2048 lds
    v_exp_f32 v168, v168
    v_add_f32 v21, v21, v160
    v_mfma_f32_32x32x16_bf16 v[80:95], a[228:231], a[144:147], v[80:95]
    ds_read_b128 a[200:203], v4 offset:24576
    v_exp_f32 v169, v169
    v_exp_f32 v170, v170
    v_mfma_f32_32x32x16_bf16 v[112:127], a[228:231], a[176:179], v[112:127]
    ds_read_b128 a[204:207], v4 offset:28672
    buffer_load_dwordx4 v50, s[24:27], s87 offen offset:3072 lds
    v_exp_f32 v171, v171
    v_add_f32 v21, v21, v161
    v_mfma_f32_32x32x16_bf16 v[64:79], a[232:235], a[148:151], v[64:79]
    s_add_u32 s47, s47, 1
    s_cmp_eq_u32 s47, 15
    s_cselect_b64 s[20:21], s[68:69], s[20:21]
    s_cselect_b32 s63, 0, s63
    s_cselect_b64 vcc, -1, 0
    v_cndmask_b32 v16, v16, v52, vcc
    v_readlane_b32 s86, v33, s47
    v_permlane32_swap_b32 v60, v62
    v_mfma_f32_32x32x16_bf16 v[96:111], a[232:235], a[180:183], v[96:111]
    s_bitcmp1_b32 s60, s47
    v_permlane32_swap_b32 v61, v63
    v_exp_f32 v172, v172
    v_exp_f32 v173, v173
    v_mfma_f32_32x32x16_bf16 v[80:95], a[236:239], a[148:151], v[80:95]
    s_cselect_b32 s90, s62, 0x28000
    buffer_store_dwordx4 v[60:63], v17, s[72:75], s11 offen
    v_exp_f32 v174, v174
    v_exp_f32 v175, v175
    v_mfma_f32_32x32x16_bf16 v[112:127], a[236:239], a[180:183], v[112:127]
    s_waitcnt lgkmcnt(4)
    buffer_load_dwordx4 v[60:63], v8, s[16:19], s70 offen
    v_cvt_pk_bf16_f32 v212, v168, v169
    v_cvt_pk_bf16_f32 v213, v170, v171
    v_cvt_pk_bf16_f32 v214, v172, v173
    v_cvt_pk_bf16_f32 v215, v174, v175
    v_mfma_f32_32x32x16_bf16 v[64:79], a[240:243], a[152:155], v[64:79]
    s_cselect_b32 s92, s63, 0x80000
    ds_read_b128 a[208:211], v4 offset:17408
    buffer_load_dword v36, v35, s[72:75], s71 offen
    v_exp_f32 v144, v144
    v_add_f32 v21, v21, v162
    v_mfma_f32_32x32x16_bf16 v[96:111], a[240:243], a[184:187], v[96:111]
    s_cselect_b32 s96, 0x8000, 0
    ds_read_b128 a[212:215], v4 offset:21504
    v_exp_f32 v145, v145
    v_exp_f32 v146, v146
    v_mfma_f32_32x32x16_bf16 v[80:95], a[244:247], a[152:155], v[80:95]
    s_add_u32 s63, s63, s96
    ds_read_b128 a[216:219], v4 offset:25600
    v_exp_f32 v147, v147
    v_exp_f32 v148, v148
    v_mfma_f32_32x32x16_bf16 v[112:127], a[244:247], a[184:187], v[112:127]
    s_lshl_b32 s96, s96, 1
    ds_read_b128 a[220:223], v4 offset:29696
    v_exp_f32 v149, v149
    v_exp_f32 v150, v150
    v_mfma_f32_32x32x16_bf16 v[64:79], a[248:251], a[156:159], v[64:79]
    s_xor_b32 s62, s62, s96
    v_exp_f32 v151, v151
    v_cvt_pk_bf16_f32 v200, v144, v145
    v_cvt_pk_bf16_f32 v201, v146, v147
    v_cvt_pk_bf16_f32 v202, v148, v149
    v_mfma_f32_32x32x16_bf16 v[96:111], a[248:251], a[188:191], v[96:111]
    s_add_u32 s91, s90, 32768
    v_cvt_pk_bf16_f32 v203, v150, v151
    v_exp_f32 v176, v176
    v_exp_f32 v177, v177
    v_mfma_f32_32x32x16_bf16 v[80:95], a[252:255], a[156:159], v[80:95]
    s_add_u32 s86, s86, s92
    v_exp_f32 v178, v178
    v_exp_f32 v179, v179
    v_readlane_b32 s70, v7, s47
    v_mfma_f32_32x32x16_bf16 v[112:127], a[252:255], a[188:191], v[112:127]
    s_waitcnt lgkmcnt(4)
    v_exp_f32 v180, v180
    v_exp_f32 v181, v181
    v_readlane_b32 s71, v34, s47
    v_mfma_f32_32x32x16_bf16 a[0:15], a[192:195], v[192:195], a[0:15]
    s_cmp_eq_u32 s80, s88
    s_cbranch_scc1 AT_MASK1
AT_MRET1:
    ds_read_b128 a[224:227], v4 offset:18432
    v_readlane_b32 s11, v9, s47
    v_mfma_f32_32x32x16_bf16 a[64:79], a[192:195], v[208:211], a[64:79]
    s_cmp_eq_u32 s47, 16
    s_cselect_b64 s[24:25], s[68:69], s[24:25]
    s_cselect_b32 s65, 262144, s65
    s_cselect_b64 vcc, -1, 0
    v_cndmask_b32 v50, v50, v52, vcc
    v_readlane_b32 s87, v51, s47
    s_bitcmp1_b32 s61, s47
    ds_read_b128 a[228:231], v4 offset:22528
    v_mfma_f32_32x32x16_bf16 a[16:31], a[196:199], v[192:195], a[16:31]
    s_cselect_b32 s93, s64, 0x28000
    ds_read_b128 a[232:235], v4 offset:26624
    v_exp_f32 v182, v182
    v_exp_f32 v183, v183
    v_mfma_f32_32x32x16_bf16 a[80:95], a[196:199], v[208:211], a[80:95]
    s_cselect_b32 s95, s65, 0x80000
    ds_read_b128 a[236:239], v4 offset:30720
    v_cvt_pk_bf16_f32 v216, v176, v177
    v_cvt_pk_bf16_f32 v217, v178, v179
    v_cvt_pk_bf16_f32 v218, v180, v181
    v_cvt_pk_bf16_f32 v219, v182, v183
    v_mfma_f32_32x32x16_bf16 a[32:47], a[200:203], v[192:195], a[32:47]
    s_cselect_b32 s96, 0x8000, 0
    v_exp_f32 v152, v152
    v_exp_f32 v153, v153
    v_max3_f32 v24, v64, v65, v66
    v_mfma_f32_32x32x16_bf16 a[96:111], a[200:203], v[208:211], a[96:111]
    s_add_u32 s65, s65, s96
    v_exp_f32 v154, v154
    v_exp_f32 v155, v155
    v_max3_f32 v24, v24, v67, v68
    v_mfma_f32_32x32x16_bf16 a[48:63], a[204:207], v[192:195], a[48:63]
    s_lshl_b32 s96, s96, 1
    v_exp_f32 v156, v156
    v_exp_f32 v157, v157
    v_max3_f32 v24, v24, v69, v70
    v_mfma_f32_32x32x16_bf16 a[112:127], a[204:207], v[208:211], a[112:127]
    s_waitcnt lgkmcnt(4)
    v_exp_f32 v158, v158
    v_exp_f32 v159, v159
    v_cvt_pk_bf16_f32 v204, v152, v153
    v_mfma_f32_32x32x16_bf16 a[0:15], a[208:211], v[196:199], a[0:15]
    s_xor_b32 s64, s64, s96
    ds_read_b128 a[240:243], v4 offset:19456
    v_cvt_pk_bf16_f32 v205, v154, v155
    v_cvt_pk_bf16_f32 v206, v156, v157
    v_cvt_pk_bf16_f32 v207, v158, v159
    v_max3_f32 v24, v24, v71, v72
    v_mfma_f32_32x32x16_bf16 a[64:79], a[208:211], v[212:215], a[64:79]
    s_add_u32 s94, s93, 32768
    ds_read_b128 a[244:247], v4 offset:23552
    v_exp_f32 v184, v184
    v_exp_f32 v185, v185
    v_mfma_f32_32x32x16_bf16 a[16:31], a[212:215], v[196:199], a[16:31]
    s_add_u32 s87, s87, s95
    ds_read_b128 a[248:251], v4 offset:27648
    v_exp_f32 v186, v186
    v_exp_f32 v187, v187
    v_mfma_f32_32x32x16_bf16 a[80:95], a[212:215], v[212:215], a[80:95]
    s_cmp_eq_u32 s47, 11
    ds_read_b128 a[252:255], v4 offset:31744
    v_exp_f32 v188, v188
    v_exp_f32 v189, v189
    v_mfma_f32_32x32x16_bf16 a[32:47], a[216:219], v[196:199], a[32:47]
    s_cselect_b64 s[16:17], s[68:69], s[16:17]
    v_exp_f32 v190, v190
    v_exp_f32 v191, v191
    v_cvt_pk_bf16_f32 v220, v184, v185
    v_mfma_f32_32x32x16_bf16 a[96:111], a[216:219], v[212:215], a[96:111]
    s_mov_b32 s57, s80
    v_cvt_pk_bf16_f32 v221, v186, v187
    v_cvt_pk_bf16_f32 v222, v188, v189
    v_cvt_pk_bf16_f32 v223, v190, v191
    v_max3_f32 v24, v24, v73, v74
    v_max3_f32 v24, v24, v75, v76
    v_mfma_f32_32x32x16_bf16 a[48:63], a[220:223], v[196:199], a[48:63]
    s_add_u32 s52, s59, 2
    v_max3_f32 v24, v24, v77, v78
    v_max3_f32 v24, v24, v79, v80
    v_max3_f32 v24, v24, v81, v82
    v_max3_f32 v24, v24, v83, v84
    v_max3_f32 v24, v24, v85, v86
    v_mfma_f32_32x32x16_bf16 a[112:127], a[220:223], v[212:215], a[112:127]
    s_waitcnt lgkmcnt(4)
    v_max3_f32 v24, v24, v87, v88
    v_max3_f32 v24, v24, v89, v90
    v_max3_f32 v24, v24, v91, v92
    v_max3_f32 v24, v24, v93, v94
    v_max_f32 v24, v24, v95
    v_mfma_f32_32x32x16_bf16 a[0:15], a[224:227], v[200:203], a[0:15]
    s_cmp_ge_u32 s47, s52
    v_cmp_lt_f32 s[76:77], s54, v24
    v_max3_f32 v25, v96, v97, v98
    v_max3_f32 v25, v25, v99, v100
    v_max3_f32 v25, v25, v101, v102
    v_max3_f32 v25, v25, v103, v104
    v_mfma_f32_32x32x16_bf16 a[64:79], a[224:227], v[216:219], a[64:79]
    s_addc_u32 s80, s57, 1
    v_max3_f32 v25, v25, v105, v106
    v_max3_f32 v25, v25, v107, v108
    v_max3_f32 v25, v25, v109, v110
    v_max3_f32 v25, v25, v111, v112
    v_max3_f32 v25, v25, v113, v114
    v_mfma_f32_32x32x16_bf16 a[16:31], a[228:231], v[200:203], a[16:31]
    s_and_b32 s50, s80, 3
    v_max3_f32 v25, v25, v115, v116
    v_max3_f32 v25, v25, v117, v118
    v_max3_f32 v25, v25, v119, v120
    v_max3_f32 v25, v25, v121, v122
    v_max3_f32 v25, v25, v123, v124
    v_mfma_f32_32x32x16_bf16 a[80:95], a[228:231], v[216:219], a[80:95]
    s_cmp_gt_u32 s80, s53
    v_max3_f32 v25, v25, v125, v126
    v_max_f32 v25, v25, v127
    v_cmp_lt_f32 s[78:79], s54, v25
    v_add_f32 v21, v21, v163
    v_add_f32 v21, v21, v164
    v_mfma_f32_32x32x16_bf16 a[32:47], a[232:235], v[200:203], a[32:47]
    s_cselect_b64 s[98:99], -1, 0
    v_add_f32 v21, v21, v165
    v_add_f32 v21, v21, v166
    v_add_f32 v21, v21, v167
    v_add_f32 v19, v19, v136
    v_add_f32 v19, v19, v137
    v_mfma_f32_32x32x16_bf16 a[96:111], a[232:235], v[216:219], a[96:111]
    s_cmp_eq_u32 s47, s66
    v_add_f32 v19, v19, v138
    v_add_f32 v19, v19, v139
    v_add_f32 v19, v19, v140
    v_add_f32 v19, v19, v141
    v_add_f32 v19, v19, v142
    v_mfma_f32_32x32x16_bf16 a[48:63], a[236:239], v[200:203], a[48:63]
    s_cselect_b32 s81, s67, 1073741824
    v_add_f32 v19, v19, v143
    v_add_f32 v21, v21, v168
    v_add_f32 v21, v21, v169
    v_add_f32 v21, v21, v170
    v_add_f32 v21, v21, v171
    v_mfma_f32_32x32x16_bf16 a[112:127], a[236:239], v[216:219], a[112:127]
    v_add_f32 v21, v21, v172
    v_add_f32 v21, v21, v173
    v_lshl_add_u32 v4, s50, 15, v17
    s_waitcnt vmcnt(3) lgkmcnt(0)
    s_barrier
    ds_read_b128 a[192:195], v4 offset:0
    ds_read_b128 a[196:199], v4 offset:8192
    buffer_store_dword v33, off, s[72:75], s81 sc1
    v_mfma_f32_32x32x16_bf16 a[0:15], a[240:243], v[204:207], a[0:15]
    s_mov_b32 m0, s90
    ds_read_b128 a[200:203], v4 offset:1024
    v_add_f32 v21, v21, v174
    v_add_f32 v21, v21, v175
    v_add_f32 v19, v19, v144
    v_add_f32 v19, v19, v145
    v_mfma_f32_32x32x16_bf16 a[64:79], a[240:243], v[220:223], a[64:79]
    ds_read_b128 a[204:207], v4 offset:9216
    buffer_load_dwordx4 v16, s[20:23], s92 offen offset:0 lds
    v_add_f32 v19, v19, v146
    v_add_f32 v19, v19, v147
    v_add_f32 v19, v19, v148
    v_mfma_f32_32x32x16_bf16 a[16:31], a[244:247], v[204:207], a[16:31]
    ds_read_b128 a[208:211], v4 offset:2048
    buffer_load_dwordx4 v16, s[20:23], s92 offen offset:1024 lds
    v_add_f32 v19, v19, v149
    v_add_f32 v19, v19, v150
    v_add_f32 v19, v19, v151
    v_mfma_f32_32x32x16_bf16 a[80:95], a[244:247], v[220:223], a[80:95]
    ds_read_b128 a[212:215], v4 offset:10240
    buffer_load_dwordx4 v16, s[20:23], s92 offen offset:2048 lds
    v_add_f32 v21, v21, v176
    v_add_f32 v21, v21, v177
    v_add_f32 v21, v21, v178
    v_mfma_f32_32x32x16_bf16 a[32:47], a[248:251], v[204:207], a[32:47]
    ds_read_b128 a[216:219], v4 offset:3072
    buffer_load_dwordx4 v16, s[20:23], s92 offen offset:3072 lds
    v_add_f32 v21, v21, v179
    v_add_f32 v21, v21, v180
    v_add_f32 v21, v21, v181
    v_mfma_f32_32x32x16_bf16 a[96:111], a[248:251], v[220:223], a[96:111]
    s_mov_b32 m0, s91
    ds_read_b128 a[220:223], v4 offset:11264
    buffer_load_dwordx4 v16, s[20:23], s86 offen offset:0 lds
    v_add_f32 v21, v21, v182
    v_add_f32 v21, v21, v183
    v_add_f32 v19, v19, v152
    v_mfma_f32_32x32x16_bf16 a[48:63], a[252:255], v[204:207], a[48:63]
    buffer_load_dwordx4 v16, s[20:23], s86 offen offset:1024 lds
    v_add_f32 v19, v19, v153
    v_add_f32 v19, v19, v154
    v_add_f32 v19, v19, v155
    v_mfma_f32_32x32x16_bf16 a[112:127], a[252:255], v[220:223], a[112:127]
    s_waitcnt lgkmcnt(4)
    v_add_f32 v19, v19, v156
    v_add_f32 v19, v19, v157
    v_add_f32 v19, v19, v158
    v_add_f32 v19, v19, v159
    v_add_f32 v21, v21, v184
    v_add_f32 v21, v21, v185
    v_add_f32 v21, v21, v186
    v_add_f32 v21, v21, v187
    v_add_f32 v21, v21, v188
    v_add_f32 v21, v21, v189
    v_add_f32 v21, v21, v190
    v_add_f32 v21, v21, v191
    s_or_b64 s[98:99], s[98:99], s[76:77]
    s_or_b64 s[98:99], s[98:99], s[78:79]
    s_cbranch_scc1 AT_EXC0
    s_branch AT_FULL0
AT_MASK0:
    s_nop 7
    s_lshl_b32 s51, s53, 6
    v_subrev_u32 v24, s51, v28
    v_mov_b32 v26, 0xf149f2ca
    v_mov_b32 v27, 0xf149f2ca
    v_pk_mov_b32 v[144:145], v[26:27], v[26:27]
    v_pk_mov_b32 v[146:147], v[26:27], v[26:27]
    v_pk_mov_b32 v[148:149], v[26:27], v[26:27]
    v_pk_mov_b32 v[150:151], v[26:27], v[26:27]
    v_pk_mov_b32 v[152:153], v[26:27], v[26:27]
    v_pk_mov_b32 v[154:155], v[26:27], v[26:27]
    v_pk_mov_b32 v[156:157], v[26:27], v[26:27]
    v_pk_mov_b32 v[158:159], v[26:27], v[26:27]
    v_cmpx_gt_i32 vcc, 27, v24
    v_mov_b32 v143, v26
    v_mov_b32 v191, v26
    v_cmpx_gt_i32 vcc, 26, v24
    v_mov_b32 v142, v26
    v_mov_b32 v190, v26
    v_cmpx_gt_i32 vcc, 25, v24
    v_mov_b32 v141, v26
    v_mov_b32 v189, v26
    v_cmpx_gt_i32 vcc, 24, v24
    v_mov_b32 v140, v26
    v_mov_b32 v188, v26
    v_cmpx_gt_i32 vcc, 19, v24
    v_mov_b32 v139, v26
    v_mov_b32 v187, v26
    v_cmpx_gt_i32 vcc, 18, v24
    v_mov_b32 v138, v26
    v_mov_b32 v186, v26
    v_cmpx_gt_i32 vcc, 17, v24
    v_mov_b32 v137, v26
    v_mov_b32 v185, v26
    v_cmpx_gt_i32 vcc, 16, v24
    v_mov_b32 v136, v26
    v_mov_b32 v184, v26
    v_cmpx_gt_i32 vcc, 11, v24
    v_mov_b32 v135, v26
    v_mov_b32 v183, v26
    v_cmpx_gt_i32 vcc, 10, v24
    v_mov_b32 v134, v26
    v_mov_b32 v182, v26
    v_cmpx_gt_i32 vcc, 9, v24
    v_mov_b32 v133, v26
    v_mov_b32 v181, v26
    v_cmpx_gt_i32 vcc, 8, v24
    v_mov_b32 v132, v26
    v_mov_b32 v180, v26
    v_cmpx_gt_i32 vcc, 3, v24
    v_mov_b32 v131, v26
    v_mov_b32 v179, v26
    v_cmpx_gt_i32 vcc, 2, v24
    v_mov_b32 v130, v26
    v_mov_b32 v178, v26
    v_cmpx_gt_i32 vcc, 1, v24
    v_mov_b32 v129, v26
    v_mov_b32 v177, v26
    v_cmpx_gt_i32 vcc, 0, v24
    v_mov_b32 v128, v26
    v_mov_b32 v176, v26
    s_mov_b64 exec, -1
    s_nop 3
    s_branch AT_MRET0
AT_EXC0:
    buffer_load_dword v57, v56, s[72:75], s35 offen sc1
    s_nop 15
    s_cmp_gt_u32 s57, s53
    s_cbranch_scc1 AT_SW0
    s_cmp_eq_u64 s[76:77], 0
    s_cbranch_scc1 AT_NORS_4
    v_mov_b32 v26, v24
    s_nop 1
    v_permlane32_swap_b32 v24, v26
    v_max3_f32 v24, v24, v26, 0
    v_add_f32 v18, v18, v24
    v_sub_f32 v26, 0, v18
    v_pk_add_f32 v[64:65], v[64:65], v[24:25] op_sel:[0,0] op_sel_hi:[1,0] neg_lo:[0,1] neg_hi:[0,1]
    v_pk_add_f32 v[66:67], v[66:67], v[24:25] op_sel:[0,0] op_sel_hi:[1,0] neg_lo:[0,1] neg_hi:[0,1]
    v_pk_add_f32 v[68:69], v[68:69], v[24:25] op_sel:[0,0] op_sel_hi:[1,0] neg_lo:[0,1] neg_hi:[0,1]
    v_pk_add_f32 v[70:71], v[70:71], v[24:25] op_sel:[0,0] op_sel_hi:[1,0] neg_lo:[0,1] neg_hi:[0,1]
    v_pk_add_f32 v[72:73], v[72:73], v[24:25] op_sel:[0,0] op_sel_hi:[1,0] neg_lo:[0,1] neg_hi:[0,1]
    v_pk_add_f32 v[74:75], v[74:75], v[24:25] op_sel:[0,0] op_sel_hi:[1,0] neg_lo:[0,1] neg_hi:[0,1]
    v_pk_add_f32 v[76:77], v[76:77], v[24:25] op_sel:[0,0] op_sel_hi:[1,0] neg_lo:[0,1] neg_hi:[0,1]
    v_pk_add_f32 v[78:79], v[78:79], v[24:25] op_sel:[0,0] op_sel_hi:[1,0] neg_lo:[0,1] neg_hi:[0,1]
    v_pk_add_f32 v[80:81], v[80:81], v[24:25] op_sel:[0,0] op_sel_hi:[1,0] neg_lo:[0,1] neg_hi:[0,1]
    v_pk_add_f32 v[82:83], v[82:83], v[24:25] op_sel:[0,0] op_sel_hi:[1,0] neg_lo:[0,1] neg_hi:[0,1]
    v_pk_add_f32 v[84:85], v[84:85], v[24:25] op_sel:[0,0] op_sel_hi:[1,0] neg_lo:[0,1] neg_hi:[0,1]
    v_pk_add_f32 v[86:87], v[86:87], v[24:25] op_sel:[0,0] op_sel_hi:[1,0] neg_lo:[0,1] neg_hi:[0,1]
    v_pk_add_f32 v[88:89], v[88:89], v[24:25] op_sel:[0,0] op_sel_hi:[1,0] neg_lo:[0,1] neg_hi:[0,1]
    v_pk_add_f32 v[90:91], v[90:91], v[24:25] op_sel:[0,0] op_sel_hi:[1,0] neg_lo:[0,1] neg_hi:[0,1]
    v_pk_add_f32 v[92:93], v[92:93], v[24:25] op_sel:[0,0] op_sel_hi:[1,0] neg_lo:[0,1] neg_hi:[0,1]
    v_pk_add_f32 v[94:95], v[94:95], v[24:25] op_sel:[0,0] op_sel_hi:[1,0] neg_lo:[0,1] neg_hi:[0,1]
    v_pk_mov_b32 v[224:225], v[26:27], v[26:27] op_sel:[0,0]
    v_pk_mov_b32 v[226:227], v[26:27], v[26:27] op_sel:[0,0]
    v_pk_mov_b32 v[228:229], v[26:27], v[26:27] op_sel:[0,0]
    v_pk_mov_b32 v[230:231], v[26:27], v[26:27] op_sel:[0,0]
    v_pk_mov_b32 v[232:233], v[26:27], v[26:27] op_sel:[0,0]
    v_pk_mov_b32 v[234:235], v[26:27], v[26:27] op_sel:[0,0]
    v_pk_mov_b32 v[236:237], v[26:27], v[26:27] op_sel:[0,0]
    v_pk_mov_b32 v[238:239], v[26:27], v[26:27] op_sel:[0,0]
    s_mov_b64 s[76:77], 0
    v_sub_f32 v30, 0, v24
    v_exp_f32 v30, v30
    s_nop 0
    v_mul_f32 v19, v19, v30
    v_accvgpr_read_b32 v128, a0
    v_accvgpr_read_b32 v129, a1
    v_accvgpr_read_b32 v130, a2
    v_accvgpr_read_b32 v131, a3
    v_accvgpr_read_b32 v132, a4
    v_accvgpr_read_b32 v133, a5
    v_accvgpr_read_b32 v134, a6
    v_accvgpr_read_b32 v135, a7
    v_accvgpr_read_b32 v136, a8
    v_accvgpr_read_b32 v137, a9
    v_accvgpr_read_b32 v138, a10
    v_accvgpr_read_b32 v139, a11
    v_accvgpr_read_b32 v140, a12
    v_accvgpr_read_b32 v141, a13
    v_accvgpr_read_b32 v142, a14
    v_accvgpr_read_b32 v143, a15
    v_mul_f32 v128, v128, v30
    v_mul_f32 v129, v129, v30
    v_mul_f32 v130, v130, v30
    v_mul_f32 v131, v131, v30
    v_mul_f32 v132, v132, v30
    v_mul_f32 v133, v133, v30
    v_mul_f32 v134, v134, v30
    v_mul_f32 v135, v135, v30
    v_mul_f32 v136, v136, v30
    v_mul_f32 v137, v137, v30
    v_mul_f32 v138, v138, v30
    v_mul_f32 v139, v139, v30
    v_mul_f32 v140, v140, v30
    v_mul_f32 v141, v141, v30
    v_mul_f32 v142, v142, v30
    v_mul_f32 v143, v143, v30
    v_accvgpr_write_b32 a0, v128
    v_accvgpr_write_b32 a1, v129
    v_accvgpr_write_b32 a2, v130
    v_accvgpr_write_b32 a3, v131
    v_accvgpr_write_b32 a4, v132
    v_accvgpr_write_b32 a5, v133
    v_accvgpr_write_b32 a6, v134
    v_accvgpr_write_b32 a7, v135
    v_accvgpr_write_b32 a8, v136
    v_accvgpr_write_b32 a9, v137
    v_accvgpr_write_b32 a10, v138
    v_accvgpr_write_b32 a11, v139
    v_accvgpr_write_b32 a12, v140
    v_accvgpr_write_b32 a13, v141
    v_accvgpr_write_b32 a14, v142
    v_accvgpr_write_b32 a15, v143
    v_accvgpr_read_b32 v128, a16
    v_accvgpr_read_b32 v129, a17
    v_accvgpr_read_b32 v130, a18
    v_accvgpr_read_b32 v131, a19
    v_accvgpr_read_b32 v132, a20
    v_accvgpr_read_b32 v133, a21
    v_accvgpr_read_b32 v134, a22
    v_accvgpr_read_b32 v135, a23
    v_accvgpr_read_b32 v136, a24
    v_accvgpr_read_b32 v137, a25
    v_accvgpr_read_b32 v138, a26
    v_accvgpr_read_b32 v139, a27
    v_accvgpr_read_b32 v140, a28
    v_accvgpr_read_b32 v141, a29
    v_accvgpr_read_b32 v142, a30
    v_accvgpr_read_b32 v143, a31
    v_mul_f32 v128, v128, v30
    v_mul_f32 v129, v129, v30
    v_mul_f32 v130, v130, v30
    v_mul_f32 v131, v131, v30
    v_mul_f32 v132, v132, v30
    v_mul_f32 v133, v133, v30
    v_mul_f32 v134, v134, v30
    v_mul_f32 v135, v135, v30
    v_mul_f32 v136, v136, v30
    v_mul_f32 v137, v137, v30
    v_mul_f32 v138, v138, v30
    v_mul_f32 v139, v139, v30
    v_mul_f32 v140, v140, v30
    v_mul_f32 v141, v141, v30
    v_mul_f32 v142, v142, v30
    v_mul_f32 v143, v143, v30
    v_accvgpr_write_b32 a16, v128
    v_accvgpr_write_b32 a17, v129
    v_accvgpr_write_b32 a18, v130
    v_accvgpr_write_b32 a19, v131
    v_accvgpr_write_b32 a20, v132
    v_accvgpr_write_b32 a21, v133
    v_accvgpr_write_b32 a22, v134
    v_accvgpr_write_b32 a23, v135
    v_accvgpr_write_b32 a24, v136
    v_accvgpr_write_b32 a25, v137
    v_accvgpr_write_b32 a26, v138
    v_accvgpr_write_b32 a27, v139
    v_accvgpr_write_b32 a28, v140
    v_accvgpr_write_b32 a29, v141
    v_accvgpr_write_b32 a30, v142
    v_accvgpr_write_b32 a31, v143
    v_accvgpr_read_b32 v128, a32
    v_accvgpr_read_b32 v129, a33
    v_accvgpr_read_b32 v130, a34
    v_accvgpr_read_b32 v131, a35
    v_accvgpr_read_b32 v132, a36
    v_accvgpr_read_b32 v133, a37
    v_accvgpr_read_b32 v134, a38
    v_accvgpr_read_b32 v135, a39
    v_accvgpr_read_b32 v136, a40
    v_accvgpr_read_b32 v137, a41
    v_accvgpr_read_b32 v138, a42
    v_accvgpr_read_b32 v139, a43
    v_accvgpr_read_b32 v140, a44
    v_accvgpr_read_b32 v141, a45
    v_accvgpr_read_b32 v142, a46
    v_accvgpr_read_b32 v143, a47
    v_mul_f32 v128, v128, v30
    v_mul_f32 v129, v129, v30
    v_mul_f32 v130, v130, v30
    v_mul_f32 v131, v131, v30
    v_mul_f32 v132, v132, v30
    v_mul_f32 v133, v133, v30
    v_mul_f32 v134, v134, v30
    v_mul_f32 v135, v135, v30
    v_mul_f32 v136, v136, v30
    v_mul_f32 v137, v137, v30
    v_mul_f32 v138, v138, v30
    v_mul_f32 v139, v139, v30
    v_mul_f32 v140, v140, v30
    v_mul_f32 v141, v141, v30
    v_mul_f32 v142, v142, v30
    v_mul_f32 v143, v143, v30
    v_accvgpr_write_b32 a32, v128
    v_accvgpr_write_b32 a33, v129
    v_accvgpr_write_b32 a34, v130
    v_accvgpr_write_b32 a35, v131
    v_accvgpr_write_b32 a36, v132
    v_accvgpr_write_b32 a37, v133
    v_accvgpr_write_b32 a38, v134
    v_accvgpr_write_b32 a39, v135
    v_accvgpr_write_b32 a40, v136
    v_accvgpr_write_b32 a41, v137
    v_accvgpr_write_b32 a42, v138
    v_accvgpr_write_b32 a43, v139
    v_accvgpr_write_b32 a44, v140
    v_accvgpr_write_b32 a45, v141
    v_accvgpr_write_b32 a46, v142
    v_accvgpr_write_b32 a47, v143
    v_accvgpr_read_b32 v128, a48
    v_accvgpr_read_b32 v129, a49
    v_accvgpr_read_b32 v130, a50
    v_accvgpr_read_b32 v131, a51
    v_accvgpr_read_b32 v132, a52
    v_accvgpr_read_b32 v133, a53
    v_accvgpr_read_b32 v134, a54
    v_accvgpr_read_b32 v135, a55
    v_accvgpr_read_b32 v136, a56
    v_accvgpr_read_b32 v137, a57
    v_accvgpr_read_b32 v138, a58
    v_accvgpr_read_b32 v139, a59
    v_accvgpr_read_b32 v140, a60
    v_accvgpr_read_b32 v141, a61
    v_accvgpr_read_b32 v142, a62
    v_accvgpr_read_b32 v143, a63
    v_mul_f32 v128, v128, v30
    v_mul_f32 v129, v129, v30
    v_mul_f32 v130, v130, v30
    v_mul_f32 v131, v131, v30
    v_mul_f32 v132, v132, v30
    v_mul_f32 v133, v133, v30
    v_mul_f32 v134, v134, v30
    v_mul_f32 v135, v135, v30
    v_mul_f32 v136, v136, v30
    v_mul_f32 v137, v137, v30
    v_mul_f32 v138, v138, v30
    v_mul_f32 v139, v139, v30
    v_mul_f32 v140, v140, v30
    v_mul_f32 v141, v141, v30
    v_mul_f32 v142, v142, v30
    v_mul_f32 v143, v143, v30
    v_accvgpr_write_b32 a48, v128
    v_accvgpr_write_b32 a49, v129
    v_accvgpr_write_b32 a50, v130
    v_accvgpr_write_b32 a51, v131
    v_accvgpr_write_b32 a52, v132
    v_accvgpr_write_b32 a53, v133
    v_accvgpr_write_b32 a54, v134
    v_accvgpr_write_b32 a55, v135
    v_accvgpr_write_b32 a56, v136
    v_accvgpr_write_b32 a57, v137
    v_accvgpr_write_b32 a58, v138
    v_accvgpr_write_b32 a59, v139
    v_accvgpr_write_b32 a60, v140
    v_accvgpr_write_b32 a61, v141
    v_accvgpr_write_b32 a62, v142
    v_accvgpr_write_b32 a63, v143
AT_NORS_4:
    s_nop 4
    s_cmp_eq_u64 s[78:79], 0
    s_cbranch_scc1 AT_NORS_5
    v_mov_b32 v27, v25
    s_nop 1
    v_permlane32_swap_b32 v25, v27
    v_max3_f32 v25, v25, v27, 0
    v_add_f32 v20, v20, v25
    v_sub_f32 v27, 0, v20
    v_pk_add_f32 v[96:97], v[96:97], v[24:25] op_sel:[0,1] op_sel_hi:[1,1] neg_lo:[0,1] neg_hi:[0,1]
    v_pk_add_f32 v[98:99], v[98:99], v[24:25] op_sel:[0,1] op_sel_hi:[1,1] neg_lo:[0,1] neg_hi:[0,1]
    v_pk_add_f32 v[100:101], v[100:101], v[24:25] op_sel:[0,1] op_sel_hi:[1,1] neg_lo:[0,1] neg_hi:[0,1]
    v_pk_add_f32 v[102:103], v[102:103], v[24:25] op_sel:[0,1] op_sel_hi:[1,1] neg_lo:[0,1] neg_hi:[0,1]
    v_pk_add_f32 v[104:105], v[104:105], v[24:25] op_sel:[0,1] op_sel_hi:[1,1] neg_lo:[0,1] neg_hi:[0,1]
    v_pk_add_f32 v[106:107], v[106:107], v[24:25] op_sel:[0,1] op_sel_hi:[1,1] neg_lo:[0,1] neg_hi:[0,1]
    v_pk_add_f32 v[108:109], v[108:109], v[24:25] op_sel:[0,1] op_sel_hi:[1,1] neg_lo:[0,1] neg_hi:[0,1]
    v_pk_add_f32 v[110:111], v[110:111], v[24:25] op_sel:[0,1] op_sel_hi:[1,1] neg_lo:[0,1] neg_hi:[0,1]
    v_pk_add_f32 v[112:113], v[112:113], v[24:25] op_sel:[0,1] op_sel_hi:[1,1] neg_lo:[0,1] neg_hi:[0,1]
    v_pk_add_f32 v[114:115], v[114:115], v[24:25] op_sel:[0,1] op_sel_hi:[1,1] neg_lo:[0,1] neg_hi:[0,1]
    v_pk_add_f32 v[116:117], v[116:117], v[24:25] op_sel:[0,1] op_sel_hi:[1,1] neg_lo:[0,1] neg_hi:[0,1]
    v_pk_add_f32 v[118:119], v[118:119], v[24:25] op_sel:[0,1] op_sel_hi:[1,1] neg_lo:[0,1] neg_hi:[0,1]
    v_pk_add_f32 v[120:121], v[120:121], v[24:25] op_sel:[0,1] op_sel_hi:[1,1] neg_lo:[0,1] neg_hi:[0,1]
    v_pk_add_f32 v[122:123], v[122:123], v[24:25] op_sel:[0,1] op_sel_hi:[1,1] neg_lo:[0,1] neg_hi:[0,1]
    v_pk_add_f32 v[124:125], v[124:125], v[24:25] op_sel:[0,1] op_sel_hi:[1,1] neg_lo:[0,1] neg_hi:[0,1]
    v_pk_add_f32 v[126:127], v[126:127], v[24:25] op_sel:[0,1] op_sel_hi:[1,1] neg_lo:[0,1] neg_hi:[0,1]
    v_pk_mov_b32 v[240:241], v[26:27], v[26:27] op_sel:[1,1]
    v_pk_mov_b32 v[242:243], v[26:27], v[26:27] op_sel:[1,1]
    v_pk_mov_b32 v[244:245], v[26:27], v[26:27] op_sel:[1,1]
    v_pk_mov_b32 v[246:247], v[26:27], v[26:27] op_sel:[1,1]
    v_pk_mov_b32 v[248:249], v[26:27], v[26:27] op_sel:[1,1]
    v_pk_mov_b32 v[250:251], v[26:27], v[26:27] op_sel:[1,1]
    v_pk_mov_b32 v[252:253], v[26:27], v[26:27] op_sel:[1,1]
    v_pk_mov_b32 v[254:255], v[26:27], v[26:27] op_sel:[1,1]
    s_mov_b64 s[78:79], 0
    v_sub_f32 v30, 0, v25
    v_exp_f32 v30, v30
    s_nop 0
    v_mul_f32 v21, v21, v30
    v_accvgpr_read_b32 v128, a64
    v_accvgpr_read_b32 v129, a65
    v_accvgpr_read_b32 v130, a66
    v_accvgpr_read_b32 v131, a67
    v_accvgpr_read_b32 v132, a68
    v_accvgpr_read_b32 v133, a69
    v_accvgpr_read_b32 v134, a70
    v_accvgpr_read_b32 v135, a71
    v_accvgpr_read_b32 v136, a72
    v_accvgpr_read_b32 v137, a73
    v_accvgpr_read_b32 v138, a74
    v_accvgpr_read_b32 v139, a75
    v_accvgpr_read_b32 v140, a76
    v_accvgpr_read_b32 v141, a77
    v_accvgpr_read_b32 v142, a78
    v_accvgpr_read_b32 v143, a79
    v_mul_f32 v128, v128, v30
    v_mul_f32 v129, v129, v30
    v_mul_f32 v130, v130, v30
    v_mul_f32 v131, v131, v30
    v_mul_f32 v132, v132, v30
    v_mul_f32 v133, v133, v30
    v_mul_f32 v134, v134, v30
    v_mul_f32 v135, v135, v30
    v_mul_f32 v136, v136, v30
    v_mul_f32 v137, v137, v30
    v_mul_f32 v138, v138, v30
    v_mul_f32 v139, v139, v30
    v_mul_f32 v140, v140, v30
    v_mul_f32 v141, v141, v30
    v_mul_f32 v142, v142, v30
    v_mul_f32 v143, v143, v30
    v_accvgpr_write_b32 a64, v128
    v_accvgpr_write_b32 a65, v129
    v_accvgpr_write_b32 a66, v130
    v_accvgpr_write_b32 a67, v131
    v_accvgpr_write_b32 a68, v132
    v_accvgpr_write_b32 a69, v133
    v_accvgpr_write_b32 a70, v134
    v_accvgpr_write_b32 a71, v135
    v_accvgpr_write_b32 a72, v136
    v_accvgpr_write_b32 a73, v137
    v_accvgpr_write_b32 a74, v138
    v_accvgpr_write_b32 a75, v139
    v_accvgpr_write_b32 a76, v140
    v_accvgpr_write_b32 a77, v141
    v_accvgpr_write_b32 a78, v142
    v_accvgpr_write_b32 a79, v143
    v_accvgpr_read_b32 v128, a80
    v_accvgpr_read_b32 v129, a81
    v_accvgpr_read_b32 v130, a82
    v_accvgpr_read_b32 v131, a83
    v_accvgpr_read_b32 v132, a84
    v_accvgpr_read_b32 v133, a85
    v_accvgpr_read_b32 v134, a86
    v_accvgpr_read_b32 v135, a87
    v_accvgpr_read_b32 v136, a88
    v_accvgpr_read_b32 v137, a89
    v_accvgpr_read_b32 v138, a90
    v_accvgpr_read_b32 v139, a91
    v_accvgpr_read_b32 v140, a92
    v_accvgpr_read_b32 v141, a93
    v_accvgpr_read_b32 v142, a94
    v_accvgpr_read_b32 v143, a95
    v_mul_f32 v128, v128, v30
    v_mul_f32 v129, v129, v30
    v_mul_f32 v130, v130, v30
    v_mul_f32 v131, v131, v30
    v_mul_f32 v132, v132, v30
    v_mul_f32 v133, v133, v30
    v_mul_f32 v134, v134, v30
    v_mul_f32 v135, v135, v30
    v_mul_f32 v136, v136, v30
    v_mul_f32 v137, v137, v30
    v_mul_f32 v138, v138, v30
    v_mul_f32 v139, v139, v30
    v_mul_f32 v140, v140, v30
    v_mul_f32 v141, v141, v30
    v_mul_f32 v142, v142, v30
    v_mul_f32 v143, v143, v30
    v_accvgpr_write_b32 a80, v128
    v_accvgpr_write_b32 a81, v129
    v_accvgpr_write_b32 a82, v130
    v_accvgpr_write_b32 a83, v131
    v_accvgpr_write_b32 a84, v132
    v_accvgpr_write_b32 a85, v133
    v_accvgpr_write_b32 a86, v134
    v_accvgpr_write_b32 a87, v135
    v_accvgpr_write_b32 a88, v136
    v_accvgpr_write_b32 a89, v137
    v_accvgpr_write_b32 a90, v138
    v_accvgpr_write_b32 a91, v139
    v_accvgpr_write_b32 a92, v140
    v_accvgpr_write_b32 a93, v141
    v_accvgpr_write_b32 a94, v142
    v_accvgpr_write_b32 a95, v143
    v_accvgpr_read_b32 v128, a96
    v_accvgpr_read_b32 v129, a97
    v_accvgpr_read_b32 v130, a98
    v_accvgpr_read_b32 v131, a99
    v_accvgpr_read_b32 v132, a100
    v_accvgpr_read_b32 v133, a101
    v_accvgpr_read_b32 v134, a102
    v_accvgpr_read_b32 v135, a103
    v_accvgpr_read_b32 v136, a104
    v_accvgpr_read_b32 v137, a105
    v_accvgpr_read_b32 v138, a106
    v_accvgpr_read_b32 v139, a107
    v_accvgpr_read_b32 v140, a108
    v_accvgpr_read_b32 v141, a109
    v_accvgpr_read_b32 v142, a110
    v_accvgpr_read_b32 v143, a111
    v_mul_f32 v128, v128, v30
    v_mul_f32 v129, v129, v30
    v_mul_f32 v130, v130, v30
    v_mul_f32 v131, v131, v30
    v_mul_f32 v132, v132, v30
    v_mul_f32 v133, v133, v30
    v_mul_f32 v134, v134, v30
    v_mul_f32 v135, v135, v30
    v_mul_f32 v136, v136, v30
    v_mul_f32 v137, v137, v30
    v_mul_f32 v138, v138, v30
    v_mul_f32 v139, v139, v30
    v_mul_f32 v140, v140, v30
    v_mul_f32 v141, v141, v30
    v_mul_f32 v142, v142, v30
    v_mul_f32 v143, v143, v30
    v_accvgpr_write_b32 a96, v128
    v_accvgpr_write_b32 a97, v129
    v_accvgpr_write_b32 a98, v130
    v_accvgpr_write_b32 a99, v131
    v_accvgpr_write_b32 a100, v132
    v_accvgpr_write_b32 a101, v133
    v_accvgpr_write_b32 a102, v134
    v_accvgpr_write_b32 a103, v135
    v_accvgpr_write_b32 a104, v136
    v_accvgpr_write_b32 a105, v137
    v_accvgpr_write_b32 a106, v138
    v_accvgpr_write_b32 a107, v139
    v_accvgpr_write_b32 a108, v140
    v_accvgpr_write_b32 a109, v141
    v_accvgpr_write_b32 a110, v142
    v_accvgpr_write_b32 a111, v143
    v_accvgpr_read_b32 v128, a112
    v_accvgpr_read_b32 v129, a113
    v_accvgpr_read_b32 v130, a114
    v_accvgpr_read_b32 v131, a115
    v_accvgpr_read_b32 v132, a116
    v_accvgpr_read_b32 v133, a117
    v_accvgpr_read_b32 v134, a118
    v_accvgpr_read_b32 v135, a119
    v_accvgpr_read_b32 v136, a120
    v_accvgpr_read_b32 v137, a121
    v_accvgpr_read_b32 v138, a122
    v_accvgpr_read_b32 v139, a123
    v_accvgpr_read_b32 v140, a124
    v_accvgpr_read_b32 v141, a125
    v_accvgpr_read_b32 v142, a126
    v_accvgpr_read_b32 v143, a127
    v_mul_f32 v128, v128, v30
    v_mul_f32 v129, v129, v30
    v_mul_f32 v130, v130, v30
    v_mul_f32 v131, v131, v30
    v_mul_f32 v132, v132, v30
    v_mul_f32 v133, v133, v30
    v_mul_f32 v134, v134, v30
    v_mul_f32 v135, v135, v30
    v_mul_f32 v136, v136, v30
    v_mul_f32 v137, v137, v30
    v_mul_f32 v138, v138, v30
    v_mul_f32 v139, v139, v30
    v_mul_f32 v140, v140, v30
    v_mul_f32 v141, v141, v30
    v_mul_f32 v142, v142, v30
    v_mul_f32 v143, v143, v30
    v_accvgpr_write_b32 a112, v128
    v_accvgpr_write_b32 a113, v129
    v_accvgpr_write_b32 a114, v130
    v_accvgpr_write_b32 a115, v131
    v_accvgpr_write_b32 a116, v132
    v_accvgpr_write_b32 a117, v133
    v_accvgpr_write_b32 a118, v134
    v_accvgpr_write_b32 a119, v135
    v_accvgpr_write_b32 a120, v136
    v_accvgpr_write_b32 a121, v137
    v_accvgpr_write_b32 a122, v138
    v_accvgpr_write_b32 a123, v139
    v_accvgpr_write_b32 a124, v140
    v_accvgpr_write_b32 a125, v141
    v_accvgpr_write_b32 a126, v142
    v_accvgpr_write_b32 a127, v143
AT_NORS_5:
    s_nop 4
    s_nop 7
    s_cmp_le_u32 s80, s53
    s_cbranch_scc1 AT_FULL0
    s_waitcnt lgkmcnt(0)
    ds_read_b128 a[192:195], v5 offset:16384
    ds_read_b128 a[196:199], v5 offset:20480
    ds_read_b128 a[200:203], v5 offset:24576
    ds_read_b128 a[204:207], v5 offset:28672
    ds_read_b128 a[208:211], v5 offset:17408
    ds_read_b128 a[212:215], v5 offset:21504
    ds_read_b128 a[216:219], v5 offset:25600
    ds_read_b128 a[220:223], v5 offset:29696
    v_exp_f32 v64, v64
    v_exp_f32 v65, v65
    v_exp_f32 v66, v66
    v_exp_f32 v67, v67
    v_exp_f32 v68, v68
    v_exp_f32 v69, v69
    s_nop 0
    buffer_load_dwordx4 v16, s[20:23], s86 offen offset:2048 lds
    v_exp_f32 v70, v70
    v_exp_f32 v71, v71
    v_cvt_pk_bf16_f32 v192, v64, v65
    v_cvt_pk_bf16_f32 v193, v66, v67
    v_cvt_pk_bf16_f32 v194, v68, v69
    v_cvt_pk_bf16_f32 v195, v70, v71
    s_nop 0
    buffer_load_dwordx4 v16, s[20:23], s86 offen offset:3072 lds
    v_exp_f32 v96, v96
    v_exp_f32 v97, v97
    v_exp_f32 v98, v98
    v_exp_f32 v99, v99
    v_exp_f32 v100, v100
    v_exp_f32 v101, v101
    s_mov_b32 m0, s93
    s_nop 0
    buffer_load_dwordx4 v50, s[24:27], s95 offen offset:0 lds
    v_exp_f32 v102, v102
    v_exp_f32 v103, v103
    v_cvt_pk_bf16_f32 v208, v96, v97
    v_cvt_pk_bf16_f32 v209, v98, v99
    v_cvt_pk_bf16_f32 v210, v100, v101
    v_cvt_pk_bf16_f32 v211, v102, v103
    s_nop 0
    buffer_load_dwordx4 v50, s[24:27], s95 offen offset:1024 lds
    s_waitcnt lgkmcnt(4)
    v_mfma_f32_32x32x16_bf16 a[0:15], a[192:195], v[192:195], a[0:15]
    ds_read_b128 a[224:227], v5 offset:18432
    v_exp_f32 v72, v72
    v_exp_f32 v73, v73
    v_exp_f32 v74, v74
    v_add_f32 v19, v19, v64
    v_mfma_f32_32x32x16_bf16 a[64:79], a[192:195], v[208:211], a[64:79]
    ds_read_b128 a[228:231], v5 offset:22528
    v_exp_f32 v75, v75
    v_exp_f32 v76, v76
    v_exp_f32 v77, v77
    v_add_f32 v19, v19, v65
    v_mfma_f32_32x32x16_bf16 a[16:31], a[196:199], v[192:195], a[16:31]
    ds_read_b128 a[232:235], v5 offset:26624
    v_exp_f32 v78, v78
    v_exp_f32 v79, v79
    v_cvt_pk_bf16_f32 v196, v72, v73
    v_cvt_pk_bf16_f32 v197, v74, v75
    v_cvt_pk_bf16_f32 v198, v76, v77
    v_mfma_f32_32x32x16_bf16 a[80:95], a[196:199], v[208:211], a[80:95]
    ds_read_b128 a[236:239], v5 offset:30720
    v_cvt_pk_bf16_f32 v199, v78, v79
    v_exp_f32 v104, v104
    v_exp_f32 v105, v105
    v_exp_f32 v106, v106
    v_mfma_f32_32x32x16_bf16 a[32:47], a[200:203], v[192:195], a[32:47]
    buffer_load_dwordx4 v50, s[24:27], s95 offen offset:2048 lds
    v_exp_f32 v107, v107
    v_exp_f32 v108, v108
    v_exp_f32 v109, v109
    v_add_f32 v19, v19, v66
    v_mfma_f32_32x32x16_bf16 a[96:111], a[200:203], v[208:211], a[96:111]
    buffer_load_dwordx4 v50, s[24:27], s95 offen offset:3072 lds
    v_exp_f32 v110, v110
    v_exp_f32 v111, v111
    v_cvt_pk_bf16_f32 v212, v104, v105
    v_cvt_pk_bf16_f32 v213, v106, v107
    v_cvt_pk_bf16_f32 v214, v108, v109
    v_mfma_f32_32x32x16_bf16 a[48:63], a[204:207], v[192:195], a[48:63]
    s_mov_b32 m0, s94
    s_nop 0
    buffer_load_dwordx4 v50, s[24:27], s87 offen offset:0 lds
    v_cvt_pk_bf16_f32 v215, v110, v111
    v_exp_f32 v80, v80
    v_exp_f32 v81, v81
    v_exp_f32 v82, v82
    v_mfma_f32_32x32x16_bf16 a[112:127], a[204:207], v[208:211], a[112:127]
    s_waitcnt lgkmcnt(4)
    buffer_load_dwordx4 v50, s[24:27], s87 offen offset:1024 lds
    v_exp_f32 v83, v83
    v_exp_f32 v84, v84
    v_exp_f32 v85, v85
    v_add_f32 v19, v19, v67
    v_mfma_f32_32x32x16_bf16 a[0:15], a[208:211], v[196:199], a[0:15]
    ds_read_b128 a[240:243], v5 offset:19456
    v_exp_f32 v86, v86
    v_exp_f32 v87, v87
    v_cvt_pk_bf16_f32 v200, v80, v81
    v_cvt_pk_bf16_f32 v201, v82, v83
    v_cvt_pk_bf16_f32 v202, v84, v85
    v_mfma_f32_32x32x16_bf16 a[64:79], a[208:211], v[212:215], a[64:79]
    ds_read_b128 a[244:247], v5 offset:23552
    v_cvt_pk_bf16_f32 v203, v86, v87
    v_exp_f32 v112, v112
    v_exp_f32 v113, v113
    v_exp_f32 v114, v114
    v_mfma_f32_32x32x16_bf16 a[16:31], a[212:215], v[196:199], a[16:31]
    ds_read_b128 a[248:251], v5 offset:27648
    v_exp_f32 v115, v115
    v_exp_f32 v116, v116
    v_exp_f32 v117, v117
    v_add_f32 v19, v19, v68
    v_mfma_f32_32x32x16_bf16 a[80:95], a[212:215], v[212:215], a[80:95]
    ds_read_b128 a[252:255], v5 offset:31744
    v_exp_f32 v118, v118
    v_exp_f32 v119, v119
    v_cvt_pk_bf16_f32 v216, v112, v113
    v_cvt_pk_bf16_f32 v217, v114, v115
    v_cvt_pk_bf16_f32 v218, v116, v117
    v_mfma_f32_32x32x16_bf16 a[32:47], a[216:219], v[196:199], a[32:47]
    buffer_load_dwordx4 v50, s[24:27], s87 offen offset:2048 lds
    v_cvt_pk_bf16_f32 v219, v118, v119
    v_exp_f32 v88, v88
    v_exp_f32 v89, v89
    v_exp_f32 v90, v90
    v_mfma_f32_32x32x16_bf16 a[96:111], a[216:219], v[212:215], a[96:111]
    buffer_load_dwordx4 v50, s[24:27], s87 offen offset:3072 lds
    v_exp_f32 v91, v91
    v_exp_f32 v92, v92
    v_exp_f32 v93, v93
    v_add_f32 v19, v19, v69
    v_mfma_f32_32x32x16_bf16 a[48:63], a[220:223], v[196:199], a[48:63]
    s_add_u32 s47, s47, 1
    s_cmp_eq_u32 s47, 15
    s_cselect_b64 s[20:21], s[68:69], s[20:21]
    s_cselect_b32 s63, 0, s63
    s_cselect_b64 vcc, -1, 0
    v_cndmask_b32 v16, v16, v52, vcc
    v_readlane_b32 s86, v33, s47
    s_bitcmp1_b32 s60, s47
    s_cselect_b32 s90, s62, 0x28000
    s_cselect_b32 s92, s63, 0x80000
    s_cselect_b32 s96, 0x8000, 0
    s_add_u32 s63, s63, s96
    s_lshl_b32 s96, s96, 1
    s_xor_b32 s62, s62, s96
    s_add_u32 s91, s90, 32768
    s_add_u32 s86, s86, s92
    s_cmp_eq_u32 s47, 16
    s_cselect_b64 s[24:25], s[68:69], s[24:25]
    v_permlane32_swap_b32 v12, v14
    v_mfma_f32_32x32x16_bf16 a[112:127], a[220:223], v[212:215], a[112:127]
    s_waitcnt lgkmcnt(4)
    v_permlane32_swap_b32 v13, v15
    v_exp_f32 v94, v94
    v_exp_f32 v95, v95
    v_cvt_pk_bf16_f32 v204, v88, v89
    v_cvt_pk_bf16_f32 v205, v90, v91
    v_cvt_pk_bf16_f32 v206, v92, v93
    v_mfma_f32_32x32x16_bf16 a[0:15], a[224:227], v[200:203], a[0:15]
    s_cselect_b32 s65, 262144, s65
    buffer_store_dwordx4 v[12:15], v17, s[72:75], s11 offen
    v_cvt_pk_bf16_f32 v207, v94, v95
    v_exp_f32 v120, v120
    v_exp_f32 v121, v121
    v_exp_f32 v122, v122
    v_mfma_f32_32x32x16_bf16 a[64:79], a[224:227], v[216:219], a[64:79]
    s_cselect_b64 vcc, -1, 0
    buffer_load_dwordx4 v[12:15], v8, s[16:19], s70 offen
    v_exp_f32 v123, v123
    v_exp_f32 v124, v124
    v_exp_f32 v125, v125
    v_add_f32 v19, v19, v70
    v_mfma_f32_32x32x16_bf16 a[16:31], a[228:231], v[200:203], a[16:31]
    v_cndmask_b32 v50, v50, v52, vcc
    buffer_load_dword v36, v35, s[72:75], s71 offen
    v_exp_f32 v126, v126
    v_exp_f32 v127, v127
    v_cvt_pk_bf16_f32 v220, v120, v121
    v_cvt_pk_bf16_f32 v221, v122, v123
    v_cvt_pk_bf16_f32 v222, v124, v125
    v_mfma_f32_32x32x16_bf16 a[80:95], a[228:231], v[216:219], a[80:95]
    v_readlane_b32 s87, v51, s47
    v_cvt_pk_bf16_f32 v223, v126, v127
    v_add_f32 v19, v19, v71
    v_add_f32 v21, v21, v96
    v_add_f32 v21, v21, v97
    v_add_f32 v21, v21, v98
    v_add_f32 v21, v21, v99
    v_add_f32 v21, v21, v100
    v_add_f32 v21, v21, v101
    v_mfma_f32_32x32x16_bf16 a[32:47], a[232:235], v[200:203], a[32:47]
    s_bitcmp1_b32 s61, s47
    v_readlane_b32 s70, v7, s47
    v_readlane_b32 s71, v34, s47
    v_readlane_b32 s11, v9, s47
    v_add_f32 v21, v21, v102
    v_add_f32 v21, v21, v103
    v_add_f32 v19, v19, v72
    v_add_f32 v19, v19, v73
    v_add_f32 v19, v19, v74
    v_mfma_f32_32x32x16_bf16 a[96:111], a[232:235], v[216:219], a[96:111]
    s_cselect_b32 s93, s64, 0x28000
    v_add_f32 v19, v19, v75
    v_add_f32 v19, v19, v76
    v_add_f32 v19, v19, v77
    v_add_f32 v19, v19, v78
    v_add_f32 v19, v19, v79
    v_add_f32 v21, v21, v104
    v_add_f32 v21, v21, v105
    v_add_f32 v21, v21, v106
    v_mfma_f32_32x32x16_bf16 a[48:63], a[236:239], v[200:203], a[48:63]
    s_cselect_b32 s95, s65, 0x80000
    v_add_f32 v21, v21, v107
    v_add_f32 v21, v21, v108
    v_add_f32 v21, v21, v109
    v_add_f32 v21, v21, v110
    v_add_f32 v21, v21, v111
    v_add_f32 v19, v19, v80
    v_add_f32 v19, v19, v81
    v_add_f32 v19, v19, v82
    v_mfma_f32_32x32x16_bf16 a[112:127], a[236:239], v[216:219], a[112:127]
    s_waitcnt lgkmcnt(0)
    v_add_f32 v19, v19, v83
    v_add_f32 v19, v19, v84
    v_add_f32 v19, v19, v85
    v_add_f32 v19, v19, v86
    v_add_f32 v19, v19, v87
    v_add_f32 v21, v21, v112
    v_add_f32 v21, v21, v113
    v_add_f32 v21, v21, v114
    v_mfma_f32_32x32x16_bf16 a[0:15], a[240:243], v[204:207], a[0:15]
    s_cselect_b32 s96, 0x8000, 0
    v_add_f32 v21, v21, v115
    v_add_f32 v21, v21, v116
    v_add_f32 v21, v21, v117
    v_add_f32 v21, v21, v118
    v_add_f32 v21, v21, v119
    v_add_f32 v19, v19, v88
    v_add_f32 v19, v19, v89
    v_add_f32 v19, v19, v90
    v_mfma_f32_32x32x16_bf16 a[64:79], a[240:243], v[220:223], a[64:79]
    s_add_u32 s65, s65, s96
    v_add_f32 v19, v19, v91
    v_add_f32 v19, v19, v92
    v_add_f32 v19, v19, v93
    v_add_f32 v19, v19, v94
    v_add_f32 v19, v19, v95
    v_add_f32 v21, v21, v120
    v_add_f32 v21, v21, v121
    v_add_f32 v21, v21, v122
    v_mfma_f32_32x32x16_bf16 a[16:31], a[244:247], v[204:207], a[16:31]
    s_lshl_b32 s96, s96, 1
    v_add_f32 v21, v21, v123
    v_add_f32 v21, v21, v124
    v_add_f32 v21, v21, v125
    v_add_f32 v21, v21, v126
    v_add_f32 v21, v21, v127
    v_mfma_f32_32x32x16_bf16 a[80:95], a[244:247], v[220:223], a[80:95]
    s_xor_b32 s64, s64, s96
    v_mfma_f32_32x32x16_bf16 a[32:47], a[248:251], v[204:207], a[32:47]
    s_add_u32 s94, s93, 32768
    v_mfma_f32_32x32x16_bf16 a[96:111], a[248:251], v[220:223], a[96:111]
    s_add_u32 s87, s87, s95
    v_mfma_f32_32x32x16_bf16 a[48:63], a[252:255], v[204:207], a[48:63]
    s_cmp_eq_u32 s47, 11
    v_mfma_f32_32x32x16_bf16 a[112:127], a[252:255], v[220:223], a[112:127]
    s_cselect_b64 s[16:17], s[68:69], s[16:17]
    s_cmp_lt_u32 s47, s89
    s_cbranch_scc1 AT_SWA
    s_branch AT_MERGE
AT_BAR0:
    s_waitcnt vmcnt(3)
AT_BARW0:
    s_nop 0
    s_mov_b32 s57, s80
    s_add_u32 s52, s59, 2
    s_cmp_ge_u32 s47, s52
    s_addc_u32 s80, s57, 1
    s_and_b32 s50, s80, 3
    s_cmp_gt_u32 s80, s53
    s_cselect_b64 s[98:99], -1, 0
    s_cmp_eq_u32 s47, s66
    s_cselect_b32 s81, s67, 1073741824
    v_lshl_add_u32 v5, s50, 15, v17
    s_waitcnt lgkmcnt(0)
    s_barrier
    ds_read_b128 a[192:195], v5 offset:0
    ds_read_b128 a[196:199], v5 offset:8192
    ds_read_b128 a[200:203], v5 offset:1024
    ds_read_b128 a[204:207], v5 offset:9216
    ds_read_b128 a[208:211], v5 offset:2048
    ds_read_b128 a[212:215], v5 offset:10240
    ds_read_b128 a[216:219], v5 offset:3072
    ds_read_b128 a[220:223], v5 offset:11264
    buffer_store_dword v33, off, s[72:75], s81 sc1
    s_mov_b32 m0, s90
    s_nop 0
    buffer_load_dwordx4 v16, s[20:23], s92 offen offset:0 lds
    buffer_load_dwordx4 v16, s[20:23], s92 offen offset:1024 lds
    buffer_load_dwordx4 v16, s[20:23], s92 offen offset:2048 lds
    buffer_load_dwordx4 v16, s[20:23], s92 offen offset:3072 lds
    s_mov_b32 m0, s91
    s_nop 0
    buffer_load_dwordx4 v16, s[20:23], s86 offen offset:0 lds
    buffer_load_dwordx4 v16, s[20:23], s86 offen offset:1024 lds
    s_waitcnt lgkmcnt(4)
    s_branch AT_EXC1
AT_MASK1:
    s_nop 7
    s_lshl_b32 s51, s53, 6
    v_subrev_u32 v24, s51, v28
    v_mov_b32 v26, 0xf149f2ca
    v_mov_b32 v27, 0xf149f2ca
    v_pk_mov_b32 v[80:81], v[26:27], v[26:27]
    v_pk_mov_b32 v[82:83], v[26:27], v[26:27]
    v_pk_mov_b32 v[84:85], v[26:27], v[26:27]
    v_pk_mov_b32 v[86:87], v[26:27], v[26:27]
    v_pk_mov_b32 v[88:89], v[26:27], v[26:27]
    v_pk_mov_b32 v[90:91], v[26:27], v[26:27]
    v_pk_mov_b32 v[92:93], v[26:27], v[26:27]
    v_pk_mov_b32 v[94:95], v[26:27], v[26:27]
    v_cmpx_gt_i32 vcc, 27, v24
    v_mov_b32 v79, v26
    v_mov_b32 v127, v26
    v_cmpx_gt_i32 vcc, 26, v24
    v_mov_b32 v78, v26
    v_mov_b32 v126, v26
    v_cmpx_gt_i32 vcc, 25, v24
    v_mov_b32 v77, v26
    v_mov_b32 v125, v26
    v_cmpx_gt_i32 vcc, 24, v24
    v_mov_b32 v76, v26
    v_mov_b32 v124, v26
    v_cmpx_gt_i32 vcc, 19, v24
    v_mov_b32 v75, v26
    v_mov_b32 v123, v26
    v_cmpx_gt_i32 vcc, 18, v24
    v_mov_b32 v74, v26
    v_mov_b32 v122, v26
    v_cmpx_gt_i32 vcc, 17, v24
    v_mov_b32 v73, v26
    v_mov_b32 v121, v26
    v_cmpx_gt_i32 vcc, 16, v24
    v_mov_b32 v72, v26
    v_mov_b32 v120, v26
    v_cmpx_gt_i32 vcc, 11, v24
    v_mov_b32 v71, v26
    v_mov_b32 v119, v26
    v_cmpx_gt_i32 vcc, 10, v24
    v_mov_b32 v70, v26
    v_mov_b32 v118, v26
    v_cmpx_gt_i32 vcc, 9, v24
    v_mov_b32 v69, v26
    v_mov_b32 v117, v26
    v_cmpx_gt_i32 vcc, 8, v24
    v_mov_b32 v68, v26
    v_mov_b32 v116, v26
    v_cmpx_gt_i32 vcc, 3, v24
    v_mov_b32 v67, v26
    v_mov_b32 v115, v26
    v_cmpx_gt_i32 vcc, 2, v24
    v_mov_b32 v66, v26
    v_mov_b32 v114, v26
    v_cmpx_gt_i32 vcc, 1, v24
    v_mov_b32 v65, v26
    v_mov_b32 v113, v26
    v_cmpx_gt_i32 vcc, 0, v24
    v_mov_b32 v64, v26
    v_mov_b32 v112, v26
    s_mov_b64 exec, -1
    s_nop 3
    s_branch AT_MRET1
AT_EXC1:
    s_nop 15
    s_cmp_gt_u32 s57, s53
    s_cbranch_scc1 AT_SW1
    s_cmp_eq_u64 s[76:77], 0
    s_cbranch_scc1 AT_NORS_6
    v_mov_b32 v26, v24
    s_nop 1
    v_permlane32_swap_b32 v24, v26
    v_max3_f32 v24, v24, v26, 0
    v_add_f32 v18, v18, v24
    v_sub_f32 v26, 0, v18
    v_pk_add_f32 v[128:129], v[128:129], v[24:25] op_sel:[0,0] op_sel_hi:[1,0] neg_lo:[0,1] neg_hi:[0,1]
    v_pk_add_f32 v[130:131], v[130:131], v[24:25] op_sel:[0,0] op_sel_hi:[1,0] neg_lo:[0,1] neg_hi:[0,1]
    v_pk_add_f32 v[132:133], v[132:133], v[24:25] op_sel:[0,0] op_sel_hi:[1,0] neg_lo:[0,1] neg_hi:[0,1]
    v_pk_add_f32 v[134:135], v[134:135], v[24:25] op_sel:[0,0] op_sel_hi:[1,0] neg_lo:[0,1] neg_hi:[0,1]
    v_pk_add_f32 v[136:137], v[136:137], v[24:25] op_sel:[0,0] op_sel_hi:[1,0] neg_lo:[0,1] neg_hi:[0,1]
    v_pk_add_f32 v[138:139], v[138:139], v[24:25] op_sel:[0,0] op_sel_hi:[1,0] neg_lo:[0,1] neg_hi:[0,1]
    v_pk_add_f32 v[140:141], v[140:141], v[24:25] op_sel:[0,0] op_sel_hi:[1,0] neg_lo:[0,1] neg_hi:[0,1]
    v_pk_add_f32 v[142:143], v[142:143], v[24:25] op_sel:[0,0] op_sel_hi:[1,0] neg_lo:[0,1] neg_hi:[0,1]
    v_pk_add_f32 v[144:145], v[144:145], v[24:25] op_sel:[0,0] op_sel_hi:[1,0] neg_lo:[0,1] neg_hi:[0,1]
    v_pk_add_f32 v[146:147], v[146:147], v[24:25] op_sel:[0,0] op_sel_hi:[1,0] neg_lo:[0,1] neg_hi:[0,1]
    v_pk_add_f32 v[148:149], v[148:149], v[24:25] op_sel:[0,0] op_sel_hi:[1,0] neg_lo:[0,1] neg_hi:[0,1]
    v_pk_add_f32 v[150:151], v[150:151], v[24:25] op_sel:[0,0] op_sel_hi:[1,0] neg_lo:[0,1] neg_hi:[0,1]
    v_pk_add_f32 v[152:153], v[152:153], v[24:25] op_sel:[0,0] op_sel_hi:[1,0] neg_lo:[0,1] neg_hi:[0,1]
    v_pk_add_f32 v[154:155], v[154:155], v[24:25] op_sel:[0,0] op_sel_hi:[1,0] neg_lo:[0,1] neg_hi:[0,1]
    v_pk_add_f32 v[156:157], v[156:157], v[24:25] op_sel:[0,0] op_sel_hi:[1,0] neg_lo:[0,1] neg_hi:[0,1]
    v_pk_add_f32 v[158:159], v[158:159], v[24:25] op_sel:[0,0] op_sel_hi:[1,0] neg_lo:[0,1] neg_hi:[0,1]
    v_pk_mov_b32 v[224:225], v[26:27], v[26:27] op_sel:[0,0]
    v_pk_mov_b32 v[226:227], v[26:27], v[26:27] op_sel:[0,0]
    v_pk_mov_b32 v[228:229], v[26:27], v[26:27] op_sel:[0,0]
    v_pk_mov_b32 v[230:231], v[26:27], v[26:27] op_sel:[0,0]
    v_pk_mov_b32 v[232:233], v[26:27], v[26:27] op_sel:[0,0]
    v_pk_mov_b32 v[234:235], v[26:27], v[26:27] op_sel:[0,0]
    v_pk_mov_b32 v[236:237], v[26:27], v[26:27] op_sel:[0,0]
    v_pk_mov_b32 v[238:239], v[26:27], v[26:27] op_sel:[0,0]
    s_mov_b64 s[76:77], 0
    v_sub_f32 v30, 0, v24
    v_exp_f32 v30, v30
    s_nop 0
    v_mul_f32 v19, v19, v30
    v_accvgpr_read_b32 v64, a0
    v_accvgpr_read_b32 v65, a1
    v_accvgpr_read_b32 v66, a2
    v_accvgpr_read_b32 v67, a3
    v_accvgpr_read_b32 v68, a4
    v_accvgpr_read_b32 v69, a5
    v_accvgpr_read_b32 v70, a6
    v_accvgpr_read_b32 v71, a7
    v_accvgpr_read_b32 v72, a8
    v_accvgpr_read_b32 v73, a9
    v_accvgpr_read_b32 v74, a10
    v_accvgpr_read_b32 v75, a11
    v_accvgpr_read_b32 v76, a12
    v_accvgpr_read_b32 v77, a13
    v_accvgpr_read_b32 v78, a14
    v_accvgpr_read_b32 v79, a15
    v_mul_f32 v64, v64, v30
    v_mul_f32 v65, v65, v30
    v_mul_f32 v66, v66, v30
    v_mul_f32 v67, v67, v30
    v_mul_f32 v68, v68, v30
    v_mul_f32 v69, v69, v30
    v_mul_f32 v70, v70, v30
    v_mul_f32 v71, v71, v30
    v_mul_f32 v72, v72, v30
    v_mul_f32 v73, v73, v30
    v_mul_f32 v74, v74, v30
    v_mul_f32 v75, v75, v30
    v_mul_f32 v76, v76, v30
    v_mul_f32 v77, v77, v30
    v_mul_f32 v78, v78, v30
    v_mul_f32 v79, v79, v30
    v_accvgpr_write_b32 a0, v64
    v_accvgpr_write_b32 a1, v65
    v_accvgpr_write_b32 a2, v66
    v_accvgpr_write_b32 a3, v67
    v_accvgpr_write_b32 a4, v68
    v_accvgpr_write_b32 a5, v69
    v_accvgpr_write_b32 a6, v70
    v_accvgpr_write_b32 a7, v71
    v_accvgpr_write_b32 a8, v72
    v_accvgpr_write_b32 a9, v73
    v_accvgpr_write_b32 a10, v74
    v_accvgpr_write_b32 a11, v75
    v_accvgpr_write_b32 a12, v76
    v_accvgpr_write_b32 a13, v77
    v_accvgpr_write_b32 a14, v78
    v_accvgpr_write_b32 a15, v79
    v_accvgpr_read_b32 v64, a16
    v_accvgpr_read_b32 v65, a17
    v_accvgpr_read_b32 v66, a18
    v_accvgpr_read_b32 v67, a19
    v_accvgpr_read_b32 v68, a20
    v_accvgpr_read_b32 v69, a21
    v_accvgpr_read_b32 v70, a22
    v_accvgpr_read_b32 v71, a23
    v_accvgpr_read_b32 v72, a24
    v_accvgpr_read_b32 v73, a25
    v_accvgpr_read_b32 v74, a26
    v_accvgpr_read_b32 v75, a27
    v_accvgpr_read_b32 v76, a28
    v_accvgpr_read_b32 v77, a29
    v_accvgpr_read_b32 v78, a30
    v_accvgpr_read_b32 v79, a31
    v_mul_f32 v64, v64, v30
    v_mul_f32 v65, v65, v30
    v_mul_f32 v66, v66, v30
    v_mul_f32 v67, v67, v30
    v_mul_f32 v68, v68, v30
    v_mul_f32 v69, v69, v30
    v_mul_f32 v70, v70, v30
    v_mul_f32 v71, v71, v30
    v_mul_f32 v72, v72, v30
    v_mul_f32 v73, v73, v30
    v_mul_f32 v74, v74, v30
    v_mul_f32 v75, v75, v30
    v_mul_f32 v76, v76, v30
    v_mul_f32 v77, v77, v30
    v_mul_f32 v78, v78, v30
    v_mul_f32 v79, v79, v30
    v_accvgpr_write_b32 a16, v64
    v_accvgpr_write_b32 a17, v65
    v_accvgpr_write_b32 a18, v66
    v_accvgpr_write_b32 a19, v67
    v_accvgpr_write_b32 a20, v68
    v_accvgpr_write_b32 a21, v69
    v_accvgpr_write_b32 a22, v70
    v_accvgpr_write_b32 a23, v71
    v_accvgpr_write_b32 a24, v72
    v_accvgpr_write_b32 a25, v73
    v_accvgpr_write_b32 a26, v74
    v_accvgpr_write_b32 a27, v75
    v_accvgpr_write_b32 a28, v76
    v_accvgpr_write_b32 a29, v77
    v_accvgpr_write_b32 a30, v78
    v_accvgpr_write_b32 a31, v79
    v_accvgpr_read_b32 v64, a32
    v_accvgpr_read_b32 v65, a33
    v_accvgpr_read_b32 v66, a34
    v_accvgpr_read_b32 v67, a35
    v_accvgpr_read_b32 v68, a36
    v_accvgpr_read_b32 v69, a37
    v_accvgpr_read_b32 v70, a38
    v_accvgpr_read_b32 v71, a39
    v_accvgpr_read_b32 v72, a40
    v_accvgpr_read_b32 v73, a41
    v_accvgpr_read_b32 v74, a42
    v_accvgpr_read_b32 v75, a43
    v_accvgpr_read_b32 v76, a44
    v_accvgpr_read_b32 v77, a45
    v_accvgpr_read_b32 v78, a46
    v_accvgpr_read_b32 v79, a47
    v_mul_f32 v64, v64, v30
    v_mul_f32 v65, v65, v30
    v_mul_f32 v66, v66, v30
    v_mul_f32 v67, v67, v30
    v_mul_f32 v68, v68, v30
    v_mul_f32 v69, v69, v30
    v_mul_f32 v70, v70, v30
    v_mul_f32 v71, v71, v30
    v_mul_f32 v72, v72, v30
    v_mul_f32 v73, v73, v30
    v_mul_f32 v74, v74, v30
    v_mul_f32 v75, v75, v30
    v_mul_f32 v76, v76, v30
    v_mul_f32 v77, v77, v30
    v_mul_f32 v78, v78, v30
    v_mul_f32 v79, v79, v30
    v_accvgpr_write_b32 a32, v64
    v_accvgpr_write_b32 a33, v65
    v_accvgpr_write_b32 a34, v66
    v_accvgpr_write_b32 a35, v67
    v_accvgpr_write_b32 a36, v68
    v_accvgpr_write_b32 a37, v69
    v_accvgpr_write_b32 a38, v70
    v_accvgpr_write_b32 a39, v71
    v_accvgpr_write_b32 a40, v72
    v_accvgpr_write_b32 a41, v73
    v_accvgpr_write_b32 a42, v74
    v_accvgpr_write_b32 a43, v75
    v_accvgpr_write_b32 a44, v76
    v_accvgpr_write_b32 a45, v77
    v_accvgpr_write_b32 a46, v78
    v_accvgpr_write_b32 a47, v79
    v_accvgpr_read_b32 v64, a48
    v_accvgpr_read_b32 v65, a49
    v_accvgpr_read_b32 v66, a50
    v_accvgpr_read_b32 v67, a51
    v_accvgpr_read_b32 v68, a52
    v_accvgpr_read_b32 v69, a53
    v_accvgpr_read_b32 v70, a54
    v_accvgpr_read_b32 v71, a55
    v_accvgpr_read_b32 v72, a56
    v_accvgpr_read_b32 v73, a57
    v_accvgpr_read_b32 v74, a58
    v_accvgpr_read_b32 v75, a59
    v_accvgpr_read_b32 v76, a60
    v_accvgpr_read_b32 v77, a61
    v_accvgpr_read_b32 v78, a62
    v_accvgpr_read_b32 v79, a63
    v_mul_f32 v64, v64, v30
    v_mul_f32 v65, v65, v30
    v_mul_f32 v66, v66, v30
    v_mul_f32 v67, v67, v30
    v_mul_f32 v68, v68, v30
    v_mul_f32 v69, v69, v30
    v_mul_f32 v70, v70, v30
    v_mul_f32 v71, v71, v30
    v_mul_f32 v72, v72, v30
    v_mul_f32 v73, v73, v30
    v_mul_f32 v74, v74, v30
    v_mul_f32 v75, v75, v30
    v_mul_f32 v76, v76, v30
    v_mul_f32 v77, v77, v30
    v_mul_f32 v78, v78, v30
    v_mul_f32 v79, v79, v30
    v_accvgpr_write_b32 a48, v64
    v_accvgpr_write_b32 a49, v65
    v_accvgpr_write_b32 a50, v66
    v_accvgpr_write_b32 a51, v67
    v_accvgpr_write_b32 a52, v68
    v_accvgpr_write_b32 a53, v69
    v_accvgpr_write_b32 a54, v70
    v_accvgpr_write_b32 a55, v71
    v_accvgpr_write_b32 a56, v72
    v_accvgpr_write_b32 a57, v73
    v_accvgpr_write_b32 a58, v74
    v_accvgpr_write_b32 a59, v75
    v_accvgpr_write_b32 a60, v76
    v_accvgpr_write_b32 a61, v77
    v_accvgpr_write_b32 a62, v78
    v_accvgpr_write_b32 a63, v79
AT_NORS_6:
    s_nop 4
    s_cmp_eq_u64 s[78:79], 0
    s_cbranch_scc1 AT_NORS_7
    v_mov_b32 v27, v25
    s_nop 1
    v_permlane32_swap_b32 v25, v27
    v_max3_f32 v25, v25, v27, 0
    v_add_f32 v20, v20, v25
    v_sub_f32 v27, 0, v20
    v_pk_add_f32 v[160:161], v[160:161], v[24:25] op_sel:[0,1] op_sel_hi:[1,1] neg_lo:[0,1] neg_hi:[0,1]
    v_pk_add_f32 v[162:163], v[162:163], v[24:25] op_sel:[0,1] op_sel_hi:[1,1] neg_lo:[0,1] neg_hi:[0,1]
    v_pk_add_f32 v[164:165], v[164:165], v[24:25] op_sel:[0,1] op_sel_hi:[1,1] neg_lo:[0,1] neg_hi:[0,1]
    v_pk_add_f32 v[166:167], v[166:167], v[24:25] op_sel:[0,1] op_sel_hi:[1,1] neg_lo:[0,1] neg_hi:[0,1]
    v_pk_add_f32 v[168:169], v[168:169], v[24:25] op_sel:[0,1] op_sel_hi:[1,1] neg_lo:[0,1] neg_hi:[0,1]
    v_pk_add_f32 v[170:171], v[170:171], v[24:25] op_sel:[0,1] op_sel_hi:[1,1] neg_lo:[0,1] neg_hi:[0,1]
    v_pk_add_f32 v[172:173], v[172:173], v[24:25] op_sel:[0,1] op_sel_hi:[1,1] neg_lo:[0,1] neg_hi:[0,1]
    v_pk_add_f32 v[174:175], v[174:175], v[24:25] op_sel:[0,1] op_sel_hi:[1,1] neg_lo:[0,1] neg_hi:[0,1]
    v_pk_add_f32 v[176:177], v[176:177], v[24:25] op_sel:[0,1] op_sel_hi:[1,1] neg_lo:[0,1] neg_hi:[0,1]
    v_pk_add_f32 v[178:179], v[178:179], v[24:25] op_sel:[0,1] op_sel_hi:[1,1] neg_lo:[0,1] neg_hi:[0,1]
    v_pk_add_f32 v[180:181], v[180:181], v[24:25] op_sel:[0,1] op_sel_hi:[1,1] neg_lo:[0,1] neg_hi:[0,1]
    v_pk_add_f32 v[182:183], v[182:183], v[24:25] op_sel:[0,1] op_sel_hi:[1,1] neg_lo:[0,1] neg_hi:[0,1]
    v_pk_add_f32 v[184:185], v[184:185], v[24:25] op_sel:[0,1] op_sel_hi:[1,1] neg_lo:[0,1] neg_hi:[0,1]
    v_pk_add_f32 v[186:187], v[186:187], v[24:25] op_sel:[0,1] op_sel_hi:[1,1] neg_lo:[0,1] neg_hi:[0,1]
    v_pk_add_f32 v[188:189], v[188:189], v[24:25] op_sel:[0,1] op_sel_hi:[1,1] neg_lo:[0,1] neg_hi:[0,1]
    v_pk_add_f32 v[190:191], v[190:191], v[24:25] op_sel:[0,1] op_sel_hi:[1,1] neg_lo:[0,1] neg_hi:[0,1]
    v_pk_mov_b32 v[240:241], v[26:27], v[26:27] op_sel:[1,1]
    v_pk_mov_b32 v[242:243], v[26:27], v[26:27] op_sel:[1,1]
    v_pk_mov_b32 v[244:245], v[26:27], v[26:27] op_sel:[1,1]
    v_pk_mov_b32 v[246:247], v[26:27], v[26:27] op_sel:[1,1]
    v_pk_mov_b32 v[248:249], v[26:27], v[26:27] op_sel:[1,1]
    v_pk_mov_b32 v[250:251], v[26:27], v[26:27] op_sel:[1,1]
    v_pk_mov_b32 v[252:253], v[26:27], v[26:27] op_sel:[1,1]
    v_pk_mov_b32 v[254:255], v[26:27], v[26:27] op_sel:[1,1]
    s_mov_b64 s[78:79], 0
    v_sub_f32 v30, 0, v25
    v_exp_f32 v30, v30
    s_nop 0
    v_mul_f32 v21, v21, v30
    v_accvgpr_read_b32 v64, a64
    v_accvgpr_read_b32 v65, a65
    v_accvgpr_read_b32 v66, a66
    v_accvgpr_read_b32 v67, a67
    v_accvgpr_read_b32 v68, a68
    v_accvgpr_read_b32 v69, a69
    v_accvgpr_read_b32 v70, a70
    v_accvgpr_read_b32 v71, a71
    v_accvgpr_read_b32 v72, a72
    v_accvgpr_read_b32 v73, a73
    v_accvgpr_read_b32 v74, a74
    v_accvgpr_read_b32 v75, a75
    v_accvgpr_read_b32 v76, a76
    v_accvgpr_read_b32 v77, a77
    v_accvgpr_read_b32 v78, a78
    v_accvgpr_read_b32 v79, a79
    v_mul_f32 v64, v64, v30
    v_mul_f32 v65, v65, v30
    v_mul_f32 v66, v66, v30
    v_mul_f32 v67, v67, v30
    v_mul_f32 v68, v68, v30
    v_mul_f32 v69, v69, v30
    v_mul_f32 v70, v70, v30
    v_mul_f32 v71, v71, v30
    v_mul_f32 v72, v72, v30
    v_mul_f32 v73, v73, v30
    v_mul_f32 v74, v74, v30
    v_mul_f32 v75, v75, v30
    v_mul_f32 v76, v76, v30
    v_mul_f32 v77, v77, v30
    v_mul_f32 v78, v78, v30
    v_mul_f32 v79, v79, v30
    v_accvgpr_write_b32 a64, v64
    v_accvgpr_write_b32 a65, v65
    v_accvgpr_write_b32 a66, v66
    v_accvgpr_write_b32 a67, v67
    v_accvgpr_write_b32 a68, v68
    v_accvgpr_write_b32 a69, v69
    v_accvgpr_write_b32 a70, v70
    v_accvgpr_write_b32 a71, v71
    v_accvgpr_write_b32 a72, v72
    v_accvgpr_write_b32 a73, v73
    v_accvgpr_write_b32 a74, v74
    v_accvgpr_write_b32 a75, v75
    v_accvgpr_write_b32 a76, v76
    v_accvgpr_write_b32 a77, v77
    v_accvgpr_write_b32 a78, v78
    v_accvgpr_write_b32 a79, v79
    v_accvgpr_read_b32 v64, a80
    v_accvgpr_read_b32 v65, a81
    v_accvgpr_read_b32 v66, a82
    v_accvgpr_read_b32 v67, a83
    v_accvgpr_read_b32 v68, a84
    v_accvgpr_read_b32 v69, a85
    v_accvgpr_read_b32 v70, a86
    v_accvgpr_read_b32 v71, a87
    v_accvgpr_read_b32 v72, a88
    v_accvgpr_read_b32 v73, a89
    v_accvgpr_read_b32 v74, a90
    v_accvgpr_read_b32 v75, a91
    v_accvgpr_read_b32 v76, a92
    v_accvgpr_read_b32 v77, a93
    v_accvgpr_read_b32 v78, a94
    v_accvgpr_read_b32 v79, a95
    v_mul_f32 v64, v64, v30
    v_mul_f32 v65, v65, v30
    v_mul_f32 v66, v66, v30
    v_mul_f32 v67, v67, v30
    v_mul_f32 v68, v68, v30
    v_mul_f32 v69, v69, v30
    v_mul_f32 v70, v70, v30
    v_mul_f32 v71, v71, v30
    v_mul_f32 v72, v72, v30
    v_mul_f32 v73, v73, v30
    v_mul_f32 v74, v74, v30
    v_mul_f32 v75, v75, v30
    v_mul_f32 v76, v76, v30
    v_mul_f32 v77, v77, v30
    v_mul_f32 v78, v78, v30
    v_mul_f32 v79, v79, v30
    v_accvgpr_write_b32 a80, v64
    v_accvgpr_write_b32 a81, v65
    v_accvgpr_write_b32 a82, v66
    v_accvgpr_write_b32 a83, v67
    v_accvgpr_write_b32 a84, v68
    v_accvgpr_write_b32 a85, v69
    v_accvgpr_write_b32 a86, v70
    v_accvgpr_write_b32 a87, v71
    v_accvgpr_write_b32 a88, v72
    v_accvgpr_write_b32 a89, v73
    v_accvgpr_write_b32 a90, v74
    v_accvgpr_write_b32 a91, v75
    v_accvgpr_write_b32 a92, v76
    v_accvgpr_write_b32 a93, v77
    v_accvgpr_write_b32 a94, v78
    v_accvgpr_write_b32 a95, v79
    v_accvgpr_read_b32 v64, a96
    v_accvgpr_read_b32 v65, a97
    v_accvgpr_read_b32 v66, a98
    v_accvgpr_read_b32 v67, a99
    v_accvgpr_read_b32 v68, a100
    v_accvgpr_read_b32 v69, a101
    v_accvgpr_read_b32 v70, a102
    v_accvgpr_read_b32 v71, a103
    v_accvgpr_read_b32 v72, a104
    v_accvgpr_read_b32 v73, a105
    v_accvgpr_read_b32 v74, a106
    v_accvgpr_read_b32 v75, a107
    v_accvgpr_read_b32 v76, a108
    v_accvgpr_read_b32 v77, a109
    v_accvgpr_read_b32 v78, a110
    v_accvgpr_read_b32 v79, a111
    v_mul_f32 v64, v64, v30
    v_mul_f32 v65, v65, v30
    v_mul_f32 v66, v66, v30
    v_mul_f32 v67, v67, v30
    v_mul_f32 v68, v68, v30
    v_mul_f32 v69, v69, v30
    v_mul_f32 v70, v70, v30
    v_mul_f32 v71, v71, v30
    v_mul_f32 v72, v72, v30
    v_mul_f32 v73, v73, v30
    v_mul_f32 v74, v74, v30
    v_mul_f32 v75, v75, v30
    v_mul_f32 v76, v76, v30
    v_mul_f32 v77, v77, v30
    v_mul_f32 v78, v78, v30
    v_mul_f32 v79, v79, v30
    v_accvgpr_write_b32 a96, v64
    v_accvgpr_write_b32 a97, v65
    v_accvgpr_write_b32 a98, v66
    v_accvgpr_write_b32 a99, v67
    v_accvgpr_write_b32 a100, v68
    v_accvgpr_write_b32 a101, v69
    v_accvgpr_write_b32 a102, v70
    v_accvgpr_write_b32 a103, v71
    v_accvgpr_write_b32 a104, v72
    v_accvgpr_write_b32 a105, v73
    v_accvgpr_write_b32 a106, v74
    v_accvgpr_write_b32 a107, v75
    v_accvgpr_write_b32 a108, v76
    v_accvgpr_write_b32 a109, v77
    v_accvgpr_write_b32 a110, v78
    v_accvgpr_write_b32 a111, v79
    v_accvgpr_read_b32 v64, a112
    v_accvgpr_read_b32 v65, a113
    v_accvgpr_read_b32 v66, a114
    v_accvgpr_read_b32 v67, a115
    v_accvgpr_read_b32 v68, a116
    v_accvgpr_read_b32 v69, a117
    v_accvgpr_read_b32 v70, a118
    v_accvgpr_read_b32 v71, a119
    v_accvgpr_read_b32 v72, a120
    v_accvgpr_read_b32 v73, a121
    v_accvgpr_read_b32 v74, a122
    v_accvgpr_read_b32 v75, a123
    v_accvgpr_read_b32 v76, a124
    v_accvgpr_read_b32 v77, a125
    v_accvgpr_read_b32 v78, a126
    v_accvgpr_read_b32 v79, a127
    v_mul_f32 v64, v64, v30
    v_mul_f32 v65, v65, v30
    v_mul_f32 v66, v66, v30
    v_mul_f32 v67, v67, v30
    v_mul_f32 v68, v68, v30
    v_mul_f32 v69, v69, v30
    v_mul_f32 v70, v70, v30
    v_mul_f32 v71, v71, v30
    v_mul_f32 v72, v72, v30
    v_mul_f32 v73, v73, v30
    v_mul_f32 v74, v74, v30
    v_mul_f32 v75, v75, v30
    v_mul_f32 v76, v76, v30
    v_mul_f32 v77, v77, v30
    v_mul_f32 v78, v78, v30
    v_mul_f32 v79, v79, v30
    v_accvgpr_write_b32 a112, v64
    v_accvgpr_write_b32 a113, v65
    v_accvgpr_write_b32 a114, v66
    v_accvgpr_write_b32 a115, v67
    v_accvgpr_write_b32 a116, v68
    v_accvgpr_write_b32 a117, v69
    v_accvgpr_write_b32 a118, v70
    v_accvgpr_write_b32 a119, v71
    v_accvgpr_write_b32 a120, v72
    v_accvgpr_write_b32 a121, v73
    v_accvgpr_write_b32 a122, v74
    v_accvgpr_write_b32 a123, v75
    v_accvgpr_write_b32 a124, v76
    v_accvgpr_write_b32 a125, v77
    v_accvgpr_write_b32 a126, v78
    v_accvgpr_write_b32 a127, v79
AT_NORS_7:
    s_nop 4
    s_nop 7
    s_cmp_le_u32 s80, s53
    s_cbranch_scc1 AT_FULL1
    s_waitcnt lgkmcnt(0)
    ds_read_b128 a[192:195], v4 offset:16384
    ds_read_b128 a[196:199], v4 offset:20480
    ds_read_b128 a[200:203], v4 offset:24576
    ds_read_b128 a[204:207], v4 offset:28672
    ds_read_b128 a[208:211], v4 offset:17408
    ds_read_b128 a[212:215], v4 offset:21504
    ds_read_b128 a[216:219], v4 offset:25600
    ds_read_b128 a[220:223], v4 offset:29696
    v_exp_f32 v128, v128
    v_exp_f32 v129, v129
    v_exp_f32 v130, v130
    v_exp_f32 v131, v131
    v_exp_f32 v132, v132
    v_exp_f32 v133, v133
    s_nop 0
    buffer_load_dwordx4 v16, s[20:23], s86 offen offset:2048 lds
    v_exp_f32 v134, v134
    v_exp_f32 v135, v135
    v_cvt_pk_bf16_f32 v192, v128, v129
    v_cvt_pk_bf16_f32 v193, v130, v131
    v_cvt_pk_bf16_f32 v194, v132, v133
    v_cvt_pk_bf16_f32 v195, v134, v135
    s_nop 0
    buffer_load_dwordx4 v16, s[20:23], s86 offen offset:3072 lds
    v_exp_f32 v160, v160
    v_exp_f32 v161, v161
    v_exp_f32 v162, v162
    v_exp_f32 v163, v163
    v_exp_f32 v164, v164
    v_exp_f32 v165, v165
    s_mov_b32 m0, s93
    s_nop 0
    buffer_load_dwordx4 v50, s[24:27], s95 offen offset:0 lds
    v_exp_f32 v166, v166
    v_exp_f32 v167, v167
    v_cvt_pk_bf16_f32 v208, v160, v161
    v_cvt_pk_bf16_f32 v209, v162, v163
    v_cvt_pk_bf16_f32 v210, v164, v165
    v_cvt_pk_bf16_f32 v211, v166, v167
    s_nop 0
    buffer_load_dwordx4 v50, s[24:27], s95 offen offset:1024 lds
    s_waitcnt lgkmcnt(4)
    v_mfma_f32_32x32x16_bf16 a[0:15], a[192:195], v[192:195], a[0:15]
    ds_read_b128 a[224:227], v4 offset:18432
    v_exp_f32 v136, v136
    v_exp_f32 v137, v137
    v_exp_f32 v138, v138
    v_add_f32 v19, v19, v128
    v_mfma_f32_32x32x16_bf16 a[64:79], a[192:195], v[208:211], a[64:79]
    ds_read_b128 a[228:231], v4 offset:22528
    v_exp_f32 v139, v139
    v_exp_f32 v140, v140
    v_exp_f32 v141, v141
    v_add_f32 v19, v19, v129
    v_mfma_f32_32x32x16_bf16 a[16:31], a[196:199], v[192:195], a[16:31]
    ds_read_b128 a[232:235], v4 offset:26624
    v_exp_f32 v142, v142
    v_exp_f32 v143, v143
    v_cvt_pk_bf16_f32 v196, v136, v137
    v_cvt_pk_bf16_f32 v197, v138, v139
    v_cvt_pk_bf16_f32 v198, v140, v141
    v_mfma_f32_32x32x16_bf16 a[80:95], a[196:199], v[208:211], a[80:95]
    ds_read_b128 a[236:239], v4 offset:30720
    v_cvt_pk_bf16_f32 v199, v142, v143
    v_exp_f32 v168, v168
    v_exp_f32 v169, v169
    v_exp_f32 v170, v170
    v_mfma_f32_32x32x16_bf16 a[32:47], a[200:203], v[192:195], a[32:47]
    buffer_load_dwordx4 v50, s[24:27], s95 offen offset:2048 lds
    v_exp_f32 v171, v171
    v_exp_f32 v172, v172
    v_exp_f32 v173, v173
    v_add_f32 v19, v19, v130
    v_mfma_f32_32x32x16_bf16 a[96:111], a[200:203], v[208:211], a[96:111]
    buffer_load_dwordx4 v50, s[24:27], s95 offen offset:3072 lds
    v_exp_f32 v174, v174
    v_exp_f32 v175, v175
    v_cvt_pk_bf16_f32 v212, v168, v169
    v_cvt_pk_bf16_f32 v213, v170, v171
    v_cvt_pk_bf16_f32 v214, v172, v173
    v_mfma_f32_32x32x16_bf16 a[48:63], a[204:207], v[192:195], a[48:63]
    s_mov_b32 m0, s94
    s_nop 0
    buffer_load_dwordx4 v50, s[24:27], s87 offen offset:0 lds
    v_cvt_pk_bf16_f32 v215, v174, v175
    v_exp_f32 v144, v144
    v_exp_f32 v145, v145
    v_exp_f32 v146, v146
    v_mfma_f32_32x32x16_bf16 a[112:127], a[204:207], v[208:211], a[112:127]
    s_waitcnt lgkmcnt(4)
    buffer_load_dwordx4 v50, s[24:27], s87 offen offset:1024 lds
    v_exp_f32 v147, v147
    v_exp_f32 v148, v148
    v_exp_f32 v149, v149
    v_add_f32 v19, v19, v131
    v_mfma_f32_32x32x16_bf16 a[0:15], a[208:211], v[196:199], a[0:15]
    ds_read_b128 a[240:243], v4 offset:19456
    v_exp_f32 v150, v150
    v_exp_f32 v151, v151
    v_cvt_pk_bf16_f32 v200, v144, v145
    v_cvt_pk_bf16_f32 v201, v146, v147
    v_cvt_pk_bf16_f32 v202, v148, v149
    v_mfma_f32_32x32x16_bf16 a[64:79], a[208:211], v[212:215], a[64:79]
    ds_read_b128 a[244:247], v4 offset:23552
    v_cvt_pk_bf16_f32 v203, v150, v151
    v_exp_f32 v176, v176
    v_exp_f32 v177, v177
    v_exp_f32 v178, v178
    v_mfma_f32_32x32x16_bf16 a[16:31], a[212:215], v[196:199], a[16:31]
    ds_read_b128 a[248:251], v4 offset:27648
    v_exp_f32 v179, v179
    v_exp_f32 v180, v180
    v_exp_f32 v181, v181
    v_add_f32 v19, v19, v132
    v_mfma_f32_32x32x16_bf16 a[80:95], a[212:215], v[212:215], a[80:95]
    ds_read_b128 a[252:255], v4 offset:31744
    v_exp_f32 v182, v182
    v_exp_f32 v183, v183
    v_cvt_pk_bf16_f32 v216, v176, v177
    v_cvt_pk_bf16_f32 v217, v178, v179
    v_cvt_pk_bf16_f32 v218, v180, v181
    v_mfma_f32_32x32x16_bf16 a[32:47], a[216:219], v[196:199], a[32:47]
    buffer_load_dwordx4 v50, s[24:27], s87 offen offset:2048 lds
    v_cvt_pk_bf16_f32 v219, v182, v183
    v_exp_f32 v152, v152
    v_exp_f32 v153, v153
    v_exp_f32 v154, v154
    v_mfma_f32_32x32x16_bf16 a[96:111], a[216:219], v[212:215], a[96:111]
    buffer_load_dwordx4 v50, s[24:27], s87 offen offset:3072 lds
    v_exp_f32 v155, v155
    v_exp_f32 v156, v156
    v_exp_f32 v157, v157
    v_add_f32 v19, v19, v133
    v_mfma_f32_32x32x16_bf16 a[48:63], a[220:223], v[196:199], a[48:63]
    s_add_u32 s47, s47, 1
    s_cmp_eq_u32 s47, 15
    s_cselect_b64 s[20:21], s[68:69], s[20:21]
    s_cselect_b32 s63, 0, s63
    s_cselect_b64 vcc, -1, 0
    v_cndmask_b32 v16, v16, v52, vcc
    v_readlane_b32 s86, v33, s47
    s_bitcmp1_b32 s60, s47
    s_cselect_b32 s90, s62, 0x28000
    s_cselect_b32 s92, s63, 0x80000
    s_cselect_b32 s96, 0x8000, 0
    s_add_u32 s63, s63, s96
    s_lshl_b32 s96, s96, 1
    s_xor_b32 s62, s62, s96
    s_add_u32 s91, s90, 32768
    s_add_u32 s86, s86, s92
    s_cmp_eq_u32 s47, 16
    s_cselect_b64 s[24:25], s[68:69], s[24:25]
    v_permlane32_swap_b32 v60, v62
    v_mfma_f32_32x32x16_bf16 a[112:127], a[220:223], v[212:215], a[112:127]
    s_waitcnt lgkmcnt(4)
    v_permlane32_swap_b32 v61, v63
    v_exp_f32 v158, v158
    v_exp_f32 v159, v159
    v_cvt_pk_bf16_f32 v204, v152, v153
    v_cvt_pk_bf16_f32 v205, v154, v155
    v_cvt_pk_bf16_f32 v206, v156, v157
    v_mfma_f32_32x32x16_bf16 a[0:15], a[224:227], v[200:203], a[0:15]
    s_cselect_b32 s65, 262144, s65
    buffer_store_dwordx4 v[60:63], v17, s[72:75], s11 offen
    v_cvt_pk_bf16_f32 v207, v158, v159
    v_exp_f32 v184, v184
    v_exp_f32 v185, v185
    v_exp_f32 v186, v186
    v_mfma_f32_32x32x16_bf16 a[64:79], a[224:227], v[216:219], a[64:79]
    s_cselect_b64 vcc, -1, 0
    buffer_load_dwordx4 v[60:63], v8, s[16:19], s70 offen
    v_exp_f32 v187, v187
    v_exp_f32 v188, v188
    v_exp_f32 v189, v189
    v_add_f32 v19, v19, v134
    v_mfma_f32_32x32x16_bf16 a[16:31], a[228:231], v[200:203], a[16:31]
    v_cndmask_b32 v50, v50, v52, vcc
    buffer_load_dword v36, v35, s[72:75], s71 offen
    v_exp_f32 v190, v190
    v_exp_f32 v191, v191
    v_cvt_pk_bf16_f32 v220, v184, v185
    v_cvt_pk_bf16_f32 v221, v186, v187
    v_cvt_pk_bf16_f32 v222, v188, v189
    v_mfma_f32_32x32x16_bf16 a[80:95], a[228:231], v[216:219], a[80:95]
    v_readlane_b32 s87, v51, s47
    v_cvt_pk_bf16_f32 v223, v190, v191
    v_add_f32 v19, v19, v135
    v_add_f32 v21, v21, v160
    v_add_f32 v21, v21, v161
    v_add_f32 v21, v21, v162
    v_add_f32 v21, v21, v163
    v_add_f32 v21, v21, v164
    v_add_f32 v21, v21, v165
    v_mfma_f32_32x32x16_bf16 a[32:47], a[232:235], v[200:203], a[32:47]
    s_bitcmp1_b32 s61, s47
    v_readlane_b32 s70, v7, s47
    v_readlane_b32 s71, v34, s47
    v_readlane_b32 s11, v9, s47
    v_add_f32 v21, v21, v166
    v_add_f32 v21, v21, v167
    v_add_f32 v19, v19, v136
    v_add_f32 v19, v19, v137
    v_add_f32 v19, v19, v138
    v_mfma_f32_32x32x16_bf16 a[96:111], a[232:235], v[216:219], a[96:111]
    s_cselect_b32 s93, s64, 0x28000
    v_add_f32 v19, v19, v139
    v_add_f32 v19, v19, v140
    v_add_f32 v19, v19, v141
    v_add_f32 v19, v19, v142
    v_add_f32 v19, v19, v143
    v_add_f32 v21, v21, v168
    v_add_f32 v21, v21, v169
    v_add_f32 v21, v21, v170
    v_mfma_f32_32x32x16_bf16 a[48:63], a[236:239], v[200:203], a[48:63]
    s_cselect_b32 s95, s65, 0x80000
    v_add_f32 v21, v21, v171
    v_add_f32 v21, v21, v172
    v_add_f32 v21, v21, v173
    v_add_f32 v21, v21, v174
    v_add_f32 v21, v21, v175
    v_add_f32 v19, v19, v144
    v_add_f32 v19, v19, v145
    v_add_f32 v19, v19, v146
    v_mfma_f32_32x32x16_bf16 a[112:127], a[236:239], v[216:219], a[112:127]
    s_waitcnt lgkmcnt(0)
    v_add_f32 v19, v19, v147
    v_add_f32 v19, v19, v148
    v_add_f32 v19, v19, v149
    v_add_f32 v19, v19, v150
    v_add_f32 v19, v19, v151
    v_add_f32 v21, v21, v176
    v_add_f32 v21, v21, v177
    v_add_f32 v21, v21, v178
    v_mfma_f32_32x32x16_bf16 a[0:15], a[240:243], v[204:207], a[0:15]
    s_cselect_b32 s96, 0x8000, 0
    v_add_f32 v21, v21, v179
    v_add_f32 v21, v21, v180
    v_add_f32 v21, v21, v181
    v_add_f32 v21, v21, v182
    v_add_f32 v21, v21, v183
    v_add_f32 v19, v19, v152
    v_add_f32 v19, v19, v153
    v_add_f32 v19, v19, v154
    v_mfma_f32_32x32x16_bf16 a[64:79], a[240:243], v[220:223], a[64:79]
    s_add_u32 s65, s65, s96
    v_add_f32 v19, v19, v155
    v_add_f32 v19, v19, v156
    v_add_f32 v19, v19, v157
    v_add_f32 v19, v19, v158
    v_add_f32 v19, v19, v159
    v_add_f32 v21, v21, v184
    v_add_f32 v21, v21, v185
    v_add_f32 v21, v21, v186
    v_mfma_f32_32x32x16_bf16 a[16:31], a[244:247], v[204:207], a[16:31]
    s_lshl_b32 s96, s96, 1
    v_add_f32 v21, v21, v187
    v_add_f32 v21, v21, v188
    v_add_f32 v21, v21, v189
    v_add_f32 v21, v21, v190
    v_add_f32 v21, v21, v191
    v_mfma_f32_32x32x16_bf16 a[80:95], a[244:247], v[220:223], a[80:95]
    s_xor_b32 s64, s64, s96
    v_mfma_f32_32x32x16_bf16 a[32:47], a[248:251], v[204:207], a[32:47]
    s_add_u32 s94, s93, 32768
    v_mfma_f32_32x32x16_bf16 a[96:111], a[248:251], v[220:223], a[96:111]
    s_add_u32 s87, s87, s95
    v_mfma_f32_32x32x16_bf16 a[48:63], a[252:255], v[204:207], a[48:63]
    s_cmp_eq_u32 s47, 11
    v_mfma_f32_32x32x16_bf16 a[112:127], a[252:255], v[220:223], a[112:127]
    s_cselect_b64 s[16:17], s[68:69], s[16:17]
    s_cmp_lt_u32 s47, s89
    s_cbranch_scc1 AT_SWA
    s_branch AT_MERGE
AT_BAR1:
    s_waitcnt vmcnt(3)
AT_BARW1:
    s_nop 0
    s_mov_b32 s57, s80
    s_add_u32 s52, s59, 2
    s_cmp_ge_u32 s47, s52
    s_addc_u32 s80, s57, 1
    s_and_b32 s50, s80, 3
    s_cmp_gt_u32 s80, s53
    s_cselect_b64 s[98:99], -1, 0
    s_cmp_eq_u32 s47, s66
    s_cselect_b32 s81, s67, 1073741824
    v_lshl_add_u32 v4, s50, 15, v17
    s_waitcnt lgkmcnt(0)
    s_barrier
    ds_read_b128 a[192:195], v4 offset:0
    ds_read_b128 a[196:199], v4 offset:8192
    ds_read_b128 a[200:203], v4 offset:1024
    ds_read_b128 a[204:207], v4 offset:9216
    ds_read_b128 a[208:211], v4 offset:2048
    ds_read_b128 a[212:215], v4 offset:10240
    ds_read_b128 a[216:219], v4 offset:3072
    ds_read_b128 a[220:223], v4 offset:11264
    buffer_store_dword v33, off, s[72:75], s81 sc1
    s_mov_b32 m0, s90
    s_nop 0
    buffer_load_dwordx4 v16, s[20:23], s92 offen offset:0 lds
    buffer_load_dwordx4 v16, s[20:23], s92 offen offset:1024 lds
    buffer_load_dwordx4 v16, s[20:23], s92 offen offset:2048 lds
    buffer_load_dwordx4 v16, s[20:23], s92 offen offset:3072 lds
    s_mov_b32 m0, s91
    s_nop 0
    buffer_load_dwordx4 v16, s[20:23], s86 offen offset:0 lds
    buffer_load_dwordx4 v16, s[20:23], s86 offen offset:1024 lds
    s_waitcnt lgkmcnt(4)
    s_branch AT_EXC0
AT_SW0:
    s_waitcnt lgkmcnt(0)
    s_sub_u32 s44, 15, s56
    s_lshl_b32 s44, s44, 7
    s_lshl_b32 s45, s3, 6
    s_add_u32 s44, s44, s45
    v_add_u32 v28, s44, v2
    v_lshlrev_b32 v24, 2, v3
    v_sub_u32 v28, v28, v24
    v_add_u32 v29, 32, v28
    s_lshr_b32 s53, s44, 6
    s_mov_b32 s88, s53
    v_mov_b32 v19, 0
    v_mov_b32 v21, 0
    v_mov_b32 v18, 0xf149f2ca
    v_mov_b32 v20, 0xf149f2ca
    s_or_b32 s53, s53, 1
    s_mov_b32 s88, 99
    s_add_u32 s80, s59, 5
    s_and_b32 s50, s80, 3
    v_lshl_add_u32 v4, s50, 15, v17
    s_cmp_gt_u32 s80, s53
    s_cbranch_scc1 AT_SWN
    ds_read_b128 a[192:195], v4 offset:0
    ds_read_b128 a[196:199], v4 offset:8192
    ds_read_b128 a[200:203], v4 offset:1024
    ds_read_b128 a[204:207], v4 offset:9216
    ds_read_b128 a[208:211], v4 offset:2048
    ds_read_b128 a[212:215], v4 offset:10240
    ds_read_b128 a[216:219], v4 offset:3072
    ds_read_b128 a[220:223], v4 offset:11264
    v_accvgpr_read_b32 v64, a32
    v_accvgpr_read_b32 v65, a33
    v_accvgpr_read_b32 v66, a34
    v_accvgpr_read_b32 v67, a35
    v_accvgpr_read_b32 v68, a36
    v_accvgpr_read_b32 v69, a37
    v_accvgpr_read_b32 v70, a38
    v_accvgpr_read_b32 v71, a39
    v_accvgpr_read_b32 v72, a40
    v_accvgpr_read_b32 v73, a41
    v_accvgpr_read_b32 v74, a42
    v_accvgpr_read_b32 v75, a43
    v_accvgpr_read_b32 v76, a44
    v_accvgpr_read_b32 v77, a45
    v_accvgpr_read_b32 v78, a46
    v_accvgpr_read_b32 v79, a47
    v_mfma_f32_32x32x16_bf16 a[32:47], v[192:195], v[192:195], 0
    v_mul_f32 v64, v64, v31
    v_mul_f32 v65, v65, v31
    v_mul_f32 v66, v66, v31
    v_mul_f32 v67, v67, v31
    v_mul_f32 v68, v68, v31
    v_mul_f32 v69, v69, v31
    v_mul_f32 v70, v70, v31
    s_waitcnt lgkmcnt(4)
    v_mfma_f32_32x32x16_bf16 v[128:143], a[192:195], a[128:131], 0
    ds_read_b128 a[224:227], v4 offset:4096
    v_mul_f32 v71, v71, v31
    v_mul_f32 v72, v72, v31
    v_mul_f32 v73, v73, v31
    v_mul_f32 v74, v74, v31
    v_mul_f32 v75, v75, v31
    v_mfma_f32_32x32x16_bf16 v[160:175], a[192:195], a[160:163], 0
    ds_read_b128 a[228:231], v4 offset:12288
    v_mul_f32 v76, v76, v31
    v_mul_f32 v77, v77, v31
    v_mul_f32 v78, v78, v31
    v_mul_f32 v79, v79, v31
    v_cvt_pk_bf16_f32 v112, v64, v65
    v_mfma_f32_32x32x16_bf16 v[144:159], a[196:199], a[128:131], 0
    ds_read_b128 a[232:235], v4 offset:5120
    v_cvt_pk_bf16_f32 v113, v66, v67
    v_cvt_pk_bf16_f32 v114, v68, v69
    v_cvt_pk_bf16_f32 v115, v70, v71
    v_mfma_f32_32x32x16_bf16 v[176:191], a[196:199], a[160:163], 0
    ds_read_b128 a[236:239], v4 offset:13312
    buffer_store_dwordx4 v[112:115], v45, s[28:31], 0 offen offset:0
    v_cvt_pk_bf16_f32 v116, v72, v73
    v_cvt_pk_bf16_f32 v117, v74, v75
    v_mfma_f32_32x32x16_bf16 v[128:143], a[200:203], a[132:135], v[128:143]
    buffer_load_dwordx4 v16, s[20:23], s86 offen offset:2048 lds
    v_cvt_pk_bf16_f32 v118, v76, v77
    v_cvt_pk_bf16_f32 v119, v78, v79
    buffer_store_dwordx4 v[116:119], v45, s[28:31], 0 offen offset:1024
    v_mfma_f32_32x32x16_bf16 v[160:175], a[200:203], a[164:167], v[160:175]
    buffer_load_dwordx4 v16, s[20:23], s86 offen offset:3072 lds
    v_accvgpr_read_b32 v80, a48
    v_accvgpr_read_b32 v81, a49
    v_accvgpr_read_b32 v82, a50
    v_accvgpr_read_b32 v83, a51
    v_accvgpr_read_b32 v84, a52
    v_mfma_f32_32x32x16_bf16 v[144:159], a[204:207], a[132:135], v[144:159]
    s_mov_b32 m0, s93
    s_nop 0
    buffer_load_dwordx4 v50, s[24:27], s95 offen offset:0 lds
    v_accvgpr_read_b32 v85, a53
    v_accvgpr_read_b32 v86, a54
    v_accvgpr_read_b32 v87, a55
    v_accvgpr_read_b32 v88, a56
    v_accvgpr_read_b32 v89, a57
    v_mfma_f32_32x32x16_bf16 v[176:191], a[204:207], a[164:167], v[176:191]
    s_waitcnt lgkmcnt(4)
    buffer_load_dwordx4 v50, s[24:27], s95 offen offset:1024 lds
    v_accvgpr_read_b32 v90, a58
    v_accvgpr_read_b32 v91, a59
    v_accvgpr_read_b32 v92, a60
    v_accvgpr_read_b32 v93, a61
    v_accvgpr_read_b32 v94, a62
    v_mfma_f32_32x32x16_bf16 v[128:143], a[208:211], a[136:139], v[128:143]
    ds_read_b128 a[240:243], v4 offset:6144
    v_accvgpr_read_b32 v95, a63
    v_mfma_f32_32x32x16_bf16 a[48:63], v[192:195], v[192:195], 0
    v_mul_f32 v80, v80, v31
    v_mul_f32 v81, v81, v31
    v_mul_f32 v82, v82, v31
    v_mfma_f32_32x32x16_bf16 v[160:175], a[208:211], a[168:171], v[160:175]
    ds_read_b128 a[244:247], v4 offset:14336
    v_mul_f32 v83, v83, v31
    v_mul_f32 v84, v84, v31
    v_mul_f32 v85, v85, v31
    v_mul_f32 v86, v86, v31
    v_mul_f32 v87, v87, v31
    v_mfma_f32_32x32x16_bf16 v[144:159], a[212:215], a[136:139], v[144:159]
    ds_read_b128 a[248:251], v4 offset:7168
    v_mul_f32 v88, v88, v31
    v_mul_f32 v89, v89, v31
    v_mul_f32 v90, v90, v31
    v_mul_f32 v91, v91, v31
    v_mul_f32 v92, v92, v31
    v_mfma_f32_32x32x16_bf16 v[176:191], a[212:215], a[168:171], v[176:191]
    ds_read_b128 a[252:255], v4 offset:15360
    v_mul_f32 v93, v93, v31
    v_mul_f32 v94, v94, v31
    v_mul_f32 v95, v95, v31
    v_cvt_pk_bf16_f32 v120, v80, v81
    v_cvt_pk_bf16_f32 v121, v82, v83
    v_mfma_f32_32x32x16_bf16 v[128:143], a[216:219], a[140:143], v[128:143]
    buffer_load_dwordx4 v50, s[24:27], s95 offen offset:2048 lds
    v_cvt_pk_bf16_f32 v122, v84, v85
    v_cvt_pk_bf16_f32 v123, v86, v87
    buffer_store_dwordx4 v[120:123], v45, s[28:31], 0 offen offset:2048
    v_mfma_f32_32x32x16_bf16 v[160:175], a[216:219], a[172:175], v[160:175]
    buffer_load_dwordx4 v50, s[24:27], s95 offen offset:3072 lds
    v_cvt_pk_bf16_f32 v124, v88, v89
    v_cvt_pk_bf16_f32 v125, v90, v91
    v_cvt_pk_bf16_f32 v126, v92, v93
    v_cvt_pk_bf16_f32 v127, v94, v95
    v_mfma_f32_32x32x16_bf16 v[144:159], a[220:223], a[140:143], v[144:159]
    s_mov_b32 m0, s94
    s_nop 0
    buffer_load_dwordx4 v50, s[24:27], s87 offen offset:0 lds
    buffer_store_dwordx4 v[124:127], v45, s[28:31], 0 offen offset:3072
    v_accvgpr_read_b32 v64, a64
    v_accvgpr_read_b32 v65, a65
    v_mfma_f32_32x32x16_bf16 v[176:191], a[220:223], a[172:175], v[176:191]
    s_waitcnt lgkmcnt(4)
    buffer_load_dwordx4 v50, s[24:27], s87 offen offset:1024 lds
    v_accvgpr_read_b32 v66, a66
    v_accvgpr_read_b32 v67, a67
    v_accvgpr_read_b32 v68, a68
    v_accvgpr_read_b32 v69, a69
    v_accvgpr_read_b32 v70, a70
    v_mfma_f32_32x32x16_bf16 v[128:143], a[224:227], a[144:147], v[128:143]
    v_accvgpr_read_b32 v71, a71
    v_accvgpr_read_b32 v72, a72
    v_accvgpr_read_b32 v73, a73
    v_accvgpr_read_b32 v74, a74
    v_accvgpr_read_b32 v75, a75
    v_accvgpr_read_b32 v76, a76
    v_mfma_f32_32x32x16_bf16 v[160:175], a[224:227], a[176:179], v[160:175]
    buffer_load_dwordx4 v50, s[24:27], s87 offen offset:2048 lds
    v_accvgpr_read_b32 v77, a77
    v_accvgpr_read_b32 v78, a78
    v_accvgpr_read_b32 v79, a79
    v_mfma_f32_32x32x16_bf16 a[64:79], v[192:195], v[192:195], 0
    v_mul_f32 v64, v64, v32
    v_mfma_f32_32x32x16_bf16 v[144:159], a[228:231], a[144:147], v[144:159]
    buffer_load_dwordx4 v50, s[24:27], s87 offen offset:3072 lds
    v_mul_f32 v65, v65, v32
    v_mul_f32 v66, v66, v32
    v_mul_f32 v67, v67, v32
    v_mul_f32 v68, v68, v32
    v_mul_f32 v69, v69, v32
    v_mfma_f32_32x32x16_bf16 v[176:191], a[228:231], a[176:179], v[176:191]
    s_add_u32 s47, s47, 1
    s_cmp_eq_u32 s47, 15
    s_cselect_b64 s[20:21], s[68:69], s[20:21]
    s_cselect_b32 s63, 0, s63
    s_cselect_b64 vcc, -1, 0
    v_cndmask_b32 v16, v16, v52, vcc
    v_readlane_b32 s86, v33, s47
    s_bitcmp1_b32 s60, s47
    s_cselect_b32 s90, s62, 0x28000
    s_cselect_b32 s92, s63, 0x80000
    s_cselect_b32 s96, 0x8000, 0
    s_add_u32 s63, s63, s96
    s_lshl_b32 s96, s96, 1
    s_xor_b32 s62, s62, s96
    s_add_u32 s91, s90, 32768
    s_add_u32 s86, s86, s92
    s_cmp_eq_u32 s47, 16
    s_cselect_b64 s[24:25], s[68:69], s[24:25]
    s_cselect_b32 s65, 262144, s65
    s_cselect_b64 vcc, -1, 0
    v_cndmask_b32 v50, v50, v52, vcc
    v_readlane_b32 s87, v51, s47
    v_permlane32_swap_b32 v12, v14
    v_mfma_f32_32x32x16_bf16 v[128:143], a[232:235], a[148:151], v[128:143]
    s_bitcmp1_b32 s61, s47
    v_permlane32_swap_b32 v13, v15
    v_mul_f32 v70, v70, v32
    v_mul_f32 v71, v71, v32
    v_mul_f32 v72, v72, v32
    v_mul_f32 v73, v73, v32
    v_mul_f32 v74, v74, v32
    v_mfma_f32_32x32x16_bf16 v[160:175], a[232:235], a[180:183], v[160:175]
    s_cselect_b32 s93, s64, 0x28000
    buffer_store_dwordx4 v[12:15], v17, s[72:75], s11 offen
    v_mul_f32 v75, v75, v32
    v_mul_f32 v76, v76, v32
    v_mul_f32 v77, v77, v32
    v_mul_f32 v78, v78, v32
    v_mul_f32 v79, v79, v32
    v_mfma_f32_32x32x16_bf16 v[144:159], a[236:239], a[148:151], v[144:159]
    s_cselect_b32 s95, s65, 0x80000
    buffer_load_dwordx4 v[12:15], v8, s[16:19], s70 offen
    v_cvt_pk_bf16_f32 v96, v64, v65
    v_cvt_pk_bf16_f32 v97, v66, v67
    v_cvt_pk_bf16_f32 v98, v68, v69
    v_cvt_pk_bf16_f32 v99, v70, v71
    v_mfma_f32_32x32x16_bf16 v[176:191], a[236:239], a[180:183], v[176:191]
    s_waitcnt lgkmcnt(0)
    buffer_load_dword v36, v35, s[72:75], s71 offen
    buffer_store_dwordx4 v[96:99], v46, s[28:31], 0 offen offset:0
    v_cvt_pk_bf16_f32 v100, v72, v73
    v_cvt_pk_bf16_f32 v101, v74, v75
    v_mfma_f32_32x32x16_bf16 v[128:143], a[240:243], a[152:155], v[128:143]
    s_cselect_b32 s96, 0x8000, 0
    v_cvt_pk_bf16_f32 v102, v76, v77
    v_cvt_pk_bf16_f32 v103, v78, v79
    buffer_store_dwordx4 v[100:103], v46, s[28:31], 0 offen offset:1024
    v_accvgpr_read_b32 v80, a80
    v_mfma_f32_32x32x16_bf16 v[160:175], a[240:243], a[184:187], v[160:175]
    s_add_u32 s65, s65, s96
    v_readlane_b32 s70, v7, s47
    v_readlane_b32 s71, v34, s47
    v_readlane_b32 s11, v9, s47
    v_accvgpr_read_b32 v81, a81
    v_accvgpr_read_b32 v82, a82
    v_accvgpr_read_b32 v83, a83
    v_mfma_f32_32x32x16_bf16 v[144:159], a[244:247], a[152:155], v[144:159]
    s_lshl_b32 s96, s96, 1
    v_accvgpr_read_b32 v84, a84
    v_accvgpr_read_b32 v85, a85
    v_accvgpr_read_b32 v86, a86
    v_accvgpr_read_b32 v87, a87
    v_accvgpr_read_b32 v88, a88
    v_accvgpr_read_b32 v89, a89
    v_mfma_f32_32x32x16_bf16 v[176:191], a[244:247], a[184:187], v[176:191]
    s_xor_b32 s64, s64, s96
    v_accvgpr_read_b32 v90, a90
    v_accvgpr_read_b32 v91, a91
    v_accvgpr_read_b32 v92, a92
    v_accvgpr_read_b32 v93, a93
    v_accvgpr_read_b32 v94, a94
    v_accvgpr_read_b32 v95, a95
    v_mfma_f32_32x32x16_bf16 v[128:143], a[248:251], a[156:159], v[128:143]
    s_add_u32 s94, s93, 32768
    v_mfma_f32_32x32x16_bf16 a[80:95], v[192:195], v[192:195], 0
    v_mul_f32 v80, v80, v32
    v_mul_f32 v81, v81, v32
    v_mul_f32 v82, v82, v32
    v_mul_f32 v83, v83, v32
    v_mul_f32 v84, v84, v32
    v_mfma_f32_32x32x16_bf16 v[160:175], a[248:251], a[188:191], v[160:175]
    s_add_u32 s87, s87, s95
    v_mul_f32 v85, v85, v32
    v_mul_f32 v86, v86, v32
    v_mul_f32 v87, v87, v32
    v_mul_f32 v88, v88, v32
    v_mul_f32 v89, v89, v32
    v_mul_f32 v90, v90, v32
    v_mfma_f32_32x32x16_bf16 v[144:159], a[252:255], a[156:159], v[144:159]
    s_cmp_eq_u32 s47, 11
    v_mul_f32 v91, v91, v32
    v_mul_f32 v92, v92, v32
    v_mul_f32 v93, v93, v32
    v_mul_f32 v94, v94, v32
    v_mul_f32 v95, v95, v32
    v_cvt_pk_bf16_f32 v104, v80, v81
    v_mfma_f32_32x32x16_bf16 v[176:191], a[252:255], a[188:191], v[176:191]
    s_cselect_b64 s[16:17], s[68:69], s[16:17]
    v_cvt_pk_bf16_f32 v105, v82, v83
    v_cvt_pk_bf16_f32 v106, v84, v85
    v_cvt_pk_bf16_f32 v107, v86, v87
    buffer_store_dwordx4 v[104:107], v46, s[28:31], 0 offen offset:2048
    v_cvt_pk_bf16_f32 v108, v88, v89
    v_cvt_pk_bf16_f32 v109, v90, v91
    v_cvt_pk_bf16_f32 v110, v92, v93
    v_cvt_pk_bf16_f32 v111, v94, v95
    buffer_store_dwordx4 v[108:111], v46, s[28:31], 0 offen offset:3072
    v_accvgpr_read_b32 v64, a96
    v_accvgpr_read_b32 v65, a97
    v_accvgpr_read_b32 v66, a98
    v_accvgpr_read_b32 v67, a99
    v_accvgpr_read_b32 v68, a100
    v_accvgpr_read_b32 v69, a101
    v_accvgpr_read_b32 v70, a102
    v_accvgpr_read_b32 v71, a103
    v_accvgpr_read_b32 v72, a104
    v_accvgpr_read_b32 v73, a105
    v_accvgpr_read_b32 v74, a106
    v_accvgpr_read_b32 v75, a107
    v_accvgpr_read_b32 v76, a108
    v_accvgpr_read_b32 v77, a109
    v_accvgpr_read_b32 v78, a110
    v_accvgpr_read_b32 v79, a111
    v_mfma_f32_32x32x16_bf16 a[96:111], v[192:195], v[192:195], 0
    v_mul_f32 v64, v64, v32
    v_mul_f32 v65, v65, v32
    v_mul_f32 v66, v66, v32
    v_mul_f32 v67, v67, v32
    v_mul_f32 v68, v68, v32
    v_mul_f32 v69, v69, v32
    v_mul_f32 v70, v70, v32
    v_mul_f32 v71, v71, v32
    v_mul_f32 v72, v72, v32
    v_mul_f32 v73, v73, v32
    v_mul_f32 v74, v74, v32
    v_mul_f32 v75, v75, v32
    v_mul_f32 v76, v76, v32
    v_mul_f32 v77, v77, v32
    v_mul_f32 v78, v78, v32
    v_mul_f32 v79, v79, v32
    v_cvt_pk_bf16_f32 v112, v64, v65
    v_cvt_pk_bf16_f32 v113, v66, v67
    v_cvt_pk_bf16_f32 v114, v68, v69
    v_cvt_pk_bf16_f32 v115, v70, v71
    buffer_store_dwordx4 v[112:115], v47, s[28:31], 0 offen offset:0
    v_cvt_pk_bf16_f32 v116, v72, v73
    v_cvt_pk_bf16_f32 v117, v74, v75
    v_cvt_pk_bf16_f32 v118, v76, v77
    v_cvt_pk_bf16_f32 v119, v78, v79
    buffer_store_dwordx4 v[116:119], v47, s[28:31], 0 offen offset:1024
    v_accvgpr_read_b32 v80, a112
    v_accvgpr_read_b32 v81, a113
    v_accvgpr_read_b32 v82, a114
    v_accvgpr_read_b32 v83, a115
    v_accvgpr_read_b32 v84, a116
    v_accvgpr_read_b32 v85, a117
    v_accvgpr_read_b32 v86, a118
    v_accvgpr_read_b32 v87, a119
    v_accvgpr_read_b32 v88, a120
    v_accvgpr_read_b32 v89, a121
    v_accvgpr_read_b32 v90, a122
    v_accvgpr_read_b32 v91, a123
    v_accvgpr_read_b32 v92, a124
    v_accvgpr_read_b32 v93, a125
    v_accvgpr_read_b32 v94, a126
    v_accvgpr_read_b32 v95, a127
    v_mfma_f32_32x32x16_bf16 a[112:127], v[192:195], v[192:195], 0
    v_mul_f32 v80, v80, v32
    v_mul_f32 v81, v81, v32
    v_mul_f32 v82, v82, v32
    v_mul_f32 v83, v83, v32
    v_mul_f32 v84, v84, v32
    v_mul_f32 v85, v85, v32
    v_mul_f32 v86, v86, v32
    v_mul_f32 v87, v87, v32
    v_mul_f32 v88, v88, v32
    v_mul_f32 v89, v89, v32
    v_mul_f32 v90, v90, v32
    v_mul_f32 v91, v91, v32
    v_mul_f32 v92, v92, v32
    v_mul_f32 v93, v93, v32
    v_mul_f32 v94, v94, v32
    v_mul_f32 v95, v95, v32
    v_cvt_pk_bf16_f32 v120, v80, v81
    v_cvt_pk_bf16_f32 v121, v82, v83
    v_cvt_pk_bf16_f32 v122, v84, v85
    v_cvt_pk_bf16_f32 v123, v86, v87
    buffer_store_dwordx4 v[120:123], v47, s[28:31], 0 offen offset:2048
    v_cvt_pk_bf16_f32 v124, v88, v89
    v_cvt_pk_bf16_f32 v125, v90, v91
    v_cvt_pk_bf16_f32 v126, v92, v93
    v_cvt_pk_bf16_f32 v127, v94, v95
    buffer_store_dwordx4 v[124:127], v47, s[28:31], 0 offen offset:3072
    v_max3_f32 v24, v128, v129, v130
    v_max3_f32 v24, v24, v131, v132
    v_max3_f32 v24, v24, v133, v134
    v_max3_f32 v24, v24, v135, v136
    v_max3_f32 v24, v24, v137, v138
    v_max3_f32 v24, v24, v139, v140
    v_max3_f32 v24, v24, v141, v142
    v_max3_f32 v24, v24, v143, v144
    v_max3_f32 v24, v24, v145, v146
    v_max3_f32 v24, v24, v147, v148
    v_max3_f32 v24, v24, v149, v150
    v_max3_f32 v24, v24, v151, v152
    v_max3_f32 v24, v24, v153, v154
    v_max3_f32 v24, v24, v155, v156
    v_max3_f32 v24, v24, v157, v158
    v_max_f32 v24, v24, v159
    v_max3_f32 v25, v160, v161, v162
    v_max3_f32 v25, v25, v163, v164
    v_max3_f32 v25, v25, v165, v166
    v_max3_f32 v25, v25, v167, v168
    v_max3_f32 v25, v25, v169, v170
    v_max3_f32 v25, v25, v171, v172
    v_max3_f32 v25, v25, v173, v174
    v_max3_f32 v25, v25, v175, v176
    v_max3_f32 v25, v25, v177, v178
    v_max3_f32 v25, v25, v179, v180
    v_max3_f32 v25, v25, v181, v182
    v_max3_f32 v25, v25, v183, v184
    v_max3_f32 v25, v25, v185, v186
    v_max3_f32 v25, v25, v187, v188
    v_max3_f32 v25, v25, v189, v190
    v_max_f32 v25, v25, v191
    v_mov_b32 v26, v24
    s_nop 1
    v_permlane32_swap_b32 v24, v26
    v_max_f32 v24, v24, v26
    v_mov_b32 v18, v24
    v_sub_f32 v26, 0, v18
    v_pk_add_f32 v[128:129], v[128:129], v[24:25] op_sel:[0,0] op_sel_hi:[1,0] neg_lo:[0,1] neg_hi:[0,1]
    v_pk_add_f32 v[130:131], v[130:131], v[24:25] op_sel:[0,0] op_sel_hi:[1,0] neg_lo:[0,1] neg_hi:[0,1]
    v_pk_add_f32 v[132:133], v[132:133], v[24:25] op_sel:[0,0] op_sel_hi:[1,0] neg_lo:[0,1] neg_hi:[0,1]
    v_pk_add_f32 v[134:135], v[134:135], v[24:25] op_sel:[0,0] op_sel_hi:[1,0] neg_lo:[0,1] neg_hi:[0,1]
    v_pk_add_f32 v[136:137], v[136:137], v[24:25] op_sel:[0,0] op_sel_hi:[1,0] neg_lo:[0,1] neg_hi:[0,1]
    v_pk_add_f32 v[138:139], v[138:139], v[24:25] op_sel:[0,0] op_sel_hi:[1,0] neg_lo:[0,1] neg_hi:[0,1]
    v_pk_add_f32 v[140:141], v[140:141], v[24:25] op_sel:[0,0] op_sel_hi:[1,0] neg_lo:[0,1] neg_hi:[0,1]
    v_pk_add_f32 v[142:143], v[142:143], v[24:25] op_sel:[0,0] op_sel_hi:[1,0] neg_lo:[0,1] neg_hi:[0,1]
    v_pk_add_f32 v[144:145], v[144:145], v[24:25] op_sel:[0,0] op_sel_hi:[1,0] neg_lo:[0,1] neg_hi:[0,1]
    v_pk_add_f32 v[146:147], v[146:147], v[24:25] op_sel:[0,0] op_sel_hi:[1,0] neg_lo:[0,1] neg_hi:[0,1]
    v_pk_add_f32 v[148:149], v[148:149], v[24:25] op_sel:[0,0] op_sel_hi:[1,0] neg_lo:[0,1] neg_hi:[0,1]
    v_pk_add_f32 v[150:151], v[150:151], v[24:25] op_sel:[0,0] op_sel_hi:[1,0] neg_lo:[0,1] neg_hi:[0,1]
    v_pk_add_f32 v[152:153], v[152:153], v[24:25] op_sel:[0,0] op_sel_hi:[1,0] neg_lo:[0,1] neg_hi:[0,1]
    v_pk_add_f32 v[154:155], v[154:155], v[24:25] op_sel:[0,0] op_sel_hi:[1,0] neg_lo:[0,1] neg_hi:[0,1]
    v_pk_add_f32 v[156:157], v[156:157], v[24:25] op_sel:[0,0] op_sel_hi:[1,0] neg_lo:[0,1] neg_hi:[0,1]
    v_pk_add_f32 v[158:159], v[158:159], v[24:25] op_sel:[0,0] op_sel_hi:[1,0] neg_lo:[0,1] neg_hi:[0,1]
    v_pk_mov_b32 v[224:225], v[26:27], v[26:27] op_sel:[0,0]
    v_pk_mov_b32 v[226:227], v[26:27], v[26:27] op_sel:[0,0]
    v_pk_mov_b32 v[228:229], v[26:27], v[26:27] op_sel:[0,0]
    v_pk_mov_b32 v[230:231], v[26:27], v[26:27] op_sel:[0,0]
    v_pk_mov_b32 v[232:233], v[26:27], v[26:27] op_sel:[0,0]
    v_pk_mov_b32 v[234:235], v[26:27], v[26:27] op_sel:[0,0]
    v_pk_mov_b32 v[236:237], v[26:27], v[26:27] op_sel:[0,0]
    v_pk_mov_b32 v[238:239], v[26:27], v[26:27] op_sel:[0,0]
    s_mov_b64 s[76:77], 0
    v_mov_b32 v27, v25
    s_nop 1
    v_permlane32_swap_b32 v25, v27
    v_max_f32 v25, v25, v27
    v_mov_b32 v20, v25
    v_sub_f32 v27, 0, v20
    v_pk_add_f32 v[160:161], v[160:161], v[24:25] op_sel:[0,1] op_sel_hi:[1,1] neg_lo:[0,1] neg_hi:[0,1]
    v_pk_add_f32 v[162:163], v[162:163], v[24:25] op_sel:[0,1] op_sel_hi:[1,1] neg_lo:[0,1] neg_hi:[0,1]
    v_pk_add_f32 v[164:165], v[164:165], v[24:25] op_sel:[0,1] op_sel_hi:[1,1] neg_lo:[0,1] neg_hi:[0,1]
    v_pk_add_f32 v[166:167], v[166:167], v[24:25] op_sel:[0,1] op_sel_hi:[1,1] neg_lo:[0,1] neg_hi:[0,1]
    v_pk_add_f32 v[168:169], v[168:169], v[24:25] op_sel:[0,1] op_sel_hi:[1,1] neg_lo:[0,1] neg_hi:[0,1]
    v_pk_add_f32 v[170:171], v[170:171], v[24:25] op_sel:[0,1] op_sel_hi:[1,1] neg_lo:[0,1] neg_hi:[0,1]
    v_pk_add_f32 v[172:173], v[172:173], v[24:25] op_sel:[0,1] op_sel_hi:[1,1] neg_lo:[0,1] neg_hi:[0,1]
    v_pk_add_f32 v[174:175], v[174:175], v[24:25] op_sel:[0,1] op_sel_hi:[1,1] neg_lo:[0,1] neg_hi:[0,1]
    v_pk_add_f32 v[176:177], v[176:177], v[24:25] op_sel:[0,1] op_sel_hi:[1,1] neg_lo:[0,1] neg_hi:[0,1]
    v_pk_add_f32 v[178:179], v[178:179], v[24:25] op_sel:[0,1] op_sel_hi:[1,1] neg_lo:[0,1] neg_hi:[0,1]
    v_pk_add_f32 v[180:181], v[180:181], v[24:25] op_sel:[0,1] op_sel_hi:[1,1] neg_lo:[0,1] neg_hi:[0,1]
    v_pk_add_f32 v[182:183], v[182:183], v[24:25] op_sel:[0,1] op_sel_hi:[1,1] neg_lo:[0,1] neg_hi:[0,1]
    v_pk_add_f32 v[184:185], v[184:185], v[24:25] op_sel:[0,1] op_sel_hi:[1,1] neg_lo:[0,1] neg_hi:[0,1]
    v_pk_add_f32 v[186:187], v[186:187], v[24:25] op_sel:[0,1] op_sel_hi:[1,1] neg_lo:[0,1] neg_hi:[0,1]
    v_pk_add_f32 v[188:189], v[188:189], v[24:25] op_sel:[0,1] op_sel_hi:[1,1] neg_lo:[0,1] neg_hi:[0,1]
    v_pk_add_f32 v[190:191], v[190:191], v[24:25] op_sel:[0,1] op_sel_hi:[1,1] neg_lo:[0,1] neg_hi:[0,1]
    v_pk_mov_b32 v[240:241], v[26:27], v[26:27] op_sel:[1,1]
    v_pk_mov_b32 v[242:243], v[26:27], v[26:27] op_sel:[1,1]
    v_pk_mov_b32 v[244:245], v[26:27], v[26:27] op_sel:[1,1]
    v_pk_mov_b32 v[246:247], v[26:27], v[26:27] op_sel:[1,1]
    v_pk_mov_b32 v[248:249], v[26:27], v[26:27] op_sel:[1,1]
    v_pk_mov_b32 v[250:251], v[26:27], v[26:27] op_sel:[1,1]
    v_pk_mov_b32 v[252:253], v[26:27], v[26:27] op_sel:[1,1]
    v_pk_mov_b32 v[254:255], v[26:27], v[26:27] op_sel:[1,1]
    s_mov_b64 s[78:79], 0
    s_waitcnt vmcnt(11)
    s_cmp_lg_u32 s8, 0
    s_cbranch_scc1 AT_BARW0
    s_waitcnt vmcnt(0)
    buffer_wbl2 sc1
    s_branch AT_BARW0
AT_SWN:
    buffer_load_dwordx4 v16, s[20:23], s86 offen offset:2048 lds
    buffer_load_dwordx4 v16, s[20:23], s86 offen offset:3072 lds
    s_mov_b32 m0, s93
    s_nop 0
    buffer_load_dwordx4 v50, s[24:27], s95 offen offset:0 lds
    buffer_load_dwordx4 v50, s[24:27], s95 offen offset:1024 lds
    buffer_load_dwordx4 v50, s[24:27], s95 offen offset:2048 lds
    buffer_load_dwordx4 v50, s[24:27], s95 offen offset:3072 lds
    s_mov_b32 m0, s94
    s_nop 0
    buffer_load_dwordx4 v50, s[24:27], s87 offen offset:0 lds
    buffer_load_dwordx4 v50, s[24:27], s87 offen offset:1024 lds
    buffer_load_dwordx4 v50, s[24:27], s87 offen offset:2048 lds
    buffer_load_dwordx4 v50, s[24:27], s87 offen offset:3072 lds
    v_accvgpr_read_b32 v64, a32
    v_accvgpr_read_b32 v65, a33
    v_accvgpr_read_b32 v66, a34
    v_accvgpr_read_b32 v67, a35
    v_accvgpr_read_b32 v68, a36
    v_accvgpr_read_b32 v69, a37
    v_accvgpr_read_b32 v70, a38
    v_accvgpr_read_b32 v71, a39
    v_accvgpr_read_b32 v72, a40
    v_accvgpr_read_b32 v73, a41
    v_accvgpr_read_b32 v74, a42
    v_accvgpr_read_b32 v75, a43
    v_accvgpr_read_b32 v76, a44
    v_accvgpr_read_b32 v77, a45
    v_accvgpr_read_b32 v78, a46
    v_accvgpr_read_b32 v79, a47
    v_mfma_f32_32x32x16_bf16 a[32:47], v[192:195], v[192:195], 0
    v_mul_f32 v64, v64, v31
    v_mul_f32 v65, v65, v31
    v_mul_f32 v66, v66, v31
    v_mul_f32 v67, v67, v31
    v_mul_f32 v68, v68, v31
    v_mul_f32 v69, v69, v31
    v_mul_f32 v70, v70, v31
    v_mul_f32 v71, v71, v31
    v_mul_f32 v72, v72, v31
    v_mul_f32 v73, v73, v31
    v_mul_f32 v74, v74, v31
    v_mul_f32 v75, v75, v31
    v_mul_f32 v76, v76, v31
    v_mul_f32 v77, v77, v31
    v_mul_f32 v78, v78, v31
    v_mul_f32 v79, v79, v31
    v_cvt_pk_bf16_f32 v112, v64, v65
    v_cvt_pk_bf16_f32 v113, v66, v67
    v_cvt_pk_bf16_f32 v114, v68, v69
    v_cvt_pk_bf16_f32 v115, v70, v71
    buffer_store_dwordx4 v[112:115], v45, s[28:31], 0 offen offset:0
    v_cvt_pk_bf16_f32 v116, v72, v73
    v_cvt_pk_bf16_f32 v117, v74, v75
    v_cvt_pk_bf16_f32 v118, v76, v77
    v_cvt_pk_bf16_f32 v119, v78, v79
    buffer_store_dwordx4 v[116:119], v45, s[28:31], 0 offen offset:1024
    v_accvgpr_read_b32 v80, a48
    v_accvgpr_read_b32 v81, a49
    v_accvgpr_read_b32 v82, a50
    v_accvgpr_read_b32 v83, a51
    v_accvgpr_read_b32 v84, a52
    v_accvgpr_read_b32 v85, a53
    v_accvgpr_read_b32 v86, a54
    v_accvgpr_read_b32 v87, a55
    v_accvgpr_read_b32 v88, a56
    v_accvgpr_read_b32 v89, a57
    v_accvgpr_read_b32 v90, a58
    v_accvgpr_read_b32 v91, a59
    v_accvgpr_read_b32 v92, a60
    v_accvgpr_read_b32 v93, a61
    v_accvgpr_read_b32 v94, a62
    v_accvgpr_read_b32 v95, a63
    v_mfma_f32_32x32x16_bf16 a[48:63], v[192:195], v[192:195], 0
    v_mul_f32 v80, v80, v31
    v_mul_f32 v81, v81, v31
    v_mul_f32 v82, v82, v31
    v_mul_f32 v83, v83, v31
    v_mul_f32 v84, v84, v31
    v_mul_f32 v85, v85, v31
    v_mul_f32 v86, v86, v31
    v_mul_f32 v87, v87, v31
    v_mul_f32 v88, v88, v31
    v_mul_f32 v89, v89, v31
    v_mul_f32 v90, v90, v31
    v_mul_f32 v91, v91, v31
    v_mul_f32 v92, v92, v31
    v_mul_f32 v93, v93, v31
    v_mul_f32 v94, v94, v31
    v_mul_f32 v95, v95, v31
    v_cvt_pk_bf16_f32 v120, v80, v81
    v_cvt_pk_bf16_f32 v121, v82, v83
    v_cvt_pk_bf16_f32 v122, v84, v85
    v_cvt_pk_bf16_f32 v123, v86, v87
    buffer_store_dwordx4 v[120:123], v45, s[28:31], 0 offen offset:2048
    v_cvt_pk_bf16_f32 v124, v88, v89
    v_cvt_pk_bf16_f32 v125, v90, v91
    v_cvt_pk_bf16_f32 v126, v92, v93
    v_cvt_pk_bf16_f32 v127, v94, v95
    buffer_store_dwordx4 v[124:127], v45, s[28:31], 0 offen offset:3072
    v_accvgpr_read_b32 v64, a64
    v_accvgpr_read_b32 v65, a65
    v_accvgpr_read_b32 v66, a66
    v_accvgpr_read_b32 v67, a67
    v_accvgpr_read_b32 v68, a68
    v_accvgpr_read_b32 v69, a69
    v_accvgpr_read_b32 v70, a70
    v_accvgpr_read_b32 v71, a71
    v_accvgpr_read_b32 v72, a72
    v_accvgpr_read_b32 v73, a73
    v_accvgpr_read_b32 v74, a74
    v_accvgpr_read_b32 v75, a75
    v_accvgpr_read_b32 v76, a76
    v_accvgpr_read_b32 v77, a77
    v_accvgpr_read_b32 v78, a78
    v_accvgpr_read_b32 v79, a79
    v_mfma_f32_32x32x16_bf16 a[64:79], v[192:195], v[192:195], 0
    v_mul_f32 v64, v64, v32
    v_mul_f32 v65, v65, v32
    v_mul_f32 v66, v66, v32
    v_mul_f32 v67, v67, v32
    v_mul_f32 v68, v68, v32
    v_mul_f32 v69, v69, v32
    v_mul_f32 v70, v70, v32
    v_mul_f32 v71, v71, v32
    v_mul_f32 v72, v72, v32
    v_mul_f32 v73, v73, v32
    v_mul_f32 v74, v74, v32
    v_mul_f32 v75, v75, v32
    v_mul_f32 v76, v76, v32
    v_mul_f32 v77, v77, v32
    v_mul_f32 v78, v78, v32
    v_mul_f32 v79, v79, v32
    v_cvt_pk_bf16_f32 v96, v64, v65
    v_cvt_pk_bf16_f32 v97, v66, v67
    v_cvt_pk_bf16_f32 v98, v68, v69
    v_cvt_pk_bf16_f32 v99, v70, v71
    buffer_store_dwordx4 v[96:99], v46, s[28:31], 0 offen offset:0
    v_cvt_pk_bf16_f32 v100, v72, v73
    v_cvt_pk_bf16_f32 v101, v74, v75
    v_cvt_pk_bf16_f32 v102, v76, v77
    v_cvt_pk_bf16_f32 v103, v78, v79
    buffer_store_dwordx4 v[100:103], v46, s[28:31], 0 offen offset:1024
    v_accvgpr_read_b32 v80, a80
    v_accvgpr_read_b32 v81, a81
    v_accvgpr_read_b32 v82, a82
    v_accvgpr_read_b32 v83, a83
    v_accvgpr_read_b32 v84, a84
    v_accvgpr_read_b32 v85, a85
    v_accvgpr_read_b32 v86, a86
    v_accvgpr_read_b32 v87, a87
    v_accvgpr_read_b32 v88, a88
    v_accvgpr_read_b32 v89, a89
    v_accvgpr_read_b32 v90, a90
    v_accvgpr_read_b32 v91, a91
    v_accvgpr_read_b32 v92, a92
    v_accvgpr_read_b32 v93, a93
    v_accvgpr_read_b32 v94, a94
    v_accvgpr_read_b32 v95, a95
    v_mfma_f32_32x32x16_bf16 a[80:95], v[192:195], v[192:195], 0
    v_mul_f32 v80, v80, v32
    v_mul_f32 v81, v81, v32
    v_mul_f32 v82, v82, v32
    v_mul_f32 v83, v83, v32
    v_mul_f32 v84, v84, v32
    v_mul_f32 v85, v85, v32
    v_mul_f32 v86, v86, v32
    v_mul_f32 v87, v87, v32
    v_mul_f32 v88, v88, v32
    v_mul_f32 v89, v89, v32
    v_mul_f32 v90, v90, v32
    v_mul_f32 v91, v91, v32
    v_mul_f32 v92, v92, v32
    v_mul_f32 v93, v93, v32
    v_mul_f32 v94, v94, v32
    v_mul_f32 v95, v95, v32
    v_cvt_pk_bf16_f32 v104, v80, v81
    v_cvt_pk_bf16_f32 v105, v82, v83
    v_cvt_pk_bf16_f32 v106, v84, v85
    v_cvt_pk_bf16_f32 v107, v86, v87
    buffer_store_dwordx4 v[104:107], v46, s[28:31], 0 offen offset:2048
    v_cvt_pk_bf16_f32 v108, v88, v89
    v_cvt_pk_bf16_f32 v109, v90, v91
    v_cvt_pk_bf16_f32 v110, v92, v93
    v_cvt_pk_bf16_f32 v111, v94, v95
    buffer_store_dwordx4 v[108:111], v46, s[28:31], 0 offen offset:3072
    v_accvgpr_read_b32 v64, a96
    v_accvgpr_read_b32 v65, a97
    v_accvgpr_read_b32 v66, a98
    v_accvgpr_read_b32 v67, a99
    v_accvgpr_read_b32 v68, a100
    v_accvgpr_read_b32 v69, a101
    v_accvgpr_read_b32 v70, a102
    v_accvgpr_read_b32 v71, a103
    v_accvgpr_read_b32 v72, a104
    v_accvgpr_read_b32 v73, a105
    v_accvgpr_read_b32 v74, a106
    v_accvgpr_read_b32 v75, a107
    v_accvgpr_read_b32 v76, a108
    v_accvgpr_read_b32 v77, a109
    v_accvgpr_read_b32 v78, a110
    v_accvgpr_read_b32 v79, a111
    v_mfma_f32_32x32x16_bf16 a[96:111], v[192:195], v[192:195], 0
    v_mul_f32 v64, v64, v32
    v_mul_f32 v65, v65, v32
    v_mul_f32 v66, v66, v32
    v_mul_f32 v67, v67, v32
    v_mul_f32 v68, v68, v32
    v_mul_f32 v69, v69, v32
    v_mul_f32 v70, v70, v32
    v_mul_f32 v71, v71, v32
    v_mul_f32 v72, v72, v32
    v_mul_f32 v73, v73, v32
    v_mul_f32 v74, v74, v32
    v_mul_f32 v75, v75, v32
    v_mul_f32 v76, v76, v32
    v_mul_f32 v77, v77, v32
    v_mul_f32 v78, v78, v32
    v_mul_f32 v79, v79, v32
    v_cvt_pk_bf16_f32 v112, v64, v65
    v_cvt_pk_bf16_f32 v113, v66, v67
    v_cvt_pk_bf16_f32 v114, v68, v69
    v_cvt_pk_bf16_f32 v115, v70, v71
    buffer_store_dwordx4 v[112:115], v47, s[28:31], 0 offen offset:0
    v_cvt_pk_bf16_f32 v116, v72, v73
    v_cvt_pk_bf16_f32 v117, v74, v75
    v_cvt_pk_bf16_f32 v118, v76, v77
    v_cvt_pk_bf16_f32 v119, v78, v79
    buffer_store_dwordx4 v[116:119], v47, s[28:31], 0 offen offset:1024
    v_accvgpr_read_b32 v80, a112
    v_accvgpr_read_b32 v81, a113
    v_accvgpr_read_b32 v82, a114
    v_accvgpr_read_b32 v83, a115
    v_accvgpr_read_b32 v84, a116
    v_accvgpr_read_b32 v85, a117
    v_accvgpr_read_b32 v86, a118
    v_accvgpr_read_b32 v87, a119
    v_accvgpr_read_b32 v88, a120
    v_accvgpr_read_b32 v89, a121
    v_accvgpr_read_b32 v90, a122
    v_accvgpr_read_b32 v91, a123
    v_accvgpr_read_b32 v92, a124
    v_accvgpr_read_b32 v93, a125
    v_accvgpr_read_b32 v94, a126
    v_accvgpr_read_b32 v95, a127
    v_mfma_f32_32x32x16_bf16 a[112:127], v[192:195], v[192:195], 0
    v_mul_f32 v80, v80, v32
    v_mul_f32 v81, v81, v32
    v_mul_f32 v82, v82, v32
    v_mul_f32 v83, v83, v32
    v_mul_f32 v84, v84, v32
    v_mul_f32 v85, v85, v32
    v_mul_f32 v86, v86, v32
    v_mul_f32 v87, v87, v32
    v_mul_f32 v88, v88, v32
    v_mul_f32 v89, v89, v32
    v_mul_f32 v90, v90, v32
    v_mul_f32 v91, v91, v32
    v_mul_f32 v92, v92, v32
    v_mul_f32 v93, v93, v32
    v_mul_f32 v94, v94, v32
    v_mul_f32 v95, v95, v32
    v_cvt_pk_bf16_f32 v120, v80, v81
    v_cvt_pk_bf16_f32 v121, v82, v83
    v_cvt_pk_bf16_f32 v122, v84, v85
    v_cvt_pk_bf16_f32 v123, v86, v87
    buffer_store_dwordx4 v[120:123], v47, s[28:31], 0 offen offset:2048
    v_cvt_pk_bf16_f32 v124, v88, v89
    v_cvt_pk_bf16_f32 v125, v90, v91
    v_cvt_pk_bf16_f32 v126, v92, v93
    v_cvt_pk_bf16_f32 v127, v94, v95
    buffer_store_dwordx4 v[124:127], v47, s[28:31], 0 offen offset:3072
    s_add_u32 s47, s47, 1
    s_cmp_eq_u32 s47, 15
    s_cselect_b64 s[20:21], s[68:69], s[20:21]
    s_cselect_b32 s63, 0, s63
    s_cselect_b64 vcc, -1, 0
    v_cndmask_b32 v16, v16, v52, vcc
    v_readlane_b32 s86, v33, s47
    s_bitcmp1_b32 s60, s47
    s_cselect_b32 s90, s62, 0x28000
    s_cselect_b32 s92, s63, 0x80000
    s_cselect_b32 s96, 0x8000, 0
    s_add_u32 s63, s63, s96
    s_lshl_b32 s96, s96, 1
    s_xor_b32 s62, s62, s96
    s_add_u32 s91, s90, 32768
    s_add_u32 s86, s86, s92
    s_cmp_eq_u32 s47, 16
    s_cselect_b64 s[24:25], s[68:69], s[24:25]
    s_cselect_b32 s65, 262144, s65
    s_cselect_b64 vcc, -1, 0
    v_cndmask_b32 v50, v50, v52, vcc
    v_readlane_b32 s87, v51, s47
    s_bitcmp1_b32 s61, s47
    s_cselect_b32 s93, s64, 0x28000
    s_cselect_b32 s95, s65, 0x80000
    s_cselect_b32 s96, 0x8000, 0
    s_add_u32 s65, s65, s96
    s_lshl_b32 s96, s96, 1
    s_xor_b32 s64, s64, s96
    s_add_u32 s94, s93, 32768
    s_add_u32 s87, s87, s95
    s_cmp_eq_u32 s47, 11
    s_cselect_b64 s[16:17], s[68:69], s[16:17]
    s_waitcnt vmcnt(0)
    s_cmp_lg_u32 s8, 0
    s_cbranch_scc1 AT_MERGE
    buffer_wbl2 sc1
    s_waitcnt vmcnt(0)
    s_branch AT_MERGE
AT_SWA:
    ds_read_b128 a[128:131], v6 offset:0
    ds_read_b128 a[132:135], v6 offset:1024
    ds_read_b128 a[136:139], v6 offset:2048
    ds_read_b128 a[140:143], v6 offset:3072
    ds_read_b128 a[144:147], v6 offset:4096
    ds_read_b128 a[148:151], v6 offset:5120
    ds_read_b128 a[152:155], v6 offset:6144
    ds_read_b128 a[156:159], v6 offset:7168
    ds_read_b128 a[160:163], v6 offset:8192
    ds_read_b128 a[164:167], v6 offset:9216
    ds_read_b128 a[168:171], v6 offset:10240
    ds_read_b128 a[172:175], v6 offset:11264
    ds_read_b128 a[176:179], v6 offset:12288
    ds_read_b128 a[180:183], v6 offset:13312
    ds_read_b128 a[184:187], v6 offset:14336
    ds_read_b128 a[188:191], v6 offset:15360
    v_mov_b32 v24, v19
    s_nop 1
    v_permlane32_swap_b32 v19, v24
    v_add_f32 v19, v19, v24
    v_rcp_f32 v31, v19
    v_mov_b32 v25, v21
    s_nop 1
    v_permlane32_swap_b32 v21, v25
    v_add_f32 v21, v21, v25
    v_rcp_f32 v32, v21
    v_mov_b32 v192, 0
    v_mov_b32 v193, 0
    v_mov_b32 v194, 0
    v_mov_b32 v195, 0
    s_lshr_b32 s45, s44, 7
    s_lshl_b32 s45, s45, 20
    s_lshl_b32 s50, s40, 15
    s_add_u32 s45, s45, s50
    s_bfe_u32 s50, s44, 0x10006
    s_lshl_b32 s50, s50, 14
    s_add_u32 s45, s45, s50
    v_add_u32 v44, s45, v17
    v_add_u32 v45, 4096, v44
    v_add_u32 v46, 8192, v44
    v_add_u32 v47, 8192, v45
    v_accvgpr_read_b32 v64, a0
    v_accvgpr_read_b32 v65, a1
    v_accvgpr_read_b32 v66, a2
    v_accvgpr_read_b32 v67, a3
    v_accvgpr_read_b32 v68, a4
    v_accvgpr_read_b32 v69, a5
    v_accvgpr_read_b32 v70, a6
    v_accvgpr_read_b32 v71, a7
    v_accvgpr_read_b32 v72, a8
    v_accvgpr_read_b32 v73, a9
    v_accvgpr_read_b32 v74, a10
    v_accvgpr_read_b32 v75, a11
    v_accvgpr_read_b32 v76, a12
    v_accvgpr_read_b32 v77, a13
    v_accvgpr_read_b32 v78, a14
    v_accvgpr_read_b32 v79, a15
    v_mfma_f32_32x32x16_bf16 a[0:15], v[192:195], v[192:195], 0
    v_mul_f32 v64, v64, v31
    v_mul_f32 v65, v65, v31
    v_mul_f32 v66, v66, v31
    v_mul_f32 v67, v67, v31
    v_mul_f32 v68, v68, v31
    v_mul_f32 v69, v69, v31
    v_mul_f32 v70, v70, v31
    v_mul_f32 v71, v71, v31
    v_mul_f32 v72, v72, v31
    v_mul_f32 v73, v73, v31
    v_mul_f32 v74, v74, v31
    v_mul_f32 v75, v75, v31
    v_mul_f32 v76, v76, v31
    v_mul_f32 v77, v77, v31
    v_mul_f32 v78, v78, v31
    v_mul_f32 v79, v79, v31
    v_cvt_pk_bf16_f32 v96, v64, v65
    v_cvt_pk_bf16_f32 v97, v66, v67
    v_cvt_pk_bf16_f32 v98, v68, v69
    v_cvt_pk_bf16_f32 v99, v70, v71
    buffer_store_dwordx4 v[96:99], v44, s[28:31], 0 offen offset:0
    v_cvt_pk_bf16_f32 v100, v72, v73
    v_cvt_pk_bf16_f32 v101, v74, v75
    v_cvt_pk_bf16_f32 v102, v76, v77
    v_cvt_pk_bf16_f32 v103, v78, v79
    buffer_store_dwordx4 v[100:103], v44, s[28:31], 0 offen offset:1024
    v_accvgpr_read_b32 v80, a16
    v_accvgpr_read_b32 v81, a17
    v_accvgpr_read_b32 v82, a18
    v_accvgpr_read_b32 v83, a19
    v_accvgpr_read_b32 v84, a20
    v_accvgpr_read_b32 v85, a21
    v_accvgpr_read_b32 v86, a22
    v_accvgpr_read_b32 v87, a23
    v_accvgpr_read_b32 v88, a24
    v_accvgpr_read_b32 v89, a25
    v_accvgpr_read_b32 v90, a26
    v_accvgpr_read_b32 v91, a27
    v_accvgpr_read_b32 v92, a28
    v_accvgpr_read_b32 v93, a29
    v_accvgpr_read_b32 v94, a30
    v_accvgpr_read_b32 v95, a31
    v_mfma_f32_32x32x16_bf16 a[16:31], v[192:195], v[192:195], 0
    v_mul_f32 v80, v80, v31
    v_mul_f32 v81, v81, v31
    v_mul_f32 v82, v82, v31
    v_mul_f32 v83, v83, v31
    v_mul_f32 v84, v84, v31
    v_mul_f32 v85, v85, v31
    v_mul_f32 v86, v86, v31
    v_mul_f32 v87, v87, v31
    v_mul_f32 v88, v88, v31
    v_mul_f32 v89, v89, v31
    v_mul_f32 v90, v90, v31
    v_mul_f32 v91, v91, v31
    v_mul_f32 v92, v92, v31
    v_mul_f32 v93, v93, v31
    v_mul_f32 v94, v94, v31
    v_mul_f32 v95, v95, v31
    v_cvt_pk_bf16_f32 v104, v80, v81
    v_cvt_pk_bf16_f32 v105, v82, v83
    v_cvt_pk_bf16_f32 v106, v84, v85
    v_cvt_pk_bf16_f32 v107, v86, v87
    buffer_store_dwordx4 v[104:107], v44, s[28:31], 0 offen offset:2048
    v_cvt_pk_bf16_f32 v108, v88, v89
    v_cvt_pk_bf16_f32 v109, v90, v91
    v_cvt_pk_bf16_f32 v110, v92, v93
    v_cvt_pk_bf16_f32 v111, v94, v95
    buffer_store_dwordx4 v[108:111], v44, s[28:31], 0 offen offset:3072
    s_waitcnt vmcnt(7)
    s_bitcmp1_b32 s47, 0
    s_cbranch_scc1 AT_BARW0
    s_branch AT_BARW1
AT_SW1:
    s_waitcnt lgkmcnt(0)
    s_sub_u32 s44, 15, s56
    s_lshl_b32 s44, s44, 7
    s_lshl_b32 s45, s3, 6
    s_add_u32 s44, s44, s45
    v_add_u32 v28, s44, v2
    v_lshlrev_b32 v24, 2, v3
    v_sub_u32 v28, v28, v24
    v_add_u32 v29, 32, v28
    s_lshr_b32 s53, s44, 6
    s_mov_b32 s88, s53
    v_mov_b32 v19, 0
    v_mov_b32 v21, 0
    v_mov_b32 v18, 0xf149f2ca
    v_mov_b32 v20, 0xf149f2ca
    s_or_b32 s53, s53, 1
    s_mov_b32 s88, 99
    s_add_u32 s80, s59, 3
    s_and_b32 s50, s80, 3
    v_lshl_add_u32 v5, s50, 15, v17
    ds_read_b128 a[192:195], v5 offset:0
    ds_read_b128 a[196:199], v5 offset:8192
    ds_read_b128 a[200:203], v5 offset:1024
    ds_read_b128 a[204:207], v5 offset:9216
    ds_read_b128 a[208:211], v5 offset:2048
    ds_read_b128 a[212:215], v5 offset:10240
    ds_read_b128 a[216:219], v5 offset:3072
    ds_read_b128 a[220:223], v5 offset:11264
    v_accvgpr_read_b32 v128, a32
    v_accvgpr_read_b32 v129, a33
    v_accvgpr_read_b32 v130, a34
    v_accvgpr_read_b32 v131, a35
    v_accvgpr_read_b32 v132, a36
    v_accvgpr_read_b32 v133, a37
    v_accvgpr_read_b32 v134, a38
    v_accvgpr_read_b32 v135, a39
    v_accvgpr_read_b32 v136, a40
    v_accvgpr_read_b32 v137, a41
    v_accvgpr_read_b32 v138, a42
    v_accvgpr_read_b32 v139, a43
    v_accvgpr_read_b32 v140, a44
    v_accvgpr_read_b32 v141, a45
    v_accvgpr_read_b32 v142, a46
    v_accvgpr_read_b32 v143, a47
    v_mfma_f32_32x32x16_bf16 a[32:47], v[192:195], v[192:195], 0
    v_mul_f32 v128, v128, v31
    v_mul_f32 v129, v129, v31
    v_mul_f32 v130, v130, v31
    v_mul_f32 v131, v131, v31
    v_mul_f32 v132, v132, v31
    v_mul_f32 v133, v133, v31
    v_mul_f32 v134, v134, v31
    s_waitcnt lgkmcnt(4)
    v_mfma_f32_32x32x16_bf16 v[64:79], a[192:195], a[128:131], 0
    ds_read_b128 a[224:227], v5 offset:4096
    v_mul_f32 v135, v135, v31
    v_mul_f32 v136, v136, v31
    v_mul_f32 v137, v137, v31
    v_mul_f32 v138, v138, v31
    v_mul_f32 v139, v139, v31
    v_mfma_f32_32x32x16_bf16 v[96:111], a[192:195], a[160:163], 0
    ds_read_b128 a[228:231], v5 offset:12288
    v_mul_f32 v140, v140, v31
    v_mul_f32 v141, v141, v31
    v_mul_f32 v142, v142, v31
    v_mul_f32 v143, v143, v31
    v_cvt_pk_bf16_f32 v176, v128, v129
    v_mfma_f32_32x32x16_bf16 v[80:95], a[196:199], a[128:131], 0
    ds_read_b128 a[232:235], v5 offset:5120
    v_cvt_pk_bf16_f32 v177, v130, v131
    v_cvt_pk_bf16_f32 v178, v132, v133
    v_cvt_pk_bf16_f32 v179, v134, v135
    v_mfma_f32_32x32x16_bf16 v[112:127], a[196:199], a[160:163], 0
    ds_read_b128 a[236:239], v5 offset:13312
    buffer_store_dwordx4 v[176:179], v45, s[28:31], 0 offen offset:0
    v_cvt_pk_bf16_f32 v180, v136, v137
    v_cvt_pk_bf16_f32 v181, v138, v139
    v_mfma_f32_32x32x16_bf16 v[64:79], a[200:203], a[132:135], v[64:79]
    buffer_load_dwordx4 v16, s[20:23], s86 offen offset:2048 lds
    v_cvt_pk_bf16_f32 v182, v140, v141
    v_cvt_pk_bf16_f32 v183, v142, v143
    buffer_store_dwordx4 v[180:183], v45, s[28:31], 0 offen offset:1024
    v_mfma_f32_32x32x16_bf16 v[96:111], a[200:203], a[164:167], v[96:111]
    buffer_load_dwordx4 v16, s[20:23], s86 offen offset:3072 lds
    v_accvgpr_read_b32 v144, a48
    v_accvgpr_read_b32 v145, a49
    v_accvgpr_read_b32 v146, a50
    v_accvgpr_read_b32 v147, a51
    v_accvgpr_read_b32 v148, a52
    v_mfma_f32_32x32x16_bf16 v[80:95], a[204:207], a[132:135], v[80:95]
    s_mov_b32 m0, s93
    s_nop 0
    buffer_load_dwordx4 v50, s[24:27], s95 offen offset:0 lds
    v_accvgpr_read_b32 v149, a53
    v_accvgpr_read_b32 v150, a54
    v_accvgpr_read_b32 v151, a55
    v_accvgpr_read_b32 v152, a56
    v_accvgpr_read_b32 v153, a57
    v_mfma_f32_32x32x16_bf16 v[112:127], a[204:207], a[164:167], v[112:127]
    s_waitcnt lgkmcnt(4)
    buffer_load_dwordx4 v50, s[24:27], s95 offen offset:1024 lds
    v_accvgpr_read_b32 v154, a58
    v_accvgpr_read_b32 v155, a59
    v_accvgpr_read_b32 v156, a60
    v_accvgpr_read_b32 v157, a61
    v_accvgpr_read_b32 v158, a62
    v_mfma_f32_32x32x16_bf16 v[64:79], a[208:211], a[136:139], v[64:79]
    ds_read_b128 a[240:243], v5 offset:6144
    v_accvgpr_read_b32 v159, a63
    v_mfma_f32_32x32x16_bf16 a[48:63], v[192:195], v[192:195], 0
    v_mul_f32 v144, v144, v31
    v_mul_f32 v145, v145, v31
    v_mul_f32 v146, v146, v31
    v_mfma_f32_32x32x16_bf16 v[96:111], a[208:211], a[168:171], v[96:111]
    ds_read_b128 a[244:247], v5 offset:14336
    v_mul_f32 v147, v147, v31
    v_mul_f32 v148, v148, v31
    v_mul_f32 v149, v149, v31
    v_mul_f32 v150, v150, v31
    v_mul_f32 v151, v151, v31
    v_mfma_f32_32x32x16_bf16 v[80:95], a[212:215], a[136:139], v[80:95]
    ds_read_b128 a[248:251], v5 offset:7168
    v_mul_f32 v152, v152, v31
    v_mul_f32 v153, v153, v31
    v_mul_f32 v154, v154, v31
    v_mul_f32 v155, v155, v31
    v_mul_f32 v156, v156, v31
    v_mfma_f32_32x32x16_bf16 v[112:127], a[212:215], a[168:171], v[112:127]
    ds_read_b128 a[252:255], v5 offset:15360
    v_mul_f32 v157, v157, v31
    v_mul_f32 v158, v158, v31
    v_mul_f32 v159, v159, v31
    v_cvt_pk_bf16_f32 v184, v144, v145
    v_cvt_pk_bf16_f32 v185, v146, v147
    v_mfma_f32_32x32x16_bf16 v[64:79], a[216:219], a[140:143], v[64:79]
    buffer_load_dwordx4 v50, s[24:27], s95 offen offset:2048 lds
    v_cvt_pk_bf16_f32 v186, v148, v149
    v_cvt_pk_bf16_f32 v187, v150, v151
    buffer_store_dwordx4 v[184:187], v45, s[28:31], 0 offen offset:2048
    v_mfma_f32_32x32x16_bf16 v[96:111], a[216:219], a[172:175], v[96:111]
    buffer_load_dwordx4 v50, s[24:27], s95 offen offset:3072 lds
    v_cvt_pk_bf16_f32 v188, v152, v153
    v_cvt_pk_bf16_f32 v189, v154, v155
    v_cvt_pk_bf16_f32 v190, v156, v157
    v_cvt_pk_bf16_f32 v191, v158, v159
    v_mfma_f32_32x32x16_bf16 v[80:95], a[220:223], a[140:143], v[80:95]
    s_mov_b32 m0, s94
    s_nop 0
    buffer_load_dwordx4 v50, s[24:27], s87 offen offset:0 lds
    buffer_store_dwordx4 v[188:191], v45, s[28:31], 0 offen offset:3072
    v_accvgpr_read_b32 v128, a64
    v_accvgpr_read_b32 v129, a65
    v_mfma_f32_32x32x16_bf16 v[112:127], a[220:223], a[172:175], v[112:127]
    s_waitcnt lgkmcnt(4)
    buffer_load_dwordx4 v50, s[24:27], s87 offen offset:1024 lds
    v_accvgpr_read_b32 v130, a66
    v_accvgpr_read_b32 v131, a67
    v_accvgpr_read_b32 v132, a68
    v_accvgpr_read_b32 v133, a69
    v_accvgpr_read_b32 v134, a70
    v_mfma_f32_32x32x16_bf16 v[64:79], a[224:227], a[144:147], v[64:79]
    v_accvgpr_read_b32 v135, a71
    v_accvgpr_read_b32 v136, a72
    v_accvgpr_read_b32 v137, a73
    v_accvgpr_read_b32 v138, a74
    v_accvgpr_read_b32 v139, a75
    v_accvgpr_read_b32 v140, a76
    v_mfma_f32_32x32x16_bf16 v[96:111], a[224:227], a[176:179], v[96:111]
    buffer_load_dwordx4 v50, s[24:27], s87 offen offset:2048 lds
    v_accvgpr_read_b32 v141, a77
    v_accvgpr_read_b32 v142, a78
    v_accvgpr_read_b32 v143, a79
    v_mfma_f32_32x32x16_bf16 a[64:79], v[192:195], v[192:195], 0
    v_mul_f32 v128, v128, v32
    v_mfma_f32_32x32x16_bf16 v[80:95], a[228:231], a[144:147], v[80:95]
    buffer_load_dwordx4 v50, s[24:27], s87 offen offset:3072 lds
    v_mul_f32 v129, v129, v32
    v_mul_f32 v130, v130, v32
    v_mul_f32 v131, v131, v32
    v_mul_f32 v132, v132, v32
    v_mul_f32 v133, v133, v32
    v_mfma_f32_32x32x16_bf16 v[112:127], a[228:231], a[176:179], v[112:127]
    s_add_u32 s47, s47, 1
    s_cmp_eq_u32 s47, 15
    s_cselect_b64 s[20:21], s[68:69], s[20:21]
    s_cselect_b32 s63, 0, s63
    s_cselect_b64 vcc, -1, 0
    v_cndmask_b32 v16, v16, v52, vcc
    v_readlane_b32 s86, v33, s47
    s_bitcmp1_b32 s60, s47
    s_cselect_b32 s90, s62, 0x28000
    s_cselect_b32 s92, s63, 0x80000
    s_cselect_b32 s96, 0x8000, 0
    s_add_u32 s63, s63, s96
    s_lshl_b32 s96, s96, 1
    s_xor_b32 s62, s62, s96
    s_add_u32 s91, s90, 32768
    s_add_u32 s86, s86, s92
    s_cmp_eq_u32 s47, 16
    s_cselect_b64 s[24:25], s[68:69], s[24:25]
    s_cselect_b32 s65, 262144, s65
    s_cselect_b64 vcc, -1, 0
    v_cndmask_b32 v50, v50, v52, vcc
    v_readlane_b32 s87, v51, s47
    v_permlane32_swap_b32 v60, v62
    v_mfma_f32_32x32x16_bf16 v[64:79], a[232:235], a[148:151], v[64:79]
    s_bitcmp1_b32 s61, s47
    v_permlane32_swap_b32 v61, v63
    v_mul_f32 v134, v134, v32
    v_mul_f32 v135, v135, v32
    v_mul_f32 v136, v136, v32
    v_mul_f32 v137, v137, v32
    v_mul_f32 v138, v138, v32
    v_mfma_f32_32x32x16_bf16 v[96:111], a[232:235], a[180:183], v[96:111]
    s_cselect_b32 s93, s64, 0x28000
    buffer_store_dwordx4 v[60:63], v17, s[72:75], s11 offen
    v_mul_f32 v139, v139, v32
    v_mul_f32 v140, v140, v32
    v_mul_f32 v141, v141, v32
    v_mul_f32 v142, v142, v32
    v_mul_f32 v143, v143, v32
    v_mfma_f32_32x32x16_bf16 v[80:95], a[236:239], a[148:151], v[80:95]
    s_cselect_b32 s95, s65, 0x80000
    buffer_load_dwordx4 v[60:63], v8, s[16:19], s70 offen
    v_cvt_pk_bf16_f32 v160, v128, v129
    v_cvt_pk_bf16_f32 v161, v130, v131
    v_cvt_pk_bf16_f32 v162, v132, v133
    v_cvt_pk_bf16_f32 v163, v134, v135
    v_mfma_f32_32x32x16_bf16 v[112:127], a[236:239], a[180:183], v[112:127]
    s_waitcnt lgkmcnt(0)
    buffer_load_dword v36, v35, s[72:75], s71 offen
    buffer_store_dwordx4 v[160:163], v46, s[28:31], 0 offen offset:0
    v_cvt_pk_bf16_f32 v164, v136, v137
    v_cvt_pk_bf16_f32 v165, v138, v139
    v_mfma_f32_32x32x16_bf16 v[64:79], a[240:243], a[152:155], v[64:79]
    s_cselect_b32 s96, 0x8000, 0
    v_cvt_pk_bf16_f32 v166, v140, v141
    v_cvt_pk_bf16_f32 v167, v142, v143
    buffer_store_dwordx4 v[164:167], v46, s[28:31], 0 offen offset:1024
    v_accvgpr_read_b32 v144, a80
    v_mfma_f32_32x32x16_bf16 v[96:111], a[240:243], a[184:187], v[96:111]
    s_add_u32 s65, s65, s96
    v_readlane_b32 s70, v7, s47
    v_readlane_b32 s71, v34, s47
    v_readlane_b32 s11, v9, s47
    v_accvgpr_read_b32 v145, a81
    v_accvgpr_read_b32 v146, a82
    v_accvgpr_read_b32 v147, a83
    v_mfma_f32_32x32x16_bf16 v[80:95], a[244:247], a[152:155], v[80:95]
    s_lshl_b32 s96, s96, 1
    v_accvgpr_read_b32 v148, a84
    v_accvgpr_read_b32 v149, a85
    v_accvgpr_read_b32 v150, a86
    v_accvgpr_read_b32 v151, a87
    v_accvgpr_read_b32 v152, a88
    v_accvgpr_read_b32 v153, a89
    v_mfma_f32_32x32x16_bf16 v[112:127], a[244:247], a[184:187], v[112:127]
    s_xor_b32 s64, s64, s96
    v_accvgpr_read_b32 v154, a90
    v_accvgpr_read_b32 v155, a91
    v_accvgpr_read_b32 v156, a92
    v_accvgpr_read_b32 v157, a93
    v_accvgpr_read_b32 v158, a94
    v_accvgpr_read_b32 v159, a95
    v_mfma_f32_32x32x16_bf16 v[64:79], a[248:251], a[156:159], v[64:79]
    s_add_u32 s94, s93, 32768
    v_mfma_f32_32x32x16_bf16 a[80:95], v[192:195], v[192:195], 0
    v_mul_f32 v144, v144, v32
    v_mul_f32 v145, v145, v32
    v_mul_f32 v146, v146, v32
    v_mul_f32 v147, v147, v32
    v_mul_f32 v148, v148, v32
    v_mfma_f32_32x32x16_bf16 v[96:111], a[248:251], a[188:191], v[96:111]
    s_add_u32 s87, s87, s95
    v_mul_f32 v149, v149, v32
    v_mul_f32 v150, v150, v32
    v_mul_f32 v151, v151, v32
    v_mul_f32 v152, v152, v32
    v_mul_f32 v153, v153, v32
    v_mul_f32 v154, v154, v32
    v_mfma_f32_32x32x16_bf16 v[80:95], a[252:255], a[156:159], v[80:95]
    s_cmp_eq_u32 s47, 11
    v_mul_f32 v155, v155, v32
    v_mul_f32 v156, v156, v32
    v_mul_f32 v157, v157, v32
    v_mul_f32 v158, v158, v32
    v_mul_f32 v159, v159, v32
    v_cvt_pk_bf16_f32 v168, v144, v145
    v_mfma_f32_32x32x16_bf16 v[112:127], a[252:255], a[188:191], v[112:127]
    s_cselect_b64 s[16:17], s[68:69], s[16:17]
    v_cvt_pk_bf16_f32 v169, v146, v147
    v_cvt_pk_bf16_f32 v170, v148, v149
    v_cvt_pk_bf16_f32 v171, v150, v151
    buffer_store_dwordx4 v[168:171], v46, s[28:31], 0 offen offset:2048
    v_cvt_pk_bf16_f32 v172, v152, v153
    v_cvt_pk_bf16_f32 v173, v154, v155
    v_cvt_pk_bf16_f32 v174, v156, v157
    v_cvt_pk_bf16_f32 v175, v158, v159
    buffer_store_dwordx4 v[172:175], v46, s[28:31], 0 offen offset:3072
    v_accvgpr_read_b32 v128, a96
    v_accvgpr_read_b32 v129, a97
    v_accvgpr_read_b32 v130, a98
    v_accvgpr_read_b32 v131, a99
    v_accvgpr_read_b32 v132, a100
    v_accvgpr_read_b32 v133, a101
    v_accvgpr_read_b32 v134, a102
    v_accvgpr_read_b32 v135, a103
    v_accvgpr_read_b32 v136, a104
    v_accvgpr_read_b32 v137, a105
    v_accvgpr_read_b32 v138, a106
    v_accvgpr_read_b32 v139, a107
    v_accvgpr_read_b32 v140, a108
    v_accvgpr_read_b32 v141, a109
    v_accvgpr_read_b32 v142, a110
    v_accvgpr_read_b32 v143, a111
    v_mfma_f32_32x32x16_bf16 a[96:111], v[192:195], v[192:195], 0
    v_mul_f32 v128, v128, v32
    v_mul_f32 v129, v129, v32
    v_mul_f32 v130, v130, v32
    v_mul_f32 v131, v131, v32
    v_mul_f32 v132, v132, v32
    v_mul_f32 v133, v133, v32
    v_mul_f32 v134, v134, v32
    v_mul_f32 v135, v135, v32
    v_mul_f32 v136, v136, v32
    v_mul_f32 v137, v137, v32
    v_mul_f32 v138, v138, v32
    v_mul_f32 v139, v139, v32
    v_mul_f32 v140, v140, v32
    v_mul_f32 v141, v141, v32
    v_mul_f32 v142, v142, v32
    v_mul_f32 v143, v143, v32
    v_cvt_pk_bf16_f32 v176, v128, v129
    v_cvt_pk_bf16_f32 v177, v130, v131
    v_cvt_pk_bf16_f32 v178, v132, v133
    v_cvt_pk_bf16_f32 v179, v134, v135
    buffer_store_dwordx4 v[176:179], v47, s[28:31], 0 offen offset:0
    v_cvt_pk_bf16_f32 v180, v136, v137
    v_cvt_pk_bf16_f32 v181, v138, v139
    v_cvt_pk_bf16_f32 v182, v140, v141
    v_cvt_pk_bf16_f32 v183, v142, v143
    buffer_store_dwordx4 v[180:183], v47, s[28:31], 0 offen offset:1024
    v_accvgpr_read_b32 v144, a112
    v_accvgpr_read_b32 v145, a113
    v_accvgpr_read_b32 v146, a114
    v_accvgpr_read_b32 v147, a115
    v_accvgpr_read_b32 v148, a116
    v_accvgpr_read_b32 v149, a117
    v_accvgpr_read_b32 v150, a118
    v_accvgpr_read_b32 v151, a119
    v_accvgpr_read_b32 v152, a120
    v_accvgpr_read_b32 v153, a121
    v_accvgpr_read_b32 v154, a122
    v_accvgpr_read_b32 v155, a123
    v_accvgpr_read_b32 v156, a124
    v_accvgpr_read_b32 v157, a125
    v_accvgpr_read_b32 v158, a126
    v_accvgpr_read_b32 v159, a127
    v_mfma_f32_32x32x16_bf16 a[112:127], v[192:195], v[192:195], 0
    v_mul_f32 v144, v144, v32
    v_mul_f32 v145, v145, v32
    v_mul_f32 v146, v146, v32
    v_mul_f32 v147, v147, v32
    v_mul_f32 v148, v148, v32
    v_mul_f32 v149, v149, v32
    v_mul_f32 v150, v150, v32
    v_mul_f32 v151, v151, v32
    v_mul_f32 v152, v152, v32
    v_mul_f32 v153, v153, v32
    v_mul_f32 v154, v154, v32
    v_mul_f32 v155, v155, v32
    v_mul_f32 v156, v156, v32
    v_mul_f32 v157, v157, v32
    v_mul_f32 v158, v158, v32
    v_mul_f32 v159, v159, v32
    v_cvt_pk_bf16_f32 v184, v144, v145
    v_cvt_pk_bf16_f32 v185, v146, v147
    v_cvt_pk_bf16_f32 v186, v148, v149
    v_cvt_pk_bf16_f32 v187, v150, v151
    buffer_store_dwordx4 v[184:187], v47, s[28:31], 0 offen offset:2048
    v_cvt_pk_bf16_f32 v188, v152, v153
    v_cvt_pk_bf16_f32 v189, v154, v155
    v_cvt_pk_bf16_f32 v190, v156, v157
    v_cvt_pk_bf16_f32 v191, v158, v159
    buffer_store_dwordx4 v[188:191], v47, s[28:31], 0 offen offset:3072
    s_lshl_b32 s51, s53, 6
    v_subrev_u32 v24, s51, v28
    v_mov_b32 v26, 0xf149f2ca
    v_mov_b32 v27, 0xf149f2ca
    v_pk_mov_b32 v[80:81], v[26:27], v[26:27]
    v_pk_mov_b32 v[82:83], v[26:27], v[26:27]
    v_pk_mov_b32 v[84:85], v[26:27], v[26:27]
    v_pk_mov_b32 v[86:87], v[26:27], v[26:27]
    v_pk_mov_b32 v[88:89], v[26:27], v[26:27]
    v_pk_mov_b32 v[90:91], v[26:27], v[26:27]
    v_pk_mov_b32 v[92:93], v[26:27], v[26:27]
    v_pk_mov_b32 v[94:95], v[26:27], v[26:27]
    v_cmpx_gt_i32 vcc, 27, v24
    v_mov_b32 v79, v26
    v_mov_b32 v127, v26
    v_cmpx_gt_i32 vcc, 26, v24
    v_mov_b32 v78, v26
    v_mov_b32 v126, v26
    v_cmpx_gt_i32 vcc, 25, v24
    v_mov_b32 v77, v26
    v_mov_b32 v125, v26
    v_cmpx_gt_i32 vcc, 24, v24
    v_mov_b32 v76, v26
    v_mov_b32 v124, v26
    v_cmpx_gt_i32 vcc, 19, v24
    v_mov_b32 v75, v26
    v_mov_b32 v123, v26
    v_cmpx_gt_i32 vcc, 18, v24
    v_mov_b32 v74, v26
    v_mov_b32 v122, v26
    v_cmpx_gt_i32 vcc, 17, v24
    v_mov_b32 v73, v26
    v_mov_b32 v121, v26
    v_cmpx_gt_i32 vcc, 16, v24
    v_mov_b32 v72, v26
    v_mov_b32 v120, v26
    v_cmpx_gt_i32 vcc, 11, v24
    v_mov_b32 v71, v26
    v_mov_b32 v119, v26
    v_cmpx_gt_i32 vcc, 10, v24
    v_mov_b32 v70, v26
    v_mov_b32 v118, v26
    v_cmpx_gt_i32 vcc, 9, v24
    v_mov_b32 v69, v26
    v_mov_b32 v117, v26
    v_cmpx_gt_i32 vcc, 8, v24
    v_mov_b32 v68, v26
    v_mov_b32 v116, v26
    v_cmpx_gt_i32 vcc, 3, v24
    v_mov_b32 v67, v26
    v_mov_b32 v115, v26
    v_cmpx_gt_i32 vcc, 2, v24
    v_mov_b32 v66, v26
    v_mov_b32 v114, v26
    v_cmpx_gt_i32 vcc, 1, v24
    v_mov_b32 v65, v26
    v_mov_b32 v113, v26
    v_cmpx_gt_i32 vcc, 0, v24
    v_mov_b32 v64, v26
    v_mov_b32 v112, v26
    s_mov_b64 exec, -1
    v_max3_f32 v24, v64, v65, v66
    v_max3_f32 v24, v24, v67, v68
    v_max3_f32 v24, v24, v69, v70
    v_max3_f32 v24, v24, v71, v72
    v_max3_f32 v24, v24, v73, v74
    v_max3_f32 v24, v24, v75, v76
    v_max3_f32 v24, v24, v77, v78
    v_max3_f32 v24, v24, v79, v80
    v_max3_f32 v24, v24, v81, v82
    v_max3_f32 v24, v24, v83, v84
    v_max3_f32 v24, v24, v85, v86
    v_max3_f32 v24, v24, v87, v88
    v_max3_f32 v24, v24, v89, v90
    v_max3_f32 v24, v24, v91, v92
    v_max3_f32 v24, v24, v93, v94
    v_max_f32 v24, v24, v95
    v_max3_f32 v25, v96, v97, v98
    v_max3_f32 v25, v25, v99, v100
    v_max3_f32 v25, v25, v101, v102
    v_max3_f32 v25, v25, v103, v104
    v_max3_f32 v25, v25, v105, v106
    v_max3_f32 v25, v25, v107, v108
    v_max3_f32 v25, v25, v109, v110
    v_max3_f32 v25, v25, v111, v112
    v_max3_f32 v25, v25, v113, v114
    v_max3_f32 v25, v25, v115, v116
    v_max3_f32 v25, v25, v117, v118
    v_max3_f32 v25, v25, v119, v120
    v_max3_f32 v25, v25, v121, v122
    v_max3_f32 v25, v25, v123, v124
    v_max3_f32 v25, v25, v125, v126
    v_max_f32 v25, v25, v127
    v_mov_b32 v26, v24
    s_nop 1
    v_permlane32_swap_b32 v24, v26
    v_max_f32 v24, v24, v26
    v_mov_b32 v18, v24
    v_sub_f32 v26, 0, v18
    v_pk_add_f32 v[64:65], v[64:65], v[24:25] op_sel:[0,0] op_sel_hi:[1,0] neg_lo:[0,1] neg_hi:[0,1]
    v_pk_add_f32 v[66:67], v[66:67], v[24:25] op_sel:[0,0] op_sel_hi:[1,0] neg_lo:[0,1] neg_hi:[0,1]
    v_pk_add_f32 v[68:69], v[68:69], v[24:25] op_sel:[0,0] op_sel_hi:[1,0] neg_lo:[0,1] neg_hi:[0,1]
    v_pk_add_f32 v[70:71], v[70:71], v[24:25] op_sel:[0,0] op_sel_hi:[1,0] neg_lo:[0,1] neg_hi:[0,1]
    v_pk_add_f32 v[72:73], v[72:73], v[24:25] op_sel:[0,0] op_sel_hi:[1,0] neg_lo:[0,1] neg_hi:[0,1]
    v_pk_add_f32 v[74:75], v[74:75], v[24:25] op_sel:[0,0] op_sel_hi:[1,0] neg_lo:[0,1] neg_hi:[0,1]
    v_pk_add_f32 v[76:77], v[76:77], v[24:25] op_sel:[0,0] op_sel_hi:[1,0] neg_lo:[0,1] neg_hi:[0,1]
    v_pk_add_f32 v[78:79], v[78:79], v[24:25] op_sel:[0,0] op_sel_hi:[1,0] neg_lo:[0,1] neg_hi:[0,1]
    v_pk_add_f32 v[80:81], v[80:81], v[24:25] op_sel:[0,0] op_sel_hi:[1,0] neg_lo:[0,1] neg_hi:[0,1]
    v_pk_add_f32 v[82:83], v[82:83], v[24:25] op_sel:[0,0] op_sel_hi:[1,0] neg_lo:[0,1] neg_hi:[0,1]
    v_pk_add_f32 v[84:85], v[84:85], v[24:25] op_sel:[0,0] op_sel_hi:[1,0] neg_lo:[0,1] neg_hi:[0,1]
    v_pk_add_f32 v[86:87], v[86:87], v[24:25] op_sel:[0,0] op_sel_hi:[1,0] neg_lo:[0,1] neg_hi:[0,1]
    v_pk_add_f32 v[88:89], v[88:89], v[24:25] op_sel:[0,0] op_sel_hi:[1,0] neg_lo:[0,1] neg_hi:[0,1]
    v_pk_add_f32 v[90:91], v[90:91], v[24:25] op_sel:[0,0] op_sel_hi:[1,0] neg_lo:[0,1] neg_hi:[0,1]
    v_pk_add_f32 v[92:93], v[92:93], v[24:25] op_sel:[0,0] op_sel_hi:[1,0] neg_lo:[0,1] neg_hi:[0,1]
    v_pk_add_f32 v[94:95], v[94:95], v[24:25] op_sel:[0,0] op_sel_hi:[1,0] neg_lo:[0,1] neg_hi:[0,1]
    v_pk_mov_b32 v[224:225], v[26:27], v[26:27] op_sel:[0,0]
    v_pk_mov_b32 v[226:227], v[26:27], v[26:27] op_sel:[0,0]
    v_pk_mov_b32 v[228:229], v[26:27], v[26:27] op_sel:[0,0]
    v_pk_mov_b32 v[230:231], v[26:27], v[26:27] op_sel:[0,0]
    v_pk_mov_b32 v[232:233], v[26:27], v[26:27] op_sel:[0,0]
    v_pk_mov_b32 v[234:235], v[26:27], v[26:27] op_sel:[0,0]
    v_pk_mov_b32 v[236:237], v[26:27], v[26:27] op_sel:[0,0]
    v_pk_mov_b32 v[238:239], v[26:27], v[26:27] op_sel:[0,0]
    s_mov_b64 s[76:77], 0
    v_mov_b32 v27, v25
    s_nop 1
    v_permlane32_swap_b32 v25, v27
    v_max_f32 v25, v25, v27
    v_mov_b32 v20, v25
    v_sub_f32 v27, 0, v20
    v_pk_add_f32 v[96:97], v[96:97], v[24:25] op_sel:[0,1] op_sel_hi:[1,1] neg_lo:[0,1] neg_hi:[0,1]
    v_pk_add_f32 v[98:99], v[98:99], v[24:25] op_sel:[0,1] op_sel_hi:[1,1] neg_lo:[0,1] neg_hi:[0,1]
    v_pk_add_f32 v[100:101], v[100:101], v[24:25] op_sel:[0,1] op_sel_hi:[1,1] neg_lo:[0,1] neg_hi:[0,1]
    v_pk_add_f32 v[102:103], v[102:103], v[24:25] op_sel:[0,1] op_sel_hi:[1,1] neg_lo:[0,1] neg_hi:[0,1]
    v_pk_add_f32 v[104:105], v[104:105], v[24:25] op_sel:[0,1] op_sel_hi:[1,1] neg_lo:[0,1] neg_hi:[0,1]
    v_pk_add_f32 v[106:107], v[106:107], v[24:25] op_sel:[0,1] op_sel_hi:[1,1] neg_lo:[0,1] neg_hi:[0,1]
    v_pk_add_f32 v[108:109], v[108:109], v[24:25] op_sel:[0,1] op_sel_hi:[1,1] neg_lo:[0,1] neg_hi:[0,1]
    v_pk_add_f32 v[110:111], v[110:111], v[24:25] op_sel:[0,1] op_sel_hi:[1,1] neg_lo:[0,1] neg_hi:[0,1]
    v_pk_add_f32 v[112:113], v[112:113], v[24:25] op_sel:[0,1] op_sel_hi:[1,1] neg_lo:[0,1] neg_hi:[0,1]
    v_pk_add_f32 v[114:115], v[114:115], v[24:25] op_sel:[0,1] op_sel_hi:[1,1] neg_lo:[0,1] neg_hi:[0,1]
    v_pk_add_f32 v[116:117], v[116:117], v[24:25] op_sel:[0,1] op_sel_hi:[1,1] neg_lo:[0,1] neg_hi:[0,1]
    v_pk_add_f32 v[118:119], v[118:119], v[24:25] op_sel:[0,1] op_sel_hi:[1,1] neg_lo:[0,1] neg_hi:[0,1]
    v_pk_add_f32 v[120:121], v[120:121], v[24:25] op_sel:[0,1] op_sel_hi:[1,1] neg_lo:[0,1] neg_hi:[0,1]
    v_pk_add_f32 v[122:123], v[122:123], v[24:25] op_sel:[0,1] op_sel_hi:[1,1] neg_lo:[0,1] neg_hi:[0,1]
    v_pk_add_f32 v[124:125], v[124:125], v[24:25] op_sel:[0,1] op_sel_hi:[1,1] neg_lo:[0,1] neg_hi:[0,1]
    v_pk_add_f32 v[126:127], v[126:127], v[24:25] op_sel:[0,1] op_sel_hi:[1,1] neg_lo:[0,1] neg_hi:[0,1]
    v_pk_mov_b32 v[240:241], v[26:27], v[26:27] op_sel:[1,1]
    v_pk_mov_b32 v[242:243], v[26:27], v[26:27] op_sel:[1,1]
    v_pk_mov_b32 v[244:245], v[26:27], v[26:27] op_sel:[1,1]
    v_pk_mov_b32 v[246:247], v[26:27], v[26:27] op_sel:[1,1]
    v_pk_mov_b32 v[248:249], v[26:27], v[26:27] op_sel:[1,1]
    v_pk_mov_b32 v[250:251], v[26:27], v[26:27] op_sel:[1,1]
    v_pk_mov_b32 v[252:253], v[26:27], v[26:27] op_sel:[1,1]
    v_pk_mov_b32 v[254:255], v[26:27], v[26:27] op_sel:[1,1]
    s_mov_b64 s[78:79], 0
    s_waitcnt vmcnt(11)
    s_cmp_lg_u32 s8, 0
    s_cbranch_scc1 AT_BARW1
    s_waitcnt vmcnt(0)
    buffer_wbl2 sc1
    s_branch AT_BARW1
AT_MERGE:
    v_mov_b32 v24, v19
    s_nop 1
    v_permlane32_swap_b32 v19, v24
    v_add_f32 v19, v19, v24
    v_mov_b32 v25, v21
    s_nop 1
    v_permlane32_swap_b32 v21, v25
    v_add_f32 v21, v21, v25
    s_sub_u32 s64, s64, s36
    s_sub_u32 s62, s62, s36
    s_lshl_b32 s45, s3, 15
    s_add_u32 s45, s45, s64
    s_lshl_b32 s50, s3, 14
    s_add_u32 s50, s50, 0x20000
    s_cmp_lt_u32 s55, 2
    s_cselect_b32 s52, s45, s50
    s_cselect_b32 s53, s50, s45
    v_add_u32 v8, s52, v17
    v_add_u32 v10, s53, v17
    s_add_u32 s45, s62, s36
    v_add_u32 v9, s45, v17
    v_xor_b32 v11, 8192, v9
    s_load_dwordx2 s[4:5], s[0:1], 0
    s_load_dwordx2 s[10:11], s[0:1], 104
    s_load_dwordx2 s[6:7], s[0:1], 72
    s_mov_b64 s[12:13], s[72:73]
    s_mov_b64 s[14:15], s[74:75]
    s_and_b32 s42, s2, 7
    s_lshr_b32 s41, s2, 3
    s_and_b32 s43, s41, 7
    s_lshr_b32 s46, s41, 3
    s_and_b32 s47, s41, 3
    s_lshr_b32 s48, s41, 2
    s_lshl_b32 s49, s42, 21
    s_add_u32 s49, s49, 16777216
    s_mul_i32 s80, s42, 20480
    s_add_u32 s80, s80, 262144
    s_lshl_b32 s78, s41, 2
    s_add_u32 s78, s78, s80
    s_add_u32 s78, s78, 19968
    s_cmp_eq_u32 s55, 0
    s_cselect_b32 s78, s78, 1073741824
    s_lshl_b32 s57, s47, 3
    s_add_u32 s57, s57, s48
    s_lshl_b32 s34, s42, 17
    s_lshl_b32 s51, s55, 13
    s_add_u32 s34, s34, s51
    s_add_u32 s34, s34, 50331648
    s_lshl_b32 s60, s56, 20
    s_add_u32 s51, s34, s60
    s_sub_u32 s60, s34, s60
    s_add_u32 s60, s60, 15728640
    s_cmp_lt_u32 s55, 2
    s_cselect_b32 s81, 1073741824, s67
    s_mov_b32 s59, s51
    s_waitcnt vmcnt(13)
    buffer_store_dword v33, off, s[72:75], s81 sc1
    v_cmp_ne_u32 vcc, 0, v57
    s_nop 0
    s_cmp_eq_u64 vcc, -1
    s_cselect_b32 s79, 1, 0
    s_cselect_b32 s51, s51, 1073741824
    buffer_load_dwordx4 a[128:131], v17, s[12:15], s51 offen offset:2048
    buffer_load_dwordx4 a[132:135], v17, s[12:15], s51 offen offset:3072
    s_add_u32 s51, s51, 4096
    buffer_load_dwordx4 a[136:139], v17, s[12:15], s51 offen offset:2048
    buffer_load_dwordx4 a[140:143], v17, s[12:15], s51 offen offset:3072
    s_add_u32 s51, s51, 28672
    s_barrier
    s_cmp_ge_u32 s55, 2
    s_cbranch_scc1 AT_MG1
    s_cmp_eq_u32 s8, 0
    s_cbranch_scc1 TL_LF_8
    v_mov_b32 v58, 1
    s_mov_b64 exec, 1
    buffer_store_dword v58, off, s[12:15], s78
    s_mov_b64 exec, -1
TL_LF_8_R:
    buffer_load_dwordx4 a[144:147], v17, s[12:15], s51 offen offset:2048
    ds_write_b128 v8, a[32:35] offset:0
    v_accvgpr_read_b32 v128, a0
    v_accvgpr_read_b32 v129, a1
    v_accvgpr_read_b32 v130, a2
    v_accvgpr_read_b32 v131, a3
    buffer_load_dwordx4 a[148:151], v17, s[12:15], s51 offen offset:3072
    s_add_u32 s51, s51, 4096
    ds_write_b128 v8, a[36:39] offset:1024
    v_accvgpr_read_b32 v132, a4
    v_accvgpr_read_b32 v133, a5
    v_accvgpr_read_b32 v134, a6
    v_accvgpr_read_b32 v135, a7
    buffer_load_dwordx4 a[152:155], v17, s[12:15], s51 offen offset:2048
    ds_write_b128 v8, a[40:43] offset:2048
    v_accvgpr_read_b32 v136, a8
    v_accvgpr_read_b32 v137, a9
    v_accvgpr_read_b32 v138, a10
    v_accvgpr_read_b32 v139, a11
    buffer_load_dwordx4 a[156:159], v17, s[12:15], s51 offen offset:3072
    s_add_u32 s51, s51, 28672
    ds_write_b128 v8, a[44:47] offset:3072
    ds_write_b128 v9, v[18:21] offset:3072
    v_accvgpr_read_b32 v140, a12
    v_accvgpr_read_b32 v141, a13
    v_accvgpr_read_b32 v142, a14
    buffer_load_dwordx4 a[160:163], v17, s[12:15], s51 offen offset:0
    v_accvgpr_read_b32 v143, a15
    ds_write_b128 v8, a[48:51] offset:4096
    v_accvgpr_read_b32 v144, a16
    v_accvgpr_read_b32 v145, a17
    v_accvgpr_read_b32 v146, a18
    buffer_load_dwordx4 a[164:167], v17, s[12:15], s51 offen offset:1024
    s_add_u32 s51, s51, 4096
    v_accvgpr_read_b32 v147, a19
    ds_write_b128 v8, a[52:55] offset:5120
    v_accvgpr_read_b32 v148, a20
    v_accvgpr_read_b32 v149, a21
    v_accvgpr_read_b32 v150, a22
    buffer_load_dwordx4 a[168:171], v17, s[12:15], s51 offen offset:0
    v_accvgpr_read_b32 v151, a23
    ds_write_b128 v8, a[56:59] offset:6144
    v_accvgpr_read_b32 v152, a24
    v_accvgpr_read_b32 v153, a25
    v_accvgpr_read_b32 v154, a26
    buffer_load_dwordx4 a[172:175], v17, s[12:15], s51 offen offset:1024
    s_add_u32 s51, s51, 28672
    v_accvgpr_read_b32 v155, a27
    ds_write_b128 v8, a[60:63] offset:7168
    v_accvgpr_read_b32 v156, a28
    v_accvgpr_read_b32 v157, a29
    v_accvgpr_read_b32 v158, a30
    buffer_load_dwordx4 a[176:179], v17, s[12:15], s51 offen offset:0
    v_accvgpr_read_b32 v159, a31
    ds_write_b128 v8, a[96:99] offset:8192
    v_accvgpr_read_b32 v160, a64
    v_accvgpr_read_b32 v161, a65
    v_accvgpr_read_b32 v162, a66
    buffer_load_dwordx4 a[180:183], v17, s[12:15], s51 offen offset:1024
    s_add_u32 s51, s51, 4096
    v_accvgpr_read_b32 v163, a67
    ds_write_b128 v8, a[100:103] offset:9216
    v_accvgpr_read_b32 v164, a68
    v_accvgpr_read_b32 v165, a69
    v_accvgpr_read_b32 v166, a70
    buffer_load_dwordx4 a[184:187], v17, s[12:15], s51 offen offset:0
    v_accvgpr_read_b32 v167, a71
    ds_write_b128 v8, a[104:107] offset:10240
    v_accvgpr_read_b32 v168, a72
    v_accvgpr_read_b32 v169, a73
    v_accvgpr_read_b32 v170, a74
    buffer_load_dwordx4 a[188:191], v17, s[12:15], s51 offen offset:1024
    s_sub_u32 s51, s51, 102400
    v_accvgpr_read_b32 v171, a75
    ds_write_b128 v8, a[108:111] offset:11264
    v_accvgpr_read_b32 v172, a76
    v_accvgpr_read_b32 v173, a77
    v_accvgpr_read_b32 v174, a78
    buffer_load_dwordx4 a[192:195], v17, s[12:15], s51 offen offset:0
    v_accvgpr_read_b32 v175, a79
    ds_write_b128 v8, a[112:115] offset:12288
    v_accvgpr_read_b32 v176, a80
    v_accvgpr_read_b32 v177, a81
    v_accvgpr_read_b32 v178, a82
    buffer_load_dwordx4 a[196:199], v17, s[12:15], s51 offen offset:1024
    s_add_u32 s51, s51, 4096
    v_accvgpr_read_b32 v179, a83
    ds_write_b128 v8, a[116:119] offset:13312
    v_accvgpr_read_b32 v180, a84
    v_accvgpr_read_b32 v181, a85
    v_accvgpr_read_b32 v182, a86
    buffer_load_dwordx4 a[200:203], v17, s[12:15], s51 offen offset:0
    v_accvgpr_read_b32 v183, a87
    ds_write_b128 v8, a[120:123] offset:14336
    v_accvgpr_read_b32 v184, a88
    v_accvgpr_read_b32 v185, a89
    v_accvgpr_read_b32 v186, a90
    buffer_load_dwordx4 a[204:207], v17, s[12:15], s51 offen offset:1024
    s_add_u32 s51, s51, 28672
    v_accvgpr_read_b32 v187, a91
    ds_write_b128 v8, a[124:127] offset:15360
    v_accvgpr_read_b32 v188, a92
    v_accvgpr_read_b32 v189, a93
    v_accvgpr_read_b32 v190, a94
    v_accvgpr_read_b32 v191, a95
    s_waitcnt lgkmcnt(0)
    s_barrier
    ds_read_b128 v[24:27], v11 offset:3072
    ds_read_b128 v[64:67], v10 offset:0
    ds_read_b128 v[68:71], v10 offset:1024
    ds_read_b128 v[72:75], v10 offset:2048
    ds_read_b128 v[76:79], v10 offset:3072
    ds_read_b128 v[80:83], v10 offset:4096
    ds_read_b128 v[84:87], v10 offset:5120
    ds_read_b128 v[88:91], v10 offset:6144
    ds_read_b128 v[92:95], v10 offset:7168
    buffer_load_dword v57, v56, s[12:15], s35 offen sc1
    s_lshr_b32 s45, s44, 7
    s_lshl_b32 s45, s45, 20
    s_lshl_b32 s50, s40, 15
    s_add_u32 s45, s45, s50
    s_bfe_u32 s50, s44, 0x10006
    s_lshl_b32 s50, s50, 14
    s_add_u32 s45, s45, s50
    v_add_u32 v44, s45, v17
    v_add_u32 v45, 4096, v44
    v_add_u32 v46, 8192, v44
    v_add_u32 v47, 8192, v45
    buffer_load_dwordx4 a[208:211], v17, s[12:15], s51 offen offset:0
    buffer_load_dwordx4 a[212:215], v17, s[12:15], s51 offen offset:1024
    s_add_u32 s51, s51, 4096
    s_waitcnt lgkmcnt(8)
    ds_read_b128 v[96:99], v10 offset:8192
    ds_read_b128 v[100:103], v10 offset:9216
    ds_read_b128 v[104:107], v10 offset:10240
    ds_read_b128 v[108:111], v10 offset:11264
    ds_read_b128 v[112:115], v10 offset:12288
    ds_read_b128 v[116:119], v10 offset:13312
    ds_read_b128 v[120:123], v10 offset:14336
    ds_read_b128 v[124:127], v10 offset:15360
    buffer_load_dwordx4 a[216:219], v17, s[12:15], s51 offen offset:0
    v_max_f32 v22, v18, v24
    v_sub_f32 v18, v18, v22
    v_sub_f32 v24, v24, v22
    v_exp_f32 v18, v18
    buffer_load_dwordx4 a[220:223], v17, s[12:15], s51 offen offset:1024
    s_add_u32 s51, s51, 28672
    v_exp_f32 v24, v24
    v_mul_f32 v19, v19, v18
    v_fma_f32 v19, v25, v24, v19
    buffer_load_dwordx4 a[224:227], v17, s[12:15], s51 offen offset:2048
    v_rcp_f32 v19, v19
    s_nop 0
    v_mul_f32 v18, v18, v19
    v_mul_f32 v24, v24, v19
    buffer_load_dwordx4 a[228:231], v17, s[12:15], s51 offen offset:3072
    s_add_u32 s51, s51, 4096
    v_max_f32 v23, v20, v26
    v_sub_f32 v20, v20, v23
    v_sub_f32 v26, v26, v23
    v_exp_f32 v20, v20
    buffer_load_dwordx4 a[232:235], v17, s[12:15], s51 offen offset:2048
    v_exp_f32 v26, v26
    v_mul_f32 v21, v21, v20
    v_fma_f32 v21, v27, v26, v21
    buffer_load_dwordx4 a[236:239], v17, s[12:15], s51 offen offset:3072
    s_add_u32 s51, s51, 28672
    v_rcp_f32 v21, v21
    s_nop 0
    v_mul_f32 v20, v20, v21
    v_mul_f32 v26, v26, v21
    buffer_load_dwordx4 a[240:243], v17, s[12:15], s51 offen offset:2048
    v_pk_mul_f32 v[128:129], v[128:129], v[18:19] op_sel_hi:[1,0]
    v_pk_mul_f32 v[130:131], v[130:131], v[18:19] op_sel_hi:[1,0]
    v_pk_mul_f32 v[132:133], v[132:133], v[18:19] op_sel_hi:[1,0]
    v_pk_mul_f32 v[134:135], v[134:135], v[18:19] op_sel_hi:[1,0]
    v_pk_mul_f32 v[136:137], v[136:137], v[18:19] op_sel_hi:[1,0]
    v_pk_mul_f32 v[138:139], v[138:139], v[18:19] op_sel_hi:[1,0]
    buffer_load_dwordx4 a[244:247], v17, s[12:15], s51 offen offset:3072
    s_add_u32 s51, s51, 4096
    v_pk_mul_f32 v[140:141], v[140:141], v[18:19] op_sel_hi:[1,0]
    v_pk_mul_f32 v[142:143], v[142:143], v[18:19] op_sel_hi:[1,0]
    v_pk_mul_f32 v[144:145], v[144:145], v[18:19] op_sel_hi:[1,0]
    v_pk_mul_f32 v[146:147], v[146:147], v[18:19] op_sel_hi:[1,0]
    v_pk_mul_f32 v[148:149], v[148:149], v[18:19] op_sel_hi:[1,0]
    v_pk_mul_f32 v[150:151], v[150:151], v[18:19] op_sel_hi:[1,0]
    buffer_load_dwordx4 a[248:251], v17, s[12:15], s51 offen offset:2048
    v_pk_mul_f32 v[152:153], v[152:153], v[18:19] op_sel_hi:[1,0]
    v_pk_mul_f32 v[154:155], v[154:155], v[18:19] op_sel_hi:[1,0]
    v_pk_mul_f32 v[156:157], v[156:157], v[18:19] op_sel_hi:[1,0]
    v_pk_mul_f32 v[158:159], v[158:159], v[18:19] op_sel_hi:[1,0]
    v_pk_mul_f32 v[160:161], v[160:161], v[20:21] op_sel_hi:[1,0]
    v_pk_mul_f32 v[162:163], v[162:163], v[20:21] op_sel_hi:[1,0]
    v_pk_mul_f32 v[164:165], v[164:165], v[20:21] op_sel_hi:[1,0]
    buffer_load_dwordx4 a[252:255], v17, s[12:15], s51 offen offset:3072
    v_pk_mul_f32 v[166:167], v[166:167], v[20:21] op_sel_hi:[1,0]
    v_pk_mul_f32 v[168:169], v[168:169], v[20:21] op_sel_hi:[1,0]
    v_pk_mul_f32 v[170:171], v[170:171], v[20:21] op_sel_hi:[1,0]
    v_pk_mul_f32 v[172:173], v[172:173], v[20:21] op_sel_hi:[1,0]
    v_pk_mul_f32 v[174:175], v[174:175], v[20:21] op_sel_hi:[1,0]
    v_pk_mul_f32 v[176:177], v[176:177], v[20:21] op_sel_hi:[1,0]
    v_pk_mul_f32 v[178:179], v[178:179], v[20:21] op_sel_hi:[1,0]
    v_pk_mul_f32 v[180:181], v[180:181], v[20:21] op_sel_hi:[1,0]
    v_pk_mul_f32 v[182:183], v[182:183], v[20:21] op_sel_hi:[1,0]
    v_pk_mul_f32 v[184:185], v[184:185], v[20:21] op_sel_hi:[1,0]
    v_pk_mul_f32 v[186:187], v[186:187], v[20:21] op_sel_hi:[1,0]
    v_pk_mul_f32 v[188:189], v[188:189], v[20:21] op_sel_hi:[1,0]
    v_pk_mul_f32 v[190:191], v[190:191], v[20:21] op_sel_hi:[1,0]
    s_waitcnt lgkmcnt(8)
    v_pk_fma_f32 v[128:129], v[64:65], v[24:25], v[128:129] op_sel_hi:[1,0,1]
    v_pk_fma_f32 v[130:131], v[66:67], v[24:25], v[130:131] op_sel_hi:[1,0,1]
    v_pk_fma_f32 v[132:133], v[68:69], v[24:25], v[132:133] op_sel_hi:[1,0,1]
    v_pk_fma_f32 v[134:135], v[70:71], v[24:25], v[134:135] op_sel_hi:[1,0,1]
    v_pk_fma_f32 v[136:137], v[72:73], v[24:25], v[136:137] op_sel_hi:[1,0,1]
    v_pk_fma_f32 v[138:139], v[74:75], v[24:25], v[138:139] op_sel_hi:[1,0,1]
    v_pk_fma_f32 v[140:141], v[76:77], v[24:25], v[140:141] op_sel_hi:[1,0,1]
    v_pk_fma_f32 v[142:143], v[78:79], v[24:25], v[142:143] op_sel_hi:[1,0,1]
    v_cvt_pk_bf16_f32 v192, v128, v129
    v_cvt_pk_bf16_f32 v193, v130, v131
    v_cvt_pk_bf16_f32 v194, v132, v133
    v_cvt_pk_bf16_f32 v195, v134, v135
    buffer_store_dwordx4 v[192:195], v44, s[28:31], 0 offen offset:0
    v_cvt_pk_bf16_f32 v196, v136, v137
    v_cvt_pk_bf16_f32 v197, v138, v139
    v_cvt_pk_bf16_f32 v198, v140, v141
    v_cvt_pk_bf16_f32 v199, v142, v143
    buffer_store_dwordx4 v[196:199], v44, s[28:31], 0 offen offset:1024
    v_pk_fma_f32 v[144:145], v[80:81], v[24:25], v[144:145] op_sel_hi:[1,0,1]
    v_pk_fma_f32 v[146:147], v[82:83], v[24:25], v[146:147] op_sel_hi:[1,0,1]
    v_pk_fma_f32 v[148:149], v[84:85], v[24:25], v[148:149] op_sel_hi:[1,0,1]
    v_pk_fma_f32 v[150:151], v[86:87], v[24:25], v[150:151] op_sel_hi:[1,0,1]
    v_pk_fma_f32 v[152:153], v[88:89], v[24:25], v[152:153] op_sel_hi:[1,0,1]
    v_pk_fma_f32 v[154:155], v[90:91], v[24:25], v[154:155] op_sel_hi:[1,0,1]
    v_pk_fma_f32 v[156:157], v[92:93], v[24:25], v[156:157] op_sel_hi:[1,0,1]
    v_pk_fma_f32 v[158:159], v[94:95], v[24:25], v[158:159] op_sel_hi:[1,0,1]
    v_cvt_pk_bf16_f32 v200, v144, v145
    v_cvt_pk_bf16_f32 v201, v146, v147
    v_cvt_pk_bf16_f32 v202, v148, v149
    v_cvt_pk_bf16_f32 v203, v150, v151
    buffer_store_dwordx4 v[200:203], v44, s[28:31], 0 offen offset:2048
    v_cvt_pk_bf16_f32 v204, v152, v153
    v_cvt_pk_bf16_f32 v205, v154, v155
    v_cvt_pk_bf16_f32 v206, v156, v157
    v_cvt_pk_bf16_f32 v207, v158, v159
    buffer_store_dwordx4 v[204:207], v44, s[28:31], 0 offen offset:3072
    s_waitcnt lgkmcnt(0)
    v_pk_fma_f32 v[160:161], v[96:97], v[26:27], v[160:161] op_sel_hi:[1,0,1]
    v_pk_fma_f32 v[162:163], v[98:99], v[26:27], v[162:163] op_sel_hi:[1,0,1]
    v_pk_fma_f32 v[164:165], v[100:101], v[26:27], v[164:165] op_sel_hi:[1,0,1]
    v_pk_fma_f32 v[166:167], v[102:103], v[26:27], v[166:167] op_sel_hi:[1,0,1]
    v_pk_fma_f32 v[168:169], v[104:105], v[26:27], v[168:169] op_sel_hi:[1,0,1]
    v_pk_fma_f32 v[170:171], v[106:107], v[26:27], v[170:171] op_sel_hi:[1,0,1]
    v_pk_fma_f32 v[172:173], v[108:109], v[26:27], v[172:173] op_sel_hi:[1,0,1]
    v_pk_fma_f32 v[174:175], v[110:111], v[26:27], v[174:175] op_sel_hi:[1,0,1]
    v_cvt_pk_bf16_f32 v208, v160, v161
    v_cvt_pk_bf16_f32 v209, v162, v163
    v_cvt_pk_bf16_f32 v210, v164, v165
    v_cvt_pk_bf16_f32 v211, v166, v167
    buffer_store_dwordx4 v[208:211], v46, s[28:31], 0 offen offset:0
    v_cvt_pk_bf16_f32 v212, v168, v169
    v_cvt_pk_bf16_f32 v213, v170, v171
    v_cvt_pk_bf16_f32 v214, v172, v173
    v_cvt_pk_bf16_f32 v215, v174, v175
    buffer_store_dwordx4 v[212:215], v46, s[28:31], 0 offen offset:1024
    v_pk_fma_f32 v[176:177], v[112:113], v[26:27], v[176:177] op_sel_hi:[1,0,1]
    v_pk_fma_f32 v[178:179], v[114:115], v[26:27], v[178:179] op_sel_hi:[1,0,1]
    v_pk_fma_f32 v[180:181], v[116:117], v[26:27], v[180:181] op_sel_hi:[1,0,1]
    v_pk_fma_f32 v[182:183], v[118:119], v[26:27], v[182:183] op_sel_hi:[1,0,1]
    v_pk_fma_f32 v[184:185], v[120:121], v[26:27], v[184:185] op_sel_hi:[1,0,1]
    v_pk_fma_f32 v[186:187], v[122:123], v[26:27], v[186:187] op_sel_hi:[1,0,1]
    v_pk_fma_f32 v[188:189], v[124:125], v[26:27], v[188:189] op_sel_hi:[1,0,1]
    v_pk_fma_f32 v[190:191], v[126:127], v[26:27], v[190:191] op_sel_hi:[1,0,1]
    v_cvt_pk_bf16_f32 v216, v176, v177
    v_cvt_pk_bf16_f32 v217, v178, v179
    v_cvt_pk_bf16_f32 v218, v180, v181
    v_cvt_pk_bf16_f32 v219, v182, v183
    buffer_store_dwordx4 v[216:219], v46, s[28:31], 0 offen offset:2048
    v_cvt_pk_bf16_f32 v220, v184, v185
    v_cvt_pk_bf16_f32 v221, v186, v187
    v_cvt_pk_bf16_f32 v222, v188, v189
    v_cvt_pk_bf16_f32 v223, v190, v191
    buffer_store_dwordx4 v[220:223], v46, s[28:31], 0 offen offset:3072
    s_branch AT_END2
AT_MG1:
    s_cmp_eq_u32 s8, 0
    s_cbranch_scc1 TL_LF_9
    v_mov_b32 v58, 1
    s_mov_b64 exec, 1
    buffer_store_dword v58, off, s[12:15], s78
    s_mov_b64 exec, -1
TL_LF_9_R:
    buffer_load_dwordx4 a[144:147], v17, s[12:15], s51 offen offset:2048
    ds_write_b128 v8, a[0:3] offset:0
    v_accvgpr_read_b32 v128, a32
    v_accvgpr_read_b32 v129, a33
    v_accvgpr_read_b32 v130, a34
    v_accvgpr_read_b32 v131, a35
    buffer_load_dwordx4 a[148:151], v17, s[12:15], s51 offen offset:3072
    s_add_u32 s51, s51, 4096
    ds_write_b128 v8, a[4:7] offset:1024
    v_accvgpr_read_b32 v132, a36
    v_accvgpr_read_b32 v133, a37
    v_accvgpr_read_b32 v134, a38
    v_accvgpr_read_b32 v135, a39
    buffer_load_dwordx4 a[152:155], v17, s[12:15], s51 offen offset:2048
    ds_write_b128 v8, a[8:11] offset:2048
    v_accvgpr_read_b32 v136, a40
    v_accvgpr_read_b32 v137, a41
    v_accvgpr_read_b32 v138, a42
    v_accvgpr_read_b32 v139, a43
    buffer_load_dwordx4 a[156:159], v17, s[12:15], s51 offen offset:3072
    s_add_u32 s51, s51, 28672
    ds_write_b128 v8, a[12:15] offset:3072
    ds_write_b128 v9, v[18:21] offset:3072
    v_accvgpr_read_b32 v140, a44
    v_accvgpr_read_b32 v141, a45
    v_accvgpr_read_b32 v142, a46
    buffer_load_dwordx4 a[160:163], v17, s[12:15], s51 offen offset:0
    v_accvgpr_read_b32 v143, a47
    ds_write_b128 v8, a[16:19] offset:4096
    v_accvgpr_read_b32 v144, a48
    v_accvgpr_read_b32 v145, a49
    v_accvgpr_read_b32 v146, a50
    buffer_load_dwordx4 a[164:167], v17, s[12:15], s51 offen offset:1024
    s_add_u32 s51, s51, 4096
    v_accvgpr_read_b32 v147, a51
    ds_write_b128 v8, a[20:23] offset:5120
    v_accvgpr_read_b32 v148, a52
    v_accvgpr_read_b32 v149, a53
    v_accvgpr_read_b32 v150, a54
    buffer_load_dwordx4 a[168:171], v17, s[12:15], s51 offen offset:0
    v_accvgpr_read_b32 v151, a55
    ds_write_b128 v8, a[24:27] offset:6144
    v_accvgpr_read_b32 v152, a56
    v_accvgpr_read_b32 v153, a57
    v_accvgpr_read_b32 v154, a58
    buffer_load_dwordx4 a[172:175], v17, s[12:15], s51 offen offset:1024
    s_add_u32 s51, s51, 28672
    v_accvgpr_read_b32 v155, a59
    ds_write_b128 v8, a[28:31] offset:7168
    v_accvgpr_read_b32 v156, a60
    v_accvgpr_read_b32 v157, a61
    v_accvgpr_read_b32 v158, a62
    buffer_load_dwordx4 a[176:179], v17, s[12:15], s51 offen offset:0
    v_accvgpr_read_b32 v159, a63
    ds_write_b128 v8, a[64:67] offset:8192
    v_accvgpr_read_b32 v160, a96
    v_accvgpr_read_b32 v161, a97
    v_accvgpr_read_b32 v162, a98
    buffer_load_dwordx4 a[180:183], v17, s[12:15], s51 offen offset:1024
    s_add_u32 s51, s51, 4096
    v_accvgpr_read_b32 v163, a99
    ds_write_b128 v8, a[68:71] offset:9216
    v_accvgpr_read_b32 v164, a100
    v_accvgpr_read_b32 v165, a101
    v_accvgpr_read_b32 v166, a102
    buffer_load_dwordx4 a[184:187], v17, s[12:15], s51 offen offset:0
    v_accvgpr_read_b32 v167, a103
    ds_write_b128 v8, a[72:75] offset:10240
    v_accvgpr_read_b32 v168, a104
    v_accvgpr_read_b32 v169, a105
    v_accvgpr_read_b32 v170, a106
    buffer_load_dwordx4 a[188:191], v17, s[12:15], s51 offen offset:1024
    s_sub_u32 s51, s51, 102400
    v_accvgpr_read_b32 v171, a107
    ds_write_b128 v8, a[76:79] offset:11264
    v_accvgpr_read_b32 v172, a108
    v_accvgpr_read_b32 v173, a109
    v_accvgpr_read_b32 v174, a110
    buffer_load_dwordx4 a[192:195], v17, s[12:15], s51 offen offset:0
    v_accvgpr_read_b32 v175, a111
    ds_write_b128 v8, a[80:83] offset:12288
    v_accvgpr_read_b32 v176, a112
    v_accvgpr_read_b32 v177, a113
    v_accvgpr_read_b32 v178, a114
    buffer_load_dwordx4 a[196:199], v17, s[12:15], s51 offen offset:1024
    s_add_u32 s51, s51, 4096
    v_accvgpr_read_b32 v179, a115
    ds_write_b128 v8, a[84:87] offset:13312
    v_accvgpr_read_b32 v180, a116
    v_accvgpr_read_b32 v181, a117
    v_accvgpr_read_b32 v182, a118
    buffer_load_dwordx4 a[200:203], v17, s[12:15], s51 offen offset:0
    v_accvgpr_read_b32 v183, a119
    ds_write_b128 v8, a[88:91] offset:14336
    v_accvgpr_read_b32 v184, a120
    v_accvgpr_read_b32 v185, a121
    v_accvgpr_read_b32 v186, a122
    buffer_load_dwordx4 a[204:207], v17, s[12:15], s51 offen offset:1024
    s_add_u32 s51, s51, 28672
    v_accvgpr_read_b32 v187, a123
    ds_write_b128 v8, a[92:95] offset:15360
    v_accvgpr_read_b32 v188, a124
    v_accvgpr_read_b32 v189, a125
    v_accvgpr_read_b32 v190, a126
    v_accvgpr_read_b32 v191, a127
    s_waitcnt lgkmcnt(0)
    s_barrier
    ds_read_b128 v[24:27], v11 offset:3072
    ds_read_b128 v[64:67], v10 offset:0
    ds_read_b128 v[68:71], v10 offset:1024
    ds_read_b128 v[72:75], v10 offset:2048
    ds_read_b128 v[76:79], v10 offset:3072
    ds_read_b128 v[80:83], v10 offset:4096
    ds_read_b128 v[84:87], v10 offset:5120
    ds_read_b128 v[88:91], v10 offset:6144
    ds_read_b128 v[92:95], v10 offset:7168
    buffer_load_dword v57, v56, s[12:15], s35 offen sc1
    s_lshr_b32 s45, s44, 7
    s_lshl_b32 s45, s45, 20
    s_lshl_b32 s50, s40, 15
    s_add_u32 s45, s45, s50
    s_bfe_u32 s50, s44, 0x10006
    s_lshl_b32 s50, s50, 14
    s_add_u32 s45, s45, s50
    v_add_u32 v44, s45, v17
    v_add_u32 v45, 4096, v44
    v_add_u32 v46, 8192, v44
    v_add_u32 v47, 8192, v45
    buffer_load_dwordx4 a[208:211], v17, s[12:15], s51 offen offset:0
    buffer_load_dwordx4 a[212:215], v17, s[12:15], s51 offen offset:1024
    s_add_u32 s51, s51, 4096
    s_waitcnt lgkmcnt(8)
    ds_read_b128 v[96:99], v10 offset:8192
    ds_read_b128 v[100:103], v10 offset:9216
    ds_read_b128 v[104:107], v10 offset:10240
    ds_read_b128 v[108:111], v10 offset:11264
    ds_read_b128 v[112:115], v10 offset:12288
    ds_read_b128 v[116:119], v10 offset:13312
    ds_read_b128 v[120:123], v10 offset:14336
    ds_read_b128 v[124:127], v10 offset:15360
    buffer_load_dwordx4 a[216:219], v17, s[12:15], s51 offen offset:0
    v_max_f32 v22, v18, v24
    v_sub_f32 v18, v18, v22
    v_sub_f32 v24, v24, v22
    v_exp_f32 v18, v18
    buffer_load_dwordx4 a[220:223], v17, s[12:15], s51 offen offset:1024
    s_add_u32 s51, s51, 28672
    v_exp_f32 v24, v24
    v_mul_f32 v19, v19, v18
    v_fma_f32 v19, v25, v24, v19
    buffer_load_dwordx4 a[224:227], v17, s[12:15], s51 offen offset:2048
    v_rcp_f32 v19, v19
    s_nop 0
    v_mul_f32 v18, v18, v19
    v_mul_f32 v24, v24, v19
    buffer_load_dwordx4 a[228:231], v17, s[12:15], s51 offen offset:3072
    s_add_u32 s51, s51, 4096
    v_max_f32 v23, v20, v26
    v_sub_f32 v20, v20, v23
    v_sub_f32 v26, v26, v23
    v_exp_f32 v20, v20
    buffer_load_dwordx4 a[232:235], v17, s[12:15], s51 offen offset:2048
    v_exp_f32 v26, v26
    v_mul_f32 v21, v21, v20
    v_fma_f32 v21, v27, v26, v21
    buffer_load_dwordx4 a[236:239], v17, s[12:15], s51 offen offset:3072
    s_add_u32 s51, s51, 28672
    v_rcp_f32 v21, v21
    s_nop 0
    v_mul_f32 v20, v20, v21
    v_mul_f32 v26, v26, v21
    buffer_load_dwordx4 a[240:243], v17, s[12:15], s51 offen offset:2048
    v_pk_mul_f32 v[128:129], v[128:129], v[18:19] op_sel_hi:[1,0]
    v_pk_mul_f32 v[130:131], v[130:131], v[18:19] op_sel_hi:[1,0]
    v_pk_mul_f32 v[132:133], v[132:133], v[18:19] op_sel_hi:[1,0]
    v_pk_mul_f32 v[134:135], v[134:135], v[18:19] op_sel_hi:[1,0]
    v_pk_mul_f32 v[136:137], v[136:137], v[18:19] op_sel_hi:[1,0]
    v_pk_mul_f32 v[138:139], v[138:139], v[18:19] op_sel_hi:[1,0]
    buffer_load_dwordx4 a[244:247], v17, s[12:15], s51 offen offset:3072
    s_add_u32 s51, s51, 4096
    v_pk_mul_f32 v[140:141], v[140:141], v[18:19] op_sel_hi:[1,0]
    v_pk_mul_f32 v[142:143], v[142:143], v[18:19] op_sel_hi:[1,0]
    v_pk_mul_f32 v[144:145], v[144:145], v[18:19] op_sel_hi:[1,0]
    v_pk_mul_f32 v[146:147], v[146:147], v[18:19] op_sel_hi:[1,0]
    v_pk_mul_f32 v[148:149], v[148:149], v[18:19] op_sel_hi:[1,0]
    v_pk_mul_f32 v[150:151], v[150:151], v[18:19] op_sel_hi:[1,0]
    buffer_load_dwordx4 a[248:251], v17, s[12:15], s51 offen offset:2048
    v_pk_mul_f32 v[152:153], v[152:153], v[18:19] op_sel_hi:[1,0]
    v_pk_mul_f32 v[154:155], v[154:155], v[18:19] op_sel_hi:[1,0]
    v_pk_mul_f32 v[156:157], v[156:157], v[18:19] op_sel_hi:[1,0]
    v_pk_mul_f32 v[158:159], v[158:159], v[18:19] op_sel_hi:[1,0]
    v_pk_mul_f32 v[160:161], v[160:161], v[20:21] op_sel_hi:[1,0]
    v_pk_mul_f32 v[162:163], v[162:163], v[20:21] op_sel_hi:[1,0]
    v_pk_mul_f32 v[164:165], v[164:165], v[20:21] op_sel_hi:[1,0]
    buffer_load_dwordx4 a[252:255], v17, s[12:15], s51 offen offset:3072
    v_pk_mul_f32 v[166:167], v[166:167], v[20:21] op_sel_hi:[1,0]
    v_pk_mul_f32 v[168:169], v[168:169], v[20:21] op_sel_hi:[1,0]
    v_pk_mul_f32 v[170:171], v[170:171], v[20:21] op_sel_hi:[1,0]
    v_pk_mul_f32 v[172:173], v[172:173], v[20:21] op_sel_hi:[1,0]
    v_pk_mul_f32 v[174:175], v[174:175], v[20:21] op_sel_hi:[1,0]
    v_pk_mul_f32 v[176:177], v[176:177], v[20:21] op_sel_hi:[1,0]
    v_pk_mul_f32 v[178:179], v[178:179], v[20:21] op_sel_hi:[1,0]
    v_pk_mul_f32 v[180:181], v[180:181], v[20:21] op_sel_hi:[1,0]
    v_pk_mul_f32 v[182:183], v[182:183], v[20:21] op_sel_hi:[1,0]
    v_pk_mul_f32 v[184:185], v[184:185], v[20:21] op_sel_hi:[1,0]
    v_pk_mul_f32 v[186:187], v[186:187], v[20:21] op_sel_hi:[1,0]
    v_pk_mul_f32 v[188:189], v[188:189], v[20:21] op_sel_hi:[1,0]
    v_pk_mul_f32 v[190:191], v[190:191], v[20:21] op_sel_hi:[1,0]
    s_waitcnt lgkmcnt(8)
    v_pk_fma_f32 v[128:129], v[64:65], v[24:25], v[128:129] op_sel_hi:[1,0,1]
    v_pk_fma_f32 v[130:131], v[66:67], v[24:25], v[130:131] op_sel_hi:[1,0,1]
    v_pk_fma_f32 v[132:133], v[68:69], v[24:25], v[132:133] op_sel_hi:[1,0,1]
    v_pk_fma_f32 v[134:135], v[70:71], v[24:25], v[134:135] op_sel_hi:[1,0,1]
    v_pk_fma_f32 v[136:137], v[72:73], v[24:25], v[136:137] op_sel_hi:[1,0,1]
    v_pk_fma_f32 v[138:139], v[74:75], v[24:25], v[138:139] op_sel_hi:[1,0,1]
    v_pk_fma_f32 v[140:141], v[76:77], v[24:25], v[140:141] op_sel_hi:[1,0,1]
    v_pk_fma_f32 v[142:143], v[78:79], v[24:25], v[142:143] op_sel_hi:[1,0,1]
    v_cvt_pk_bf16_f32 v192, v128, v129
    v_cvt_pk_bf16_f32 v193, v130, v131
    v_cvt_pk_bf16_f32 v194, v132, v133
    v_cvt_pk_bf16_f32 v195, v134, v135
    buffer_store_dwordx4 v[192:195], v45, s[28:31], 0 offen offset:0
    v_cvt_pk_bf16_f32 v196, v136, v137
    v_cvt_pk_bf16_f32 v197, v138, v139
    v_cvt_pk_bf16_f32 v198, v140, v141
    v_cvt_pk_bf16_f32 v199, v142, v143
    buffer_store_dwordx4 v[196:199], v45, s[28:31], 0 offen offset:1024
    v_pk_fma_f32 v[144:145], v[80:81], v[24:25], v[144:145] op_sel_hi:[1,0,1]
    v_pk_fma_f32 v[146:147], v[82:83], v[24:25], v[146:147] op_sel_hi:[1,0,1]
    v_pk_fma_f32 v[148:149], v[84:85], v[24:25], v[148:149] op_sel_hi:[1,0,1]
    v_pk_fma_f32 v[150:151], v[86:87], v[24:25], v[150:151] op_sel_hi:[1,0,1]
    v_pk_fma_f32 v[152:153], v[88:89], v[24:25], v[152:153] op_sel_hi:[1,0,1]
    v_pk_fma_f32 v[154:155], v[90:91], v[24:25], v[154:155] op_sel_hi:[1,0,1]
    v_pk_fma_f32 v[156:157], v[92:93], v[24:25], v[156:157] op_sel_hi:[1,0,1]
    v_pk_fma_f32 v[158:159], v[94:95], v[24:25], v[158:159] op_sel_hi:[1,0,1]
    v_cvt_pk_bf16_f32 v200, v144, v145
    v_cvt_pk_bf16_f32 v201, v146, v147
    v_cvt_pk_bf16_f32 v202, v148, v149
    v_cvt_pk_bf16_f32 v203, v150, v151
    buffer_store_dwordx4 v[200:203], v45, s[28:31], 0 offen offset:2048
    v_cvt_pk_bf16_f32 v204, v152, v153
    v_cvt_pk_bf16_f32 v205, v154, v155
    v_cvt_pk_bf16_f32 v206, v156, v157
    v_cvt_pk_bf16_f32 v207, v158, v159
    buffer_store_dwordx4 v[204:207], v45, s[28:31], 0 offen offset:3072
    s_waitcnt lgkmcnt(0)
    v_pk_fma_f32 v[160:161], v[96:97], v[26:27], v[160:161] op_sel_hi:[1,0,1]
    v_pk_fma_f32 v[162:163], v[98:99], v[26:27], v[162:163] op_sel_hi:[1,0,1]
    v_pk_fma_f32 v[164:165], v[100:101], v[26:27], v[164:165] op_sel_hi:[1,0,1]
    v_pk_fma_f32 v[166:167], v[102:103], v[26:27], v[166:167] op_sel_hi:[1,0,1]
    v_pk_fma_f32 v[168:169], v[104:105], v[26:27], v[168:169] op_sel_hi:[1,0,1]
    v_pk_fma_f32 v[170:171], v[106:107], v[26:27], v[170:171] op_sel_hi:[1,0,1]
    v_pk_fma_f32 v[172:173], v[108:109], v[26:27], v[172:173] op_sel_hi:[1,0,1]
    v_pk_fma_f32 v[174:175], v[110:111], v[26:27], v[174:175] op_sel_hi:[1,0,1]
    v_cvt_pk_bf16_f32 v208, v160, v161
    v_cvt_pk_bf16_f32 v209, v162, v163
    v_cvt_pk_bf16_f32 v210, v164, v165
    v_cvt_pk_bf16_f32 v211, v166, v167
    buffer_store_dwordx4 v[208:211], v47, s[28:31], 0 offen offset:0
    v_cvt_pk_bf16_f32 v212, v168, v169
    v_cvt_pk_bf16_f32 v213, v170, v171
    v_cvt_pk_bf16_f32 v214, v172, v173
    v_cvt_pk_bf16_f32 v215, v174, v175
    buffer_store_dwordx4 v[212:215], v47, s[28:31], 0 offen offset:1024
    v_pk_fma_f32 v[176:177], v[112:113], v[26:27], v[176:177] op_sel_hi:[1,0,1]
    v_pk_fma_f32 v[178:179], v[114:115], v[26:27], v[178:179] op_sel_hi:[1,0,1]
    v_pk_fma_f32 v[180:181], v[116:117], v[26:27], v[180:181] op_sel_hi:[1,0,1]
    v_pk_fma_f32 v[182:183], v[118:119], v[26:27], v[182:183] op_sel_hi:[1,0,1]
    v_pk_fma_f32 v[184:185], v[120:121], v[26:27], v[184:185] op_sel_hi:[1,0,1]
    v_pk_fma_f32 v[186:187], v[122:123], v[26:27], v[186:187] op_sel_hi:[1,0,1]
    v_pk_fma_f32 v[188:189], v[124:125], v[26:27], v[188:189] op_sel_hi:[1,0,1]
    v_pk_fma_f32 v[190:191], v[126:127], v[26:27], v[190:191] op_sel_hi:[1,0,1]
    v_cvt_pk_bf16_f32 v216, v176, v177
    v_cvt_pk_bf16_f32 v217, v178, v179
    v_cvt_pk_bf16_f32 v218, v180, v181
    v_cvt_pk_bf16_f32 v219, v182, v183
    buffer_store_dwordx4 v[216:219], v47, s[28:31], 0 offen offset:2048
    v_cvt_pk_bf16_f32 v220, v184, v185
    v_cvt_pk_bf16_f32 v221, v186, v187
    v_cvt_pk_bf16_f32 v222, v188, v189
    v_cvt_pk_bf16_f32 v223, v190, v191
    buffer_store_dwordx4 v[220:223], v47, s[28:31], 0 offen offset:3072
AT_END2:
    s_nop 3
    v_mov_b32 v2, v17
    s_waitcnt vmcnt(46)
    s_barrier
    s_add_u32 m0, s64, s36
    s_mov_b32 s34, 294912
    s_mov_b64 s[24:25], s[68:69]
    buffer_load_dwordx4 v52, s[24:27], s34 offen offset:0 lds
    buffer_load_dwordx4 v52, s[24:27], s34 offen offset:1024 lds
    buffer_load_dwordx4 v52, s[24:27], s34 offen offset:2048 lds
    buffer_load_dwordx4 v52, s[24:27], s34 offen offset:3072 lds
    s_add_u32 m0, m0, 32768
    s_nop 0
    buffer_load_dwordx4 v53, s[24:27], s34 offen offset:0 lds
    buffer_load_dwordx4 v53, s[24:27], s34 offen offset:1024 lds
    buffer_load_dwordx4 v53, s[24:27], s34 offen offset:2048 lds
    buffer_load_dwordx4 v53, s[24:27], s34 offen offset:3072 lds
    s_mov_b32 s65, s62
    s_xor_b32 s62, s62, 0x10000
    s_xor_b32 s63, s64, 0x10000
    s_add_u32 m0, s65, s36
    s_add_u32 s34, s36, 108003328
    buffer_load_dwordx4 v52, s[24:27], 0 offen offset:3072 lds
    s_add_u32 m0, s36, 131072
    s_nop 0
    buffer_load_dwordx4 v2, s[12:15], s34 offen offset:0 lds
    buffer_load_dwordx4 v2, s[12:15], s34 offen offset:1024 lds
    buffer_load_dwordx4 v2, s[12:15], s34 offen offset:2048 lds
    buffer_load_dwordx4 v2, s[12:15], s34 offen offset:3072 lds
    v_bfe_u32 v58, v1, 2, 2
    v_lshrrev_b32 v3, 5, v1
    v_lshlrev_b32 v3, 10, v3
    v_lshl_add_u32 v3, v58, 8, v3
    v_and_b32 v56, 3, v1
    v_lshl_add_u32 v3, v56, 3, v3
    v_bfe_u32 v56, v1, 4, 1
    v_lshl_add_u32 v3, v56, 5, v3
    v_xor_b32 v56, 0, v58
    v_lshl_add_u32 v56, v56, 6, v3
    v_add_u32 v4, s62, v56
    v_add_u32 v8, s63, v56
    v_add_u32 v12, s65, v56
    v_add_u32 v16, s64, v56
    v_xor_b32 v56, 1, v58
    v_lshl_add_u32 v56, v56, 6, v3
    v_add_u32 v5, s62, v56
    v_add_u32 v9, s63, v56
    v_add_u32 v13, s65, v56
    v_add_u32 v17, s64, v56
    v_xor_b32 v56, 2, v58
    v_lshl_add_u32 v56, v56, 6, v3
    v_add_u32 v6, s62, v56
    v_add_u32 v10, s63, v56
    v_add_u32 v14, s65, v56
    v_add_u32 v18, s64, v56
    v_xor_b32 v56, 3, v58
    v_lshl_add_u32 v56, v56, 6, v3
    v_add_u32 v7, s62, v56
    v_add_u32 v11, s63, v56
    v_add_u32 v15, s65, v56
    v_add_u32 v19, s64, v56
    ds_read_b64_tr_b16 v[192:193], v4 offset:0
    ds_read_b64_tr_b16 v[194:195], v4 offset:2048
    ds_read_b64_tr_b16 v[196:197], v5 offset:0
    ds_read_b64_tr_b16 v[198:199], v5 offset:2048
    ds_read_b64_tr_b16 v[200:201], v6 offset:0
    ds_read_b64_tr_b16 v[202:203], v6 offset:2048
    ds_read_b64_tr_b16 v[204:205], v7 offset:0
    ds_read_b64_tr_b16 v[206:207], v7 offset:2048
    s_lshl_b32 s34, s56, 1
    s_add_u32 s34, s34, s3
    s_lshl_b32 s34, s34, 1
    s_lshr_b32 s38, s55, 1
    s_add_u32 s34, s34, s38
    s_lshl_b32 s34, s34, 2
    s_add_u32 s34, s34, s47
    s_lshl_b32 s34, s34, 2
    s_add_u32 s34, s34, s80
    s_add_u32 s99, s34, 16384
    s_waitcnt lgkmcnt(0)
    s_mov_b32 s16, s4
    s_mov_b32 s17, s5
    s_mov_b32 s18, 2097152
    s_mov_b32 s19, 0x00020000
    s_mov_b32 s20, s10
    s_mov_b32 s21, s11
    s_mov_b32 s22, 2097152
    s_mov_b32 s23, 0x00020000
    s_mov_b32 s24, s6
    s_mov_b32 s25, s7
    s_mov_b32 s26, 4096
    s_mov_b32 s27, 0x00020000
    s_cmp_eq_u32 s79, 0
    s_cbranch_scc1 TL_LATE
TL_LATER:
    s_waitcnt vmcnt(54)
    v_mfma_f32_32x32x16_bf16 v[64:79], v[192:195], a[128:131], 0
    ds_read_b64_tr_b16 v[208:209], v4 offset:4096
    ds_read_b64_tr_b16 v[210:211], v4 offset:6144
    ds_read_b64_tr_b16 v[212:213], v5 offset:4096
    v_and_b32 v20, 31, v1
    v_lshrrev_b32 v21, 5, v1
    v_mfma_f32_32x32x16_bf16 v[80:95], v[196:199], a[128:131], 0
    ds_read_b64_tr_b16 v[214:215], v5 offset:6144
    ds_read_b64_tr_b16 v[216:217], v6 offset:4096
    ds_read_b64_tr_b16 v[218:219], v6 offset:6144
    v_lshlrev_b32 v22, 10, v20
    v_lshl_add_u32 v22, v21, 3, v22
    v_mfma_f32_32x32x16_bf16 v[96:111], v[200:203], a[128:131], 0
    ds_read_b64_tr_b16 v[220:221], v7 offset:4096
    ds_read_b64_tr_b16 v[222:223], v7 offset:6144
    v_lshlrev_b32 v23, 4, v21
    s_lshl_b32 s34, s42, 2
    s_add_u32 s34, s34, s55
    s_sub_u32 s38, 60, s34
    s_add_u32 s38, s38, s55
    v_mfma_f32_32x32x16_bf16 v[112:127], v[204:207], a[128:131], 0
    s_add_u32 s38, s38, s55
    s_lshl_b32 s61, s57, 5
    s_lshl_b32 s34, s34, 15
    s_add_u32 s34, s34, s61
    s_lshl_b32 s38, s38, 15
    s_add_u32 s38, s38, s61
    s_lshl_b32 s61, s57, 6
    s_add_u32 s59, s61, 4096
    s_add_u32 s61, s61, 8192
    s_waitcnt vmcnt(53) lgkmcnt(0)
    v_mfma_f32_32x32x16_bf16 v[64:79], v[208:211], a[132:135], v[64:79]
    ds_read_b64_tr_b16 v[192:193], v4 offset:8192
    ds_read_b64_tr_b16 v[194:195], v4 offset:10240
    ds_read_b64_tr_b16 v[196:197], v5 offset:8192
    buffer_load_dwordx2 v[32:33], v22, s[16:19], s34 offen offset:0
    v_mfma_f32_32x32x16_bf16 v[80:95], v[212:215], a[132:135], v[80:95]
    ds_read_b64_tr_b16 v[198:199], v5 offset:10240
    ds_read_b64_tr_b16 v[200:201], v6 offset:8192
    ds_read_b64_tr_b16 v[202:203], v6 offset:10240
    buffer_load_dwordx2 v[34:35], v22, s[16:19], s34 offen offset:16
    v_mfma_f32_32x32x16_bf16 v[96:111], v[216:219], a[132:135], v[96:111]
    ds_read_b64_tr_b16 v[204:205], v7 offset:8192
    ds_read_b64_tr_b16 v[206:207], v7 offset:10240
    buffer_load_dwordx2 v[36:37], v22, s[16:19], s38 offen offset:0
    v_mfma_f32_32x32x16_bf16 v[112:127], v[220:223], a[132:135], v[112:127]
    buffer_load_dwordx2 v[38:39], v22, s[16:19], s38 offen offset:16
    buffer_load_dwordx4 v[40:43], v23, s[12:15], s59 offen offset:0
    s_waitcnt vmcnt(57) lgkmcnt(0)
    v_mfma_f32_32x32x16_bf16 v[64:79], v[192:195], a[136:139], v[64:79]
    ds_read_b64_tr_b16 v[208:209], v4 offset:12288
    ds_read_b64_tr_b16 v[210:211], v4 offset:14336
    ds_read_b64_tr_b16 v[212:213], v5 offset:12288
    buffer_load_dwordx4 v[48:51], v23, s[12:15], s61 offen offset:0
    v_mfma_f32_32x32x16_bf16 v[80:95], v[196:199], a[136:139], v[80:95]
    ds_read_b64_tr_b16 v[214:215], v5 offset:14336
    ds_read_b64_tr_b16 v[216:217], v6 offset:12288
    ds_read_b64_tr_b16 v[218:219], v6 offset:14336
    buffer_load_dwordx4 v[44:47], v23, s[12:15], s59 offen offset:32
    v_mfma_f32_32x32x16_bf16 v[96:111], v[200:203], a[136:139], v[96:111]
    ds_read_b64_tr_b16 v[220:221], v7 offset:12288
    ds_read_b64_tr_b16 v[222:223], v7 offset:14336
    buffer_load_dwordx4 v[52:55], v23, s[12:15], s61 offen offset:32
    s_lshl_b32 s34, s47, 2
    s_add_u32 s34, s34, s55
    v_mfma_f32_32x32x16_bf16 v[112:127], v[204:207], a[136:139], v[112:127]
    s_lshl_b32 s34, s34, 7
    s_add_u32 s34, s34, 442368
    s_lshl_b32 s58, s42, 11
    s_add_u32 s58, s58, s34
    s_lshl_b32 s92, s56, 11
    s_add_u32 s92, s92, s34
    s_lshl_b32 s34, s42, 2
    s_add_u32 s92, s92, s34
    s_lshl_b32 s34, s55, 13
    s_add_u32 s34, s34, 134217728
    s_waitcnt vmcnt(59) lgkmcnt(0)
    v_mfma_f32_32x32x16_bf16 v[64:79], v[208:211], a[140:143], v[64:79]
    ds_read_b64_tr_b16 v[192:193], v4 offset:32768
    ds_read_b64_tr_b16 v[194:195], v4 offset:34816
    ds_read_b64_tr_b16 v[196:197], v5 offset:32768
    s_lshl_b32 s84, s56, 20
    s_add_u32 s84, s84, s34
    s_lshl_b32 s38, s47, 18
    s_add_u32 s84, s84, s38
    v_mfma_f32_32x32x16_bf16 v[80:95], v[212:215], a[140:143], v[80:95]
    ds_read_b64_tr_b16 v[198:199], v5 offset:34816
    ds_read_b64_tr_b16 v[200:201], v6 offset:32768
    ds_read_b64_tr_b16 v[202:203], v6 offset:34816
    s_lshl_b32 s38, s42, 10
    s_add_u32 s84, s84, s38
    s_lshl_b32 s91, s42, 20
    s_add_u32 s91, s91, s34
    v_mfma_f32_32x32x16_bf16 v[96:111], v[216:219], a[140:143], v[96:111]
    ds_read_b64_tr_b16 v[204:205], v7 offset:32768
    ds_read_b64_tr_b16 v[206:207], v7 offset:34816
    s_lshl_b32 s38, s57, 15
    s_add_u32 s91, s91, s38
    s_add_u32 s78, s80, 19968
    v_and_b32 v24, 7, v1
    v_mfma_f32_32x32x16_bf16 v[112:127], v[220:223], a[140:143], v[112:127]
    v_lshlrev_b32 v24, 2, v24
    v_bfe_u32 v26, v1, 4, 1
    v_lshlrev_b32 v26, 14, v26
    v_lshl_add_u32 v26, v21, 8, v26
    v_and_b32 v27, 15, v1
    s_waitcnt vmcnt(57) lgkmcnt(0)
    v_mfma_f32_32x32x16_bf16 v[64:79], v[192:195], a[144:147], v[64:79]
    ds_read_b64_tr_b16 v[208:209], v4 offset:36864
    ds_read_b64_tr_b16 v[210:211], v4 offset:38912
    ds_read_b64_tr_b16 v[212:213], v5 offset:36864
    v_lshl_add_u32 v26, v27, 4, v26
    v_lshlrev_b32 v27, 6, v20
    v_mfma_f32_32x32x16_bf16 v[80:95], v[196:199], a[144:147], v[80:95]
    ds_read_b64_tr_b16 v[214:215], v5 offset:38912
    ds_read_b64_tr_b16 v[216:217], v6 offset:36864
    ds_read_b64_tr_b16 v[218:219], v6 offset:38912
    s_lshl_b32 s30, s43, 2
    s_add_u32 s30, s30, s55
    s_mul_i32 s30, s30, 49152
    s_add_u32 s30, s30, 104857600
    v_mfma_f32_32x32x16_bf16 v[96:111], v[200:203], a[144:147], v[96:111]
    ds_read_b64_tr_b16 v[220:221], v7 offset:36864
    ds_read_b64_tr_b16 v[222:223], v7 offset:38912
    s_lshl_b32 s34, s55, 19
    s_add_u32 s34, s34, s49
    s_lshl_b32 s38, s57, 9
    s_add_u32 s95, s34, s38
    s_add_u32 s96, s95, s38
    s_add_u32 s95, s95, 229376
    v_mfma_f32_32x32x16_bf16 v[112:127], v[204:207], a[144:147], v[112:127]
    s_add_u32 s96, s96, 196608
    s_lshl_b32 s97, s47, 11
    s_lshl_b32 s38, s48, 3
    s_add_u32 s97, s97, s38
    s_add_u32 s97, s97, s34
    s_add_u32 s97, s97, 180224
    s_lshl_b32 s98, s55, 7
    s_lshl_b32 s38, s57, 2
    s_add_u32 s98, s98, s38
    s_add_u32 s98, s98, s80
    s_waitcnt vmcnt(56) lgkmcnt(0)
    v_mfma_f32_32x32x16_bf16 v[64:79], v[208:211], a[148:151], v[64:79]
    ds_read_b64_tr_b16 v[192:193], v4 offset:40960
    ds_read_b64_tr_b16 v[194:195], v4 offset:43008
    ds_read_b64_tr_b16 v[196:197], v5 offset:40960
    s_add_u32 s98, s98, 18432
    v_lshlrev_b32 v28, 2, v20
    v_mfma_f32_32x32x16_bf16 v[80:95], v[212:215], a[148:151], v[80:95]
    ds_read_b64_tr_b16 v[198:199], v5 offset:43008
    ds_read_b64_tr_b16 v[200:201], v6 offset:40960
    ds_read_b64_tr_b16 v[202:203], v6 offset:43008
    v_mfma_f32_32x32x16_bf16 v[96:111], v[216:219], a[148:151], v[96:111]
    ds_read_b64_tr_b16 v[204:205], v7 offset:40960
    ds_read_b64_tr_b16 v[206:207], v7 offset:43008
    v_mfma_f32_32x32x16_bf16 v[112:127], v[220:223], a[148:151], v[112:127]
    s_waitcnt vmcnt(55) lgkmcnt(0)
    v_mfma_f32_32x32x16_bf16 v[64:79], v[192:195], a[152:155], v[64:79]
    ds_read_b64_tr_b16 v[208:209], v4 offset:45056
    ds_read_b64_tr_b16 v[210:211], v4 offset:47104
    ds_read_b64_tr_b16 v[212:213], v5 offset:45056
    buffer_load_dwordx4 a[0:3], v2, s[12:15], s30 offen offset:0
    v_mfma_f32_32x32x16_bf16 v[80:95], v[196:199], a[152:155], v[80:95]
    ds_read_b64_tr_b16 v[214:215], v5 offset:47104
    ds_read_b64_tr_b16 v[216:217], v6 offset:45056
    ds_read_b64_tr_b16 v[218:219], v6 offset:47104
    v_mfma_f32_32x32x16_bf16 v[96:111], v[200:203], a[152:155], v[96:111]
    ds_read_b64_tr_b16 v[220:221], v7 offset:45056
    ds_read_b64_tr_b16 v[222:223], v7 offset:47104
    buffer_load_dwordx4 a[4:7], v2, s[12:15], s30 offen offset:1024
    v_mfma_f32_32x32x16_bf16 v[112:127], v[204:207], a[152:155], v[112:127]
    s_waitcnt vmcnt(56) lgkmcnt(0)
    v_mfma_f32_32x32x16_bf16 v[64:79], v[208:211], a[156:159], v[64:79]
    ds_read_b64_tr_b16 v[192:193], v8 offset:0
    ds_read_b64_tr_b16 v[194:195], v8 offset:2048
    ds_read_b64_tr_b16 v[196:197], v9 offset:0
    buffer_load_dwordx4 a[8:11], v2, s[12:15], s30 offen offset:2048
    v_mfma_f32_32x32x16_bf16 v[80:95], v[212:215], a[156:159], v[80:95]
    ds_read_b64_tr_b16 v[198:199], v9 offset:2048
    ds_read_b64_tr_b16 v[200:201], v10 offset:0
    ds_read_b64_tr_b16 v[202:203], v10 offset:2048
    v_mfma_f32_32x32x16_bf16 v[96:111], v[216:219], a[156:159], v[96:111]
    ds_read_b64_tr_b16 v[204:205], v11 offset:0
    ds_read_b64_tr_b16 v[206:207], v11 offset:2048
    buffer_load_dwordx4 a[12:15], v2, s[12:15], s30 offen offset:3072
    s_add_u32 s30, s30, 4096
    v_mfma_f32_32x32x16_bf16 v[112:127], v[220:223], a[156:159], v[112:127]
    s_waitcnt vmcnt(57) lgkmcnt(0)
    v_mfma_f32_32x32x16_bf16 v[64:79], v[192:195], a[160:163], v[64:79]
    ds_read_b64_tr_b16 v[208:209], v8 offset:4096
    ds_read_b64_tr_b16 v[210:211], v8 offset:6144
    ds_read_b64_tr_b16 v[212:213], v9 offset:4096
    s_waitcnt vmcnt(25)
    v_mfma_f32_32x32x16_bf16 v[80:95], v[196:199], a[160:163], v[80:95]
    ds_read_b64_tr_b16 v[214:215], v9 offset:6144
    ds_read_b64_tr_b16 v[216:217], v10 offset:4096
    ds_read_b64_tr_b16 v[218:219], v10 offset:6144
    buffer_load_dwordx4 a[16:19], v2, s[12:15], s30 offen offset:0
    v_mfma_f32_32x32x16_bf16 v[96:111], v[200:203], a[160:163], v[96:111]
    ds_read_b64_tr_b16 v[220:221], v11 offset:4096
    ds_read_b64_tr_b16 v[222:223], v11 offset:6144
    buffer_load_dwordx4 a[20:23], v2, s[12:15], s30 offen offset:1024
    v_mfma_f32_32x32x16_bf16 v[112:127], v[204:207], a[160:163], v[112:127]
    s_cmp_eq_u32 s8, 0
    s_cbranch_scc1 TL_LF_10
    v_mov_b32 v58, 1
    s_mov_b64 exec, 1
    buffer_store_dword v58, off, s[12:15], s99
    s_mov_b64 exec, -1
TL_LF_10_R:
    s_waitcnt lgkmcnt(0)
    v_mfma_f32_32x32x16_bf16 v[64:79], v[208:211], a[164:167], v[64:79]
    ds_read_b64_tr_b16 v[192:193], v8 offset:8192
    ds_read_b64_tr_b16 v[194:195], v8 offset:10240
    ds_read_b64_tr_b16 v[196:197], v9 offset:8192
    buffer_load_dwordx4 a[24:27], v2, s[12:15], s30 offen offset:2048
    v_mfma_f32_32x32x16_bf16 v[80:95], v[212:215], a[164:167], v[80:95]
    ds_read_b64_tr_b16 v[198:199], v9 offset:10240
    ds_read_b64_tr_b16 v[200:201], v10 offset:8192
    ds_read_b64_tr_b16 v[202:203], v10 offset:10240
    v_mfma_f32_32x32x16_bf16 v[96:111], v[216:219], a[164:167], v[96:111]
    ds_read_b64_tr_b16 v[204:205], v11 offset:8192
    ds_read_b64_tr_b16 v[206:207], v11 offset:10240
    buffer_load_dwordx4 a[28:31], v2, s[12:15], s30 offen offset:3072
    s_add_u32 s30, s30, 4096
    v_mfma_f32_32x32x16_bf16 v[112:127], v[220:223], a[164:167], v[112:127]
    s_waitcnt lgkmcnt(0)
    v_mfma_f32_32x32x16_bf16 v[64:79], v[192:195], a[168:171], v[64:79]
    ds_read_b64_tr_b16 v[208:209], v8 offset:12288
    ds_read_b64_tr_b16 v[210:211], v8 offset:14336
    ds_read_b64_tr_b16 v[212:213], v9 offset:12288
    buffer_load_dwordx4 a[32:35], v2, s[12:15], s30 offen offset:0
    v_mfma_f32_32x32x16_bf16 v[80:95], v[196:199], a[168:171], v[80:95]
    ds_read_b64_tr_b16 v[214:215], v9 offset:14336
    ds_read_b64_tr_b16 v[216:217], v10 offset:12288
    ds_read_b64_tr_b16 v[218:219], v10 offset:14336
    v_mfma_f32_32x32x16_bf16 v[96:111], v[200:203], a[168:171], v[96:111]
    ds_read_b64_tr_b16 v[220:221], v11 offset:12288
    ds_read_b64_tr_b16 v[222:223], v11 offset:14336
    buffer_load_dwordx4 a[36:39], v2, s[12:15], s30 offen offset:1024
    v_mfma_f32_32x32x16_bf16 v[112:127], v[204:207], a[168:171], v[112:127]
    s_waitcnt lgkmcnt(0)
    v_mfma_f32_32x32x16_bf16 v[64:79], v[208:211], a[172:175], v[64:79]
    ds_read_b64_tr_b16 v[192:193], v8 offset:32768
    ds_read_b64_tr_b16 v[194:195], v8 offset:34816
    ds_read_b64_tr_b16 v[196:197], v9 offset:32768
    buffer_load_dwordx4 a[40:43], v2, s[12:15], s30 offen offset:2048
    v_mfma_f32_32x32x16_bf16 v[80:95], v[212:215], a[172:175], v[80:95]
    ds_read_b64_tr_b16 v[198:199], v9 offset:34816
    ds_read_b64_tr_b16 v[200:201], v10 offset:32768
    ds_read_b64_tr_b16 v[202:203], v10 offset:34816
    v_mfma_f32_32x32x16_bf16 v[96:111], v[216:219], a[172:175], v[96:111]
    ds_read_b64_tr_b16 v[204:205], v11 offset:32768
    ds_read_b64_tr_b16 v[206:207], v11 offset:34816
    buffer_load_dwordx4 a[44:47], v2, s[12:15], s30 offen offset:3072
    s_add_u32 s30, s30, 4096
    v_mfma_f32_32x32x16_bf16 v[112:127], v[220:223], a[172:175], v[112:127]
    s_waitcnt lgkmcnt(0)
    v_mfma_f32_32x32x16_bf16 v[64:79], v[192:195], a[176:179], v[64:79]
    ds_read_b64_tr_b16 v[208:209], v8 offset:36864
    ds_read_b64_tr_b16 v[210:211], v8 offset:38912
    ds_read_b64_tr_b16 v[212:213], v9 offset:36864
    buffer_load_dwordx4 a[48:51], v2, s[12:15], s30 offen offset:0
    v_mfma_f32_32x32x16_bf16 v[80:95], v[196:199], a[176:179], v[80:95]
    ds_read_b64_tr_b16 v[214:215], v9 offset:38912
    ds_read_b64_tr_b16 v[216:217], v10 offset:36864
    ds_read_b64_tr_b16 v[218:219], v10 offset:38912
    v_mfma_f32_32x32x16_bf16 v[96:111], v[200:203], a[176:179], v[96:111]
    ds_read_b64_tr_b16 v[220:221], v11 offset:36864
    ds_read_b64_tr_b16 v[222:223], v11 offset:38912
    buffer_load_dwordx4 a[52:55], v2, s[12:15], s30 offen offset:1024
    v_mfma_f32_32x32x16_bf16 v[112:127], v[204:207], a[176:179], v[112:127]
    s_waitcnt lgkmcnt(0)
    v_mfma_f32_32x32x16_bf16 v[64:79], v[208:211], a[180:183], v[64:79]
    ds_read_b64_tr_b16 v[192:193], v8 offset:40960
    ds_read_b64_tr_b16 v[194:195], v8 offset:43008
    ds_read_b64_tr_b16 v[196:197], v9 offset:40960
    buffer_load_dwordx4 a[56:59], v2, s[12:15], s30 offen offset:2048
    v_mfma_f32_32x32x16_bf16 v[80:95], v[212:215], a[180:183], v[80:95]
    ds_read_b64_tr_b16 v[198:199], v9 offset:43008
    ds_read_b64_tr_b16 v[200:201], v10 offset:40960
    ds_read_b64_tr_b16 v[202:203], v10 offset:43008
    v_mfma_f32_32x32x16_bf16 v[96:111], v[216:219], a[180:183], v[96:111]
    ds_read_b64_tr_b16 v[204:205], v11 offset:40960
    ds_read_b64_tr_b16 v[206:207], v11 offset:43008
    buffer_load_dwordx4 a[60:63], v2, s[12:15], s30 offen offset:3072
    s_add_u32 s30, s30, 4096
    v_mfma_f32_32x32x16_bf16 v[112:127], v[220:223], a[180:183], v[112:127]
    s_waitcnt lgkmcnt(0)
    v_mfma_f32_32x32x16_bf16 v[64:79], v[192:195], a[184:187], v[64:79]
    ds_read_b64_tr_b16 v[208:209], v8 offset:45056
    ds_read_b64_tr_b16 v[210:211], v8 offset:47104
    ds_read_b64_tr_b16 v[212:213], v9 offset:45056
    buffer_load_dwordx4 a[64:67], v2, s[12:15], s30 offen offset:0
    v_mfma_f32_32x32x16_bf16 v[80:95], v[196:199], a[184:187], v[80:95]
    ds_read_b64_tr_b16 v[214:215], v9 offset:47104
    ds_read_b64_tr_b16 v[216:217], v10 offset:45056
    ds_read_b64_tr_b16 v[218:219], v10 offset:47104
    v_mfma_f32_32x32x16_bf16 v[96:111], v[200:203], a[184:187], v[96:111]
    ds_read_b64_tr_b16 v[220:221], v11 offset:45056
    ds_read_b64_tr_b16 v[222:223], v11 offset:47104
    buffer_load_dwordx4 a[68:71], v2, s[12:15], s30 offen offset:1024
    v_mfma_f32_32x32x16_bf16 v[112:127], v[204:207], a[184:187], v[112:127]
    s_waitcnt lgkmcnt(0)
    v_mfma_f32_32x32x16_bf16 v[64:79], v[208:211], a[188:191], v[64:79]
    s_waitcnt vmcnt(27)
    s_barrier
    ds_read_b64_tr_b16 v[192:193], v12 offset:0
    ds_read_b64_tr_b16 v[194:195], v12 offset:2048
    v_mfma_f32_32x32x16_bf16 v[80:95], v[212:215], a[188:191], v[80:95]
    ds_read_b64_tr_b16 v[196:197], v13 offset:0
    ds_read_b64_tr_b16 v[198:199], v13 offset:2048
    ds_read_b64_tr_b16 v[200:201], v14 offset:0
    buffer_load_dwordx4 a[72:75], v2, s[12:15], s30 offen offset:2048
    v_mfma_f32_32x32x16_bf16 v[96:111], v[216:219], a[188:191], v[96:111]
    ds_read_b64_tr_b16 v[202:203], v14 offset:2048
    ds_read_b64_tr_b16 v[204:205], v15 offset:0
    ds_read_b64_tr_b16 v[206:207], v15 offset:2048
    v_mfma_f32_32x32x16_bf16 v[112:127], v[220:223], a[188:191], v[112:127]
    buffer_load_dwordx4 a[76:79], v2, s[12:15], s30 offen offset:3072
    s_add_u32 s30, s30, 4096
    s_waitcnt lgkmcnt(0)
    v_mfma_f32_32x32x16_bf16 v[64:79], v[192:195], a[192:195], v[64:79]
    ds_read_b64_tr_b16 v[208:209], v12 offset:4096
    ds_read_b64_tr_b16 v[210:211], v12 offset:6144
    ds_read_b64_tr_b16 v[212:213], v13 offset:4096
    buffer_load_dwordx4 a[80:83], v2, s[12:15], s30 offen offset:0
    v_mfma_f32_32x32x16_bf16 v[80:95], v[196:199], a[192:195], v[80:95]
    ds_read_b64_tr_b16 v[214:215], v13 offset:6144
    ds_read_b64_tr_b16 v[216:217], v14 offset:4096
    ds_read_b64_tr_b16 v[218:219], v14 offset:6144
    v_mfma_f32_32x32x16_bf16 v[96:111], v[200:203], a[192:195], v[96:111]
    ds_read_b64_tr_b16 v[220:221], v15 offset:4096
    ds_read_b64_tr_b16 v[222:223], v15 offset:6144
    buffer_load_dwordx4 a[84:87], v2, s[12:15], s30 offen offset:1024
    v_mfma_f32_32x32x16_bf16 v[112:127], v[204:207], a[192:195], v[112:127]
    s_waitcnt lgkmcnt(0)
    v_mfma_f32_32x32x16_bf16 v[64:79], v[208:211], a[196:199], v[64:79]
    ds_read_b64_tr_b16 v[192:193], v12 offset:8192
    ds_read_b64_tr_b16 v[194:195], v12 offset:10240
    ds_read_b64_tr_b16 v[196:197], v13 offset:8192
    buffer_load_dwordx4 a[88:91], v2, s[12:15], s30 offen offset:2048
    v_mfma_f32_32x32x16_bf16 v[80:95], v[212:215], a[196:199], v[80:95]
    ds_read_b64_tr_b16 v[198:199], v13 offset:10240
    ds_read_b64_tr_b16 v[200:201], v14 offset:8192
    ds_read_b64_tr_b16 v[202:203], v14 offset:10240
    v_mfma_f32_32x32x16_bf16 v[96:111], v[216:219], a[196:199], v[96:111]
    ds_read_b64_tr_b16 v[204:205], v15 offset:8192
    ds_read_b64_tr_b16 v[206:207], v15 offset:10240
    buffer_load_dwordx4 a[92:95], v2, s[12:15], s30 offen offset:3072
    s_add_u32 s30, s30, 4096
    v_mfma_f32_32x32x16_bf16 v[112:127], v[220:223], a[196:199], v[112:127]
    s_waitcnt lgkmcnt(0)
    v_mfma_f32_32x32x16_bf16 v[64:79], v[192:195], a[200:203], v[64:79]
    ds_read_b64_tr_b16 v[208:209], v12 offset:12288
    ds_read_b64_tr_b16 v[210:211], v12 offset:14336
    ds_read_b64_tr_b16 v[212:213], v13 offset:12288
    buffer_load_dword v57, v24, s[12:15], s37 offen sc1
    v_mfma_f32_32x32x16_bf16 v[80:95], v[196:199], a[200:203], v[80:95]
    ds_read_b64_tr_b16 v[214:215], v13 offset:14336
    ds_read_b64_tr_b16 v[216:217], v14 offset:12288
    ds_read_b64_tr_b16 v[218:219], v14 offset:14336
    buffer_load_dwordx4 a[96:99], v2, s[12:15], s30 offen offset:0
    v_mfma_f32_32x32x16_bf16 v[96:111], v[200:203], a[200:203], v[96:111]
    ds_read_b64_tr_b16 v[220:221], v15 offset:12288
    ds_read_b64_tr_b16 v[222:223], v15 offset:14336
    buffer_load_dwordx4 a[100:103], v2, s[12:15], s30 offen offset:1024
    v_mfma_f32_32x32x16_bf16 v[112:127], v[204:207], a[200:203], v[112:127]
    s_waitcnt lgkmcnt(0)
    v_mfma_f32_32x32x16_bf16 v[64:79], v[208:211], a[204:207], v[64:79]
    ds_read_b64_tr_b16 v[192:193], v12 offset:32768
    ds_read_b64_tr_b16 v[194:195], v12 offset:34816
    ds_read_b64_tr_b16 v[196:197], v13 offset:32768
    buffer_load_dwordx4 a[104:107], v2, s[12:15], s30 offen offset:2048
    v_mfma_f32_32x32x16_bf16 v[80:95], v[212:215], a[204:207], v[80:95]
    ds_read_b64_tr_b16 v[198:199], v13 offset:34816
    ds_read_b64_tr_b16 v[200:201], v14 offset:32768
    ds_read_b64_tr_b16 v[202:203], v14 offset:34816
    v_mfma_f32_32x32x16_bf16 v[96:111], v[216:219], a[204:207], v[96:111]
    ds_read_b64_tr_b16 v[204:205], v15 offset:32768
    ds_read_b64_tr_b16 v[206:207], v15 offset:34816
    buffer_load_dwordx4 a[108:111], v2, s[12:15], s30 offen offset:3072
    s_add_u32 s30, s30, 4096
    v_mfma_f32_32x32x16_bf16 v[112:127], v[220:223], a[204:207], v[112:127]
    s_waitcnt lgkmcnt(0)
    v_mfma_f32_32x32x16_bf16 v[64:79], v[192:195], a[208:211], v[64:79]
    ds_read_b64_tr_b16 v[208:209], v12 offset:36864
    ds_read_b64_tr_b16 v[210:211], v12 offset:38912
    ds_read_b64_tr_b16 v[212:213], v13 offset:36864
    buffer_load_dwordx4 a[112:115], v2, s[12:15], s30 offen offset:0
    v_mfma_f32_32x32x16_bf16 v[80:95], v[196:199], a[208:211], v[80:95]
    ds_read_b64_tr_b16 v[214:215], v13 offset:38912
    ds_read_b64_tr_b16 v[216:217], v14 offset:36864
    ds_read_b64_tr_b16 v[218:219], v14 offset:38912
    v_mfma_f32_32x32x16_bf16 v[96:111], v[200:203], a[208:211], v[96:111]
    ds_read_b64_tr_b16 v[220:221], v15 offset:36864
    ds_read_b64_tr_b16 v[222:223], v15 offset:38912
    buffer_load_dwordx4 a[116:119], v2, s[12:15], s30 offen offset:1024
    v_mfma_f32_32x32x16_bf16 v[112:127], v[204:207], a[208:211], v[112:127]
    s_waitcnt lgkmcnt(0)
    v_mfma_f32_32x32x16_bf16 v[64:79], v[208:211], a[212:215], v[64:79]
    ds_read_b64_tr_b16 v[192:193], v12 offset:40960
    ds_read_b64_tr_b16 v[194:195], v12 offset:43008
    ds_read_b64_tr_b16 v[196:197], v13 offset:40960
    buffer_load_dwordx4 a[120:123], v2, s[12:15], s30 offen offset:2048
    v_mfma_f32_32x32x16_bf16 v[80:95], v[212:215], a[212:215], v[80:95]
    ds_read_b64_tr_b16 v[198:199], v13 offset:43008
    ds_read_b64_tr_b16 v[200:201], v14 offset:40960
    ds_read_b64_tr_b16 v[202:203], v14 offset:43008
    v_mfma_f32_32x32x16_bf16 v[96:111], v[216:219], a[212:215], v[96:111]
    ds_read_b64_tr_b16 v[204:205], v15 offset:40960
    ds_read_b64_tr_b16 v[206:207], v15 offset:43008
    buffer_load_dwordx4 a[124:127], v2, s[12:15], s30 offen offset:3072
    s_add_u32 s30, s30, 4096
    v_mfma_f32_32x32x16_bf16 v[112:127], v[220:223], a[212:215], v[112:127]
    s_waitcnt lgkmcnt(0)
    v_mfma_f32_32x32x16_bf16 v[64:79], v[192:195], a[216:219], v[64:79]
    ds_read_b64_tr_b16 v[208:209], v12 offset:45056
    ds_read_b64_tr_b16 v[210:211], v12 offset:47104
    ds_read_b64_tr_b16 v[212:213], v13 offset:45056
    v_mfma_f32_32x32x16_bf16 v[80:95], v[196:199], a[216:219], v[80:95]
    ds_read_b64_tr_b16 v[214:215], v13 offset:47104
    ds_read_b64_tr_b16 v[216:217], v14 offset:45056
    ds_read_b64_tr_b16 v[218:219], v14 offset:47104
    v_mfma_f32_32x32x16_bf16 v[96:111], v[200:203], a[216:219], v[96:111]
    ds_read_b64_tr_b16 v[220:221], v15 offset:45056
    ds_read_b64_tr_b16 v[222:223], v15 offset:47104
    v_mfma_f32_32x32x16_bf16 v[112:127], v[204:207], a[216:219], v[112:127]
    s_waitcnt lgkmcnt(0)
    v_mfma_f32_32x32x16_bf16 v[64:79], v[208:211], a[220:223], v[64:79]
    ds_read_b64_tr_b16 v[192:193], v16 offset:0
    ds_read_b64_tr_b16 v[194:195], v16 offset:2048
    ds_read_b64_tr_b16 v[196:197], v17 offset:0
    v_mfma_f32_32x32x16_bf16 v[80:95], v[212:215], a[220:223], v[80:95]
    ds_read_b64_tr_b16 v[198:199], v17 offset:2048
    ds_read_b64_tr_b16 v[200:201], v18 offset:0
    ds_read_b64_tr_b16 v[202:203], v18 offset:2048
    v_mfma_f32_32x32x16_bf16 v[96:111], v[216:219], a[220:223], v[96:111]
    ds_read_b64_tr_b16 v[204:205], v19 offset:0
    ds_read_b64_tr_b16 v[206:207], v19 offset:2048
    v_mfma_f32_32x32x16_bf16 v[112:127], v[220:223], a[220:223], v[112:127]
    s_waitcnt lgkmcnt(0)
    v_mfma_f32_32x32x16_bf16 v[64:79], v[192:195], a[224:227], v[64:79]
    ds_read_b64_tr_b16 v[208:209], v16 offset:4096
    ds_read_b64_tr_b16 v[210:211], v16 offset:6144
    ds_read_b64_tr_b16 v[212:213], v17 offset:4096
    v_mfma_f32_32x32x16_bf16 v[80:95], v[196:199], a[224:227], v[80:95]
    ds_read_b64_tr_b16 v[214:215], v17 offset:6144
    ds_read_b64_tr_b16 v[216:217], v18 offset:4096
    ds_read_b64_tr_b16 v[218:219], v18 offset:6144
    v_mfma_f32_32x32x16_bf16 v[96:111], v[200:203], a[224:227], v[96:111]
    ds_read_b64_tr_b16 v[220:221], v19 offset:4096
    ds_read_b64_tr_b16 v[222:223], v19 offset:6144
    s_waitcnt vmcnt(8)
    v_cmp_le_u32 vcc, 1, v57
    s_nop 0
    s_cmp_eq_u64 vcc, -1
    s_cbranch_scc0 TPH_S
TPH_R:
    v_mfma_f32_32x32x16_bf16 v[112:127], v[204:207], a[224:227], v[112:127]
    s_mov_b32 s51, s60
    buffer_load_dwordx4 a[128:131], v2, s[12:15], s51 offen offset:2048
    buffer_load_dwordx4 a[132:135], v2, s[12:15], s51 offen offset:3072
    s_add_u32 s51, s51, 4096
    s_waitcnt lgkmcnt(0)
    v_mfma_f32_32x32x16_bf16 v[64:79], v[208:211], a[228:231], v[64:79]
    ds_read_b64_tr_b16 v[192:193], v16 offset:8192
    ds_read_b64_tr_b16 v[194:195], v16 offset:10240
    ds_read_b64_tr_b16 v[196:197], v17 offset:8192
    buffer_load_dwordx4 a[136:139], v2, s[12:15], s51 offen offset:2048
    v_mfma_f32_32x32x16_bf16 v[80:95], v[212:215], a[228:231], v[80:95]
    ds_read_b64_tr_b16 v[198:199], v17 offset:10240
    ds_read_b64_tr_b16 v[200:201], v18 offset:8192
    ds_read_b64_tr_b16 v[202:203], v18 offset:10240
    v_mfma_f32_32x32x16_bf16 v[96:111], v[216:219], a[228:231], v[96:111]
    ds_read_b64_tr_b16 v[204:205], v19 offset:8192
    ds_read_b64_tr_b16 v[206:207], v19 offset:10240
    buffer_load_dwordx4 a[140:143], v2, s[12:15], s51 offen offset:3072
    s_add_u32 s51, s51, 28672
    v_mfma_f32_32x32x16_bf16 v[112:127], v[220:223], a[228:231], v[112:127]
    buffer_load_dwordx4 a[144:147], v2, s[12:15], s51 offen offset:2048
    buffer_load_dwordx4 a[148:151], v2, s[12:15], s51 offen offset:3072
    s_add_u32 s51, s51, 4096
    s_waitcnt lgkmcnt(0)
    v_mfma_f32_32x32x16_bf16 v[64:79], v[192:195], a[232:235], v[64:79]
    ds_read_b64_tr_b16 v[208:209], v16 offset:12288
    ds_read_b64_tr_b16 v[210:211], v16 offset:14336
    ds_read_b64_tr_b16 v[212:213], v17 offset:12288
    buffer_load_dwordx4 a[152:155], v2, s[12:15], s51 offen offset:2048
    v_mfma_f32_32x32x16_bf16 v[80:95], v[196:199], a[232:235], v[80:95]
    ds_read_b64_tr_b16 v[214:215], v17 offset:14336
    ds_read_b64_tr_b16 v[216:217], v18 offset:12288
    ds_read_b64_tr_b16 v[218:219], v18 offset:14336
    v_mfma_f32_32x32x16_bf16 v[96:111], v[200:203], a[232:235], v[96:111]
    ds_read_b64_tr_b16 v[220:221], v19 offset:12288
    ds_read_b64_tr_b16 v[222:223], v19 offset:14336
    buffer_load_dwordx4 a[156:159], v2, s[12:15], s51 offen offset:3072
    s_add_u32 s51, s51, 28672
    v_mfma_f32_32x32x16_bf16 v[112:127], v[204:207], a[232:235], v[112:127]
    buffer_load_dwordx4 a[160:163], v2, s[12:15], s51 offen offset:0
    buffer_load_dwordx4 a[164:167], v2, s[12:15], s51 offen offset:1024
    s_add_u32 s51, s51, 4096
    s_waitcnt lgkmcnt(0)
    v_mfma_f32_32x32x16_bf16 v[64:79], v[208:211], a[236:239], v[64:79]
    ds_read_b64_tr_b16 v[192:193], v16 offset:32768
    ds_read_b64_tr_b16 v[194:195], v16 offset:34816
    ds_read_b64_tr_b16 v[196:197], v17 offset:32768
    buffer_load_dwordx4 a[168:171], v2, s[12:15], s51 offen offset:0
    v_mfma_f32_32x32x16_bf16 v[80:95], v[212:215], a[236:239], v[80:95]
    ds_read_b64_tr_b16 v[198:199], v17 offset:34816
    ds_read_b64_tr_b16 v[200:201], v18 offset:32768
    ds_read_b64_tr_b16 v[202:203], v18 offset:34816
    buffer_load_dword v29, v28, s[12:15], s78 offen sc1
    v_mfma_f32_32x32x16_bf16 v[96:111], v[216:219], a[236:239], v[96:111]
    ds_read_b64_tr_b16 v[204:205], v19 offset:32768
    ds_read_b64_tr_b16 v[206:207], v19 offset:34816
    buffer_load_dwordx4 a[172:175], v2, s[12:15], s51 offen offset:1024
    s_add_u32 s51, s51, 28672
    v_mfma_f32_32x32x16_bf16 v[112:127], v[220:223], a[236:239], v[112:127]
    buffer_load_dwordx4 a[176:179], v2, s[12:15], s51 offen offset:0
    buffer_load_dwordx4 a[180:183], v2, s[12:15], s51 offen offset:1024
    s_add_u32 s51, s51, 4096
    s_waitcnt lgkmcnt(0)
    v_mfma_f32_32x32x16_bf16 v[64:79], v[192:195], a[240:243], v[64:79]
    ds_read_b64_tr_b16 v[208:209], v16 offset:36864
    ds_read_b64_tr_b16 v[210:211], v16 offset:38912
    ds_read_b64_tr_b16 v[212:213], v17 offset:36864
    buffer_load_dwordx4 a[184:187], v2, s[12:15], s51 offen offset:0
    v_mfma_f32_32x32x16_bf16 v[80:95], v[196:199], a[240:243], v[80:95]
    ds_read_b64_tr_b16 v[214:215], v17 offset:38912
    ds_read_b64_tr_b16 v[216:217], v18 offset:36864
    ds_read_b64_tr_b16 v[218:219], v18 offset:38912
    v_mfma_f32_32x32x16_bf16 v[96:111], v[200:203], a[240:243], v[96:111]
    ds_read_b64_tr_b16 v[220:221], v19 offset:36864
    ds_read_b64_tr_b16 v[222:223], v19 offset:38912
    buffer_load_dwordx4 a[188:191], v2, s[12:15], s51 offen offset:1024
    s_sub_u32 s51, s51, 102400
    v_mfma_f32_32x32x16_bf16 v[112:127], v[204:207], a[240:243], v[112:127]
    buffer_load_dwordx4 a[192:195], v2, s[12:15], s51 offen offset:0
    buffer_load_dwordx4 a[196:199], v2, s[12:15], s51 offen offset:1024
    s_add_u32 s51, s51, 4096
    s_waitcnt lgkmcnt(0)
    v_mfma_f32_32x32x16_bf16 v[64:79], v[208:211], a[244:247], v[64:79]
    ds_read_b64_tr_b16 v[192:193], v16 offset:40960
    ds_read_b64_tr_b16 v[194:195], v16 offset:43008
    ds_read_b64_tr_b16 v[196:197], v17 offset:40960
    buffer_load_dwordx4 a[200:203], v2, s[12:15], s51 offen offset:0
    v_mfma_f32_32x32x16_bf16 v[80:95], v[212:215], a[244:247], v[80:95]
    ds_read_b64_tr_b16 v[198:199], v17 offset:43008
    ds_read_b64_tr_b16 v[200:201], v18 offset:40960
    ds_read_b64_tr_b16 v[202:203], v18 offset:43008
    v_mfma_f32_32x32x16_bf16 v[96:111], v[216:219], a[244:247], v[96:111]
    ds_read_b64_tr_b16 v[204:205], v19 offset:40960
    ds_read_b64_tr_b16 v[206:207], v19 offset:43008
    buffer_load_dwordx4 a[204:207], v2, s[12:15], s51 offen offset:1024
    s_add_u32 s51, s51, 28672
    v_mfma_f32_32x32x16_bf16 v[112:127], v[220:223], a[244:247], v[112:127]
    buffer_load_dwordx4 a[208:211], v2, s[12:15], s51 offen offset:0
    buffer_load_dwordx4 a[212:215], v2, s[12:15], s51 offen offset:1024
    s_add_u32 s51, s51, 4096
    s_waitcnt lgkmcnt(0)
    v_mfma_f32_32x32x16_bf16 v[64:79], v[192:195], a[248:251], v[64:79]
    ds_read_b64_tr_b16 v[208:209], v16 offset:45056
    ds_read_b64_tr_b16 v[210:211], v16 offset:47104
    ds_read_b64_tr_b16 v[212:213], v17 offset:45056
    buffer_load_dwordx4 a[216:219], v2, s[12:15], s51 offen offset:0
    v_mfma_f32_32x32x16_bf16 v[80:95], v[196:199], a[248:251], v[80:95]
    ds_read_b64_tr_b16 v[214:215], v17 offset:47104
    ds_read_b64_tr_b16 v[216:217], v18 offset:45056
    ds_read_b64_tr_b16 v[218:219], v18 offset:47104
    v_mfma_f32_32x32x16_bf16 v[96:111], v[200:203], a[248:251], v[96:111]
    ds_read_b64_tr_b16 v[220:221], v19 offset:45056
    ds_read_b64_tr_b16 v[222:223], v19 offset:47104
    buffer_load_dwordx4 a[220:223], v2, s[12:15], s51 offen offset:1024
    s_add_u32 s51, s51, 28672
    v_mfma_f32_32x32x16_bf16 v[112:127], v[204:207], a[248:251], v[112:127]
    buffer_load_dwordx4 a[224:227], v2, s[12:15], s51 offen offset:2048
    buffer_load_dwordx4 a[228:231], v2, s[12:15], s51 offen offset:3072
    s_add_u32 s51, s51, 4096
    s_waitcnt lgkmcnt(0)
    v_mfma_f32_32x32x16_bf16 v[64:79], v[208:211], a[252:255], v[64:79]
    ds_read_b64_tr_b16 v[192:193], v4 offset:0
    ds_read_b64_tr_b16 v[194:195], v4 offset:2048
    ds_read_b64_tr_b16 v[196:197], v5 offset:0
    buffer_load_dwordx4 a[232:235], v2, s[12:15], s51 offen offset:2048
    v_mfma_f32_32x32x16_bf16 v[80:95], v[212:215], a[252:255], v[80:95]
    ds_read_b64_tr_b16 v[198:199], v5 offset:2048
    ds_read_b64_tr_b16 v[200:201], v6 offset:0
    ds_read_b64_tr_b16 v[202:203], v6 offset:2048
    v_mfma_f32_32x32x16_bf16 v[96:111], v[216:219], a[252:255], v[96:111]
    ds_read_b64_tr_b16 v[204:205], v7 offset:0
    ds_read_b64_tr_b16 v[206:207], v7 offset:2048
    buffer_load_dwordx4 a[236:239], v2, s[12:15], s51 offen offset:3072
    s_add_u32 s51, s51, 28672
    v_mfma_f32_32x32x16_bf16 v[112:127], v[220:223], a[252:255], v[112:127]
    buffer_load_dwordx4 a[240:243], v2, s[12:15], s51 offen offset:2048
    buffer_load_dwordx4 a[244:247], v2, s[12:15], s51 offen offset:3072
    s_add_u32 s51, s51, 4096
    s_waitcnt vmcnt(30) lgkmcnt(0)
    v_mfma_f32_32x32x16_bf16 v[128:143], v[192:195], a[128:131], 0
    ds_read_b64_tr_b16 v[208:209], v4 offset:4096
    ds_read_b64_tr_b16 v[210:211], v4 offset:6144
    ds_read_b64_tr_b16 v[212:213], v5 offset:4096
    buffer_load_dwordx4 a[248:251], v2, s[12:15], s51 offen offset:2048
    v_mfma_f32_32x32x16_bf16 v[144:159], v[196:199], a[128:131], 0
    ds_read_b64_tr_b16 v[214:215], v5 offset:6144
    ds_read_b64_tr_b16 v[216:217], v6 offset:4096
    ds_read_b64_tr_b16 v[218:219], v6 offset:6144
    buffer_load_dwordx4 a[252:255], v2, s[12:15], s51 offen offset:3072
    v_mfma_f32_32x32x16_bf16 v[160:175], v[200:203], a[128:131], 0
    ds_read_b64_tr_b16 v[220:221], v7 offset:4096
    ds_read_b64_tr_b16 v[222:223], v7 offset:6144
    v_mfma_f32_32x32x16_bf16 v[176:191], v[204:207], a[128:131], 0
    v_cvt_pk_bf16_f32 v64, v64, v65
    v_cvt_pk_bf16_f32 v65, v66, v67
    v_cvt_pk_bf16_f32 v66, v68, v69
    v_cvt_pk_bf16_f32 v67, v70, v71
    s_waitcnt vmcnt(31) lgkmcnt(0)
    v_mfma_f32_32x32x16_bf16 v[128:143], v[208:211], a[132:135], v[128:143]
    ds_read_b64_tr_b16 v[192:193], v4 offset:8192
    ds_read_b64_tr_b16 v[194:195], v4 offset:10240
    ds_read_b64_tr_b16 v[196:197], v5 offset:8192
    v_mfma_f32_32x32x16_bf16 v[144:159], v[212:215], a[132:135], v[144:159]
    ds_read_b64_tr_b16 v[198:199], v5 offset:10240
    ds_read_b64_tr_b16 v[200:201], v6 offset:8192
    ds_read_b64_tr_b16 v[202:203], v6 offset:10240
    v_mfma_f32_32x32x16_bf16 v[160:175], v[216:219], a[132:135], v[160:175]
    ds_read_b64_tr_b16 v[204:205], v7 offset:8192
    ds_read_b64_tr_b16 v[206:207], v7 offset:10240
    buffer_store_dwordx4 v[64:67], v2, s[12:15], s84 offen sc1
    s_add_u32 s84, s84, 32768
    v_mfma_f32_32x32x16_bf16 v[176:191], v[220:223], a[132:135], v[176:191]
    v_cvt_pk_bf16_f32 v72, v72, v73
    v_cvt_pk_bf16_f32 v73, v74, v75
    v_cvt_pk_bf16_f32 v74, v76, v77
    v_cvt_pk_bf16_f32 v75, v78, v79
    s_waitcnt vmcnt(31) lgkmcnt(0)
    v_mfma_f32_32x32x16_bf16 v[128:143], v[192:195], a[136:139], v[128:143]
    ds_read_b64_tr_b16 v[208:209], v4 offset:12288
    ds_read_b64_tr_b16 v[210:211], v4 offset:14336
    ds_read_b64_tr_b16 v[212:213], v5 offset:12288
    v_mfma_f32_32x32x16_bf16 v[144:159], v[196:199], a[136:139], v[144:159]
    ds_read_b64_tr_b16 v[214:215], v5 offset:14336
    ds_read_b64_tr_b16 v[216:217], v6 offset:12288
    ds_read_b64_tr_b16 v[218:219], v6 offset:14336
    v_mfma_f32_32x32x16_bf16 v[160:175], v[200:203], a[136:139], v[160:175]
    ds_read_b64_tr_b16 v[220:221], v7 offset:12288
    ds_read_b64_tr_b16 v[222:223], v7 offset:14336
    buffer_store_dwordx4 v[72:75], v2, s[12:15], s84 offen sc1
    s_add_u32 s84, s84, 32768
    v_mfma_f32_32x32x16_bf16 v[176:191], v[204:207], a[136:139], v[176:191]
    v_cvt_pk_bf16_f32 v80, v80, v81
    v_cvt_pk_bf16_f32 v81, v82, v83
    v_cvt_pk_bf16_f32 v82, v84, v85
    v_cvt_pk_bf16_f32 v83, v86, v87
    s_waitcnt vmcnt(31) lgkmcnt(0)
    v_mfma_f32_32x32x16_bf16 v[128:143], v[208:211], a[140:143], v[128:143]
    ds_read_b64_tr_b16 v[192:193], v4 offset:32768
    ds_read_b64_tr_b16 v[194:195], v4 offset:34816
    ds_read_b64_tr_b16 v[196:197], v5 offset:32768
    v_mfma_f32_32x32x16_bf16 v[144:159], v[212:215], a[140:143], v[144:159]
    ds_read_b64_tr_b16 v[198:199], v5 offset:34816
    ds_read_b64_tr_b16 v[200:201], v6 offset:32768
    ds_read_b64_tr_b16 v[202:203], v6 offset:34816
    v_mfma_f32_32x32x16_bf16 v[160:175], v[216:219], a[140:143], v[160:175]
    ds_read_b64_tr_b16 v[204:205], v7 offset:32768
    ds_read_b64_tr_b16 v[206:207], v7 offset:34816
    buffer_store_dwordx4 v[80:83], v2, s[12:15], s84 offen sc1
    s_add_u32 s84, s84, 32768
    v_mfma_f32_32x32x16_bf16 v[176:191], v[220:223], a[140:143], v[176:191]
    v_cvt_pk_bf16_f32 v88, v88, v89
    v_cvt_pk_bf16_f32 v89, v90, v91
    v_cvt_pk_bf16_f32 v90, v92, v93
    v_cvt_pk_bf16_f32 v91, v94, v95
    s_waitcnt vmcnt(31) lgkmcnt(0)
    v_mfma_f32_32x32x16_bf16 v[128:143], v[192:195], a[144:147], v[128:143]
    ds_read_b64_tr_b16 v[208:209], v4 offset:36864
    ds_read_b64_tr_b16 v[210:211], v4 offset:38912
    ds_read_b64_tr_b16 v[212:213], v5 offset:36864
    v_mfma_f32_32x32x16_bf16 v[144:159], v[196:199], a[144:147], v[144:159]
    ds_read_b64_tr_b16 v[214:215], v5 offset:38912
    ds_read_b64_tr_b16 v[216:217], v6 offset:36864
    ds_read_b64_tr_b16 v[218:219], v6 offset:38912
    v_mfma_f32_32x32x16_bf16 v[160:175], v[200:203], a[144:147], v[160:175]
    ds_read_b64_tr_b16 v[220:221], v7 offset:36864
    ds_read_b64_tr_b16 v[222:223], v7 offset:38912
    buffer_store_dwordx4 v[88:91], v2, s[12:15], s84 offen sc1
    s_add_u32 s84, s84, 32768
    v_mfma_f32_32x32x16_bf16 v[176:191], v[204:207], a[144:147], v[176:191]
    v_cvt_pk_bf16_f32 v96, v96, v97
    v_cvt_pk_bf16_f32 v97, v98, v99
    v_cvt_pk_bf16_f32 v98, v100, v101
    v_cvt_pk_bf16_f32 v99, v102, v103
    s_waitcnt vmcnt(31) lgkmcnt(0)
    v_mfma_f32_32x32x16_bf16 v[128:143], v[208:211], a[148:151], v[128:143]
    ds_read_b64_tr_b16 v[192:193], v4 offset:40960
    ds_read_b64_tr_b16 v[194:195], v4 offset:43008
    ds_read_b64_tr_b16 v[196:197], v5 offset:40960
    v_mfma_f32_32x32x16_bf16 v[144:159], v[212:215], a[148:151], v[144:159]
    ds_read_b64_tr_b16 v[198:199], v5 offset:43008
    ds_read_b64_tr_b16 v[200:201], v6 offset:40960
    ds_read_b64_tr_b16 v[202:203], v6 offset:43008
    v_mfma_f32_32x32x16_bf16 v[160:175], v[216:219], a[148:151], v[160:175]
    ds_read_b64_tr_b16 v[204:205], v7 offset:40960
    ds_read_b64_tr_b16 v[206:207], v7 offset:43008
    buffer_store_dwordx4 v[96:99], v2, s[12:15], s84 offen sc1
    s_add_u32 s84, s84, 32768
    v_mfma_f32_32x32x16_bf16 v[176:191], v[220:223], a[148:151], v[176:191]
    v_cvt_pk_bf16_f32 v104, v104, v105
    v_cvt_pk_bf16_f32 v105, v106, v107
    v_cvt_pk_bf16_f32 v106, v108, v109
    v_cvt_pk_bf16_f32 v107, v110, v111
    s_waitcnt vmcnt(31) lgkmcnt(0)
    v_mfma_f32_32x32x16_bf16 v[128:143], v[192:195], a[152:155], v[128:143]
    ds_read_b64_tr_b16 v[208:209], v4 offset:45056
    ds_read_b64_tr_b16 v[210:211], v4 offset:47104
    ds_read_b64_tr_b16 v[212:213], v5 offset:45056
    v_mfma_f32_32x32x16_bf16 v[144:159], v[196:199], a[152:155], v[144:159]
    ds_read_b64_tr_b16 v[214:215], v5 offset:47104
    ds_read_b64_tr_b16 v[216:217], v6 offset:45056
    ds_read_b64_tr_b16 v[218:219], v6 offset:47104
    v_mfma_f32_32x32x16_bf16 v[160:175], v[200:203], a[152:155], v[160:175]
    ds_read_b64_tr_b16 v[220:221], v7 offset:45056
    ds_read_b64_tr_b16 v[222:223], v7 offset:47104
    buffer_store_dwordx4 v[104:107], v2, s[12:15], s84 offen sc1
    s_add_u32 s84, s84, 32768
    v_mfma_f32_32x32x16_bf16 v[176:191], v[204:207], a[152:155], v[176:191]
    v_cvt_pk_bf16_f32 v112, v112, v113
    v_cvt_pk_bf16_f32 v113, v114, v115
    v_cvt_pk_bf16_f32 v114, v116, v117
    v_cvt_pk_bf16_f32 v115, v118, v119
    s_waitcnt vmcnt(31) lgkmcnt(0)
    v_mfma_f32_32x32x16_bf16 v[128:143], v[208:211], a[156:159], v[128:143]
    ds_read_b64_tr_b16 v[192:193], v8 offset:0
    ds_read_b64_tr_b16 v[194:195], v8 offset:2048
    ds_read_b64_tr_b16 v[196:197], v9 offset:0
    v_mfma_f32_32x32x16_bf16 v[144:159], v[212:215], a[156:159], v[144:159]
    ds_read_b64_tr_b16 v[198:199], v9 offset:2048
    ds_read_b64_tr_b16 v[200:201], v10 offset:0
    ds_read_b64_tr_b16 v[202:203], v10 offset:2048
    v_mfma_f32_32x32x16_bf16 v[160:175], v[216:219], a[156:159], v[160:175]
    ds_read_b64_tr_b16 v[204:205], v11 offset:0
    ds_read_b64_tr_b16 v[206:207], v11 offset:2048
    buffer_store_dwordx4 v[112:115], v2, s[12:15], s84 offen sc1
    s_add_u32 s84, s84, 32768
    v_mfma_f32_32x32x16_bf16 v[176:191], v[220:223], a[156:159], v[176:191]
    v_cvt_pk_bf16_f32 v120, v120, v121
    v_cvt_pk_bf16_f32 v121, v122, v123
    v_cvt_pk_bf16_f32 v122, v124, v125
    v_cvt_pk_bf16_f32 v123, v126, v127
    s_waitcnt vmcnt(31) lgkmcnt(0)
    v_mfma_f32_32x32x16_bf16 v[128:143], v[192:195], a[160:163], v[128:143]
    ds_read_b64_tr_b16 v[208:209], v8 offset:4096
    ds_read_b64_tr_b16 v[210:211], v8 offset:6144
    ds_read_b64_tr_b16 v[212:213], v9 offset:4096
    v_mfma_f32_32x32x16_bf16 v[144:159], v[196:199], a[160:163], v[144:159]
    ds_read_b64_tr_b16 v[214:215], v9 offset:6144
    ds_read_b64_tr_b16 v[216:217], v10 offset:4096
    ds_read_b64_tr_b16 v[218:219], v10 offset:6144
    v_mfma_f32_32x32x16_bf16 v[160:175], v[200:203], a[160:163], v[160:175]
    ds_read_b64_tr_b16 v[220:221], v11 offset:4096
    ds_read_b64_tr_b16 v[222:223], v11 offset:6144
    buffer_store_dwordx4 v[120:123], v2, s[12:15], s84 offen sc1
    s_add_u32 s84, s84, 8159232
    v_mfma_f32_32x32x16_bf16 v[176:191], v[204:207], a[160:163], v[176:191]
    s_waitcnt vmcnt(29)
    v_cmp_le_u32 vcc, 1, v29
    s_nop 0
    s_cmp_eq_u64 vcc, -1
    s_cbranch_scc0 TPD_S
TPD_R:
    s_waitcnt lgkmcnt(0)
    v_mfma_f32_32x32x16_bf16 v[128:143], v[208:211], a[164:167], v[128:143]
    ds_read_b64_tr_b16 v[192:193], v8 offset:8192
    ds_read_b64_tr_b16 v[194:195], v8 offset:10240
    ds_read_b64_tr_b16 v[196:197], v9 offset:8192
    v_mfma_f32_32x32x16_bf16 v[144:159], v[212:215], a[164:167], v[144:159]
    ds_read_b64_tr_b16 v[198:199], v9 offset:10240
    ds_read_b64_tr_b16 v[200:201], v10 offset:8192
    ds_read_b64_tr_b16 v[202:203], v10 offset:10240
    v_mfma_f32_32x32x16_bf16 v[160:175], v[216:219], a[164:167], v[160:175]
    ds_read_b64_tr_b16 v[204:205], v11 offset:8192
    ds_read_b64_tr_b16 v[206:207], v11 offset:10240
    v_mfma_f32_32x32x16_bf16 v[176:191], v[220:223], a[164:167], v[176:191]
    s_waitcnt lgkmcnt(0)
    v_mfma_f32_32x32x16_bf16 v[128:143], v[192:195], a[168:171], v[128:143]
    ds_read_b64_tr_b16 v[208:209], v8 offset:12288
    ds_read_b64_tr_b16 v[210:211], v8 offset:14336
    ds_read_b64_tr_b16 v[212:213], v9 offset:12288
    v_mfma_f32_32x32x16_bf16 v[144:159], v[196:199], a[168:171], v[144:159]
    ds_read_b64_tr_b16 v[214:215], v9 offset:14336
    ds_read_b64_tr_b16 v[216:217], v10 offset:12288
    ds_read_b64_tr_b16 v[218:219], v10 offset:14336
    v_mfma_f32_32x32x16_bf16 v[160:175], v[200:203], a[168:171], v[160:175]
    ds_read_b64_tr_b16 v[220:221], v11 offset:12288
    ds_read_b64_tr_b16 v[222:223], v11 offset:14336
    v_mfma_f32_32x32x16_bf16 v[176:191], v[204:207], a[168:171], v[176:191]
    s_waitcnt vmcnt(28) lgkmcnt(0)
    v_mfma_f32_32x32x16_bf16 v[128:143], v[208:211], a[172:175], v[128:143]
    ds_read_b64_tr_b16 v[192:193], v8 offset:32768
    ds_read_b64_tr_b16 v[194:195], v8 offset:34816
    ds_read_b64_tr_b16 v[196:197], v9 offset:32768
    v_mfma_f32_32x32x16_bf16 v[144:159], v[212:215], a[172:175], v[144:159]
    ds_read_b64_tr_b16 v[198:199], v9 offset:34816
    ds_read_b64_tr_b16 v[200:201], v10 offset:32768
    ds_read_b64_tr_b16 v[202:203], v10 offset:34816
    v_mfma_f32_32x32x16_bf16 v[160:175], v[216:219], a[172:175], v[160:175]
    ds_read_b64_tr_b16 v[204:205], v11 offset:32768
    ds_read_b64_tr_b16 v[206:207], v11 offset:34816
    v_mfma_f32_32x32x16_bf16 v[176:191], v[220:223], a[172:175], v[176:191]
    s_waitcnt vmcnt(27) lgkmcnt(0)
    v_mfma_f32_32x32x16_bf16 v[128:143], v[192:195], a[176:179], v[128:143]
    ds_read_b64_tr_b16 v[208:209], v8 offset:36864
    ds_read_b64_tr_b16 v[210:211], v8 offset:38912
    ds_read_b64_tr_b16 v[212:213], v9 offset:36864
    s_waitcnt vmcnt(0)
    v_mfma_f32_32x32x16_bf16 v[144:159], v[196:199], a[176:179], v[144:159]
    ds_read_b64_tr_b16 v[214:215], v9 offset:38912
    ds_read_b64_tr_b16 v[216:217], v10 offset:36864
    ds_read_b64_tr_b16 v[218:219], v10 offset:38912
    v_mfma_f32_32x32x16_bf16 v[160:175], v[200:203], a[176:179], v[160:175]
    ds_read_b64_tr_b16 v[220:221], v11 offset:36864
    ds_read_b64_tr_b16 v[222:223], v11 offset:38912
    v_mfma_f32_32x32x16_bf16 v[176:191], v[204:207], a[176:179], v[176:191]
    v_mov_b32 v58, 1
    s_mov_b64 exec, 1
    buffer_store_dword v58, off, s[12:15], s92 sc1
    s_mov_b64 exec, -1
    s_waitcnt lgkmcnt(0)
    v_mfma_f32_32x32x16_bf16 v[128:143], v[208:211], a[180:183], v[128:143]
    ds_read_b64_tr_b16 v[192:193], v8 offset:40960
    ds_read_b64_tr_b16 v[194:195], v8 offset:43008
    ds_read_b64_tr_b16 v[196:197], v9 offset:40960
    v_mfma_f32_32x32x16_bf16 v[144:159], v[212:215], a[180:183], v[144:159]
    ds_read_b64_tr_b16 v[198:199], v9 offset:43008
    ds_read_b64_tr_b16 v[200:201], v10 offset:40960
    ds_read_b64_tr_b16 v[202:203], v10 offset:43008
    v_mfma_f32_32x32x16_bf16 v[160:175], v[216:219], a[180:183], v[160:175]
    ds_read_b64_tr_b16 v[204:205], v11 offset:40960
    ds_read_b64_tr_b16 v[206:207], v11 offset:43008
    v_mfma_f32_32x32x16_bf16 v[176:191], v[220:223], a[180:183], v[176:191]
    s_waitcnt lgkmcnt(0)
    v_mfma_f32_32x32x16_bf16 v[128:143], v[192:195], a[184:187], v[128:143]
    ds_read_b64_tr_b16 v[208:209], v8 offset:45056
    ds_read_b64_tr_b16 v[210:211], v8 offset:47104
    ds_read_b64_tr_b16 v[212:213], v9 offset:45056
    v_mfma_f32_32x32x16_bf16 v[144:159], v[196:199], a[184:187], v[144:159]
    ds_read_b64_tr_b16 v[214:215], v9 offset:47104
    ds_read_b64_tr_b16 v[216:217], v10 offset:45056
    ds_read_b64_tr_b16 v[218:219], v10 offset:47104
    v_mfma_f32_32x32x16_bf16 v[160:175], v[200:203], a[184:187], v[160:175]
    ds_read_b64_tr_b16 v[220:221], v11 offset:45056
    ds_read_b64_tr_b16 v[222:223], v11 offset:47104
    v_mfma_f32_32x32x16_bf16 v[176:191], v[204:207], a[184:187], v[176:191]
    s_waitcnt lgkmcnt(0)
    v_mfma_f32_32x32x16_bf16 v[128:143], v[208:211], a[188:191], v[128:143]
    ds_read_b64_tr_b16 v[192:193], v12 offset:0
    ds_read_b64_tr_b16 v[194:195], v12 offset:2048
    ds_read_b64_tr_b16 v[196:197], v13 offset:0
    v_mfma_f32_32x32x16_bf16 v[144:159], v[212:215], a[188:191], v[144:159]
    ds_read_b64_tr_b16 v[198:199], v13 offset:2048
    ds_read_b64_tr_b16 v[200:201], v14 offset:0
    ds_read_b64_tr_b16 v[202:203], v14 offset:2048
    v_mfma_f32_32x32x16_bf16 v[160:175], v[216:219], a[188:191], v[160:175]
    ds_read_b64_tr_b16 v[204:205], v15 offset:0
    ds_read_b64_tr_b16 v[206:207], v15 offset:2048
    v_mfma_f32_32x32x16_bf16 v[176:191], v[220:223], a[188:191], v[176:191]
    s_waitcnt lgkmcnt(0)
    v_mfma_f32_32x32x16_bf16 v[128:143], v[192:195], a[192:195], v[128:143]
    ds_read_b64_tr_b16 v[208:209], v12 offset:4096
    ds_read_b64_tr_b16 v[210:211], v12 offset:6144
    ds_read_b64_tr_b16 v[212:213], v13 offset:4096
    v_mfma_f32_32x32x16_bf16 v[144:159], v[196:199], a[192:195], v[144:159]
    ds_read_b64_tr_b16 v[214:215], v13 offset:6144
    ds_read_b64_tr_b16 v[216:217], v14 offset:4096
    ds_read_b64_tr_b16 v[218:219], v14 offset:6144
    v_mfma_f32_32x32x16_bf16 v[160:175], v[200:203], a[192:195], v[160:175]
    ds_read_b64_tr_b16 v[220:221], v15 offset:4096
    ds_read_b64_tr_b16 v[222:223], v15 offset:6144
    v_mfma_f32_32x32x16_bf16 v[176:191], v[204:207], a[192:195], v[176:191]
    s_waitcnt lgkmcnt(0)
    v_mfma_f32_32x32x16_bf16 v[128:143], v[208:211], a[196:199], v[128:143]
    ds_read_b64_tr_b16 v[192:193], v12 offset:8192
    ds_read_b64_tr_b16 v[194:195], v12 offset:10240
    ds_read_b64_tr_b16 v[196:197], v13 offset:8192
    v_mfma_f32_32x32x16_bf16 v[144:159], v[212:215], a[196:199], v[144:159]
    ds_read_b64_tr_b16 v[198:199], v13 offset:10240
    ds_read_b64_tr_b16 v[200:201], v14 offset:8192
    ds_read_b64_tr_b16 v[202:203], v14 offset:10240
    v_mfma_f32_32x32x16_bf16 v[160:175], v[216:219], a[196:199], v[160:175]
    ds_read_b64_tr_b16 v[204:205], v15 offset:8192
    ds_read_b64_tr_b16 v[206:207], v15 offset:10240
    v_mfma_f32_32x32x16_bf16 v[176:191], v[220:223], a[196:199], v[176:191]
    s_waitcnt lgkmcnt(0)
    v_mfma_f32_32x32x16_bf16 v[128:143], v[192:195], a[200:203], v[128:143]
    s_barrier
    ds_read_b64_tr_b16 v[208:209], v12 offset:12288
    ds_read_b64_tr_b16 v[210:211], v12 offset:14336
    buffer_load_dword v57, v24, s[12:15], s58 offen sc1
    v_mfma_f32_32x32x16_bf16 v[144:159], v[196:199], a[200:203], v[144:159]
    ds_read_b64_tr_b16 v[212:213], v13 offset:12288
    ds_read_b64_tr_b16 v[214:215], v13 offset:14336
    ds_read_b64_tr_b16 v[216:217], v14 offset:12288
    buffer_load_dwordx4 a[128:131], v2, s[12:15], s30 offen offset:0
    v_mfma_f32_32x32x16_bf16 v[160:175], v[200:203], a[200:203], v[160:175]
    ds_read_b64_tr_b16 v[218:219], v14 offset:14336
    ds_read_b64_tr_b16 v[220:221], v15 offset:12288
    ds_read_b64_tr_b16 v[222:223], v15 offset:14336
    buffer_load_dwordx4 a[132:135], v2, s[12:15], s30 offen offset:1024
    v_mfma_f32_32x32x16_bf16 v[176:191], v[204:207], a[200:203], v[176:191]
    s_waitcnt lgkmcnt(0)
    v_mfma_f32_32x32x16_bf16 v[128:143], v[208:211], a[204:207], v[128:143]
    ds_read_b64_tr_b16 v[192:193], v12 offset:32768
    ds_read_b64_tr_b16 v[194:195], v12 offset:34816
    ds_read_b64_tr_b16 v[196:197], v13 offset:32768
    buffer_load_dwordx4 a[136:139], v2, s[12:15], s30 offen offset:2048
    v_mfma_f32_32x32x16_bf16 v[144:159], v[212:215], a[204:207], v[144:159]
    ds_read_b64_tr_b16 v[198:199], v13 offset:34816
    ds_read_b64_tr_b16 v[200:201], v14 offset:32768
    ds_read_b64_tr_b16 v[202:203], v14 offset:34816
    v_mfma_f32_32x32x16_bf16 v[160:175], v[216:219], a[204:207], v[160:175]
    ds_read_b64_tr_b16 v[204:205], v15 offset:32768
    ds_read_b64_tr_b16 v[206:207], v15 offset:34816
    buffer_load_dwordx4 a[140:143], v2, s[12:15], s30 offen offset:3072
    s_add_u32 s30, s30, 4096
    v_mfma_f32_32x32x16_bf16 v[176:191], v[220:223], a[204:207], v[176:191]
    s_waitcnt lgkmcnt(0)
    v_mfma_f32_32x32x16_bf16 v[128:143], v[192:195], a[208:211], v[128:143]
    ds_read_b64_tr_b16 v[208:209], v12 offset:36864
    ds_read_b64_tr_b16 v[210:211], v12 offset:38912
    ds_read_b64_tr_b16 v[212:213], v13 offset:36864
    buffer_load_dwordx4 a[144:147], v2, s[12:15], s30 offen offset:0
    v_mfma_f32_32x32x16_bf16 v[144:159], v[196:199], a[208:211], v[144:159]
    ds_read_b64_tr_b16 v[214:215], v13 offset:38912
    ds_read_b64_tr_b16 v[216:217], v14 offset:36864
    ds_read_b64_tr_b16 v[218:219], v14 offset:38912
    v_mfma_f32_32x32x16_bf16 v[160:175], v[200:203], a[208:211], v[160:175]
    ds_read_b64_tr_b16 v[220:221], v15 offset:36864
    ds_read_b64_tr_b16 v[222:223], v15 offset:38912
    buffer_load_dwordx4 a[148:151], v2, s[12:15], s30 offen offset:1024
    v_mfma_f32_32x32x16_bf16 v[176:191], v[204:207], a[208:211], v[176:191]
    s_waitcnt lgkmcnt(0)
    v_mfma_f32_32x32x16_bf16 v[128:143], v[208:211], a[212:215], v[128:143]
    ds_read_b64_tr_b16 v[192:193], v12 offset:40960
    ds_read_b64_tr_b16 v[194:195], v12 offset:43008
    ds_read_b64_tr_b16 v[196:197], v13 offset:40960
    buffer_load_dwordx4 a[152:155], v2, s[12:15], s30 offen offset:2048
    v_mfma_f32_32x32x16_bf16 v[144:159], v[212:215], a[212:215], v[144:159]
    ds_read_b64_tr_b16 v[198:199], v13 offset:43008
    ds_read_b64_tr_b16 v[200:201], v14 offset:40960
    ds_read_b64_tr_b16 v[202:203], v14 offset:43008
    v_mfma_f32_32x32x16_bf16 v[160:175], v[216:219], a[212:215], v[160:175]
    ds_read_b64_tr_b16 v[204:205], v15 offset:40960
    ds_read_b64_tr_b16 v[206:207], v15 offset:43008
    buffer_load_dwordx4 a[156:159], v2, s[12:15], s30 offen offset:3072
    s_add_u32 s30, s30, 4096
    v_mfma_f32_32x32x16_bf16 v[176:191], v[220:223], a[212:215], v[176:191]
    s_waitcnt lgkmcnt(0)
    v_mfma_f32_32x32x16_bf16 v[128:143], v[192:195], a[216:219], v[128:143]
    ds_read_b64_tr_b16 v[208:209], v12 offset:45056
    ds_read_b64_tr_b16 v[210:211], v12 offset:47104
    ds_read_b64_tr_b16 v[212:213], v13 offset:45056
    buffer_load_dwordx4 a[160:163], v2, s[12:15], s30 offen offset:0
    v_mfma_f32_32x32x16_bf16 v[144:159], v[196:199], a[216:219], v[144:159]
    ds_read_b64_tr_b16 v[214:215], v13 offset:47104
    ds_read_b64_tr_b16 v[216:217], v14 offset:45056
    ds_read_b64_tr_b16 v[218:219], v14 offset:47104
    v_mfma_f32_32x32x16_bf16 v[160:175], v[200:203], a[216:219], v[160:175]
    ds_read_b64_tr_b16 v[220:221], v15 offset:45056
    ds_read_b64_tr_b16 v[222:223], v15 offset:47104
    buffer_load_dwordx4 a[164:167], v2, s[12:15], s30 offen offset:1024
    v_mfma_f32_32x32x16_bf16 v[176:191], v[204:207], a[216:219], v[176:191]
    s_waitcnt lgkmcnt(0)
    v_mfma_f32_32x32x16_bf16 v[128:143], v[208:211], a[220:223], v[128:143]
    ds_read_b64_tr_b16 v[192:193], v16 offset:0
    ds_read_b64_tr_b16 v[194:195], v16 offset:2048
    ds_read_b64_tr_b16 v[196:197], v17 offset:0
    buffer_load_dwordx4 a[168:171], v2, s[12:15], s30 offen offset:2048
    v_mfma_f32_32x32x16_bf16 v[144:159], v[212:215], a[220:223], v[144:159]
    ds_read_b64_tr_b16 v[198:199], v17 offset:2048
    ds_read_b64_tr_b16 v[200:201], v18 offset:0
    ds_read_b64_tr_b16 v[202:203], v18 offset:2048
    v_mfma_f32_32x32x16_bf16 v[160:175], v[216:219], a[220:223], v[160:175]
    ds_read_b64_tr_b16 v[204:205], v19 offset:0
    ds_read_b64_tr_b16 v[206:207], v19 offset:2048
    buffer_load_dwordx4 a[172:175], v2, s[12:15], s30 offen offset:3072
    s_add_u32 s30, s30, 4096
    v_mfma_f32_32x32x16_bf16 v[176:191], v[220:223], a[220:223], v[176:191]
    s_waitcnt lgkmcnt(0)
    v_mfma_f32_32x32x16_bf16 v[128:143], v[192:195], a[224:227], v[128:143]
    ds_read_b64_tr_b16 v[208:209], v16 offset:4096
    ds_read_b64_tr_b16 v[210:211], v16 offset:6144
    ds_read_b64_tr_b16 v[212:213], v17 offset:4096
    buffer_load_dwordx4 a[176:179], v2, s[12:15], s30 offen offset:0
    v_mfma_f32_32x32x16_bf16 v[144:159], v[196:199], a[224:227], v[144:159]
    ds_read_b64_tr_b16 v[214:215], v17 offset:6144
    ds_read_b64_tr_b16 v[216:217], v18 offset:4096
    ds_read_b64_tr_b16 v[218:219], v18 offset:6144
    v_mfma_f32_32x32x16_bf16 v[160:175], v[200:203], a[224:227], v[160:175]
    ds_read_b64_tr_b16 v[220:221], v19 offset:4096
    ds_read_b64_tr_b16 v[222:223], v19 offset:6144
    s_waitcnt vmcnt(13)
    v_cmp_le_u32 vcc, 1, v57
    s_nop 0
    s_cmp_eq_u64 vcc, -1
    s_cbranch_scc0 TPX0_S
TPX0_R:
    v_mfma_f32_32x32x16_bf16 v[176:191], v[204:207], a[224:227], v[176:191]
    buffer_load_dwordx4 v[96:99], v2, s[12:15], s91 offen offset:0
    buffer_load_dwordx4 v[100:103], v2, s[12:15], s91 offen offset:1024
    s_waitcnt lgkmcnt(0)
    v_mfma_f32_32x32x16_bf16 v[128:143], v[208:211], a[228:231], v[128:143]
    ds_read_b64_tr_b16 v[192:193], v16 offset:8192
    ds_read_b64_tr_b16 v[194:195], v16 offset:10240
    ds_read_b64_tr_b16 v[196:197], v17 offset:8192
    buffer_load_dwordx4 v[104:107], v2, s[12:15], s91 offen offset:2048
    v_mfma_f32_32x32x16_bf16 v[144:159], v[212:215], a[228:231], v[144:159]
    ds_read_b64_tr_b16 v[198:199], v17 offset:10240
    ds_read_b64_tr_b16 v[200:201], v18 offset:8192
    ds_read_b64_tr_b16 v[202:203], v18 offset:10240
    buffer_load_dwordx4 a[180:183], v2, s[12:15], s30 offen offset:1024
    v_mfma_f32_32x32x16_bf16 v[160:175], v[216:219], a[228:231], v[160:175]
    ds_read_b64_tr_b16 v[204:205], v19 offset:8192
    ds_read_b64_tr_b16 v[206:207], v19 offset:10240
    buffer_load_dwordx4 v[108:111], v2, s[12:15], s91 offen offset:3072
    s_add_u32 s91, s91, 4096
    v_mfma_f32_32x32x16_bf16 v[176:191], v[220:223], a[228:231], v[176:191]
    buffer_load_dwordx4 v[112:115], v2, s[12:15], s91 offen offset:0
    buffer_load_dwordx4 v[116:119], v2, s[12:15], s91 offen offset:1024
    s_waitcnt lgkmcnt(0)
    v_mfma_f32_32x32x16_bf16 v[128:143], v[192:195], a[232:235], v[128:143]
    ds_read_b64_tr_b16 v[208:209], v16 offset:12288
    ds_read_b64_tr_b16 v[210:211], v16 offset:14336
    ds_read_b64_tr_b16 v[212:213], v17 offset:12288
    buffer_load_dwordx4 v[120:123], v2, s[12:15], s91 offen offset:2048
    v_mfma_f32_32x32x16_bf16 v[144:159], v[196:199], a[232:235], v[144:159]
    ds_read_b64_tr_b16 v[214:215], v17 offset:14336
    ds_read_b64_tr_b16 v[216:217], v18 offset:12288
    ds_read_b64_tr_b16 v[218:219], v18 offset:14336
    buffer_load_dwordx4 a[184:187], v2, s[12:15], s30 offen offset:2048
    v_mfma_f32_32x32x16_bf16 v[160:175], v[200:203], a[232:235], v[160:175]
    ds_read_b64_tr_b16 v[220:221], v19 offset:12288
    ds_read_b64_tr_b16 v[222:223], v19 offset:14336
    buffer_load_dwordx4 v[124:127], v2, s[12:15], s91 offen offset:3072
    s_add_u32 s91, s91, 8384512
    v_mfma_f32_32x32x16_bf16 v[176:191], v[204:207], a[232:235], v[176:191]
    buffer_load_dwordx4 a[188:191], v2, s[12:15], s30 offen offset:3072
    s_add_u32 s30, s30, 4096
    s_waitcnt lgkmcnt(0)
    v_mfma_f32_32x32x16_bf16 v[128:143], v[208:211], a[236:239], v[128:143]
    ds_read_b64_tr_b16 v[192:193], v16 offset:32768
    ds_read_b64_tr_b16 v[194:195], v16 offset:34816
    ds_read_b64_tr_b16 v[196:197], v17 offset:32768
    v_mfma_f32_32x32x16_bf16 v[144:159], v[212:215], a[236:239], v[144:159]
    ds_read_b64_tr_b16 v[198:199], v17 offset:34816
    ds_read_b64_tr_b16 v[200:201], v18 offset:32768
    ds_read_b64_tr_b16 v[202:203], v18 offset:34816
    v_mfma_f32_32x32x16_bf16 v[160:175], v[216:219], a[236:239], v[160:175]
    ds_read_b64_tr_b16 v[204:205], v19 offset:32768
    ds_read_b64_tr_b16 v[206:207], v19 offset:34816
    v_mfma_f32_32x32x16_bf16 v[176:191], v[220:223], a[236:239], v[176:191]
    s_waitcnt lgkmcnt(0)
    v_mfma_f32_32x32x16_bf16 v[128:143], v[192:195], a[240:243], v[128:143]
    ds_read_b64_tr_b16 v[208:209], v16 offset:36864
    ds_read_b64_tr_b16 v[210:211], v16 offset:38912
    ds_read_b64_tr_b16 v[212:213], v17 offset:36864
    v_mfma_f32_32x32x16_bf16 v[144:159], v[196:199], a[240:243], v[144:159]
    ds_read_b64_tr_b16 v[214:215], v17 offset:38912
    ds_read_b64_tr_b16 v[216:217], v18 offset:36864
    ds_read_b64_tr_b16 v[218:219], v18 offset:38912
    v_mfma_f32_32x32x16_bf16 v[160:175], v[200:203], a[240:243], v[160:175]
    ds_read_b64_tr_b16 v[220:221], v19 offset:36864
    ds_read_b64_tr_b16 v[222:223], v19 offset:38912
    v_mfma_f32_32x32x16_bf16 v[176:191], v[204:207], a[240:243], v[176:191]
    s_waitcnt lgkmcnt(0)
    v_mfma_f32_32x32x16_bf16 v[128:143], v[208:211], a[244:247], v[128:143]
    ds_read_b64_tr_b16 v[192:193], v16 offset:40960
    ds_read_b64_tr_b16 v[194:195], v16 offset:43008
    ds_read_b64_tr_b16 v[196:197], v17 offset:40960
    v_mfma_f32_32x32x16_bf16 v[144:159], v[212:215], a[244:247], v[144:159]
    ds_read_b64_tr_b16 v[198:199], v17 offset:43008
    ds_read_b64_tr_b16 v[200:201], v18 offset:40960
    ds_read_b64_tr_b16 v[202:203], v18 offset:43008
    v_mfma_f32_32x32x16_bf16 v[160:175], v[216:219], a[244:247], v[160:175]
    ds_read_b64_tr_b16 v[204:205], v19 offset:40960
    ds_read_b64_tr_b16 v[206:207], v19 offset:43008
    v_mfma_f32_32x32x16_bf16 v[176:191], v[220:223], a[244:247], v[176:191]
    s_waitcnt lgkmcnt(0)
    v_mfma_f32_32x32x16_bf16 v[128:143], v[192:195], a[248:251], v[128:143]
    ds_read_b64_tr_b16 v[208:209], v16 offset:45056
    ds_read_b64_tr_b16 v[210:211], v16 offset:47104
    ds_read_b64_tr_b16 v[212:213], v17 offset:45056
    v_add_f32 v48, 1.0, v48
    v_mfma_f32_32x32x16_bf16 v[144:159], v[196:199], a[248:251], v[144:159]
    ds_read_b64_tr_b16 v[214:215], v17 offset:47104
    ds_read_b64_tr_b16 v[216:217], v18 offset:45056
    ds_read_b64_tr_b16 v[218:219], v18 offset:47104
    v_add_f32 v49, 1.0, v49
    v_add_f32 v50, 1.0, v50
    v_mfma_f32_32x32x16_bf16 v[160:175], v[200:203], a[248:251], v[160:175]
    ds_read_b64_tr_b16 v[220:221], v19 offset:45056
    ds_read_b64_tr_b16 v[222:223], v19 offset:47104
    v_add_f32 v51, 1.0, v51
    v_add_f32 v52, 1.0, v52
    v_add_f32 v53, 1.0, v53
    v_mfma_f32_32x32x16_bf16 v[176:191], v[204:207], a[248:251], v[176:191]
    v_add_f32 v54, 1.0, v54
    v_add_f32 v55, 1.0, v55
    v_cvt_pk_bf16_f32 v59, v48, v49
    v_lshlrev_b32 v48, 16, v59
    v_and_b32 v49, 0xffff0000, v59
    s_waitcnt lgkmcnt(0)
    v_mfma_f32_32x32x16_bf16 v[128:143], v[208:211], a[252:255], v[128:143]
    v_cvt_pk_bf16_f32 v59, v50, v51
    v_lshlrev_b32 v50, 16, v59
    v_and_b32 v51, 0xffff0000, v59
    v_cvt_pk_bf16_f32 v59, v52, v53
    v_lshlrev_b32 v52, 16, v59
    v_mfma_f32_32x32x16_bf16 v[144:159], v[212:215], a[252:255], v[144:159]
    v_and_b32 v53, 0xffff0000, v59
    v_cvt_pk_bf16_f32 v59, v54, v55
    v_lshlrev_b32 v54, 16, v59
    v_and_b32 v55, 0xffff0000, v59
    v_lshlrev_b32 v72, 16, v32
    v_mfma_f32_32x32x16_bf16 v[160:175], v[216:219], a[252:255], v[160:175]
    v_and_b32 v73, 0xffff0000, v32
    v_lshlrev_b32 v74, 16, v33
    v_and_b32 v75, 0xffff0000, v33
    v_lshlrev_b32 v76, 16, v34
    v_and_b32 v77, 0xffff0000, v34
    v_mfma_f32_32x32x16_bf16 v[176:191], v[220:223], a[252:255], v[176:191]
    v_lshlrev_b32 v78, 16, v35
    v_and_b32 v79, 0xffff0000, v35
    s_waitcnt vmcnt(10)
    v_lshlrev_b32 v64, 16, v96
    v_and_b32 v65, 0xffff0000, v96
    s_nop 6
    v_cvt_pk_bf16_f32 v128, v128, v129
    v_cvt_pk_bf16_f32 v129, v130, v131
    v_cvt_pk_bf16_f32 v130, v132, v133
    v_cvt_pk_bf16_f32 v131, v134, v135
    buffer_store_dwordx4 v[128:131], v2, s[12:15], s84 offen sc1
    s_add_u32 s84, s84, 32768
    v_cvt_pk_bf16_f32 v136, v136, v137
    v_cvt_pk_bf16_f32 v137, v138, v139
    v_cvt_pk_bf16_f32 v138, v140, v141
    v_cvt_pk_bf16_f32 v139, v142, v143
    buffer_store_dwordx4 v[136:139], v2, s[12:15], s84 offen sc1
    s_add_u32 s84, s84, 32768
    v_cvt_pk_bf16_f32 v144, v144, v145
    v_cvt_pk_bf16_f32 v145, v146, v147
    v_cvt_pk_bf16_f32 v146, v148, v149
    v_cvt_pk_bf16_f32 v147, v150, v151
    buffer_store_dwordx4 v[144:147], v2, s[12:15], s84 offen sc1
    s_add_u32 s84, s84, 32768
    v_cvt_pk_bf16_f32 v152, v152, v153
    v_cvt_pk_bf16_f32 v153, v154, v155
    v_cvt_pk_bf16_f32 v154, v156, v157
    v_cvt_pk_bf16_f32 v155, v158, v159
    buffer_store_dwordx4 v[152:155], v2, s[12:15], s84 offen sc1
    s_add_u32 s84, s84, 32768
    v_cvt_pk_bf16_f32 v160, v160, v161
    v_cvt_pk_bf16_f32 v161, v162, v163
    v_cvt_pk_bf16_f32 v162, v164, v165
    v_cvt_pk_bf16_f32 v163, v166, v167
    buffer_store_dwordx4 v[160:163], v2, s[12:15], s84 offen sc1
    s_add_u32 s84, s84, 32768
    v_cvt_pk_bf16_f32 v168, v168, v169
    v_cvt_pk_bf16_f32 v169, v170, v171
    v_cvt_pk_bf16_f32 v170, v172, v173
    v_cvt_pk_bf16_f32 v171, v174, v175
    buffer_store_dwordx4 v[168:171], v2, s[12:15], s84 offen sc1
    s_add_u32 s84, s84, 32768
    v_cvt_pk_bf16_f32 v176, v176, v177
    v_cvt_pk_bf16_f32 v177, v178, v179
    v_cvt_pk_bf16_f32 v178, v180, v181
    v_cvt_pk_bf16_f32 v179, v182, v183
    buffer_store_dwordx4 v[176:179], v2, s[12:15], s84 offen sc1
    s_add_u32 s84, s84, 32768
    v_cvt_pk_bf16_f32 v184, v184, v185
    v_cvt_pk_bf16_f32 v185, v186, v187
    v_cvt_pk_bf16_f32 v186, v188, v189
    v_cvt_pk_bf16_f32 v187, v190, v191
    buffer_store_dwordx4 v[184:187], v2, s[12:15], s84 offen sc1
    s_add_u32 s84, s84, 8159232
    v_lshlrev_b32 v66, 16, v97
    v_and_b32 v67, 0xffff0000, v97
    v_lshlrev_b32 v68, 16, v98
    v_and_b32 v69, 0xffff0000, v98
    v_lshlrev_b32 v70, 16, v99
    v_and_b32 v71, 0xffff0000, v99
    s_waitcnt vmcnt(17)
    v_lshlrev_b32 v80, 16, v100
    v_and_b32 v81, 0xffff0000, v100
    v_lshlrev_b32 v82, 16, v101
    v_and_b32 v83, 0xffff0000, v101
    v_lshlrev_b32 v84, 16, v102
    v_and_b32 v85, 0xffff0000, v102
    v_lshlrev_b32 v86, 16, v103
    v_and_b32 v87, 0xffff0000, v103
    v_add_f32 v64, v64, v80
    v_add_f32 v65, v65, v81
    v_add_f32 v66, v66, v82
    v_add_f32 v67, v67, v83
    v_add_f32 v68, v68, v84
    v_add_f32 v69, v69, v85
    v_add_f32 v70, v70, v86
    v_add_f32 v71, v71, v87
    s_waitcnt vmcnt(16)
    v_lshlrev_b32 v80, 16, v104
    v_and_b32 v81, 0xffff0000, v104
    v_lshlrev_b32 v82, 16, v105
    v_and_b32 v83, 0xffff0000, v105
    v_lshlrev_b32 v84, 16, v106
    v_and_b32 v85, 0xffff0000, v106
    v_lshlrev_b32 v86, 16, v107
    v_and_b32 v87, 0xffff0000, v107
    v_add_f32 v64, v64, v80
    v_add_f32 v65, v65, v81
    v_add_f32 v66, v66, v82
    v_add_f32 v67, v67, v83
    v_add_f32 v68, v68, v84
    v_add_f32 v69, v69, v85
    v_add_f32 v70, v70, v86
    v_add_f32 v71, v71, v87
    s_waitcnt vmcnt(14)
    v_lshlrev_b32 v80, 16, v108
    v_and_b32 v81, 0xffff0000, v108
    v_lshlrev_b32 v82, 16, v109
    v_and_b32 v83, 0xffff0000, v109
    v_lshlrev_b32 v84, 16, v110
    v_and_b32 v85, 0xffff0000, v110
    v_lshlrev_b32 v86, 16, v111
    v_and_b32 v87, 0xffff0000, v111
    v_add_f32 v64, v64, v80
    v_add_f32 v65, v65, v81
    v_add_f32 v66, v66, v82
    v_add_f32 v67, v67, v83
    v_add_f32 v68, v68, v84
    v_add_f32 v69, v69, v85
    v_add_f32 v70, v70, v86
    v_add_f32 v71, v71, v87
    s_waitcnt vmcnt(13)
    v_lshlrev_b32 v80, 16, v112
    v_and_b32 v81, 0xffff0000, v112
    v_lshlrev_b32 v82, 16, v113
    v_and_b32 v83, 0xffff0000, v113
    v_lshlrev_b32 v84, 16, v114
    v_and_b32 v85, 0xffff0000, v114
    v_lshlrev_b32 v86, 16, v115
    v_and_b32 v87, 0xffff0000, v115
    v_add_f32 v64, v64, v80
    v_add_f32 v65, v65, v81
    v_add_f32 v66, v66, v82
    v_add_f32 v67, v67, v83
    v_add_f32 v68, v68, v84
    v_add_f32 v69, v69, v85
    v_add_f32 v70, v70, v86
    v_add_f32 v71, v71, v87
    s_waitcnt vmcnt(12)
    v_lshlrev_b32 v80, 16, v116
    v_and_b32 v81, 0xffff0000, v116
    v_lshlrev_b32 v82, 16, v117
    v_and_b32 v83, 0xffff0000, v117
    v_lshlrev_b32 v84, 16, v118
    v_and_b32 v85, 0xffff0000, v118
    v_lshlrev_b32 v86, 16, v119
    v_and_b32 v87, 0xffff0000, v119
    v_add_f32 v64, v64, v80
    v_add_f32 v65, v65, v81
    v_add_f32 v66, v66, v82
    v_add_f32 v67, v67, v83
    v_add_f32 v68, v68, v84
    v_add_f32 v69, v69, v85
    v_add_f32 v70, v70, v86
    v_add_f32 v71, v71, v87
    s_waitcnt vmcnt(11)
    v_lshlrev_b32 v80, 16, v120
    v_and_b32 v81, 0xffff0000, v120
    v_lshlrev_b32 v82, 16, v121
    v_and_b32 v83, 0xffff0000, v121
    v_lshlrev_b32 v84, 16, v122
    v_and_b32 v85, 0xffff0000, v122
    v_lshlrev_b32 v86, 16, v123
    v_and_b32 v87, 0xffff0000, v123
    v_add_f32 v64, v64, v80
    v_add_f32 v65, v65, v81
    v_add_f32 v66, v66, v82
    v_add_f32 v67, v67, v83
    v_add_f32 v68, v68, v84
    v_add_f32 v69, v69, v85
    v_add_f32 v70, v70, v86
    v_add_f32 v71, v71, v87
    s_waitcnt vmcnt(9)
    v_lshlrev_b32 v80, 16, v124
    v_and_b32 v81, 0xffff0000, v124
    v_lshlrev_b32 v82, 16, v125
    v_and_b32 v83, 0xffff0000, v125
    v_lshlrev_b32 v84, 16, v126
    v_and_b32 v85, 0xffff0000, v126
    v_lshlrev_b32 v86, 16, v127
    v_and_b32 v87, 0xffff0000, v127
    v_add_f32 v64, v64, v80
    v_add_f32 v65, v65, v81
    v_add_f32 v66, v66, v82
    v_add_f32 v67, v67, v83
    v_add_f32 v68, v68, v84
    v_add_f32 v69, v69, v85
    v_add_f32 v70, v70, v86
    v_add_f32 v71, v71, v87
    v_fma_f32 v64, v64, v40, v72
    v_fma_f32 v65, v65, v41, v73
    v_fma_f32 v66, v66, v42, v74
    v_fma_f32 v67, v67, v43, v75
    v_fma_f32 v68, v68, v44, v76
    v_fma_f32 v69, v69, v45, v77
    v_fma_f32 v70, v70, v46, v78
    v_fma_f32 v71, v71, v47, v79
    v_cvt_pk_bf16_f32 v80, v64, v65
    v_cvt_pk_bf16_f32 v81, v66, v67
    v_cvt_pk_bf16_f32 v82, v68, v69
    v_cvt_pk_bf16_f32 v83, v70, v71
    v_lshlrev_b32 v64, 16, v80
    v_and_b32 v65, 0xffff0000, v80
    v_lshlrev_b32 v66, 16, v81
    v_and_b32 v67, 0xffff0000, v81
    v_lshlrev_b32 v68, 16, v82
    v_and_b32 v69, 0xffff0000, v82
    v_lshlrev_b32 v70, 16, v83
    v_and_b32 v71, 0xffff0000, v83
    v_mul_f32 v72, v64, v48
    v_mul_f32 v73, v65, v49
    v_mul_f32 v74, v66, v50
    v_mul_f32 v75, v67, v51
    v_mul_f32 v76, v68, v52
    v_mul_f32 v77, v69, v53
    v_mul_f32 v78, v70, v54
    v_mul_f32 v79, v71, v55
    v_cvt_pk_bf16_f32 v84, v72, v73
    v_cvt_pk_bf16_f32 v85, v74, v75
    v_cvt_pk_bf16_f32 v86, v76, v77
    v_cvt_pk_bf16_f32 v87, v78, v79
    buffer_store_dwordx4 v[84:87], v26, s[12:15], s95 offen
    v_add_f32 v88, v64, v65
    v_mul_f32 v89, v64, v64
    v_add_f32 v90, v66, v67
    v_mul_f32 v91, v65, v65
    v_fmac_f32 v89, v66, v66
    v_fmac_f32 v91, v67, v67
    v_fmac_f32 v89, v68, v68
    v_fmac_f32 v91, v69, v69
    v_fmac_f32 v89, v70, v70
    v_fmac_f32 v91, v71, v71
    v_add_f32 v88, v88, v68
    v_add_f32 v90, v90, v69
    v_add_f32 v88, v88, v70
    v_add_f32 v90, v90, v71
    v_add_f32 v88, v88, v90
    v_add_f32 v89, v89, v91
    v_mov_b32 v90, v88
    v_mov_b32 v91, v89
    s_nop 0
    v_permlane32_swap_b32 v88, v90
    v_permlane32_swap_b32 v89, v91
    v_add_f32 v88, v88, v90
    v_add_f32 v89, v89, v91
    buffer_store_dwordx2 v[88:89], v27, s[12:15], s97 offen
    buffer_store_dwordx4 v[80:83], v2, s[12:15], s96 offen
    s_lshl_b32 s34, s42, 2
    s_add_u32 s70, s34, s46
    s_sub_u32 s71, 60, s34
    s_add_u32 s71, s71, s46
    s_lshl_b32 s34, s70, 2
    s_add_u32 s34, s34, s55
    s_lshl_b32 s34, s34, 16
    s_add_u32 s34, s34, 109051904
    s_lshr_b32 s38, s55, 1
    s_lshl_b32 s38, s38, 10
    s_add_u32 s31, s34, s38
    s_xor_b32 s33, s31, 1024
    v_add_u32 v18, 131072, v2
    buffer_load_dwordx4 a[192:195], v2, s[12:15], s31 offen offset:0
    buffer_load_dwordx4 a[196:199], v2, s[12:15], s33 offen offset:0
    buffer_load_dwordx4 a[200:203], v2, s[12:15], s31 offen offset:2048
    buffer_load_dwordx4 a[204:207], v2, s[12:15], s33 offen offset:2048
    s_add_u32 s31, s31, 4096
    s_add_u32 s33, s33, 4096
    buffer_load_dwordx4 a[208:211], v2, s[12:15], s31 offen offset:0
    buffer_load_dwordx4 a[212:215], v2, s[12:15], s33 offen offset:0
    buffer_load_dwordx4 a[216:219], v2, s[12:15], s31 offen offset:2048
    buffer_load_dwordx4 a[220:223], v2, s[12:15], s33 offen offset:2048
    s_add_u32 s31, s31, 4096
    s_add_u32 s33, s33, 4096
    ds_read_b128 v[192:195], v18 offset:0
    ds_read_b128 v[196:199], v18 offset:1024
    ds_read_b128 v[200:203], v18 offset:2048
    ds_read_b128 v[204:207], v18 offset:3072
    s_lshl_b32 s34, s46, 7
    s_lshl_b32 s38, s55, 5
    s_add_u32 s34, s34, s38
    s_add_u32 s34, s34, s80
    s_add_u32 s28, s34, 18432
    s_lshl_b32 s34, s46, 19
    s_add_u32 s49, s34, s49
    s_add_u32 s29, s49, s36
    s_add_u32 s29, s29, 229376
    s_lshl_b32 s34, s55, 11
    s_add_u32 s34, s34, s49
    s_add_u32 s30, s34, 180224
    s_mov_b32 s44, 0xc0135761
    v_mov_b32 v60, 0xbdd2d3e8
    v_add_u32 v16, s62, v2
    v_add_u32 v17, s63, v2
    v_lshlrev_b32 v19, 5, v1
    s_cmp_ge_u32 s55, 2
    s_cbranch_scc1 TL_WB
    s_waitcnt lgkmcnt(3)
    v_mfma_f32_16x16x32_bf16 v[4:7], v[192:195], a[0:3], 0
    ds_read_b128 v[208:211], v18 offset:4096
    s_lshl_b32 s34, s55, 8
    s_add_u32 s34, s34, 131072
    v_lshrrev_b32 v56, 1, v1
    v_mfma_f32_16x16x32_bf16 v[8:11], v[192:195], a[64:67], 0
    v_lshl_add_u32 v22, v56, 3, s34
    v_lshlrev_b32 v23, 3, v20
    v_add_u32 v23, 131072, v23
    v_mfma_f32_16x16x32_bf16 v[12:15], a[128:131], v[192:195], 0
    v_bfe_u32 v56, v1, 2, 1
    v_lshlrev_b32 v56, 7, v56
    v_lshrrev_b32 v59, 4, v1
    s_waitcnt lgkmcnt(3)
    v_mfma_f32_16x16x32_bf16 v[4:7], v[196:199], a[4:7], v[4:7]
    ds_read_b128 v[212:215], v18 offset:5120
    v_lshl_add_u32 v56, v59, 5, v56
    v_and_b32 v30, 3, v1
    v_mfma_f32_16x16x32_bf16 v[8:11], v[196:199], a[68:71], v[8:11]
    v_lshl_add_u32 v56, v30, 3, v56
    v_bfe_u32 v30, v1, 3, 1
    v_lshl_add_u32 v56, v30, 2, v56
    v_mfma_f32_16x16x32_bf16 v[12:15], a[132:135], v[196:199], v[12:15]
    v_add_u32 v30, s34, v56
    s_lshl_b32 s34, s55, 9
    s_add_u32 s34, s34, 131072
    v_lshl_add_u32 v25, v20, 2, s34
    s_waitcnt lgkmcnt(3)
    v_mfma_f32_16x16x32_bf16 v[4:7], v[200:203], a[8:11], v[4:7]
    ds_read_b128 v[216:219], v18 offset:6144
    s_waitcnt vmcnt(11)
    v_mov_b32 v58, 2
    s_mov_b64 exec, 1
    buffer_store_dword v58, off, s[12:15], s92 sc1
    s_mov_b64 exec, -1
    v_mfma_f32_16x16x32_bf16 v[8:11], v[200:203], a[72:75], v[8:11]
    v_lshl_add_u32 v28, v59, 4, s34
    v_and_b32 v56, 15, v1
    v_mul_u32_u24 v29, 200, v56
    v_mfma_f32_16x16x32_bf16 v[12:15], a[136:139], v[200:203], v[12:15]
    v_lshl_add_u32 v29, v59, 3, v29
    v_lshl_add_u32 v31, v21, 5, v27
    v_mul_u32_u24 v3, 3072, v21
    s_waitcnt lgkmcnt(3)
    v_mfma_f32_16x16x32_bf16 v[4:7], v[204:207], a[12:15], v[4:7]
    ds_read_b128 v[220:223], v18 offset:7168
    v_bfe_u32 v59, v1, 4, 1
    v_lshl_add_u32 v3, v59, 9, v3
    v_mfma_f32_16x16x32_bf16 v[8:11], v[204:207], a[76:79], v[8:11]
    v_lshl_add_u32 v3, v56, 4, v3
    s_mov_b32 s52, 0xcccccccc
    s_mov_b32 s53, 0xcccccccc
    s_mov_b32 s60, 0xaaaaaaaa
    s_mov_b32 s61, 0xaaaaaaaa
    v_mfma_f32_16x16x32_bf16 v[12:15], a[140:143], v[204:207], v[12:15]
    s_lshl_b32 s34, s55, 3
    s_mov_b64 s[66:67], 0xff
    s_lshl_b64 s[66:67], s[66:67], s34
    s_lshl_b32 s34, s55, 5
    s_add_u32 s34, s34, 131072
    s_waitcnt lgkmcnt(3)
    v_mfma_f32_16x16x32_bf16 v[4:7], v[208:211], a[16:19], v[4:7]
    ds_read_b128 v[192:195], v18 offset:8192
    v_add_u32 v29, s34, v29
    s_lshl_b32 s34, s55, 10
    v_mfma_f32_16x16x32_bf16 v[8:11], v[208:211], a[80:83], v[8:11]
    v_add_u32 v3, s34, v3
    v_add_u32 v0, 256, v3
    s_lshl_b32 s50, s46, 11
    s_add_u32 s50, s50, s80
    v_mfma_f32_16x16x32_bf16 v[12:15], a[144:147], v[208:211], v[12:15]
    s_add_u32 s50, s50, 0
    s_lshl_b32 s45, s43, 3
    s_add_u32 s45, s45, s50
    s_lshl_b32 s34, s43, 6
    s_add_u32 s34, s34, s70
    s_lshl_b32 s59, s34, 4
    s_waitcnt lgkmcnt(3)
    v_mfma_f32_16x16x32_bf16 v[4:7], v[212:215], a[20:23], v[4:7]
    ds_read_b128 v[196:199], v18 offset:9216
    s_mul_i32 s34, s34, 6144
    s_add_u32 s54, s34, 75497472
    s_lshl_b32 s34, s55, 2
    s_add_u32 s59, s59, s34
    v_mfma_f32_16x16x32_bf16 v[8:11], v[212:215], a[84:87], v[8:11]
    s_add_u32 s59, s59, 434176
    v_mfma_f32_16x16x32_bf16 v[12:15], a[148:151], v[212:215], v[12:15]
    s_waitcnt lgkmcnt(3)
    v_mfma_f32_16x16x32_bf16 v[4:7], v[216:219], a[24:27], v[4:7]
    ds_read_b128 v[200:203], v18 offset:10240
    v_mfma_f32_16x16x32_bf16 v[8:11], v[216:219], a[88:91], v[8:11]
    v_mfma_f32_16x16x32_bf16 v[12:15], a[152:155], v[216:219], v[12:15]
    s_waitcnt vmcnt(10)
    s_cmp_eq_u32 s8, 0
    s_cbranch_scc1 TL_LF_11
    v_mov_b32 v58, 1
    s_mov_b64 exec, 1
    buffer_store_dword v58, off, s[12:15], s98
    s_mov_b64 exec, -1
TL_LF_11_R:
    s_add_u32 s95, s95, 16777216
    s_add_u32 s96, s96, 16777216
    s_add_u32 s97, s97, 16777216
    s_waitcnt lgkmcnt(3)
    v_mfma_f32_16x16x32_bf16 v[4:7], v[220:223], a[28:31], v[4:7]
    ds_read_b128 v[204:207], v18 offset:11264
    v_mfma_f32_16x16x32_bf16 v[8:11], v[220:223], a[92:95], v[8:11]
    v_mfma_f32_16x16x32_bf16 v[12:15], a[156:159], v[220:223], v[12:15]
    s_waitcnt lgkmcnt(3)
    v_mfma_f32_16x16x32_bf16 v[4:7], v[192:195], a[32:35], v[4:7]
    ds_read_b128 v[208:211], v18 offset:12288
    v_mfma_f32_16x16x32_bf16 v[8:11], v[192:195], a[96:99], v[8:11]
    v_mfma_f32_16x16x32_bf16 v[12:15], a[160:163], v[192:195], v[12:15]
    s_waitcnt lgkmcnt(3)
    v_mfma_f32_16x16x32_bf16 v[4:7], v[196:199], a[36:39], v[4:7]
    ds_read_b128 v[212:215], v18 offset:13312
    v_mfma_f32_16x16x32_bf16 v[8:11], v[196:199], a[100:103], v[8:11]
    v_mfma_f32_16x16x32_bf16 v[12:15], a[164:167], v[196:199], v[12:15]
    s_waitcnt lgkmcnt(3)
    v_mfma_f32_16x16x32_bf16 v[4:7], v[200:203], a[40:43], v[4:7]
    ds_read_b128 v[216:219], v18 offset:14336
    v_mfma_f32_16x16x32_bf16 v[8:11], v[200:203], a[104:107], v[8:11]
    v_mfma_f32_16x16x32_bf16 v[12:15], a[168:171], v[200:203], v[12:15]
    s_waitcnt lgkmcnt(3)
    v_mfma_f32_16x16x32_bf16 v[4:7], v[204:207], a[44:47], v[4:7]
    ds_read_b128 v[220:223], v18 offset:15360
    v_mfma_f32_16x16x32_bf16 v[8:11], v[204:207], a[108:111], v[8:11]
    v_mfma_f32_16x16x32_bf16 v[12:15], a[172:175], v[204:207], v[12:15]
    s_waitcnt lgkmcnt(3)
    v_mfma_f32_16x16x32_bf16 v[4:7], v[208:211], a[48:51], v[4:7]
    v_mfma_f32_16x16x32_bf16 v[8:11], v[208:211], a[112:115], v[8:11]
    v_mfma_f32_16x16x32_bf16 v[12:15], a[176:179], v[208:211], v[12:15]
    s_waitcnt lgkmcnt(2)
    v_mfma_f32_16x16x32_bf16 v[4:7], v[212:215], a[52:55], v[4:7]
    v_mfma_f32_16x16x32_bf16 v[8:11], v[212:215], a[116:119], v[8:11]
    buffer_load_dword v57, v24, s[12:15], s28 offen sc1
    v_mfma_f32_16x16x32_bf16 v[12:15], a[180:183], v[212:215], v[12:15]
    s_waitcnt lgkmcnt(1)
    v_mfma_f32_16x16x32_bf16 v[4:7], v[216:219], a[56:59], v[4:7]
    v_mfma_f32_16x16x32_bf16 v[8:11], v[216:219], a[120:123], v[8:11]
    v_mfma_f32_16x16x32_bf16 v[12:15], a[184:187], v[216:219], v[12:15]
    s_waitcnt lgkmcnt(0)
    v_mfma_f32_16x16x32_bf16 v[4:7], v[220:223], a[60:63], v[4:7]
    v_mfma_f32_16x16x32_bf16 v[8:11], v[220:223], a[124:127], v[8:11]
    v_mfma_f32_16x16x32_bf16 v[12:15], a[188:191], v[220:223], v[12:15]
    s_nop 7
    v_mov_b32_dpp v64, v12 row_newbcast:0 row_mask:0xf bank_mask:0xf
    v_mov_b32_dpp v68, v12 row_newbcast:1 row_mask:0xf bank_mask:0xf
    v_mov_b32_dpp v65, v13 row_newbcast:0 row_mask:0xf bank_mask:0xf
    v_mov_b32_dpp v69, v13 row_newbcast:1 row_mask:0xf bank_mask:0xf
    v_mov_b32_dpp v66, v14 row_newbcast:0 row_mask:0xf bank_mask:0xf
    v_mov_b32_dpp v70, v14 row_newbcast:1 row_mask:0xf bank_mask:0xf
    v_mov_b32_dpp v67, v15 row_newbcast:0 row_mask:0xf bank_mask:0xf
    v_mov_b32_dpp v71, v15 row_newbcast:1 row_mask:0xf bank_mask:0xf
    s_waitcnt vmcnt(0)
    v_cmp_le_u32 vcc, 1, v57
    s_nop 0
    s_cmp_eq_u64 vcc, -1
    s_cbranch_scc0 TAX2L_S
TAX2L_R:
    s_add_u32 s38, s62, s36
    s_add_u32 m0, s38, 0
    s_nop 0
    buffer_load_dwordx4 v2, s[12:15], s29 offen offset:0 sc1 lds
    buffer_load_dwordx4 v2, s[12:15], s29 offen offset:1024 sc1 lds
    buffer_load_dwordx4 v2, s[12:15], s29 offen offset:2048 sc1 lds
    buffer_load_dwordx4 v2, s[12:15], s29 offen offset:3072 sc1 lds
    s_add_u32 s29, s29, 16384
    buffer_load_dwordx4 v[224:227], v19, s[12:15], s30 offen sc1
    buffer_load_dwordx4 v[228:231], v19, s[12:15], s30 offen offset:16 sc1
    s_add_u32 s30, s30, 16777216
    s_add_u32 m0, s38, 32768
    s_nop 0
    buffer_load_dwordx4 v2, s[12:15], s29 offen offset:0 sc1 lds
    buffer_load_dwordx4 v2, s[12:15], s29 offen offset:1024 sc1 lds
    buffer_load_dwordx4 v2, s[12:15], s29 offen offset:2048 sc1 lds
    buffer_load_dwordx4 v2, s[12:15], s29 offen offset:3072 sc1 lds
    s_add_u32 s29, s29, 16760832
    s_waitcnt vmcnt(4)
    v_add_f32 v224, v224, v226
    v_add_f32 v225, v225, v227
    v_add_f32 v228, v228, v230
    v_add_f32 v229, v229, v231
    v_add_f32 v224, v224, v228
    v_add_f32 v225, v225, v229
    s_nop 0
    v_add_f32_dpp v226, v224, v224 quad_perm:[1,0,3,2] row_mask:0xf bank_mask:0xf
    v_add_f32_dpp v227, v225, v225 quad_perm:[1,0,3,2] row_mask:0xf bank_mask:0xf
    ds_write_b64 v22, v[226:227] offset:16384
    buffer_load_dword v57, v24, s[12:15], s58 offen sc1
    s_waitcnt vmcnt(1) lgkmcnt(0)
    s_barrier
    ds_read_b128 v[192:195], v16 offset:0
    ds_read_b128 v[196:199], v16 offset:1024
    ds_read_b128 v[200:203], v16 offset:2048
    ds_read_b128 v[204:207], v16 offset:3072
    s_waitcnt lgkmcnt(3)
    v_mfma_f32_16x16x32_bf16 v[100:103], v[192:195], a[0:3], 0
    ds_read_b64 v[224:225], v23 offset:16384
    ds_read_b64 v[226:227], v23 offset:16640
    ds_read_b64 v[228:229], v23 offset:16896
    v_mfma_f32_16x16x32_bf16 v[108:111], v[192:195], a[64:67], 0
    ds_read_b64 v[230:231], v23 offset:17152
    v_mfma_f32_16x16x32_bf16 v[116:119], a[128:131], v[192:195], 0
    ds_read_b128 v[208:211], v16 offset:4096
    s_waitcnt lgkmcnt(7)
    v_mfma_f32_16x16x32_bf16 v[100:103], v[196:199], a[4:7], v[100:103]
    v_mfma_f32_16x16x32_bf16 v[108:111], v[196:199], a[68:71], v[108:111]
    s_waitcnt vmcnt(0)
    v_cmp_le_u32 vcc, 2, v57
    s_nop 0
    s_cmp_eq_u64 vcc, -1
    s_cbranch_scc0 TAPX1_S
TAPX1_R:
    v_mfma_f32_16x16x32_bf16 v[116:119], a[132:135], v[196:199], v[116:119]
    ds_read_b128 v[212:215], v16 offset:5120
    s_waitcnt lgkmcnt(7)
    v_mfma_f32_16x16x32_bf16 v[100:103], v[200:203], a[8:11], v[100:103]
    s_waitcnt lgkmcnt(2)
    v_add_f32 v224, v224, v226
    v_add_f32 v225, v225, v227
    v_mfma_f32_16x16x32_bf16 v[108:111], v[200:203], a[72:75], v[108:111]
    v_add_f32 v228, v228, v230
    v_add_f32 v229, v229, v231
    v_add_f32 v224, v224, v228
    v_mfma_f32_16x16x32_bf16 v[116:119], a[136:139], v[200:203], v[116:119]
    ds_read_b128 v[216:219], v16 offset:6144
    v_add_f32 v225, v225, v229
    v_mul_f32 v96, 0xbb000000, v224
    v_mfma_f32_16x16x32_bf16 v[100:103], v[204:207], a[12:15], v[100:103]
    v_mul_f32 v225, 0x3b000000, v225
    v_fma_f32 v225, -v96, v96, v225
    v_max_f32 v225, 0, v225
    v_mfma_f32_16x16x32_bf16 v[108:111], v[204:207], a[76:79], v[108:111]
    v_add_f32 v225, 0x3727c5ac, v225
    v_rsq_f32 v97, v225
    v_mfma_f32_16x16x32_bf16 v[116:119], a[140:143], v[204:207], v[116:119]
    ds_read_b128 v[220:223], v16 offset:7168
    ds_write_b32 v25, v96 offset:20480
    ds_write_b32 v25, v97 offset:20736
    s_waitcnt lgkmcnt(5)
    v_mfma_f32_16x16x32_bf16 v[100:103], v[208:211], a[16:19], v[100:103]
    v_mov_b32 v98, v96
    v_mov_b32 v99, v97
    v_mfma_f32_16x16x32_bf16 v[108:111], v[208:211], a[80:83], v[108:111]
    buffer_load_dwordx4 v[160:163], v2, s[12:15], s91 offen offset:0
    v_mfma_f32_16x16x32_bf16 v[116:119], a[144:147], v[208:211], v[116:119]
    ds_read_b128 v[192:195], v16 offset:8192
    buffer_load_dwordx4 v[164:167], v2, s[12:15], s91 offen offset:1024
    s_waitcnt lgkmcnt(5)
    v_mfma_f32_16x16x32_bf16 v[100:103], v[212:215], a[20:23], v[100:103]
    buffer_load_dwordx4 v[168:171], v2, s[12:15], s91 offen offset:2048
    v_mfma_f32_16x16x32_bf16 v[108:111], v[212:215], a[84:87], v[108:111]
    s_waitcnt lgkmcnt(1)
    ds_read_b128 v[80:83], v28 offset:20480
    ds_read_b128 v[88:91], v28 offset:20736
    v_mfma_f32_16x16x32_bf16 v[116:119], a[148:151], v[212:215], v[116:119]
    ds_read_b128 v[196:199], v16 offset:9216
    ds_read_b128 v[84:87], v28 offset:20544
    ds_read_b128 v[92:95], v28 offset:20800
    v_mfma_f32_16x16x32_bf16 v[100:103], v[216:219], a[24:27], v[100:103]
    v_permlane16_swap_b32 v96, v98
    v_permlane16_swap_b32 v97, v99
    v_mfma_f32_16x16x32_bf16 v[108:111], v[216:219], a[88:91], v[108:111]
    buffer_load_dwordx4 v[172:175], v2, s[12:15], s91 offen offset:3072
    s_add_u32 s91, s91, 4096
    v_mfma_f32_16x16x32_bf16 v[116:119], a[152:155], v[216:219], v[116:119]
    ds_read_b128 v[200:203], v16 offset:10240
    buffer_load_dwordx4 v[176:179], v2, s[12:15], s91 offen offset:0
    v_mfma_f32_16x16x32_bf16 v[100:103], v[220:223], a[28:31], v[100:103]
    buffer_load_dwordx4 v[180:183], v2, s[12:15], s91 offen offset:1024
    v_mfma_f32_16x16x32_bf16 v[108:111], v[220:223], a[92:95], v[108:111]
    buffer_load_dwordx4 v[184:187], v2, s[12:15], s91 offen offset:2048
    v_mfma_f32_16x16x32_bf16 v[116:119], a[156:159], v[220:223], v[116:119]
    ds_read_b128 v[204:207], v16 offset:11264
    s_waitcnt lgkmcnt(7)
    v_mfma_f32_16x16x32_bf16 v[100:103], v[192:195], a[32:35], v[100:103]
    buffer_load_dwordx4 v[188:191], v2, s[12:15], s91 offen offset:3072
    s_add_u32 s91, s91, 8384512
    v_mfma_f32_16x16x32_bf16 v[108:111], v[192:195], a[96:99], v[108:111]
    buffer_load_dwordx4 a[224:227], v2, s[12:15], s31 offen offset:0
    v_mfma_f32_16x16x32_bf16 v[116:119], a[160:163], v[192:195], v[116:119]
    ds_read_b128 v[208:211], v16 offset:12288
    s_waitcnt lgkmcnt(3)
    v_mfma_f32_16x16x32_bf16 v[100:103], v[196:199], a[36:39], v[100:103]
    buffer_load_dwordx4 a[228:231], v2, s[12:15], s33 offen offset:0
    v_mfma_f32_16x16x32_bf16 v[108:111], v[196:199], a[100:103], v[108:111]
    v_lshlrev_b32 v136, 16, v36
    v_and_b32 v137, 0xffff0000, v36
    v_lshlrev_b32 v138, 16, v37
    v_mfma_f32_16x16x32_bf16 v[116:119], a[164:167], v[196:199], v[116:119]
    ds_read_b128 v[212:215], v16 offset:13312
    v_and_b32 v139, 0xffff0000, v37
    v_lshlrev_b32 v140, 16, v38
    s_waitcnt lgkmcnt(3)
    v_mfma_f32_16x16x32_bf16 v[100:103], v[200:203], a[40:43], v[100:103]
    v_and_b32 v141, 0xffff0000, v38
    v_lshlrev_b32 v142, 16, v39
    v_and_b32 v143, 0xffff0000, v39
    v_mfma_f32_16x16x32_bf16 v[108:111], v[200:203], a[104:107], v[108:111]
    s_waitcnt vmcnt(9)
    v_lshlrev_b32 v128, 16, v160
    v_and_b32 v129, 0xffff0000, v160
    v_mfma_f32_16x16x32_bf16 v[116:119], a[168:171], v[200:203], v[116:119]
    ds_read_b128 v[216:219], v16 offset:14336
    v_lshlrev_b32 v130, 16, v161
    v_and_b32 v131, 0xffff0000, v161
    s_waitcnt lgkmcnt(3)
    v_mfma_f32_16x16x32_bf16 v[100:103], v[204:207], a[44:47], v[100:103]
    v_lshlrev_b32 v132, 16, v162
    v_and_b32 v133, 0xffff0000, v162
    v_lshlrev_b32 v134, 16, v163
    v_mfma_f32_16x16x32_bf16 v[108:111], v[204:207], a[108:111], v[108:111]
    v_and_b32 v135, 0xffff0000, v163
    s_waitcnt vmcnt(8)
    v_lshlrev_b32 v144, 16, v164
    v_mfma_f32_16x16x32_bf16 v[116:119], a[172:175], v[204:207], v[116:119]
    ds_read_b128 v[220:223], v16 offset:15360
    v_and_b32 v145, 0xffff0000, v164
    v_lshlrev_b32 v146, 16, v165
    s_waitcnt lgkmcnt(3)
    v_mfma_f32_16x16x32_bf16 v[100:103], v[208:211], a[48:51], v[100:103]
    v_and_b32 v147, 0xffff0000, v165
    v_lshlrev_b32 v148, 16, v166
    v_and_b32 v149, 0xffff0000, v166
    v_mfma_f32_16x16x32_bf16 v[108:111], v[208:211], a[112:115], v[108:111]
    v_lshlrev_b32 v150, 16, v167
    v_and_b32 v151, 0xffff0000, v167
    v_add_f32 v128, v128, v144
    v_mfma_f32_16x16x32_bf16 v[116:119], a[176:179], v[208:211], v[116:119]
    ds_read_b128 v[192:195], v16 offset:32768
    v_add_f32 v129, v129, v145
    v_add_f32 v130, v130, v146
    s_waitcnt lgkmcnt(3)
    v_mfma_f32_16x16x32_bf16 v[100:103], v[212:215], a[52:55], v[100:103]
    v_add_f32 v131, v131, v147
    v_add_f32 v132, v132, v148
    v_add_f32 v133, v133, v149
    v_mfma_f32_16x16x32_bf16 v[108:111], v[212:215], a[116:119], v[108:111]
    v_add_f32 v134, v134, v150
    v_add_f32 v135, v135, v151
    s_waitcnt vmcnt(7)
    v_mfma_f32_16x16x32_bf16 v[116:119], a[180:183], v[212:215], v[116:119]
    ds_read_b128 v[196:199], v16 offset:33792
    v_lshlrev_b32 v144, 16, v168
    v_and_b32 v145, 0xffff0000, v168
    s_waitcnt lgkmcnt(3)
    v_mfma_f32_16x16x32_bf16 v[100:103], v[216:219], a[56:59], v[100:103]
    v_lshlrev_b32 v146, 16, v169
    v_and_b32 v147, 0xffff0000, v169
    v_lshlrev_b32 v148, 16, v170
    v_mfma_f32_16x16x32_bf16 v[108:111], v[216:219], a[120:123], v[108:111]
    v_and_b32 v149, 0xffff0000, v170
    v_lshlrev_b32 v150, 16, v171
    v_and_b32 v151, 0xffff0000, v171
    v_mfma_f32_16x16x32_bf16 v[116:119], a[184:187], v[216:219], v[116:119]
    ds_read_b128 v[200:203], v16 offset:34816
    v_add_f32 v128, v128, v144
    v_add_f32 v129, v129, v145
    s_waitcnt lgkmcnt(3)
    v_mfma_f32_16x16x32_bf16 v[100:103], v[220:223], a[60:63], v[100:103]
    v_add_f32 v130, v130, v146
    v_add_f32 v131, v131, v147
    v_add_f32 v132, v132, v148
    v_mfma_f32_16x16x32_bf16 v[108:111], v[220:223], a[124:127], v[108:111]
    v_add_f32 v133, v133, v149
    v_add_f32 v134, v134, v150
    v_add_f32 v135, v135, v151
    v_mfma_f32_16x16x32_bf16 v[116:119], a[188:191], v[220:223], v[116:119]
    ds_read_b128 v[204:207], v16 offset:35840
    s_waitcnt vmcnt(6)
    v_lshlrev_b32 v144, 16, v172
    s_waitcnt lgkmcnt(3)
    v_mfma_f32_16x16x32_bf16 v[104:107], v[192:195], a[0:3], 0
    v_and_b32 v145, 0xffff0000, v172
    v_lshlrev_b32 v146, 16, v173
    v_and_b32 v147, 0xffff0000, v173
    v_mfma_f32_16x16x32_bf16 v[112:115], v[192:195], a[64:67], 0
    v_lshlrev_b32 v148, 16, v174
    v_and_b32 v149, 0xffff0000, v174
    v_lshlrev_b32 v150, 16, v175
    v_mfma_f32_16x16x32_bf16 v[120:123], a[128:131], v[192:195], 0
    ds_read_b128 v[208:211], v16 offset:36864
    v_and_b32 v151, 0xffff0000, v175
    v_add_f32 v128, v128, v144
    s_waitcnt lgkmcnt(3)
    v_mfma_f32_16x16x32_bf16 v[104:107], v[196:199], a[4:7], v[104:107]
    v_add_f32 v129, v129, v145
    v_add_f32 v130, v130, v146
    v_add_f32 v131, v131, v147
    v_mfma_f32_16x16x32_bf16 v[112:115], v[196:199], a[68:71], v[112:115]
    v_add_f32 v132, v132, v148
    v_add_f32 v133, v133, v149
    v_add_f32 v134, v134, v150
    v_mfma_f32_16x16x32_bf16 v[120:123], a[132:135], v[196:199], v[120:123]
    ds_read_b128 v[212:215], v16 offset:37888
    v_add_f32 v135, v135, v151
    s_waitcnt vmcnt(5)
    s_waitcnt lgkmcnt(3)
    v_mfma_f32_16x16x32_bf16 v[104:107], v[200:203], a[8:11], v[104:107]
    v_lshlrev_b32 v144, 16, v176
    v_and_b32 v145, 0xffff0000, v176
    v_lshlrev_b32 v146, 16, v177
    v_mfma_f32_16x16x32_bf16 v[112:115], v[200:203], a[72:75], v[112:115]
    v_and_b32 v147, 0xffff0000, v177
    v_lshlrev_b32 v148, 16, v178
    v_and_b32 v149, 0xffff0000, v178
    v_mfma_f32_16x16x32_bf16 v[120:123], a[136:139], v[200:203], v[120:123]
    ds_read_b128 v[216:219], v16 offset:38912
    v_lshlrev_b32 v150, 16, v179
    v_and_b32 v151, 0xffff0000, v179
    s_waitcnt lgkmcnt(3)
    v_mfma_f32_16x16x32_bf16 v[104:107], v[204:207], a[12:15], v[104:107]
    v_add_f32 v128, v128, v144
    v_add_f32 v129, v129, v145
    v_add_f32 v130, v130, v146
    v_mfma_f32_16x16x32_bf16 v[112:115], v[204:207], a[76:79], v[112:115]
    v_add_f32 v131, v131, v147
    v_add_f32 v132, v132, v148
    v_add_f32 v133, v133, v149
    v_mfma_f32_16x16x32_bf16 v[120:123], a[140:143], v[204:207], v[120:123]
    ds_read_b128 v[220:223], v16 offset:39936
    v_add_f32 v134, v134, v150
    v_add_f32 v135, v135, v151
    s_waitcnt lgkmcnt(3)
    v_mfma_f32_16x16x32_bf16 v[104:107], v[208:211], a[16:19], v[104:107]
    s_waitcnt vmcnt(4)
    v_lshlrev_b32 v144, 16, v180
    v_and_b32 v145, 0xffff0000, v180
    v_mfma_f32_16x16x32_bf16 v[112:115], v[208:211], a[80:83], v[112:115]
    v_lshlrev_b32 v146, 16, v181
    v_and_b32 v147, 0xffff0000, v181
    v_lshlrev_b32 v148, 16, v182
    v_mfma_f32_16x16x32_bf16 v[120:123], a[144:147], v[208:211], v[120:123]
    ds_read_b128 v[192:195], v16 offset:40960
    v_and_b32 v149, 0xffff0000, v182
    v_lshlrev_b32 v150, 16, v183
    s_waitcnt lgkmcnt(3)
    v_mfma_f32_16x16x32_bf16 v[104:107], v[212:215], a[20:23], v[104:107]
    v_and_b32 v151, 0xffff0000, v183
    v_add_f32 v128, v128, v144
    v_add_f32 v129, v129, v145
    v_mfma_f32_16x16x32_bf16 v[112:115], v[212:215], a[84:87], v[112:115]
    v_add_f32 v130, v130, v146
    v_add_f32 v131, v131, v147
    v_add_f32 v132, v132, v148
    v_mfma_f32_16x16x32_bf16 v[120:123], a[148:151], v[212:215], v[120:123]
    ds_read_b128 v[196:199], v16 offset:41984
    v_add_f32 v133, v133, v149
    v_add_f32 v134, v134, v150
    s_waitcnt lgkmcnt(3)
    v_mfma_f32_16x16x32_bf16 v[104:107], v[216:219], a[24:27], v[104:107]
    v_add_f32 v135, v135, v151
    s_waitcnt vmcnt(3)
    v_lshlrev_b32 v144, 16, v184
    v_mfma_f32_16x16x32_bf16 v[112:115], v[216:219], a[88:91], v[112:115]
    v_and_b32 v145, 0xffff0000, v184
    v_lshlrev_b32 v146, 16, v185
    v_and_b32 v147, 0xffff0000, v185
    v_mfma_f32_16x16x32_bf16 v[120:123], a[152:155], v[216:219], v[120:123]
    ds_read_b128 v[200:203], v16 offset:43008
    v_lshlrev_b32 v148, 16, v186
    v_and_b32 v149, 0xffff0000, v186
    s_waitcnt lgkmcnt(3)
    v_mfma_f32_16x16x32_bf16 v[104:107], v[220:223], a[28:31], v[104:107]
    v_lshlrev_b32 v150, 16, v187
    v_and_b32 v151, 0xffff0000, v187
    v_add_f32 v128, v128, v144
    v_mfma_f32_16x16x32_bf16 v[112:115], v[220:223], a[92:95], v[112:115]
    v_add_f32 v129, v129, v145
    v_add_f32 v130, v130, v146
    v_add_f32 v131, v131, v147
    v_mfma_f32_16x16x32_bf16 v[120:123], a[156:159], v[220:223], v[120:123]
    ds_read_b128 v[204:207], v16 offset:44032
    v_add_f32 v132, v132, v148
    v_add_f32 v133, v133, v149
    s_waitcnt lgkmcnt(3)
    v_mfma_f32_16x16x32_bf16 v[104:107], v[192:195], a[32:35], v[104:107]
    v_add_f32 v134, v134, v150
    v_add_f32 v135, v135, v151
    s_waitcnt vmcnt(2)
    v_mfma_f32_16x16x32_bf16 v[112:115], v[192:195], a[96:99], v[112:115]
    v_lshlrev_b32 v144, 16, v188
    v_and_b32 v145, 0xffff0000, v188
    v_lshlrev_b32 v146, 16, v189
    v_mfma_f32_16x16x32_bf16 v[120:123], a[160:163], v[192:195], v[120:123]
    ds_read_b128 v[208:211], v16 offset:45056
    v_and_b32 v147, 0xffff0000, v189
    v_lshlrev_b32 v148, 16, v190
    s_waitcnt lgkmcnt(3)
    v_mfma_f32_16x16x32_bf16 v[104:107], v[196:199], a[36:39], v[104:107]
    v_and_b32 v149, 0xffff0000, v190
    v_lshlrev_b32 v150, 16, v191
    v_and_b32 v151, 0xffff0000, v191
    v_mfma_f32_16x16x32_bf16 v[112:115], v[196:199], a[100:103], v[112:115]
    v_add_f32 v128, v128, v144
    v_add_f32 v129, v129, v145
    v_add_f32 v130, v130, v146
    v_mfma_f32_16x16x32_bf16 v[120:123], a[164:167], v[196:199], v[120:123]
    ds_read_b128 v[212:215], v16 offset:46080
    v_add_f32 v131, v131, v147
    v_add_f32 v132, v132, v148
    s_waitcnt lgkmcnt(3)
    v_mfma_f32_16x16x32_bf16 v[104:107], v[200:203], a[40:43], v[104:107]
    v_add_f32 v133, v133, v149
    v_add_f32 v134, v134, v150
    v_add_f32 v135, v135, v151
    v_mfma_f32_16x16x32_bf16 v[112:115], v[200:203], a[104:107], v[112:115]
    v_fma_f32 v128, v128, v40, v136
    v_fma_f32 v129, v129, v41, v137
    v_fma_f32 v130, v130, v42, v138
    v_mfma_f32_16x16x32_bf16 v[120:123], a[168:171], v[200:203], v[120:123]
    ds_read_b128 v[216:219], v16 offset:47104
    v_fma_f32 v131, v131, v43, v139
    v_fma_f32 v132, v132, v44, v140
    s_waitcnt lgkmcnt(3)
    v_mfma_f32_16x16x32_bf16 v[104:107], v[204:207], a[44:47], v[104:107]
    v_fma_f32 v133, v133, v45, v141
    v_fma_f32 v134, v134, v46, v142
    v_fma_f32 v135, v135, v47, v143
    v_mfma_f32_16x16x32_bf16 v[112:115], v[204:207], a[108:111], v[112:115]
    v_cvt_pk_bf16_f32 v144, v128, v129
    v_cvt_pk_bf16_f32 v145, v130, v131
    v_cvt_pk_bf16_f32 v146, v132, v133
    v_mfma_f32_16x16x32_bf16 v[120:123], a[172:175], v[204:207], v[120:123]
    ds_read_b128 v[220:223], v16 offset:48128
    v_cvt_pk_bf16_f32 v147, v134, v135
    v_lshlrev_b32 v128, 16, v144
    s_waitcnt lgkmcnt(3)
    v_mfma_f32_16x16x32_bf16 v[104:107], v[208:211], a[48:51], v[104:107]
    v_and_b32 v129, 0xffff0000, v144
    v_lshlrev_b32 v130, 16, v145
    v_and_b32 v131, 0xffff0000, v145
    v_mfma_f32_16x16x32_bf16 v[112:115], v[208:211], a[112:115], v[112:115]
    v_lshlrev_b32 v132, 16, v146
    v_and_b32 v133, 0xffff0000, v146
    v_lshlrev_b32 v134, 16, v147
    v_mfma_f32_16x16x32_bf16 v[120:123], a[176:179], v[208:211], v[120:123]
    v_and_b32 v135, 0xffff0000, v147
    v_mul_f32 v136, v128, v48
    v_mul_f32 v137, v129, v49
    s_waitcnt lgkmcnt(2)
    v_mfma_f32_16x16x32_bf16 v[104:107], v[212:215], a[52:55], v[104:107]
    v_mul_f32 v138, v130, v50
    v_mul_f32 v139, v131, v51
    v_mul_f32 v140, v132, v52
    v_mfma_f32_16x16x32_bf16 v[112:115], v[212:215], a[116:119], v[112:115]
    v_mul_f32 v141, v133, v53
    v_mul_f32 v142, v134, v54
    v_mul_f32 v143, v135, v55
    v_mfma_f32_16x16x32_bf16 v[120:123], a[180:183], v[212:215], v[120:123]
    v_cvt_pk_bf16_f32 v148, v136, v137
    v_cvt_pk_bf16_f32 v149, v138, v139
    v_cvt_pk_bf16_f32 v150, v140, v141
    s_waitcnt lgkmcnt(1)
    v_mfma_f32_16x16x32_bf16 v[104:107], v[216:219], a[56:59], v[104:107]
    v_cvt_pk_bf16_f32 v151, v142, v143
    buffer_store_dwordx4 v[148:151], v26, s[12:15], s95 offen
    v_mfma_f32_16x16x32_bf16 v[112:115], v[216:219], a[120:123], v[112:115]
    v_add_f32 v152, v128, v129
    v_mul_f32 v153, v128, v128
    v_add_f32 v154, v130, v131
    v_mfma_f32_16x16x32_bf16 v[120:123], a[184:187], v[216:219], v[120:123]
    v_mul_f32 v155, v129, v129
    v_fmac_f32 v153, v130, v130
    v_fmac_f32 v155, v131, v131
    s_waitcnt lgkmcnt(0)
    v_mfma_f32_16x16x32_bf16 v[104:107], v[220:223], a[60:63], v[104:107]
    v_fmac_f32 v153, v132, v132
    v_fmac_f32 v155, v133, v133
    v_fmac_f32 v153, v134, v134
    v_mfma_f32_16x16x32_bf16 v[112:115], v[220:223], a[124:127], v[112:115]
    v_fmac_f32 v155, v135, v135
    v_add_f32 v152, v152, v132
    v_add_f32 v154, v154, v133
    v_mfma_f32_16x16x32_bf16 v[120:123], a[188:191], v[220:223], v[120:123]
    v_add_f32 v152, v152, v134
    v_add_f32 v154, v154, v135
    v_add_f32 v152, v152, v154
    v_add_f32 v153, v153, v155
    v_mov_b32 v154, v152
    v_mov_b32 v155, v153
    s_nop 0
    v_permlane32_swap_b32 v152, v154
    v_permlane32_swap_b32 v153, v155
    v_add_f32 v152, v152, v154
    v_add_f32 v153, v153, v155
    buffer_store_dwordx2 v[152:153], v27, s[12:15], s97 offen
    buffer_store_dwordx4 v[144:147], v2, s[12:15], s96 offen
    buffer_load_dwordx4 a[232:235], v2, s[12:15], s31 offen offset:2048
    buffer_load_dwordx4 a[236:239], v2, s[12:15], s33 offen offset:2048
    s_add_u32 s31, s31, 4096
    s_add_u32 s33, s33, 4096
    buffer_load_dwordx4 a[240:243], v2, s[12:15], s31 offen offset:0
    buffer_load_dwordx4 a[244:247], v2, s[12:15], s33 offen offset:0
    buffer_load_dwordx4 a[248:251], v2, s[12:15], s31 offen offset:2048
    buffer_load_dwordx4 a[252:255], v2, s[12:15], s33 offen offset:2048
    s_add_u32 s31, s31, 4096
    s_add_u32 s33, s33, 4096
    s_add_u32 s38, s65, s36
    s_add_u32 m0, s38, 0
    s_nop 0
    buffer_load_dwordx4 v2, s[12:15], s31 offen offset:0 lds
    s_add_u32 s38, s65, s36
    s_add_u32 m0, s38, 1024
    s_nop 0
    buffer_load_dwordx4 v2, s[12:15], s33 offen offset:0 lds
    s_add_u32 s38, s65, s36
    s_add_u32 m0, s38, 0
    s_nop 0
    buffer_load_dwordx4 v2, s[12:15], s31 offen offset:2048 lds
    s_add_u32 s38, s65, s36
    s_add_u32 m0, s38, 1024
    s_nop 0
    buffer_load_dwordx4 v2, s[12:15], s33 offen offset:2048 lds
    s_add_u32 s31, s31, 4096
    s_add_u32 s33, s33, 4096
    s_add_u32 s38, s65, s36
    s_add_u32 m0, s38, 32768
    s_nop 0
    buffer_load_dwordx4 v2, s[12:15], s31 offen offset:0 lds
    s_add_u32 s38, s65, s36
    s_add_u32 m0, s38, 33792
    s_nop 0
    buffer_load_dwordx4 v2, s[12:15], s33 offen offset:0 lds
    s_add_u32 s38, s65, s36
    s_add_u32 m0, s38, 32768
    s_nop 0
    buffer_load_dwordx4 v2, s[12:15], s31 offen offset:2048 lds
    s_add_u32 s38, s65, s36
    s_add_u32 m0, s38, 33792
    s_nop 0
    buffer_load_dwordx4 v2, s[12:15], s33 offen offset:2048 lds
    s_add_u32 s31, s31, 4096
    s_add_u32 s33, s33, 4096
    v_fma_f32 v100, v80, v4, v100
    v_fma_f32 v101, v81, v4, v101
    v_fma_f32 v102, v82, v4, v102
    v_fma_f32 v103, v83, v4, v103
    v_fma_f32 v108, v80, v8, v108
    v_fma_f32 v109, v81, v8, v109
    v_fma_f32 v110, v82, v8, v110
    v_fma_f32 v111, v83, v8, v111
    v_fma_f32 v100, v88, v100, v5
    v_fma_f32 v101, v89, v101, v5
    v_fma_f32 v102, v90, v102, v5
    v_fma_f32 v103, v91, v103, v5
    v_fma_f32 v108, v88, v108, v9
    v_fma_f32 v109, v89, v109, v9
    v_fma_f32 v110, v90, v110, v9
    v_fma_f32 v111, v91, v111, v9
    v_mul_f32 v224, v100, v100
    v_mul_f32 v225, v101, v101
    v_mul_f32 v226, v102, v102
    v_mul_f32 v227, v103, v103
    v_mul_f32 v228, v108, v108
    v_mul_f32 v229, v109, v109
    v_mul_f32 v230, v110, v110
    v_mul_f32 v231, v111, v111
    v_fma_f32 v224, v224, v60, s44
    v_fma_f32 v225, v225, v60, s44
    v_fma_f32 v226, v226, v60, s44
    v_fma_f32 v227, v227, v60, s44
    v_fma_f32 v228, v228, v60, s44
    v_fma_f32 v229, v229, v60, s44
    v_fma_f32 v230, v230, v60, s44
    v_fma_f32 v231, v231, v60, s44
    v_mul_f32 v224, v224, v100
    v_mul_f32 v225, v225, v101
    v_mul_f32 v226, v226, v102
    v_mul_f32 v227, v227, v103
    v_mul_f32 v228, v228, v108
    v_mul_f32 v229, v229, v109
    v_mul_f32 v230, v230, v110
    v_mul_f32 v231, v231, v111
    v_exp_f32 v224, v224
    v_exp_f32 v225, v225
    v_exp_f32 v226, v226
    v_exp_f32 v227, v227
    v_exp_f32 v228, v228
    v_exp_f32 v229, v229
    v_exp_f32 v230, v230
    v_exp_f32 v231, v231
    v_add_f32 v224, 1.0, v224
    v_add_f32 v225, 1.0, v225
    v_add_f32 v226, 1.0, v226
    v_add_f32 v227, 1.0, v227
    v_add_f32 v228, 1.0, v228
    v_add_f32 v229, 1.0, v229
    v_add_f32 v230, 1.0, v230
    v_add_f32 v231, 1.0, v231
    v_rcp_f32 v224, v224
    v_rcp_f32 v225, v225
    v_rcp_f32 v226, v226
    v_rcp_f32 v227, v227
    s_waitcnt vmcnt(15)
    s_add_u32 s98, s98, 512
    s_cmp_eq_u32 s8, 0
    s_cbranch_scc1 TL_LF_12
    v_mov_b32 v58, 1
    s_mov_b64 exec, 1
    buffer_store_dword v58, off, s[12:15], s98
    s_mov_b64 exec, -1
TL_LF_12_R:
    s_add_u32 s28, s28, 512
    v_rcp_f32 v228, v228
    v_rcp_f32 v229, v229
    v_rcp_f32 v230, v230
    v_rcp_f32 v231, v231
    v_mul_f32 v100, v100, v224
    v_mul_f32 v101, v101, v225
    v_mul_f32 v102, v102, v226
    v_mul_f32 v103, v103, v227
    v_mul_f32 v108, v108, v228
    v_mul_f32 v109, v109, v229
    v_mul_f32 v110, v110, v230
    v_mul_f32 v111, v111, v231
    v_add_f32 v232, v100, v108
    v_mul_f32 v240, v100, v100
    v_add_f32 v233, v101, v109
    v_mul_f32 v241, v101, v101
    v_add_f32 v234, v102, v110
    v_mul_f32 v242, v102, v102
    v_add_f32 v235, v103, v111
    v_mul_f32 v243, v103, v103
    v_fmac_f32 v240, v108, v108
    v_fmac_f32 v241, v109, v109
    v_fmac_f32 v242, v110, v110
    v_fmac_f32 v243, v111, v111
    v_fma_f32 v116, v96, v64, v116
    v_fma_f32 v117, v96, v65, v117
    v_fma_f32 v118, v96, v66, v118
    v_fma_f32 v119, v96, v67, v119
    v_fma_f32 v116, v97, v116, v68
    v_fma_f32 v117, v97, v117, v69
    v_fma_f32 v118, v97, v118, v70
    v_fma_f32 v119, v97, v119, v71
    v_mul_f32 v224, v116, v116
    v_mul_f32 v225, v117, v117
    v_mul_f32 v226, v118, v118
    v_mul_f32 v227, v119, v119
    v_fma_f32 v224, v224, v60, s44
    v_fma_f32 v225, v225, v60, s44
    v_fma_f32 v226, v226, v60, s44
    v_fma_f32 v227, v227, v60, s44
    v_mul_f32 v224, v224, v116
    v_mul_f32 v225, v225, v117
    v_mul_f32 v226, v226, v118
    v_mul_f32 v227, v227, v119
    v_exp_f32 v224, v224
    v_exp_f32 v225, v225
    v_exp_f32 v226, v226
    v_exp_f32 v227, v227
    v_add_f32 v224, 1.0, v224
    v_add_f32 v225, 1.0, v225
    v_add_f32 v226, 1.0, v226
    v_add_f32 v227, 1.0, v227
    v_rcp_f32 v224, v224
    v_rcp_f32 v225, v225
    v_rcp_f32 v226, v226
    v_rcp_f32 v227, v227
    v_mul_f32 v116, v116, v224
    v_mul_f32 v117, v117, v225
    v_mul_f32 v118, v118, v226
    v_mul_f32 v119, v119, v227
    v_cvt_pk_bf16_f32 v224, v116, v117
    v_cvt_pk_bf16_f32 v225, v118, v119
    ds_write_b64 v29, v[224:225] offset:0
    v_fma_f32 v104, v84, v4, v104
    v_fma_f32 v105, v85, v4, v105
    v_fma_f32 v106, v86, v4, v106
    v_fma_f32 v107, v87, v4, v107
    v_fma_f32 v112, v84, v8, v112
    v_fma_f32 v113, v85, v8, v113
    v_fma_f32 v114, v86, v8, v114
    v_fma_f32 v115, v87, v8, v115
    v_fma_f32 v104, v92, v104, v5
    v_fma_f32 v105, v93, v105, v5
    v_fma_f32 v106, v94, v106, v5
    v_fma_f32 v107, v95, v107, v5
    v_fma_f32 v112, v92, v112, v9
    v_fma_f32 v113, v93, v113, v9
    v_fma_f32 v114, v94, v114, v9
    v_fma_f32 v115, v95, v115, v9
    v_mul_f32 v224, v104, v104
    v_mul_f32 v225, v105, v105
    v_mul_f32 v226, v106, v106
    v_mul_f32 v227, v107, v107
    v_mul_f32 v228, v112, v112
    v_mul_f32 v229, v113, v113
    v_mul_f32 v230, v114, v114
    v_mul_f32 v231, v115, v115
    v_fma_f32 v224, v224, v60, s44
    v_fma_f32 v225, v225, v60, s44
    v_fma_f32 v226, v226, v60, s44
    v_fma_f32 v227, v227, v60, s44
    v_fma_f32 v228, v228, v60, s44
    v_fma_f32 v229, v229, v60, s44
    v_fma_f32 v230, v230, v60, s44
    v_fma_f32 v231, v231, v60, s44
    v_mul_f32 v224, v224, v104
    v_mul_f32 v225, v225, v105
    v_mul_f32 v226, v226, v106
    v_mul_f32 v227, v227, v107
    v_mul_f32 v228, v228, v112
    v_mul_f32 v229, v229, v113
    v_mul_f32 v230, v230, v114
    v_mul_f32 v231, v231, v115
    v_exp_f32 v224, v224
    v_exp_f32 v225, v225
    v_exp_f32 v226, v226
    v_exp_f32 v227, v227
    v_exp_f32 v228, v228
    v_exp_f32 v229, v229
    v_exp_f32 v230, v230
    v_exp_f32 v231, v231
    v_add_f32 v224, 1.0, v224
    v_add_f32 v225, 1.0, v225
    v_add_f32 v226, 1.0, v226
    v_add_f32 v227, 1.0, v227
    v_add_f32 v228, 1.0, v228
    v_add_f32 v229, 1.0, v229
    v_add_f32 v230, 1.0, v230
    v_add_f32 v231, 1.0, v231
    v_rcp_f32 v224, v224
    v_rcp_f32 v225, v225
    v_rcp_f32 v226, v226
    v_rcp_f32 v227, v227
    v_rcp_f32 v228, v228
    v_rcp_f32 v229, v229
    v_rcp_f32 v230, v230
    v_rcp_f32 v231, v231
    v_mul_f32 v104, v104, v224
    v_mul_f32 v105, v105, v225
    v_mul_f32 v106, v106, v226
    v_mul_f32 v107, v107, v227
    v_mul_f32 v112, v112, v228
    v_mul_f32 v113, v113, v229
    v_mul_f32 v114, v114, v230
    v_mul_f32 v115, v115, v231
    v_add_f32 v236, v104, v112
    v_mul_f32 v244, v104, v104
    v_add_f32 v237, v105, v113
    v_mul_f32 v245, v105, v105
    v_add_f32 v238, v106, v114
    v_mul_f32 v246, v106, v106
    v_add_f32 v239, v107, v115
    v_mul_f32 v247, v107, v107
    v_fmac_f32 v244, v112, v112
    v_fmac_f32 v245, v113, v113
    v_fmac_f32 v246, v114, v114
    v_fmac_f32 v247, v115, v115
    v_add_f32_dpp v248, v232, v232 row_ror:8 row_mask:0xf bank_mask:0x3
    v_add_f32_dpp v249, v233, v233 row_ror:8 row_mask:0xf bank_mask:0x3
    v_add_f32_dpp v250, v234, v234 row_ror:8 row_mask:0xf bank_mask:0x3
    v_add_f32_dpp v251, v235, v235 row_ror:8 row_mask:0xf bank_mask:0x3
    v_add_f32_dpp v252, v236, v236 row_ror:8 row_mask:0xf bank_mask:0x3
    v_add_f32_dpp v253, v237, v237 row_ror:8 row_mask:0xf bank_mask:0x3
    v_add_f32_dpp v254, v238, v238 row_ror:8 row_mask:0xf bank_mask:0x3
    v_add_f32_dpp v255, v239, v239 row_ror:8 row_mask:0xf bank_mask:0x3
    v_add_f32_dpp v248, v240, v240 row_ror:8 row_mask:0xf bank_mask:0xc
    v_add_f32_dpp v249, v241, v241 row_ror:8 row_mask:0xf bank_mask:0xc
    v_add_f32_dpp v250, v242, v242 row_ror:8 row_mask:0xf bank_mask:0xc
    v_add_f32_dpp v251, v243, v243 row_ror:8 row_mask:0xf bank_mask:0xc
    v_add_f32_dpp v252, v244, v244 row_ror:8 row_mask:0xf bank_mask:0xc
    v_add_f32_dpp v253, v245, v245 row_ror:8 row_mask:0xf bank_mask:0xc
    v_add_f32_dpp v254, v246, v246 row_ror:8 row_mask:0xf bank_mask:0xc
    v_add_f32_dpp v255, v247, v247 row_ror:8 row_mask:0xf bank_mask:0xc
    v_add_f32_dpp v232, v248, v248 row_half_mirror row_mask:0xf bank_mask:0x5
    v_add_f32_dpp v233, v249, v249 row_half_mirror row_mask:0xf bank_mask:0x5
    v_add_f32_dpp v234, v250, v250 row_half_mirror row_mask:0xf bank_mask:0x5
    v_add_f32_dpp v235, v251, v251 row_half_mirror row_mask:0xf bank_mask:0x5
    v_add_f32_dpp v232, v252, v252 row_half_mirror row_mask:0xf bank_mask:0xa
    v_add_f32_dpp v233, v253, v253 row_half_mirror row_mask:0xf bank_mask:0xa
    v_add_f32_dpp v234, v254, v254 row_half_mirror row_mask:0xf bank_mask:0xa
    v_add_f32_dpp v235, v255, v255 row_half_mirror row_mask:0xf bank_mask:0xa
    v_cndmask_b32_e64 v248, v232, v234, s[52:53]
    v_cndmask_b32_e64 v250, v234, v232, s[52:53]
    v_cndmask_b32_e64 v249, v233, v235, s[52:53]
    v_cndmask_b32_e64 v251, v235, v233, s[52:53]
    v_add_f32_dpp v232, v250, v248 quad_perm:[2,3,0,1] row_mask:0xf bank_mask:0xf
    s_nop 0
    v_add_f32_dpp v233, v251, v249 quad_perm:[2,3,0,1] row_mask:0xf bank_mask:0xf
    v_cndmask_b32_e64 v248, v232, v233, s[60:61]
    v_cndmask_b32_e64 v249, v233, v232, s[60:61]
    s_nop 1
    v_add_f32_dpp v232, v249, v248 quad_perm:[1,0,3,2] row_mask:0xf bank_mask:0xf
    ds_write_b32 v30, v232 offset:24576
    s_waitcnt lgkmcnt(0)
    s_barrier
    ds_read_b64 v[248:249], v23 offset:24576
    ds_read_b64 v[250:251], v23 offset:24832
    ds_read_b64 v[252:253], v23 offset:25088
    ds_read_b64 v[254:255], v23 offset:25344
    s_waitcnt lgkmcnt(0)
    v_add_f32 v248, v248, v250
    v_add_f32 v249, v249, v251
    v_add_f32 v252, v252, v254
    v_add_f32 v253, v253, v255
    v_add_f32 v248, v248, v252
    v_add_f32 v249, v249, v253
    v_or_b32 v249, 0x80000000, v249
    s_cmp_eq_u32 s8, 0
    s_cbranch_scc1 TL_LF_13
    s_mov_b64 exec, s[66:67]
    buffer_store_dwordx2 v[248:249], v27, s[12:15], s45 offen
    s_mov_b64 exec, -1
TL_LF_13_R:
    v_fma_f32 v120, v98, v64, v120
    v_fma_f32 v121, v98, v65, v121
    v_fma_f32 v122, v98, v66, v122
    v_fma_f32 v123, v98, v67, v123
    v_fma_f32 v120, v99, v120, v68
    v_fma_f32 v121, v99, v121, v69
    v_fma_f32 v122, v99, v122, v70
    v_fma_f32 v123, v99, v123, v71
    v_mul_f32 v224, v120, v120
    v_mul_f32 v225, v121, v121
    v_mul_f32 v226, v122, v122
    v_mul_f32 v227, v123, v123
    v_fma_f32 v224, v224, v60, s44
    v_fma_f32 v225, v225, v60, s44
    v_fma_f32 v226, v226, v60, s44
    v_fma_f32 v227, v227, v60, s44
    v_mul_f32 v224, v224, v120
    v_mul_f32 v225, v225, v121
    v_mul_f32 v226, v226, v122
    v_mul_f32 v227, v227, v123
    v_exp_f32 v224, v224
    v_exp_f32 v225, v225
    v_exp_f32 v226, v226
    v_exp_f32 v227, v227
    v_add_f32 v224, 1.0, v224
    v_add_f32 v225, 1.0, v225
    v_add_f32 v226, 1.0, v226
    v_add_f32 v227, 1.0, v227
    v_rcp_f32 v224, v224
    v_rcp_f32 v225, v225
    v_rcp_f32 v226, v226
    v_rcp_f32 v227, v227
    v_mul_f32 v120, v120, v224
    v_mul_f32 v121, v121, v225
    v_mul_f32 v122, v122, v226
    v_mul_f32 v123, v123, v227
    v_cvt_pk_bf16_f32 v224, v120, v121
    v_cvt_pk_bf16_f32 v225, v122, v123
    ds_write_b64 v29, v[224:225] offset:3200
    buffer_load_dword v57, v24, s[12:15], s28 offen sc1
    buffer_load_dwordx4 v[236:239], v31, s[12:15], s50 offen sc0 sc1
    buffer_load_dwordx4 v[240:243], v31, s[12:15], s50 offen offset:16 sc0 sc1
    s_waitcnt vmcnt(2)
    v_cmp_le_u32 vcc, 1, v57
    s_nop 0
    s_cmp_eq_u64 vcc, -1
    s_cbranch_scc0 TAX2H_S
TAX2H_R:
    s_add_u32 s38, s63, s36
    s_add_u32 m0, s38, 0
    s_nop 0
    buffer_load_dwordx4 v2, s[12:15], s29 offen offset:0 sc1 lds
    buffer_load_dwordx4 v2, s[12:15], s29 offen offset:1024 sc1 lds
    buffer_load_dwordx4 v2, s[12:15], s29 offen offset:2048 sc1 lds
    buffer_load_dwordx4 v2, s[12:15], s29 offen offset:3072 sc1 lds
    s_add_u32 s29, s29, 16384
    buffer_load_dwordx4 v[32:35], v19, s[12:15], s30 offen sc1
    buffer_load_dwordx4 v[36:39], v19, s[12:15], s30 offen offset:16 sc1
    s_add_u32 s30, s30, 16777216
    s_add_u32 m0, s38, 32768
    s_nop 0
    buffer_load_dwordx4 v2, s[12:15], s29 offen offset:0 sc1 lds
    buffer_load_dwordx4 v2, s[12:15], s29 offen offset:1024 sc1 lds
    buffer_load_dwordx4 v2, s[12:15], s29 offen offset:2048 sc1 lds
    buffer_load_dwordx4 v2, s[12:15], s29 offen offset:3072 sc1 lds
    s_add_u32 s29, s29, 16760832
    s_waitcnt vmcnt(10)
    v_and_b32 v57, v237, v239
    v_and_b32 v56, v241, v243
    v_and_b32 v57, v57, v56
    v_cmp_gt_i32 vcc, 0, v57
    s_nop 0
    s_cmp_eq_u64 vcc, -1
    s_cbranch_scc0 TAZL_S
TAZL_R:
    v_add_f32 v236, v236, v238
    v_add_f32 v237, v237, v239
    v_add_f32 v240, v240, v242
    v_add_f32 v241, v241, v243
    v_add_f32 v236, v236, v240
    v_add_f32 v237, v237, v241
    v_mov_b32 v238, v236
    v_mov_b32 v239, v237
    s_nop 0
    v_permlane32_swap_b32 v236, v238
    v_permlane32_swap_b32 v237, v239
    v_add_f32 v236, v236, v238
    v_add_f32 v237, v237, v239
    v_mul_f32 v236, 0xbabe82fa, v236
    v_mul_f32 v237, 0xbabe82fa, v237
    v_fma_f32 v237, -v236, v236, v237
    v_max_f32 v237, 0, v237
    v_add_f32 v237, 0x3727c5ac, v237
    v_rsq_f32 v237, v237
    s_nop 0
    v_mul_f32 v236, v236, v237
    ds_write_b32 v25, v236 offset:28672
    ds_write_b32 v25, v237 offset:28928
    s_waitcnt lgkmcnt(0)
    ds_read_b128 v[236:239], v28 offset:28672
    ds_read_b128 v[244:247], v28 offset:28928
    ds_read_b128 v[240:243], v28 offset:28736
    ds_read_b128 v[248:251], v28 offset:28992
    s_waitcnt lgkmcnt(0)
    v_fma_f32 v100, v100, v244, v236
    v_fma_f32 v101, v101, v245, v237
    v_fma_f32 v102, v102, v246, v238
    v_fma_f32 v103, v103, v247, v239
    v_fma_f32 v104, v104, v248, v240
    v_fma_f32 v105, v105, v249, v241
    v_fma_f32 v106, v106, v250, v242
    v_fma_f32 v107, v107, v251, v243
    v_cvt_pk_bf16_f32 v100, v100, v101
    v_cvt_pk_bf16_f32 v101, v102, v103
    v_cvt_pk_bf16_f32 v102, v104, v105
    v_cvt_pk_bf16_f32 v103, v106, v107
    buffer_store_dwordx4 v[100:103], v3, s[12:15], s54 offen sc1
    v_fma_f32 v108, v108, v244, v236
    v_fma_f32 v109, v109, v245, v237
    v_fma_f32 v110, v110, v246, v238
    v_fma_f32 v111, v111, v247, v239
    v_fma_f32 v112, v112, v248, v240
    v_fma_f32 v113, v113, v249, v241
    v_fma_f32 v114, v114, v250, v242
    v_fma_f32 v115, v115, v251, v243
    v_cvt_pk_bf16_f32 v108, v108, v109
    v_cvt_pk_bf16_f32 v109, v110, v111
    v_cvt_pk_bf16_f32 v110, v112, v113
    v_cvt_pk_bf16_f32 v111, v114, v115
    buffer_store_dwordx4 v[108:111], v0, s[12:15], s54 offen sc1
    s_waitcnt vmcnt(6)
    v_add_f32 v32, v32, v34
    v_add_f32 v33, v33, v35
    v_add_f32 v36, v36, v38
    v_add_f32 v37, v37, v39
    v_add_f32 v32, v32, v36
    v_add_f32 v33, v33, v37
    s_nop 0
    v_add_f32_dpp v34, v32, v32 quad_perm:[1,0,3,2] row_mask:0xf bank_mask:0xf
    v_add_f32_dpp v35, v33, v33 quad_perm:[1,0,3,2] row_mask:0xf bank_mask:0xf
    ds_write_b64 v22, v[34:35] offset:18432
    s_waitcnt vmcnt(2) lgkmcnt(0)
    s_barrier
    ds_read_b128 v[128:131], v17 offset:0
    ds_read_b128 v[132:135], v17 offset:1024
    ds_read_b128 v[136:139], v17 offset:2048
    ds_read_b128 v[140:143], v17 offset:3072
    s_waitcnt lgkmcnt(3)
    v_mfma_f32_16x16x32_bf16 v[212:215], v[128:131], a[0:3], 0
    ds_read_b64 v[32:33], v23 offset:18432
    ds_read_b64 v[34:35], v23 offset:18688
    ds_read_b64 v[36:37], v23 offset:18944
    v_mfma_f32_16x16x32_bf16 v[220:223], v[128:131], a[64:67], 0
    ds_read_b64 v[38:39], v23 offset:19200
    s_lshl_b32 s50, s46, 11
    s_add_u32 s50, s50, s80
    s_add_u32 s50, s50, 8192
    s_lshl_b32 s45, s43, 3
    v_mfma_f32_16x16x32_bf16 v[228:231], a[128:131], v[128:131], 0
    ds_read_b128 v[144:147], v17 offset:4096
    s_add_u32 s45, s45, s50
    s_waitcnt lgkmcnt(7)
    v_mfma_f32_16x16x32_bf16 v[212:215], v[132:135], a[4:7], v[212:215]
    v_mfma_f32_16x16x32_bf16 v[220:223], v[132:135], a[68:71], v[220:223]
    s_add_u32 s38, s64, s36
    s_add_u32 m0, s38, 0
    s_nop 0
    buffer_load_dwordx4 v2, s[12:15], s31 offen offset:0 lds
    v_mfma_f32_16x16x32_bf16 v[228:231], a[132:135], v[132:135], v[228:231]
    ds_read_b128 v[148:151], v17 offset:5120
    s_waitcnt lgkmcnt(7)
    v_mfma_f32_16x16x32_bf16 v[212:215], v[136:139], a[8:11], v[212:215]
    s_waitcnt lgkmcnt(2)
    v_add_f32 v32, v32, v34
    v_add_f32 v33, v33, v35
    v_mfma_f32_16x16x32_bf16 v[220:223], v[136:139], a[72:75], v[220:223]
    v_add_f32 v36, v36, v38
    v_add_f32 v37, v37, v39
    v_add_f32 v32, v32, v36
    v_mfma_f32_16x16x32_bf16 v[228:231], a[136:139], v[136:139], v[228:231]
    ds_read_b128 v[152:155], v17 offset:6144
    v_add_f32 v33, v33, v37
    v_mul_f32 v96, 0xbb000000, v32
    v_mfma_f32_16x16x32_bf16 v[212:215], v[140:143], a[12:15], v[212:215]
    v_mul_f32 v33, 0x3b000000, v33
    v_fma_f32 v33, -v96, v96, v33
    v_max_f32 v33, 0, v33
    v_mfma_f32_16x16x32_bf16 v[220:223], v[140:143], a[76:79], v[220:223]
    v_add_f32 v33, 0x3727c5ac, v33
    v_rsq_f32 v97, v33
    v_mfma_f32_16x16x32_bf16 v[228:231], a[140:143], v[140:143], v[228:231]
    ds_read_b128 v[156:159], v17 offset:7168
    ds_write_b32 v25, v96 offset:22528
    ds_write_b32 v25, v97 offset:22784
    s_waitcnt lgkmcnt(5)
    v_mfma_f32_16x16x32_bf16 v[212:215], v[144:147], a[16:19], v[212:215]
    v_mov_b32 v98, v96
    v_mov_b32 v99, v97
    v_mfma_f32_16x16x32_bf16 v[220:223], v[144:147], a[80:83], v[220:223]
    s_add_u32 s38, s64, s36
    s_add_u32 m0, s38, 1024
    s_nop 0
    buffer_load_dwordx4 v2, s[12:15], s33 offen offset:0 lds
    v_mfma_f32_16x16x32_bf16 v[228:231], a[144:147], v[144:147], v[228:231]
    ds_read_b128 v[160:163], v17 offset:8192
    s_waitcnt lgkmcnt(5)
    v_mfma_f32_16x16x32_bf16 v[212:215], v[148:151], a[20:23], v[212:215]
    s_add_u32 s38, s64, s36
    s_add_u32 m0, s38, 0
    s_nop 0
    buffer_load_dwordx4 v2, s[12:15], s31 offen offset:2048 lds
    v_mfma_f32_16x16x32_bf16 v[220:223], v[148:151], a[84:87], v[220:223]
    s_waitcnt lgkmcnt(1)
    ds_read_b128 v[80:83], v28 offset:22528
    ds_read_b128 v[88:91], v28 offset:22784
    v_mfma_f32_16x16x32_bf16 v[228:231], a[148:151], v[148:151], v[228:231]
    ds_read_b128 v[164:167], v17 offset:9216
    ds_read_b128 v[84:87], v28 offset:22592
    ds_read_b128 v[92:95], v28 offset:22848
    v_mfma_f32_16x16x32_bf16 v[212:215], v[152:155], a[24:27], v[212:215]
    v_permlane16_swap_b32 v96, v98
    v_permlane16_swap_b32 v97, v99
    v_mfma_f32_16x16x32_bf16 v[220:223], v[152:155], a[88:91], v[220:223]
    s_add_u32 s38, s64, s36
    s_add_u32 m0, s38, 1024
    s_nop 0
    buffer_load_dwordx4 v2, s[12:15], s33 offen offset:2048 lds
    s_add_u32 s31, s31, 4096
    s_add_u32 s33, s33, 4096
    v_mfma_f32_16x16x32_bf16 v[228:231], a[152:155], v[152:155], v[228:231]
    ds_read_b128 v[168:171], v17 offset:10240
    v_mfma_f32_16x16x32_bf16 v[212:215], v[156:159], a[28:31], v[212:215]
    s_add_u32 s38, s64, s36
    s_add_u32 m0, s38, 32768
    s_nop 0
    buffer_load_dwordx4 v2, s[12:15], s31 offen offset:0 lds
    v_mfma_f32_16x16x32_bf16 v[220:223], v[156:159], a[92:95], v[220:223]
    s_add_u32 s38, s64, s36
    s_add_u32 m0, s38, 33792
    s_nop 0
    buffer_load_dwordx4 v2, s[12:15], s33 offen offset:0 lds
    v_mfma_f32_16x16x32_bf16 v[228:231], a[156:159], v[156:159], v[228:231]
    ds_read_b128 v[172:175], v17 offset:11264
    s_waitcnt lgkmcnt(7)
    v_mfma_f32_16x16x32_bf16 v[212:215], v[160:163], a[32:35], v[212:215]
    s_add_u32 s38, s64, s36
    s_add_u32 m0, s38, 32768
    s_nop 0
    buffer_load_dwordx4 v2, s[12:15], s31 offen offset:2048 lds
    v_mfma_f32_16x16x32_bf16 v[220:223], v[160:163], a[96:99], v[220:223]
    s_add_u32 s38, s64, s36
    s_add_u32 m0, s38, 33792
    s_nop 0
    buffer_load_dwordx4 v2, s[12:15], s33 offen offset:2048 lds
    s_add_u32 s31, s31, 4096
    s_add_u32 s33, s33, 4096
    v_mfma_f32_16x16x32_bf16 v[228:231], a[160:163], v[160:163], v[228:231]
    ds_read_b128 v[176:179], v17 offset:12288
    s_waitcnt lgkmcnt(3)
    v_mfma_f32_16x16x32_bf16 v[212:215], v[164:167], a[36:39], v[212:215]
    v_mfma_f32_16x16x32_bf16 v[220:223], v[164:167], a[100:103], v[220:223]
    s_add_u32 s38, s62, s36
    s_add_u32 m0, s38, 0
    s_nop 0
    buffer_load_dwordx4 v2, s[12:15], s31 offen offset:0 lds
    v_mfma_f32_16x16x32_bf16 v[228:231], a[164:167], v[164:167], v[228:231]
    ds_read_b128 v[180:183], v17 offset:13312
    s_waitcnt lgkmcnt(3)
    v_mfma_f32_16x16x32_bf16 v[212:215], v[168:171], a[40:43], v[212:215]
    v_mfma_f32_16x16x32_bf16 v[220:223], v[168:171], a[104:107], v[220:223]
    s_add_u32 s38, s62, s36
    s_add_u32 m0, s38, 1024
    s_nop 0
    buffer_load_dwordx4 v2, s[12:15], s33 offen offset:0 lds
    v_mfma_f32_16x16x32_bf16 v[228:231], a[168:171], v[168:171], v[228:231]
    ds_read_b128 v[184:187], v17 offset:14336
    s_waitcnt lgkmcnt(3)
    v_mfma_f32_16x16x32_bf16 v[212:215], v[172:175], a[44:47], v[212:215]
    v_mfma_f32_16x16x32_bf16 v[220:223], v[172:175], a[108:111], v[220:223]
    s_add_u32 s38, s62, s36
    s_add_u32 m0, s38, 0
    s_nop 0
    buffer_load_dwordx4 v2, s[12:15], s31 offen offset:2048 lds
    v_mfma_f32_16x16x32_bf16 v[228:231], a[172:175], v[172:175], v[228:231]
    ds_read_b128 v[188:191], v17 offset:15360
    s_waitcnt lgkmcnt(3)
    v_mfma_f32_16x16x32_bf16 v[212:215], v[176:179], a[48:51], v[212:215]
    v_mfma_f32_16x16x32_bf16 v[220:223], v[176:179], a[112:115], v[220:223]
    s_add_u32 s38, s62, s36
    s_add_u32 m0, s38, 1024
    s_nop 0
    buffer_load_dwordx4 v2, s[12:15], s33 offen offset:2048 lds
    s_add_u32 s31, s31, 4096
    s_add_u32 s33, s33, 4096
    v_mfma_f32_16x16x32_bf16 v[228:231], a[176:179], v[176:179], v[228:231]
    ds_read_b128 v[128:131], v17 offset:32768
    s_waitcnt lgkmcnt(3)
    v_mfma_f32_16x16x32_bf16 v[212:215], v[180:183], a[52:55], v[212:215]
    v_mfma_f32_16x16x32_bf16 v[220:223], v[180:183], a[116:119], v[220:223]
    ds_read_b128 v[132:135], v17 offset:33792
    v_mfma_f32_16x16x32_bf16 v[228:231], a[180:183], v[180:183], v[228:231]
    s_add_u32 s38, s62, s36
    s_add_u32 m0, s38, 32768
    s_nop 0
    buffer_load_dwordx4 v2, s[12:15], s31 offen offset:0 lds
    s_waitcnt lgkmcnt(3)
    v_mfma_f32_16x16x32_bf16 v[212:215], v[184:187], a[56:59], v[212:215]
    ds_read_b128 v[136:139], v17 offset:34816
    v_mfma_f32_16x16x32_bf16 v[220:223], v[184:187], a[120:123], v[220:223]
    s_add_u32 s38, s62, s36
    s_add_u32 m0, s38, 33792
    s_nop 0
    buffer_load_dwordx4 v2, s[12:15], s33 offen offset:0 lds
    v_mfma_f32_16x16x32_bf16 v[228:231], a[184:187], v[184:187], v[228:231]
    ds_read_b128 v[140:143], v17 offset:35840
    s_waitcnt lgkmcnt(4)
    v_mfma_f32_16x16x32_bf16 v[212:215], v[188:191], a[60:63], v[212:215]
    v_mfma_f32_16x16x32_bf16 v[220:223], v[188:191], a[124:127], v[220:223]
    ds_read_b128 v[144:147], v17 offset:36864
    v_mfma_f32_16x16x32_bf16 v[228:231], a[188:191], v[188:191], v[228:231]
    s_add_u32 s38, s62, s36
    s_add_u32 m0, s38, 32768
    s_nop 0
    buffer_load_dwordx4 v2, s[12:15], s31 offen offset:2048 lds
    s_waitcnt lgkmcnt(4)
    v_mfma_f32_16x16x32_bf16 v[216:219], v[128:131], a[0:3], 0
    ds_read_b128 v[148:151], v17 offset:37888
    v_mfma_f32_16x16x32_bf16 v[224:227], v[128:131], a[64:67], 0
    s_add_u32 s38, s62, s36
    s_add_u32 m0, s38, 33792
    s_nop 0
    buffer_load_dwordx4 v2, s[12:15], s33 offen offset:2048 lds
    s_add_u32 s31, s31, 4096
    s_add_u32 s33, s33, 4096
    s_waitcnt lgkmcnt(4)
    v_mfma_f32_16x16x32_bf16 v[216:219], v[132:135], a[4:7], v[216:219]
    ds_read_b128 v[152:155], v17 offset:38912
    v_fma_f32 v212, v80, v4, v212
    v_fma_f32 v213, v81, v4, v213
    v_mfma_f32_16x16x32_bf16 v[224:227], v[132:135], a[68:71], v[224:227]
    v_fma_f32 v214, v82, v4, v214
    v_fma_f32 v215, v83, v4, v215
    v_fma_f32 v220, v80, v8, v220
    s_waitcnt lgkmcnt(4)
    v_mfma_f32_16x16x32_bf16 v[216:219], v[136:139], a[8:11], v[216:219]
    ds_read_b128 v[156:159], v17 offset:39936
    v_fma_f32 v221, v81, v8, v221
    v_fma_f32 v222, v82, v8, v222
    v_mfma_f32_16x16x32_bf16 v[224:227], v[136:139], a[72:75], v[224:227]
    v_fma_f32 v223, v83, v8, v223
    v_fma_f32 v212, v88, v212, v5
    v_fma_f32 v213, v89, v213, v5
    s_waitcnt lgkmcnt(4)
    v_mfma_f32_16x16x32_bf16 v[216:219], v[140:143], a[12:15], v[216:219]
    ds_read_b128 v[160:163], v17 offset:40960
    v_fma_f32 v214, v90, v214, v5
    v_fma_f32 v215, v91, v215, v5
    v_mfma_f32_16x16x32_bf16 v[224:227], v[140:143], a[76:79], v[224:227]
    v_fma_f32 v220, v88, v220, v9
    v_fma_f32 v221, v89, v221, v9
    v_fma_f32 v222, v90, v222, v9
    s_waitcnt lgkmcnt(4)
    v_mfma_f32_16x16x32_bf16 v[216:219], v[144:147], a[16:19], v[216:219]
    ds_read_b128 v[164:167], v17 offset:41984
    v_fma_f32 v223, v91, v223, v9
    v_mul_f32 v32, v212, v212
    v_mfma_f32_16x16x32_bf16 v[224:227], v[144:147], a[80:83], v[224:227]
    v_mul_f32 v33, v213, v213
    v_mul_f32 v34, v214, v214
    v_mul_f32 v35, v215, v215
    s_waitcnt lgkmcnt(4)
    v_mfma_f32_16x16x32_bf16 v[216:219], v[148:151], a[20:23], v[216:219]
    ds_read_b128 v[168:171], v17 offset:43008
    v_mul_f32 v36, v220, v220
    v_mul_f32 v37, v221, v221
    v_mfma_f32_16x16x32_bf16 v[224:227], v[148:151], a[84:87], v[224:227]
    v_mul_f32 v38, v222, v222
    v_mul_f32 v39, v223, v223
    v_fma_f32 v32, v32, v60, s44
    s_waitcnt lgkmcnt(4)
    v_mfma_f32_16x16x32_bf16 v[216:219], v[152:155], a[24:27], v[216:219]
    ds_read_b128 v[172:175], v17 offset:44032
    s_waitcnt vmcnt(16)
    v_fma_f32 v33, v33, v60, s44
    v_mfma_f32_16x16x32_bf16 v[224:227], v[152:155], a[88:91], v[224:227]
    v_mov_b32 v58, 1
    s_mov_b64 exec, 1
    buffer_store_dword v58, off, s[12:15], s59 sc1
    s_mov_b64 exec, -1
    s_waitcnt lgkmcnt(4)
    v_mfma_f32_16x16x32_bf16 v[216:219], v[156:159], a[28:31], v[216:219]
    ds_read_b128 v[176:179], v17 offset:45056
    s_lshl_b32 s34, s43, 6
    s_add_u32 s34, s34, s71
    v_mfma_f32_16x16x32_bf16 v[224:227], v[156:159], a[92:95], v[224:227]
    s_lshl_b32 s59, s34, 4
    s_mul_i32 s34, s34, 6144
    s_add_u32 s54, s34, 75497472
    s_lshl_b32 s34, s55, 2
    s_add_u32 s59, s59, s34
    s_add_u32 s59, s59, 434176
    s_waitcnt lgkmcnt(4)
    v_mfma_f32_16x16x32_bf16 v[216:219], v[160:163], a[32:35], v[216:219]
    ds_read_b128 v[180:183], v17 offset:46080
    v_fma_f32 v34, v34, v60, s44
    v_fma_f32 v35, v35, v60, s44
    v_mfma_f32_16x16x32_bf16 v[224:227], v[160:163], a[96:99], v[224:227]
    v_fma_f32 v36, v36, v60, s44
    v_fma_f32 v37, v37, v60, s44
    v_fma_f32 v38, v38, v60, s44
    s_waitcnt lgkmcnt(4)
    v_mfma_f32_16x16x32_bf16 v[216:219], v[164:167], a[36:39], v[216:219]
    ds_read_b128 v[184:187], v17 offset:47104
    v_fma_f32 v39, v39, v60, s44
    v_mul_f32 v32, v32, v212
    v_mfma_f32_16x16x32_bf16 v[224:227], v[164:167], a[100:103], v[224:227]
    v_mul_f32 v33, v33, v213
    v_mul_f32 v34, v34, v214
    v_mul_f32 v35, v35, v215
    s_waitcnt lgkmcnt(4)
    v_mfma_f32_16x16x32_bf16 v[216:219], v[168:171], a[40:43], v[216:219]
    ds_read_b128 v[188:191], v17 offset:48128
    v_mul_f32 v36, v36, v220
    v_mul_f32 v37, v37, v221
    v_mfma_f32_16x16x32_bf16 v[224:227], v[168:171], a[104:107], v[224:227]
    v_mul_f32 v38, v38, v222
    v_mul_f32 v39, v39, v223
    v_fma_f32 v228, v96, v64, v228
    s_waitcnt lgkmcnt(4)
    v_mfma_f32_16x16x32_bf16 v[216:219], v[172:175], a[44:47], v[216:219]
    v_exp_f32 v32, v32
    v_fma_f32 v229, v96, v65, v229
    v_mfma_f32_16x16x32_bf16 v[224:227], v[172:175], a[108:111], v[224:227]
    v_exp_f32 v33, v33
    v_fma_f32 v230, v96, v66, v230
    s_waitcnt lgkmcnt(3)
    v_mfma_f32_16x16x32_bf16 v[216:219], v[176:179], a[48:51], v[216:219]
    v_exp_f32 v34, v34
    v_fma_f32 v231, v96, v67, v231
    v_mfma_f32_16x16x32_bf16 v[224:227], v[176:179], a[112:115], v[224:227]
    v_exp_f32 v35, v35
    v_fma_f32 v228, v97, v228, v68
    s_waitcnt lgkmcnt(2)
    v_mfma_f32_16x16x32_bf16 v[216:219], v[180:183], a[52:55], v[216:219]
    v_exp_f32 v36, v36
    v_fma_f32 v229, v97, v229, v69
    v_mfma_f32_16x16x32_bf16 v[224:227], v[180:183], a[116:119], v[224:227]
    v_exp_f32 v37, v37
    v_fma_f32 v230, v97, v230, v70
    s_waitcnt lgkmcnt(1)
    v_mfma_f32_16x16x32_bf16 v[216:219], v[184:187], a[56:59], v[216:219]
    v_exp_f32 v38, v38
    v_fma_f32 v231, v97, v231, v71
    v_mfma_f32_16x16x32_bf16 v[224:227], v[184:187], a[120:123], v[224:227]
    v_exp_f32 v39, v39
    v_add_f32 v32, 1.0, v32
    s_waitcnt lgkmcnt(0)
    v_mfma_f32_16x16x32_bf16 v[216:219], v[188:191], a[60:63], v[216:219]
    v_add_f32 v33, 1.0, v33
    v_add_f32 v34, 1.0, v34
    v_add_f32 v35, 1.0, v35
    v_mfma_f32_16x16x32_bf16 v[224:227], v[188:191], a[124:127], v[224:227]
    v_add_f32 v36, 1.0, v36
    v_add_f32 v37, 1.0, v37
    v_add_f32 v38, 1.0, v38
    v_mfma_f32_16x16x32_bf16 v[232:235], a[128:131], v[128:131], 0
    v_add_f32 v39, 1.0, v39
    v_rcp_f32 v32, v32
    v_mfma_f32_16x16x32_bf16 v[232:235], a[132:135], v[132:135], v[232:235]
    v_rcp_f32 v33, v33
    v_mul_f32 v192, v228, v228
    v_mfma_f32_16x16x32_bf16 v[232:235], a[136:139], v[136:139], v[232:235]
    v_rcp_f32 v34, v34
    v_mul_f32 v193, v229, v229
    v_mfma_f32_16x16x32_bf16 v[232:235], a[140:143], v[140:143], v[232:235]
    v_rcp_f32 v35, v35
    v_mul_f32 v194, v230, v230
    v_mfma_f32_16x16x32_bf16 v[232:235], a[144:147], v[144:147], v[232:235]
    v_rcp_f32 v36, v36
    v_mul_f32 v195, v231, v231
    v_mfma_f32_16x16x32_bf16 v[232:235], a[148:151], v[148:151], v[232:235]
    v_rcp_f32 v37, v37
    v_fma_f32 v192, v192, v60, s44
    v_mfma_f32_16x16x32_bf16 v[232:235], a[152:155], v[152:155], v[232:235]
    v_rcp_f32 v38, v38
    v_fma_f32 v193, v193, v60, s44
    v_mfma_f32_16x16x32_bf16 v[232:235], a[156:159], v[156:159], v[232:235]
    v_rcp_f32 v39, v39
    v_mul_f32 v212, v212, v32
    v_mfma_f32_16x16x32_bf16 v[232:235], a[160:163], v[160:163], v[232:235]
    v_mul_f32 v213, v213, v33
    v_mul_f32 v214, v214, v34
    v_mul_f32 v215, v215, v35
    v_mfma_f32_16x16x32_bf16 v[232:235], a[164:167], v[164:167], v[232:235]
    v_mul_f32 v220, v220, v36
    v_mul_f32 v221, v221, v37
    v_mul_f32 v222, v222, v38
    v_mfma_f32_16x16x32_bf16 v[232:235], a[168:171], v[168:171], v[232:235]
    v_mul_f32 v223, v223, v39
    v_add_f32 v40, v212, v220
    v_mul_f32 v48, v212, v212
    v_mfma_f32_16x16x32_bf16 v[232:235], a[172:175], v[172:175], v[232:235]
    v_add_f32 v41, v213, v221
    v_mul_f32 v49, v213, v213
    v_add_f32 v42, v214, v222
    v_mfma_f32_16x16x32_bf16 v[232:235], a[176:179], v[176:179], v[232:235]
    v_mul_f32 v50, v214, v214
    v_add_f32 v43, v215, v223
    v_mul_f32 v51, v215, v215
    v_mfma_f32_16x16x32_bf16 v[232:235], a[180:183], v[180:183], v[232:235]
    v_fmac_f32 v48, v220, v220
    v_fmac_f32 v49, v221, v221
    v_fmac_f32 v50, v222, v222
    v_mfma_f32_16x16x32_bf16 v[232:235], a[184:187], v[184:187], v[232:235]
    v_fmac_f32 v51, v223, v223
    v_fma_f32 v216, v84, v4, v216
    v_fma_f32 v217, v85, v4, v217
    v_mfma_f32_16x16x32_bf16 v[232:235], a[188:191], v[188:191], v[232:235]
    v_fma_f32 v218, v86, v4, v218
    v_fma_f32 v219, v87, v4, v219
    v_fma_f32 v224, v84, v8, v224
    v_add_u32 v56, s36, v2
    v_add_u32 v59, s64, v56
    v_add_u32 v58, s62, v56
    v_add_u32 v56, s65, v56
    s_waitcnt vmcnt(1)
    ds_read_b128 a[0:3], v56 offset:0
    ds_read_b128 a[4:7], v56 offset:1024
    ds_read_b128 a[8:11], v56 offset:2048
    ds_read_b128 a[12:15], v56 offset:3072
    ds_read_b128 a[16:19], v56 offset:32768
    ds_read_b128 a[20:23], v56 offset:33792
    ds_read_b128 a[24:27], v56 offset:34816
    ds_read_b128 a[28:31], v56 offset:35840
    ds_read_b128 a[32:35], v59 offset:0
    ds_read_b128 a[36:39], v59 offset:1024
    ds_read_b128 a[40:43], v59 offset:2048
    ds_read_b128 a[44:47], v59 offset:3072
    ds_read_b128 a[48:51], v59 offset:32768
    ds_read_b128 a[52:55], v59 offset:33792
    ds_read_b128 a[56:59], v59 offset:34816
    ds_read_b128 a[60:63], v59 offset:35840
    ds_read_b128 a[64:67], v58 offset:0
    ds_read_b128 a[68:71], v58 offset:1024
    ds_read_b128 a[72:75], v58 offset:2048
    ds_read_b128 a[76:79], v58 offset:3072
    ds_read_b128 a[80:83], v58 offset:32768
    ds_read_b128 a[84:87], v58 offset:33792
    ds_read_b128 a[88:91], v58 offset:34816
    ds_read_b128 a[92:95], v58 offset:35840
    s_lshl_b32 s34, s43, 10
    s_lshl_b32 s38, s55, 7
    s_add_u32 s34, s34, s38
    s_add_u32 s28, s34, 434176
    v_lshlrev_b32 v18, 2, v20
    buffer_load_dword v57, v18, s[12:15], s28 offen sc1
    s_lshl_b32 s34, s3, 4
    v_xor_b32 v58, s34, v20
    v_lshlrev_b32 v16, 4, v58
    v_lshl_add_u32 v16, v21, 9, v16
    s_cmp_eq_u32 s43, 7
    s_cselect_b32 s34, 8, 24
    v_cmp_gt_u32 vcc, s34, v58
    v_mov_b32 v17, 1073741824
    s_nop 0
    v_cndmask_b32 v17, v17, v16, vcc
    s_lshl_b32 s34, s43, 7
    s_lshl_b32 s38, s55, 4
    s_add_u32 s34, s34, s38
    s_mul_i32 s34, s34, 3072
    s_add_u32 s29, s34, 75497472
    v_fma_f32 v225, v85, v8, v225
    v_fma_f32 v226, v86, v8, v226
    v_fma_f32 v227, v87, v8, v227
    v_fma_f32 v216, v92, v216, v5
    v_fma_f32 v217, v93, v217, v5
    v_fma_f32 v218, v94, v218, v5
    buffer_load_dwordx4 a[96:99], v2, s[12:15], s31 offen offset:0
    v_fma_f32 v219, v95, v219, v5
    v_fma_f32 v224, v92, v224, v9
    v_fma_f32 v225, v93, v225, v9
    v_fma_f32 v226, v94, v226, v9
    v_fma_f32 v227, v95, v227, v9
    v_mul_f32 v32, v216, v216
    buffer_load_dwordx4 a[100:103], v2, s[12:15], s33 offen offset:0
    v_mul_f32 v33, v217, v217
    v_mul_f32 v34, v218, v218
    v_mul_f32 v35, v219, v219
    v_mul_f32 v36, v224, v224
    v_mul_f32 v37, v225, v225
    v_mul_f32 v38, v226, v226
    buffer_load_dwordx4 a[104:107], v2, s[12:15], s31 offen offset:2048
    v_mul_f32 v39, v227, v227
    v_fma_f32 v32, v32, v60, s44
    v_fma_f32 v33, v33, v60, s44
    v_fma_f32 v34, v34, v60, s44
    v_fma_f32 v35, v35, v60, s44
    v_fma_f32 v36, v36, v60, s44
    buffer_load_dwordx4 a[108:111], v2, s[12:15], s33 offen offset:2048
    s_add_u32 s31, s31, 4096
    s_add_u32 s33, s33, 4096
    v_fma_f32 v37, v37, v60, s44
    v_fma_f32 v38, v38, v60, s44
    v_fma_f32 v39, v39, v60, s44
    v_mul_f32 v32, v32, v216
    v_mul_f32 v33, v33, v217
    v_mul_f32 v34, v34, v218
    buffer_load_dwordx4 a[112:115], v2, s[12:15], s31 offen offset:0
    v_mul_f32 v35, v35, v219
    v_mul_f32 v36, v36, v224
    v_mul_f32 v37, v37, v225
    v_mul_f32 v38, v38, v226
    v_mul_f32 v39, v39, v227
    v_exp_f32 v32, v32
    buffer_load_dwordx4 a[116:119], v2, s[12:15], s33 offen offset:0
    v_exp_f32 v33, v33
    v_exp_f32 v34, v34
    v_exp_f32 v35, v35
    v_exp_f32 v36, v36
    v_exp_f32 v37, v37
    v_exp_f32 v38, v38
    buffer_load_dwordx4 a[120:123], v2, s[12:15], s31 offen offset:2048
    v_exp_f32 v39, v39
    v_add_f32 v32, 1.0, v32
    v_add_f32 v33, 1.0, v33
    v_add_f32 v34, 1.0, v34
    v_add_f32 v35, 1.0, v35
    v_add_f32 v36, 1.0, v36
    buffer_load_dwordx4 a[124:127], v2, s[12:15], s33 offen offset:2048
    s_add_u32 s31, s31, 4096
    s_add_u32 s33, s33, 4096
    v_add_f32 v37, 1.0, v37
    v_add_f32 v38, 1.0, v38
    v_add_f32 v39, 1.0, v39
    v_rcp_f32 v32, v32
    v_rcp_f32 v33, v33
    v_rcp_f32 v34, v34
    buffer_load_dwordx4 a[128:131], v2, s[12:15], s31 offen offset:0
    v_rcp_f32 v35, v35
    v_rcp_f32 v36, v36
    v_rcp_f32 v37, v37
    v_rcp_f32 v38, v38
    v_rcp_f32 v39, v39
    v_mul_f32 v216, v216, v32
    buffer_load_dwordx4 a[132:135], v2, s[12:15], s33 offen offset:0
    v_mul_f32 v217, v217, v33
    v_mul_f32 v218, v218, v34
    v_mul_f32 v219, v219, v35
    v_mul_f32 v224, v224, v36
    v_mul_f32 v225, v225, v37
    v_mul_f32 v226, v226, v38
    buffer_load_dwordx4 a[136:139], v2, s[12:15], s31 offen offset:2048
    v_mul_f32 v227, v227, v39
    v_add_f32 v44, v216, v224
    v_mul_f32 v52, v216, v216
    v_add_f32 v45, v217, v225
    v_mul_f32 v53, v217, v217
    v_add_f32 v46, v218, v226
    buffer_load_dwordx4 a[140:143], v2, s[12:15], s33 offen offset:2048
    s_add_u32 s31, s31, 4096
    s_add_u32 s33, s33, 4096
    v_mul_f32 v54, v218, v218
    v_add_f32 v47, v219, v227
    v_mul_f32 v55, v219, v219
    v_fmac_f32 v52, v224, v224
    v_fmac_f32 v53, v225, v225
    v_fmac_f32 v54, v226, v226
    buffer_load_dwordx4 a[144:147], v2, s[12:15], s31 offen offset:0
    v_fmac_f32 v55, v227, v227
    v_add_f32_dpp v100, v40, v40 row_ror:8 row_mask:0xf bank_mask:0x3
    v_add_f32_dpp v101, v41, v41 row_ror:8 row_mask:0xf bank_mask:0x3
    v_add_f32_dpp v102, v42, v42 row_ror:8 row_mask:0xf bank_mask:0x3
    v_add_f32_dpp v103, v43, v43 row_ror:8 row_mask:0xf bank_mask:0x3
    v_add_f32_dpp v104, v44, v44 row_ror:8 row_mask:0xf bank_mask:0x3
    buffer_load_dwordx4 a[148:151], v2, s[12:15], s33 offen offset:0
    v_add_f32_dpp v105, v45, v45 row_ror:8 row_mask:0xf bank_mask:0x3
    v_add_f32_dpp v106, v46, v46 row_ror:8 row_mask:0xf bank_mask:0x3
    v_add_f32_dpp v107, v47, v47 row_ror:8 row_mask:0xf bank_mask:0x3
    v_add_f32_dpp v100, v48, v48 row_ror:8 row_mask:0xf bank_mask:0xc
    v_add_f32_dpp v101, v49, v49 row_ror:8 row_mask:0xf bank_mask:0xc
    v_add_f32_dpp v102, v50, v50 row_ror:8 row_mask:0xf bank_mask:0xc
    buffer_load_dwordx4 a[152:155], v2, s[12:15], s31 offen offset:2048
    v_add_f32_dpp v103, v51, v51 row_ror:8 row_mask:0xf bank_mask:0xc
    v_add_f32_dpp v104, v52, v52 row_ror:8 row_mask:0xf bank_mask:0xc
    v_add_f32_dpp v105, v53, v53 row_ror:8 row_mask:0xf bank_mask:0xc
    v_add_f32_dpp v106, v54, v54 row_ror:8 row_mask:0xf bank_mask:0xc
    v_add_f32_dpp v107, v55, v55 row_ror:8 row_mask:0xf bank_mask:0xc
    v_add_f32_dpp v40, v100, v100 row_half_mirror row_mask:0xf bank_mask:0x5
    buffer_load_dwordx4 a[156:159], v2, s[12:15], s33 offen offset:2048
    s_add_u32 s31, s31, 4096
    s_add_u32 s33, s33, 4096
    v_add_f32_dpp v41, v101, v101 row_half_mirror row_mask:0xf bank_mask:0x5
    v_add_f32_dpp v42, v102, v102 row_half_mirror row_mask:0xf bank_mask:0x5
    v_add_f32_dpp v43, v103, v103 row_half_mirror row_mask:0xf bank_mask:0x5
    v_add_f32_dpp v40, v104, v104 row_half_mirror row_mask:0xf bank_mask:0xa
    v_add_f32_dpp v41, v105, v105 row_half_mirror row_mask:0xf bank_mask:0xa
    v_add_f32_dpp v42, v106, v106 row_half_mirror row_mask:0xf bank_mask:0xa
    v_add_f32_dpp v43, v107, v107 row_half_mirror row_mask:0xf bank_mask:0xa
    v_cndmask_b32_e64 v100, v40, v42, s[52:53]
    v_cndmask_b32_e64 v102, v42, v40, s[52:53]
    v_cndmask_b32_e64 v101, v41, v43, s[52:53]
    v_cndmask_b32_e64 v103, v43, v41, s[52:53]
    v_add_f32_dpp v40, v102, v100 quad_perm:[2,3,0,1] row_mask:0xf bank_mask:0xf
    s_nop 0
    v_add_f32_dpp v41, v103, v101 quad_perm:[2,3,0,1] row_mask:0xf bank_mask:0xf
    v_cndmask_b32_e64 v100, v40, v41, s[60:61]
    v_cndmask_b32_e64 v101, v41, v40, s[60:61]
    s_nop 1
    v_add_f32_dpp v40, v101, v100 quad_perm:[1,0,3,2] row_mask:0xf bank_mask:0xf
    ds_write_b32 v30, v40 offset:26624
    s_waitcnt lgkmcnt(0)
    s_barrier
    ds_read_b64 v[100:101], v23 offset:26624
    ds_read_b64 v[102:103], v23 offset:26880
    ds_read_b64 v[104:105], v23 offset:27136
    ds_read_b64 v[106:107], v23 offset:27392
    s_waitcnt lgkmcnt(0)
    v_add_f32 v100, v100, v102
    v_add_f32 v101, v101, v103
    v_add_f32 v104, v104, v106
    v_add_f32 v105, v105, v107
    v_add_f32 v100, v100, v104
    v_add_f32 v101, v101, v105
    v_or_b32 v101, 0x80000000, v101
    s_cmp_eq_u32 s8, 0
    s_cbranch_scc1 TL_LF_14
    s_mov_b64 exec, s[66:67]
    buffer_store_dwordx2 v[100:101], v27, s[12:15], s45 offen
    s_mov_b64 exec, -1
TL_LF_14_R:
    s_waitcnt vmcnt(17)
    v_cmp_le_u32 vcc, 1, v57
    s_nop 0
    s_cmp_eq_u64 vcc, -1
    s_cbranch_scc0 TAFZL_S
TAFZL_R:
    buffer_load_dwordx4 v[128:131], v16, s[12:15], s29 offen offset:0
    buffer_load_dwordx4 v[132:135], v16, s[12:15], s29 offen offset:1024
    buffer_load_dwordx4 v[136:139], v17, s[12:15], s29 offen offset:2048
    s_add_u32 s29, s29, 3072
    buffer_load_dwordx4 v[140:143], v16, s[12:15], s29 offen offset:0
    buffer_load_dwordx4 v[144:147], v16, s[12:15], s29 offen offset:1024
    buffer_load_dwordx4 v[148:151], v17, s[12:15], s29 offen offset:2048
    s_add_u32 s29, s29, 3072
    v_fma_f32 v194, v194, v60, s44
    v_fma_f32 v195, v195, v60, s44
    v_mul_f32 v192, v192, v228
    v_mul_f32 v193, v193, v229
    v_mul_f32 v194, v194, v230
    v_mul_f32 v195, v195, v231
    v_exp_f32 v192, v192
    v_exp_f32 v193, v193
    v_exp_f32 v194, v194
    v_exp_f32 v195, v195
    v_add_f32 v192, 1.0, v192
    v_add_f32 v193, 1.0, v193
    v_add_f32 v194, 1.0, v194
    v_add_f32 v195, 1.0, v195
    v_rcp_f32 v192, v192
    v_rcp_f32 v193, v193
    v_rcp_f32 v194, v194
    v_rcp_f32 v195, v195
    v_mul_f32 v228, v228, v192
    v_mul_f32 v229, v229, v193
    v_mul_f32 v230, v230, v194
    v_mul_f32 v231, v231, v195
    v_cvt_pk_bf16_f32 v192, v228, v229
    v_cvt_pk_bf16_f32 v193, v230, v231
    ds_write_b64 v29, v[192:193] offset:6400
    v_fma_f32 v232, v98, v64, v232
    v_fma_f32 v233, v98, v65, v233
    v_fma_f32 v234, v98, v66, v234
    v_fma_f32 v235, v98, v67, v235
    v_fma_f32 v232, v99, v232, v68
    v_fma_f32 v233, v99, v233, v69
    v_fma_f32 v234, v99, v234, v70
    buffer_load_dwordx4 v[236:239], v31, s[12:15], s50 offen sc0 sc1
    buffer_load_dwordx4 v[240:243], v31, s[12:15], s50 offen offset:16 sc0 sc1
    buffer_load_dwordx4 v[152:155], v16, s[12:15], s29 offen offset:0
    buffer_load_dwordx4 v[156:159], v16, s[12:15], s29 offen offset:1024
    buffer_load_dwordx4 v[160:163], v17, s[12:15], s29 offen offset:2048
    s_add_u32 s29, s29, 3072
    buffer_load_dwordx4 v[164:167], v16, s[12:15], s29 offen offset:0
    buffer_load_dwordx4 v[168:171], v16, s[12:15], s29 offen offset:1024
    buffer_load_dwordx4 v[172:175], v17, s[12:15], s29 offen offset:2048
    s_add_u32 s29, s29, 3072
    buffer_load_dwordx4 v[176:179], v16, s[12:15], s29 offen offset:0
    buffer_load_dwordx4 v[180:183], v16, s[12:15], s29 offen offset:1024
    buffer_load_dwordx4 v[184:187], v17, s[12:15], s29 offen offset:2048
    s_add_u32 s29, s29, 3072
    v_fma_f32 v235, v99, v235, v71
    v_mul_f32 v192, v232, v232
    v_mul_f32 v193, v233, v233
    v_mul_f32 v194, v234, v234
    v_mul_f32 v195, v235, v235
    v_fma_f32 v192, v192, v60, s44
    v_fma_f32 v193, v193, v60, s44
    v_fma_f32 v194, v194, v60, s44
    v_fma_f32 v195, v195, v60, s44
    v_mul_f32 v192, v192, v232
    v_mul_f32 v193, v193, v233
    v_mul_f32 v194, v194, v234
    v_mul_f32 v195, v195, v235
    v_exp_f32 v192, v192
    v_exp_f32 v193, v193
    v_exp_f32 v194, v194
    v_exp_f32 v195, v195
    v_add_f32 v192, 1.0, v192
    v_add_f32 v193, 1.0, v193
    v_add_f32 v194, 1.0, v194
    v_add_f32 v195, 1.0, v195
    v_rcp_f32 v192, v192
    v_rcp_f32 v193, v193
    v_rcp_f32 v194, v194
    v_rcp_f32 v195, v195
    v_mul_f32 v232, v232, v192
    v_mul_f32 v233, v233, v193
    v_mul_f32 v234, v234, v194
    v_mul_f32 v235, v235, v195
    v_cvt_pk_bf16_f32 v192, v232, v233
    v_cvt_pk_bf16_f32 v193, v234, v235
    ds_write_b64 v29, v[192:193] offset:9600
    buffer_load_dwordx4 v[188:191], v16, s[12:15], s29 offen offset:0
    buffer_load_dwordx4 v[192:195], v16, s[12:15], s29 offen offset:1024
    buffer_load_dwordx4 v[196:199], v17, s[12:15], s29 offen offset:2048
    s_add_u32 s29, s29, 3072
    buffer_load_dwordx4 v[200:203], v16, s[12:15], s29 offen offset:0
    buffer_load_dwordx4 v[204:207], v16, s[12:15], s29 offen offset:1024
    buffer_load_dwordx4 v[208:211], v17, s[12:15], s29 offen offset:2048
    s_add_u32 s29, s29, 3072
    s_waitcnt lgkmcnt(0)
    s_branch TL_S
TL_WB:
    s_waitcnt lgkmcnt(3)
    v_mfma_f32_16x16x32_bf16 v[4:7], v[192:195], a[0:3], 0
    ds_read_b128 v[208:211], v18 offset:4096
    s_lshl_b32 s34, s55, 8
    s_add_u32 s34, s34, 131072
    v_lshrrev_b32 v56, 1, v1
    v_mfma_f32_16x16x32_bf16 v[8:11], a[64:67], v[192:195], 0
    v_lshl_add_u32 v22, v56, 3, s34
    v_lshlrev_b32 v23, 3, v20
    v_add_u32 v23, 131072, v23
    v_mfma_f32_16x16x32_bf16 v[12:15], a[128:131], v[192:195], 0
    v_bfe_u32 v56, v1, 2, 1
    v_lshlrev_b32 v56, 7, v56
    v_lshrrev_b32 v59, 4, v1
    s_waitcnt lgkmcnt(3)
    v_mfma_f32_16x16x32_bf16 v[4:7], v[196:199], a[4:7], v[4:7]
    ds_read_b128 v[212:215], v18 offset:5120
    v_lshl_add_u32 v56, v59, 5, v56
    v_and_b32 v30, 3, v1
    v_mfma_f32_16x16x32_bf16 v[8:11], a[68:71], v[196:199], v[8:11]
    v_lshl_add_u32 v56, v30, 3, v56
    v_bfe_u32 v30, v1, 3, 1
    v_lshl_add_u32 v56, v30, 2, v56
    v_mfma_f32_16x16x32_bf16 v[12:15], a[132:135], v[196:199], v[12:15]
    v_add_u32 v30, s34, v56
    s_lshl_b32 s34, s55, 9
    s_add_u32 s34, s34, 131072
    v_lshl_add_u32 v25, v20, 2, s34
    s_waitcnt lgkmcnt(3)
    v_mfma_f32_16x16x32_bf16 v[4:7], v[200:203], a[8:11], v[4:7]
    ds_read_b128 v[216:219], v18 offset:6144
    s_waitcnt vmcnt(11)
    v_mov_b32 v58, 2
    s_mov_b64 exec, 1
    buffer_store_dword v58, off, s[12:15], s92 sc1
    s_mov_b64 exec, -1
    v_mfma_f32_16x16x32_bf16 v[8:11], a[72:75], v[200:203], v[8:11]
    v_lshl_add_u32 v28, v59, 4, s34
    v_and_b32 v56, 15, v1
    v_mul_u32_u24 v29, 200, v56
    v_mfma_f32_16x16x32_bf16 v[12:15], a[136:139], v[200:203], v[12:15]
    v_lshl_add_u32 v29, v59, 3, v29
    v_lshl_add_u32 v31, v21, 5, v27
    v_mul_u32_u24 v3, 3072, v21
    s_waitcnt lgkmcnt(3)
    v_mfma_f32_16x16x32_bf16 v[4:7], v[204:207], a[12:15], v[4:7]
    ds_read_b128 v[220:223], v18 offset:7168
    v_bfe_u32 v59, v1, 4, 1
    v_lshl_add_u32 v3, v59, 9, v3
    v_mfma_f32_16x16x32_bf16 v[8:11], a[76:79], v[204:207], v[8:11]
    v_lshl_add_u32 v3, v56, 4, v3
    s_mov_b32 s52, 0xcccccccc
    s_mov_b32 s53, 0xcccccccc
    s_mov_b32 s60, 0xaaaaaaaa
    s_mov_b32 s61, 0xaaaaaaaa
    v_mfma_f32_16x16x32_bf16 v[12:15], a[140:143], v[204:207], v[12:15]
    s_lshl_b32 s34, s55, 3
    s_mov_b64 s[66:67], 0xff
    s_lshl_b64 s[66:67], s[66:67], s34
    s_lshl_b32 s34, s55, 6
    s_add_u32 s34, s34, 131008
    s_waitcnt lgkmcnt(3)
    v_mfma_f32_16x16x32_bf16 v[4:7], v[208:211], a[16:19], v[4:7]
    ds_read_b128 v[192:195], v18 offset:8192
    v_add_u32 v29, s34, v29
    s_cmp_eq_u32 s43, 7
    s_cselect_b32 s34, 8, 16
    v_mfma_f32_16x16x32_bf16 v[8:11], a[80:83], v[208:211], v[8:11]
    s_lshl_b32 s38, s55, 3
    s_sub_u32 s38, s38, 16
    s_sub_u32 s34, s34, s38
    v_mfma_f32_16x16x32_bf16 v[12:15], a[144:147], v[208:211], v[12:15]
    v_cmp_gt_u32 vcc, s34, v56
    s_nop 1
    v_cndmask_b32 v61, 0, 1.0, vcc
    s_lshl_b32 s34, s3, 8
    s_add_u32 s34, s34, 2048
    s_waitcnt lgkmcnt(3)
    v_mfma_f32_16x16x32_bf16 v[4:7], v[212:215], a[20:23], v[4:7]
    ds_read_b128 v[196:199], v18 offset:9216
    v_add_u32 v3, s34, v3
    v_mov_b32 v0, 1073741824
    v_mfma_f32_16x16x32_bf16 v[8:11], a[84:87], v[212:215], v[8:11]
    s_lshl_b32 s50, s46, 11
    s_add_u32 s50, s50, s80
    s_add_u32 s50, s50, 0
    s_lshl_b32 s45, s43, 3
    s_add_u32 s45, s45, s50
    s_lshl_b32 s34, s43, 6
    v_mfma_f32_16x16x32_bf16 v[12:15], a[148:151], v[212:215], v[12:15]
    s_add_u32 s34, s34, s70
    s_lshl_b32 s59, s34, 4
    s_mul_i32 s34, s34, 6144
    s_add_u32 s54, s34, 75497472
    s_lshl_b32 s34, s55, 2
    s_add_u32 s59, s59, s34
    s_waitcnt lgkmcnt(3)
    v_mfma_f32_16x16x32_bf16 v[4:7], v[216:219], a[24:27], v[4:7]
    ds_read_b128 v[200:203], v18 offset:10240
    s_add_u32 s59, s59, 434176
    v_mfma_f32_16x16x32_bf16 v[8:11], a[88:91], v[216:219], v[8:11]
    v_mfma_f32_16x16x32_bf16 v[12:15], a[152:155], v[216:219], v[12:15]
    s_waitcnt vmcnt(10)
    s_cmp_eq_u32 s8, 0
    s_cbranch_scc1 TL_LF_15
    v_mov_b32 v58, 1
    s_mov_b64 exec, 1
    buffer_store_dword v58, off, s[12:15], s98
    s_mov_b64 exec, -1
TL_LF_15_R:
    s_add_u32 s95, s95, 16777216
    s_add_u32 s96, s96, 16777216
    s_add_u32 s97, s97, 16777216
    s_waitcnt lgkmcnt(3)
    v_mfma_f32_16x16x32_bf16 v[4:7], v[220:223], a[28:31], v[4:7]
    ds_read_b128 v[204:207], v18 offset:11264
    v_mfma_f32_16x16x32_bf16 v[8:11], a[92:95], v[220:223], v[8:11]
    v_mfma_f32_16x16x32_bf16 v[12:15], a[156:159], v[220:223], v[12:15]
    s_waitcnt lgkmcnt(3)
    v_mfma_f32_16x16x32_bf16 v[4:7], v[192:195], a[32:35], v[4:7]
    ds_read_b128 v[208:211], v18 offset:12288
    v_mfma_f32_16x16x32_bf16 v[8:11], a[96:99], v[192:195], v[8:11]
    v_mfma_f32_16x16x32_bf16 v[12:15], a[160:163], v[192:195], v[12:15]
    s_waitcnt lgkmcnt(3)
    v_mfma_f32_16x16x32_bf16 v[4:7], v[196:199], a[36:39], v[4:7]
    ds_read_b128 v[212:215], v18 offset:13312
    v_mfma_f32_16x16x32_bf16 v[8:11], a[100:103], v[196:199], v[8:11]
    v_mfma_f32_16x16x32_bf16 v[12:15], a[164:167], v[196:199], v[12:15]
    s_waitcnt lgkmcnt(3)
    v_mfma_f32_16x16x32_bf16 v[4:7], v[200:203], a[40:43], v[4:7]
    ds_read_b128 v[216:219], v18 offset:14336
    v_mfma_f32_16x16x32_bf16 v[8:11], a[104:107], v[200:203], v[8:11]
    v_mfma_f32_16x16x32_bf16 v[12:15], a[168:171], v[200:203], v[12:15]
    s_waitcnt lgkmcnt(3)
    v_mfma_f32_16x16x32_bf16 v[4:7], v[204:207], a[44:47], v[4:7]
    ds_read_b128 v[220:223], v18 offset:15360
    v_mfma_f32_16x16x32_bf16 v[8:11], a[108:111], v[204:207], v[8:11]
    v_mfma_f32_16x16x32_bf16 v[12:15], a[172:175], v[204:207], v[12:15]
    s_waitcnt lgkmcnt(3)
    v_mfma_f32_16x16x32_bf16 v[4:7], v[208:211], a[48:51], v[4:7]
    v_mfma_f32_16x16x32_bf16 v[8:11], a[112:115], v[208:211], v[8:11]
    v_mfma_f32_16x16x32_bf16 v[12:15], a[176:179], v[208:211], v[12:15]
    s_waitcnt lgkmcnt(2)
    v_mfma_f32_16x16x32_bf16 v[4:7], v[212:215], a[52:55], v[4:7]
    v_mfma_f32_16x16x32_bf16 v[8:11], a[116:119], v[212:215], v[8:11]
    buffer_load_dword v57, v24, s[12:15], s28 offen sc1
    v_mfma_f32_16x16x32_bf16 v[12:15], a[180:183], v[212:215], v[12:15]
    s_waitcnt lgkmcnt(1)
    v_mfma_f32_16x16x32_bf16 v[4:7], v[216:219], a[56:59], v[4:7]
    v_mfma_f32_16x16x32_bf16 v[8:11], a[120:123], v[216:219], v[8:11]
    v_mfma_f32_16x16x32_bf16 v[12:15], a[184:187], v[216:219], v[12:15]
    s_waitcnt lgkmcnt(0)
    v_mfma_f32_16x16x32_bf16 v[4:7], v[220:223], a[60:63], v[4:7]
    v_mfma_f32_16x16x32_bf16 v[8:11], a[124:127], v[220:223], v[8:11]
    v_mfma_f32_16x16x32_bf16 v[12:15], a[188:191], v[220:223], v[12:15]
    s_nop 6
    v_mov_b32_dpp v64, v8 row_newbcast:0 row_mask:0xf bank_mask:0xf
    v_mov_b32_dpp v68, v8 row_newbcast:1 row_mask:0xf bank_mask:0xf
    v_mov_b32_dpp v65, v9 row_newbcast:0 row_mask:0xf bank_mask:0xf
    v_mov_b32_dpp v69, v9 row_newbcast:1 row_mask:0xf bank_mask:0xf
    v_mov_b32_dpp v66, v10 row_newbcast:0 row_mask:0xf bank_mask:0xf
    v_mov_b32_dpp v70, v10 row_newbcast:1 row_mask:0xf bank_mask:0xf
    v_mov_b32_dpp v67, v11 row_newbcast:0 row_mask:0xf bank_mask:0xf
    v_mov_b32_dpp v71, v11 row_newbcast:1 row_mask:0xf bank_mask:0xf
    v_mov_b32_dpp v72, v12 row_newbcast:0 row_mask:0xf bank_mask:0xf
    v_mov_b32_dpp v76, v12 row_newbcast:1 row_mask:0xf bank_mask:0xf
    v_mov_b32_dpp v73, v13 row_newbcast:0 row_mask:0xf bank_mask:0xf
    v_mov_b32_dpp v77, v13 row_newbcast:1 row_mask:0xf bank_mask:0xf
    v_mov_b32_dpp v74, v14 row_newbcast:0 row_mask:0xf bank_mask:0xf
    v_mov_b32_dpp v78, v14 row_newbcast:1 row_mask:0xf bank_mask:0xf
    v_mov_b32_dpp v75, v15 row_newbcast:0 row_mask:0xf bank_mask:0xf
    v_mov_b32_dpp v79, v15 row_newbcast:1 row_mask:0xf bank_mask:0xf
    s_waitcnt vmcnt(0)
    v_cmp_le_u32 vcc, 1, v57
    s_nop 0
    s_cmp_eq_u64 vcc, -1
    s_cbranch_scc0 TBX2L_S
TBX2L_R:
    s_add_u32 s38, s62, s36
    s_add_u32 m0, s38, 0
    s_nop 0
    buffer_load_dwordx4 v2, s[12:15], s29 offen offset:0 sc1 lds
    buffer_load_dwordx4 v2, s[12:15], s29 offen offset:1024 sc1 lds
    buffer_load_dwordx4 v2, s[12:15], s29 offen offset:2048 sc1 lds
    buffer_load_dwordx4 v2, s[12:15], s29 offen offset:3072 sc1 lds
    s_add_u32 s29, s29, 16384
    buffer_load_dwordx4 v[224:227], v19, s[12:15], s30 offen sc1
    buffer_load_dwordx4 v[228:231], v19, s[12:15], s30 offen offset:16 sc1
    s_add_u32 s30, s30, 16777216
    s_add_u32 m0, s38, 32768
    s_nop 0
    buffer_load_dwordx4 v2, s[12:15], s29 offen offset:0 sc1 lds
    buffer_load_dwordx4 v2, s[12:15], s29 offen offset:1024 sc1 lds
    buffer_load_dwordx4 v2, s[12:15], s29 offen offset:2048 sc1 lds
    buffer_load_dwordx4 v2, s[12:15], s29 offen offset:3072 sc1 lds
    s_add_u32 s29, s29, 16760832
    s_waitcnt vmcnt(4)
    v_add_f32 v224, v224, v226
    v_add_f32 v225, v225, v227
    v_add_f32 v228, v228, v230
    v_add_f32 v229, v229, v231
    v_add_f32 v224, v224, v228
    v_add_f32 v225, v225, v229
    s_nop 0
    v_add_f32_dpp v226, v224, v224 quad_perm:[1,0,3,2] row_mask:0xf bank_mask:0xf
    v_add_f32_dpp v227, v225, v225 quad_perm:[1,0,3,2] row_mask:0xf bank_mask:0xf
    ds_write_b64 v22, v[226:227] offset:16384
    buffer_load_dword v57, v24, s[12:15], s58 offen sc1
    s_waitcnt vmcnt(1) lgkmcnt(0)
    s_barrier
    ds_read_b128 v[192:195], v16 offset:0
    ds_read_b128 v[196:199], v16 offset:1024
    ds_read_b128 v[200:203], v16 offset:2048
    ds_read_b128 v[204:207], v16 offset:3072
    s_waitcnt lgkmcnt(3)
    v_mfma_f32_16x16x32_bf16 v[100:103], v[192:195], a[0:3], 0
    ds_read_b64 v[224:225], v23 offset:16384
    ds_read_b64 v[226:227], v23 offset:16640
    ds_read_b64 v[228:229], v23 offset:16896
    v_mfma_f32_16x16x32_bf16 v[108:111], a[64:67], v[192:195], 0
    ds_read_b64 v[230:231], v23 offset:17152
    v_mfma_f32_16x16x32_bf16 v[116:119], a[128:131], v[192:195], 0
    ds_read_b128 v[208:211], v16 offset:4096
    s_waitcnt lgkmcnt(7)
    v_mfma_f32_16x16x32_bf16 v[100:103], v[196:199], a[4:7], v[100:103]
    v_mfma_f32_16x16x32_bf16 v[108:111], a[68:71], v[196:199], v[108:111]
    s_waitcnt vmcnt(0)
    v_cmp_le_u32 vcc, 2, v57
    s_nop 0
    s_cmp_eq_u64 vcc, -1
    s_cbranch_scc0 TBPX1_S
TBPX1_R:
    v_mfma_f32_16x16x32_bf16 v[116:119], a[132:135], v[196:199], v[116:119]
    ds_read_b128 v[212:215], v16 offset:5120
    s_waitcnt lgkmcnt(7)
    v_mfma_f32_16x16x32_bf16 v[100:103], v[200:203], a[8:11], v[100:103]
    s_waitcnt lgkmcnt(2)
    v_add_f32 v224, v224, v226
    v_add_f32 v225, v225, v227
    v_mfma_f32_16x16x32_bf16 v[108:111], a[72:75], v[200:203], v[108:111]
    v_add_f32 v228, v228, v230
    v_add_f32 v229, v229, v231
    v_add_f32 v224, v224, v228
    v_mfma_f32_16x16x32_bf16 v[116:119], a[136:139], v[200:203], v[116:119]
    ds_read_b128 v[216:219], v16 offset:6144
    v_add_f32 v225, v225, v229
    v_mul_f32 v96, 0xbb000000, v224
    v_mfma_f32_16x16x32_bf16 v[100:103], v[204:207], a[12:15], v[100:103]
    v_mul_f32 v225, 0x3b000000, v225
    v_fma_f32 v225, -v96, v96, v225
    v_max_f32 v225, 0, v225
    v_mfma_f32_16x16x32_bf16 v[108:111], a[76:79], v[204:207], v[108:111]
    v_add_f32 v225, 0x3727c5ac, v225
    v_rsq_f32 v97, v225
    v_mfma_f32_16x16x32_bf16 v[116:119], a[140:143], v[204:207], v[116:119]
    ds_read_b128 v[220:223], v16 offset:7168
    ds_write_b32 v25, v96 offset:20480
    ds_write_b32 v25, v97 offset:20736
    s_waitcnt lgkmcnt(5)
    v_mfma_f32_16x16x32_bf16 v[100:103], v[208:211], a[16:19], v[100:103]
    v_mov_b32 v98, v96
    v_mov_b32 v99, v97
    v_mfma_f32_16x16x32_bf16 v[108:111], a[80:83], v[208:211], v[108:111]
    buffer_load_dwordx4 v[160:163], v2, s[12:15], s91 offen offset:0
    v_mfma_f32_16x16x32_bf16 v[116:119], a[144:147], v[208:211], v[116:119]
    ds_read_b128 v[192:195], v16 offset:8192
    buffer_load_dwordx4 v[164:167], v2, s[12:15], s91 offen offset:1024
    s_waitcnt lgkmcnt(5)
    v_mfma_f32_16x16x32_bf16 v[100:103], v[212:215], a[20:23], v[100:103]
    buffer_load_dwordx4 v[168:171], v2, s[12:15], s91 offen offset:2048
    v_mfma_f32_16x16x32_bf16 v[108:111], a[84:87], v[212:215], v[108:111]
    s_waitcnt lgkmcnt(1)
    ds_read_b128 v[80:83], v28 offset:20480
    ds_read_b128 v[88:91], v28 offset:20736
    v_mfma_f32_16x16x32_bf16 v[116:119], a[148:151], v[212:215], v[116:119]
    ds_read_b128 v[196:199], v16 offset:9216
    ds_read_b128 v[84:87], v28 offset:20544
    ds_read_b128 v[92:95], v28 offset:20800
    v_mfma_f32_16x16x32_bf16 v[100:103], v[216:219], a[24:27], v[100:103]
    v_permlane16_swap_b32 v96, v98
    v_permlane16_swap_b32 v97, v99
    v_mfma_f32_16x16x32_bf16 v[108:111], a[88:91], v[216:219], v[108:111]
    buffer_load_dwordx4 v[172:175], v2, s[12:15], s91 offen offset:3072
    s_add_u32 s91, s91, 4096
    v_mfma_f32_16x16x32_bf16 v[116:119], a[152:155], v[216:219], v[116:119]
    ds_read_b128 v[200:203], v16 offset:10240
    buffer_load_dwordx4 v[176:179], v2, s[12:15], s91 offen offset:0
    v_mfma_f32_16x16x32_bf16 v[100:103], v[220:223], a[28:31], v[100:103]
    buffer_load_dwordx4 v[180:183], v2, s[12:15], s91 offen offset:1024
    v_mfma_f32_16x16x32_bf16 v[108:111], a[92:95], v[220:223], v[108:111]
    buffer_load_dwordx4 v[184:187], v2, s[12:15], s91 offen offset:2048
    v_mfma_f32_16x16x32_bf16 v[116:119], a[156:159], v[220:223], v[116:119]
    ds_read_b128 v[204:207], v16 offset:11264
    s_waitcnt lgkmcnt(7)
    v_mfma_f32_16x16x32_bf16 v[100:103], v[192:195], a[32:35], v[100:103]
    buffer_load_dwordx4 v[188:191], v2, s[12:15], s91 offen offset:3072
    s_add_u32 s91, s91, 8384512
    v_mfma_f32_16x16x32_bf16 v[108:111], a[96:99], v[192:195], v[108:111]
    buffer_load_dwordx4 a[224:227], v2, s[12:15], s31 offen offset:0
    v_mfma_f32_16x16x32_bf16 v[116:119], a[160:163], v[192:195], v[116:119]
    ds_read_b128 v[208:211], v16 offset:12288
    s_waitcnt lgkmcnt(3)
    v_mfma_f32_16x16x32_bf16 v[100:103], v[196:199], a[36:39], v[100:103]
    buffer_load_dwordx4 a[228:231], v2, s[12:15], s33 offen offset:0
    v_mfma_f32_16x16x32_bf16 v[108:111], a[100:103], v[196:199], v[108:111]
    v_lshlrev_b32 v136, 16, v36
    v_and_b32 v137, 0xffff0000, v36
    v_lshlrev_b32 v138, 16, v37
    v_mfma_f32_16x16x32_bf16 v[116:119], a[164:167], v[196:199], v[116:119]
    ds_read_b128 v[212:215], v16 offset:13312
    v_and_b32 v139, 0xffff0000, v37
    v_lshlrev_b32 v140, 16, v38
    s_waitcnt lgkmcnt(3)
    v_mfma_f32_16x16x32_bf16 v[100:103], v[200:203], a[40:43], v[100:103]
    v_and_b32 v141, 0xffff0000, v38
    v_lshlrev_b32 v142, 16, v39
    v_and_b32 v143, 0xffff0000, v39
    v_mfma_f32_16x16x32_bf16 v[108:111], a[104:107], v[200:203], v[108:111]
    s_waitcnt vmcnt(9)
    v_lshlrev_b32 v128, 16, v160
    v_and_b32 v129, 0xffff0000, v160
    v_mfma_f32_16x16x32_bf16 v[116:119], a[168:171], v[200:203], v[116:119]
    ds_read_b128 v[216:219], v16 offset:14336
    v_lshlrev_b32 v130, 16, v161
    v_and_b32 v131, 0xffff0000, v161
    s_waitcnt lgkmcnt(3)
    v_mfma_f32_16x16x32_bf16 v[100:103], v[204:207], a[44:47], v[100:103]
    v_lshlrev_b32 v132, 16, v162
    v_and_b32 v133, 0xffff0000, v162
    v_lshlrev_b32 v134, 16, v163
    v_mfma_f32_16x16x32_bf16 v[108:111], a[108:111], v[204:207], v[108:111]
    v_and_b32 v135, 0xffff0000, v163
    s_waitcnt vmcnt(8)
    v_lshlrev_b32 v144, 16, v164
    v_mfma_f32_16x16x32_bf16 v[116:119], a[172:175], v[204:207], v[116:119]
    ds_read_b128 v[220:223], v16 offset:15360
    v_and_b32 v145, 0xffff0000, v164
    v_lshlrev_b32 v146, 16, v165
    s_waitcnt lgkmcnt(3)
    v_mfma_f32_16x16x32_bf16 v[100:103], v[208:211], a[48:51], v[100:103]
    v_and_b32 v147, 0xffff0000, v165
    v_lshlrev_b32 v148, 16, v166
    v_and_b32 v149, 0xffff0000, v166
    v_mfma_f32_16x16x32_bf16 v[108:111], a[112:115], v[208:211], v[108:111]
    v_lshlrev_b32 v150, 16, v167
    v_and_b32 v151, 0xffff0000, v167
    v_add_f32 v128, v128, v144
    v_mfma_f32_16x16x32_bf16 v[116:119], a[176:179], v[208:211], v[116:119]
    ds_read_b128 v[192:195], v16 offset:32768
    v_add_f32 v129, v129, v145
    v_add_f32 v130, v130, v146
    s_waitcnt lgkmcnt(3)
    v_mfma_f32_16x16x32_bf16 v[100:103], v[212:215], a[52:55], v[100:103]
    v_add_f32 v131, v131, v147
    v_add_f32 v132, v132, v148
    v_add_f32 v133, v133, v149
    v_mfma_f32_16x16x32_bf16 v[108:111], a[116:119], v[212:215], v[108:111]
    v_add_f32 v134, v134, v150
    v_add_f32 v135, v135, v151
    s_waitcnt vmcnt(7)
    v_mfma_f32_16x16x32_bf16 v[116:119], a[180:183], v[212:215], v[116:119]
    ds_read_b128 v[196:199], v16 offset:33792
    v_lshlrev_b32 v144, 16, v168
    v_and_b32 v145, 0xffff0000, v168
    s_waitcnt lgkmcnt(3)
    v_mfma_f32_16x16x32_bf16 v[100:103], v[216:219], a[56:59], v[100:103]
    v_lshlrev_b32 v146, 16, v169
    v_and_b32 v147, 0xffff0000, v169
    v_lshlrev_b32 v148, 16, v170
    v_mfma_f32_16x16x32_bf16 v[108:111], a[120:123], v[216:219], v[108:111]
    v_and_b32 v149, 0xffff0000, v170
    v_lshlrev_b32 v150, 16, v171
    v_and_b32 v151, 0xffff0000, v171
    v_mfma_f32_16x16x32_bf16 v[116:119], a[184:187], v[216:219], v[116:119]
    ds_read_b128 v[200:203], v16 offset:34816
    v_add_f32 v128, v128, v144
    v_add_f32 v129, v129, v145
    s_waitcnt lgkmcnt(3)
    v_mfma_f32_16x16x32_bf16 v[100:103], v[220:223], a[60:63], v[100:103]
    v_add_f32 v130, v130, v146
    v_add_f32 v131, v131, v147
    v_add_f32 v132, v132, v148
    v_mfma_f32_16x16x32_bf16 v[108:111], a[124:127], v[220:223], v[108:111]
    v_add_f32 v133, v133, v149
    v_add_f32 v134, v134, v150
    v_add_f32 v135, v135, v151
    v_mfma_f32_16x16x32_bf16 v[116:119], a[188:191], v[220:223], v[116:119]
    ds_read_b128 v[204:207], v16 offset:35840
    s_waitcnt vmcnt(6)
    v_lshlrev_b32 v144, 16, v172
    s_waitcnt lgkmcnt(3)
    v_mfma_f32_16x16x32_bf16 v[104:107], v[192:195], a[0:3], 0
    v_and_b32 v145, 0xffff0000, v172
    v_lshlrev_b32 v146, 16, v173
    v_and_b32 v147, 0xffff0000, v173
    v_mfma_f32_16x16x32_bf16 v[112:115], a[64:67], v[192:195], 0
    v_lshlrev_b32 v148, 16, v174
    v_and_b32 v149, 0xffff0000, v174
    v_lshlrev_b32 v150, 16, v175
    v_mfma_f32_16x16x32_bf16 v[120:123], a[128:131], v[192:195], 0
    ds_read_b128 v[208:211], v16 offset:36864
    v_and_b32 v151, 0xffff0000, v175
    v_add_f32 v128, v128, v144
    s_waitcnt lgkmcnt(3)
    v_mfma_f32_16x16x32_bf16 v[104:107], v[196:199], a[4:7], v[104:107]
    v_add_f32 v129, v129, v145
    v_add_f32 v130, v130, v146
    v_add_f32 v131, v131, v147
    v_mfma_f32_16x16x32_bf16 v[112:115], a[68:71], v[196:199], v[112:115]
    v_add_f32 v132, v132, v148
    v_add_f32 v133, v133, v149
    v_add_f32 v134, v134, v150
    v_mfma_f32_16x16x32_bf16 v[120:123], a[132:135], v[196:199], v[120:123]
    ds_read_b128 v[212:215], v16 offset:37888
    v_add_f32 v135, v135, v151
    s_waitcnt vmcnt(5)
    s_waitcnt lgkmcnt(3)
    v_mfma_f32_16x16x32_bf16 v[104:107], v[200:203], a[8:11], v[104:107]
    v_lshlrev_b32 v144, 16, v176
    v_and_b32 v145, 0xffff0000, v176
    v_lshlrev_b32 v146, 16, v177
    v_mfma_f32_16x16x32_bf16 v[112:115], a[72:75], v[200:203], v[112:115]
    v_and_b32 v147, 0xffff0000, v177
    v_lshlrev_b32 v148, 16, v178
    v_and_b32 v149, 0xffff0000, v178
    v_mfma_f32_16x16x32_bf16 v[120:123], a[136:139], v[200:203], v[120:123]
    ds_read_b128 v[216:219], v16 offset:38912
    v_lshlrev_b32 v150, 16, v179
    v_and_b32 v151, 0xffff0000, v179
    s_waitcnt lgkmcnt(3)
    v_mfma_f32_16x16x32_bf16 v[104:107], v[204:207], a[12:15], v[104:107]
    v_add_f32 v128, v128, v144
    v_add_f32 v129, v129, v145
    v_add_f32 v130, v130, v146
    v_mfma_f32_16x16x32_bf16 v[112:115], a[76:79], v[204:207], v[112:115]
    v_add_f32 v131, v131, v147
    v_add_f32 v132, v132, v148
    v_add_f32 v133, v133, v149
    v_mfma_f32_16x16x32_bf16 v[120:123], a[140:143], v[204:207], v[120:123]
    ds_read_b128 v[220:223], v16 offset:39936
    v_add_f32 v134, v134, v150
    v_add_f32 v135, v135, v151
    s_waitcnt lgkmcnt(3)
    v_mfma_f32_16x16x32_bf16 v[104:107], v[208:211], a[16:19], v[104:107]
    s_waitcnt vmcnt(4)
    v_lshlrev_b32 v144, 16, v180
    v_and_b32 v145, 0xffff0000, v180
    v_mfma_f32_16x16x32_bf16 v[112:115], a[80:83], v[208:211], v[112:115]
    v_lshlrev_b32 v146, 16, v181
    v_and_b32 v147, 0xffff0000, v181
    v_lshlrev_b32 v148, 16, v182
    v_mfma_f32_16x16x32_bf16 v[120:123], a[144:147], v[208:211], v[120:123]
    ds_read_b128 v[192:195], v16 offset:40960
    v_and_b32 v149, 0xffff0000, v182
    v_lshlrev_b32 v150, 16, v183
    s_waitcnt lgkmcnt(3)
    v_mfma_f32_16x16x32_bf16 v[104:107], v[212:215], a[20:23], v[104:107]
    v_and_b32 v151, 0xffff0000, v183
    v_add_f32 v128, v128, v144
    v_add_f32 v129, v129, v145
    v_mfma_f32_16x16x32_bf16 v[112:115], a[84:87], v[212:215], v[112:115]
    v_add_f32 v130, v130, v146
    v_add_f32 v131, v131, v147
    v_add_f32 v132, v132, v148
    v_mfma_f32_16x16x32_bf16 v[120:123], a[148:151], v[212:215], v[120:123]
    ds_read_b128 v[196:199], v16 offset:41984
    v_add_f32 v133, v133, v149
    v_add_f32 v134, v134, v150
    s_waitcnt lgkmcnt(3)
    v_mfma_f32_16x16x32_bf16 v[104:107], v[216:219], a[24:27], v[104:107]
    v_add_f32 v135, v135, v151
    s_waitcnt vmcnt(3)
    v_lshlrev_b32 v144, 16, v184
    v_mfma_f32_16x16x32_bf16 v[112:115], a[88:91], v[216:219], v[112:115]
    v_and_b32 v145, 0xffff0000, v184
    v_lshlrev_b32 v146, 16, v185
    v_and_b32 v147, 0xffff0000, v185
    v_mfma_f32_16x16x32_bf16 v[120:123], a[152:155], v[216:219], v[120:123]
    ds_read_b128 v[200:203], v16 offset:43008
    v_lshlrev_b32 v148, 16, v186
    v_and_b32 v149, 0xffff0000, v186
    s_waitcnt lgkmcnt(3)
    v_mfma_f32_16x16x32_bf16 v[104:107], v[220:223], a[28:31], v[104:107]
    v_lshlrev_b32 v150, 16, v187
    v_and_b32 v151, 0xffff0000, v187
    v_add_f32 v128, v128, v144
    v_mfma_f32_16x16x32_bf16 v[112:115], a[92:95], v[220:223], v[112:115]
    v_add_f32 v129, v129, v145
    v_add_f32 v130, v130, v146
    v_add_f32 v131, v131, v147
    v_mfma_f32_16x16x32_bf16 v[120:123], a[156:159], v[220:223], v[120:123]
    ds_read_b128 v[204:207], v16 offset:44032
    v_add_f32 v132, v132, v148
    v_add_f32 v133, v133, v149
    s_waitcnt lgkmcnt(3)
    v_mfma_f32_16x16x32_bf16 v[104:107], v[192:195], a[32:35], v[104:107]
    v_add_f32 v134, v134, v150
    v_add_f32 v135, v135, v151
    s_waitcnt vmcnt(2)
    v_mfma_f32_16x16x32_bf16 v[112:115], a[96:99], v[192:195], v[112:115]
    v_lshlrev_b32 v144, 16, v188
    v_and_b32 v145, 0xffff0000, v188
    v_lshlrev_b32 v146, 16, v189
    v_mfma_f32_16x16x32_bf16 v[120:123], a[160:163], v[192:195], v[120:123]
    ds_read_b128 v[208:211], v16 offset:45056
    v_and_b32 v147, 0xffff0000, v189
    v_lshlrev_b32 v148, 16, v190
    s_waitcnt lgkmcnt(3)
    v_mfma_f32_16x16x32_bf16 v[104:107], v[196:199], a[36:39], v[104:107]
    v_and_b32 v149, 0xffff0000, v190
    v_lshlrev_b32 v150, 16, v191
    v_and_b32 v151, 0xffff0000, v191
    v_mfma_f32_16x16x32_bf16 v[112:115], a[100:103], v[196:199], v[112:115]
    v_add_f32 v128, v128, v144
    v_add_f32 v129, v129, v145
    v_add_f32 v130, v130, v146
    v_mfma_f32_16x16x32_bf16 v[120:123], a[164:167], v[196:199], v[120:123]
    ds_read_b128 v[212:215], v16 offset:46080
    v_add_f32 v131, v131, v147
    v_add_f32 v132, v132, v148
    s_waitcnt lgkmcnt(3)
    v_mfma_f32_16x16x32_bf16 v[104:107], v[200:203], a[40:43], v[104:107]
    v_add_f32 v133, v133, v149
    v_add_f32 v134, v134, v150
    v_add_f32 v135, v135, v151
    v_mfma_f32_16x16x32_bf16 v[112:115], a[104:107], v[200:203], v[112:115]
    v_fma_f32 v128, v128, v40, v136
    v_fma_f32 v129, v129, v41, v137
    v_fma_f32 v130, v130, v42, v138
    v_mfma_f32_16x16x32_bf16 v[120:123], a[168:171], v[200:203], v[120:123]
    ds_read_b128 v[216:219], v16 offset:47104
    v_fma_f32 v131, v131, v43, v139
    v_fma_f32 v132, v132, v44, v140
    s_waitcnt lgkmcnt(3)
    v_mfma_f32_16x16x32_bf16 v[104:107], v[204:207], a[44:47], v[104:107]
    v_fma_f32 v133, v133, v45, v141
    v_fma_f32 v134, v134, v46, v142
    v_fma_f32 v135, v135, v47, v143
    v_mfma_f32_16x16x32_bf16 v[112:115], a[108:111], v[204:207], v[112:115]
    v_cvt_pk_bf16_f32 v144, v128, v129
    v_cvt_pk_bf16_f32 v145, v130, v131
    v_cvt_pk_bf16_f32 v146, v132, v133
    v_mfma_f32_16x16x32_bf16 v[120:123], a[172:175], v[204:207], v[120:123]
    ds_read_b128 v[220:223], v16 offset:48128
    v_cvt_pk_bf16_f32 v147, v134, v135
    v_lshlrev_b32 v128, 16, v144
    s_waitcnt lgkmcnt(3)
    v_mfma_f32_16x16x32_bf16 v[104:107], v[208:211], a[48:51], v[104:107]
    v_and_b32 v129, 0xffff0000, v144
    v_lshlrev_b32 v130, 16, v145
    v_and_b32 v131, 0xffff0000, v145
    v_mfma_f32_16x16x32_bf16 v[112:115], a[112:115], v[208:211], v[112:115]
    v_lshlrev_b32 v132, 16, v146
    v_and_b32 v133, 0xffff0000, v146
    v_lshlrev_b32 v134, 16, v147
    v_mfma_f32_16x16x32_bf16 v[120:123], a[176:179], v[208:211], v[120:123]
    v_and_b32 v135, 0xffff0000, v147
    v_mul_f32 v136, v128, v48
    v_mul_f32 v137, v129, v49
    s_waitcnt lgkmcnt(2)
    v_mfma_f32_16x16x32_bf16 v[104:107], v[212:215], a[52:55], v[104:107]
    v_mul_f32 v138, v130, v50
    v_mul_f32 v139, v131, v51
    v_mul_f32 v140, v132, v52
    v_mfma_f32_16x16x32_bf16 v[112:115], a[116:119], v[212:215], v[112:115]
    v_mul_f32 v141, v133, v53
    v_mul_f32 v142, v134, v54
    v_mul_f32 v143, v135, v55
    v_mfma_f32_16x16x32_bf16 v[120:123], a[180:183], v[212:215], v[120:123]
    v_cvt_pk_bf16_f32 v148, v136, v137
    v_cvt_pk_bf16_f32 v149, v138, v139
    v_cvt_pk_bf16_f32 v150, v140, v141
    s_waitcnt lgkmcnt(1)
    v_mfma_f32_16x16x32_bf16 v[104:107], v[216:219], a[56:59], v[104:107]
    v_cvt_pk_bf16_f32 v151, v142, v143
    buffer_store_dwordx4 v[148:151], v26, s[12:15], s95 offen
    v_mfma_f32_16x16x32_bf16 v[112:115], a[120:123], v[216:219], v[112:115]
    v_add_f32 v152, v128, v129
    v_mul_f32 v153, v128, v128
    v_add_f32 v154, v130, v131
    v_mfma_f32_16x16x32_bf16 v[120:123], a[184:187], v[216:219], v[120:123]
    v_mul_f32 v155, v129, v129
    v_fmac_f32 v153, v130, v130
    v_fmac_f32 v155, v131, v131
    s_waitcnt lgkmcnt(0)
    v_mfma_f32_16x16x32_bf16 v[104:107], v[220:223], a[60:63], v[104:107]
    v_fmac_f32 v153, v132, v132
    v_fmac_f32 v155, v133, v133
    v_fmac_f32 v153, v134, v134
    v_mfma_f32_16x16x32_bf16 v[112:115], a[124:127], v[220:223], v[112:115]
    v_fmac_f32 v155, v135, v135
    v_add_f32 v152, v152, v132
    v_add_f32 v154, v154, v133
    v_mfma_f32_16x16x32_bf16 v[120:123], a[188:191], v[220:223], v[120:123]
    v_add_f32 v152, v152, v134
    v_add_f32 v154, v154, v135
    v_add_f32 v152, v152, v154
    v_add_f32 v153, v153, v155
    v_mov_b32 v154, v152
    v_mov_b32 v155, v153
    s_nop 0
    v_permlane32_swap_b32 v152, v154
    v_permlane32_swap_b32 v153, v155
    v_add_f32 v152, v152, v154
    v_add_f32 v153, v153, v155
    buffer_store_dwordx2 v[152:153], v27, s[12:15], s97 offen
    buffer_store_dwordx4 v[144:147], v2, s[12:15], s96 offen
    buffer_load_dwordx4 a[232:235], v2, s[12:15], s31 offen offset:2048
    buffer_load_dwordx4 a[236:239], v2, s[12:15], s33 offen offset:2048
    s_add_u32 s31, s31, 4096
    s_add_u32 s33, s33, 4096
    buffer_load_dwordx4 a[240:243], v2, s[12:15], s31 offen offset:0
    buffer_load_dwordx4 a[244:247], v2, s[12:15], s33 offen offset:0
    buffer_load_dwordx4 a[248:251], v2, s[12:15], s31 offen offset:2048
    buffer_load_dwordx4 a[252:255], v2, s[12:15], s33 offen offset:2048
    s_add_u32 s31, s31, 4096
    s_add_u32 s33, s33, 4096
    s_add_u32 s38, s65, s36
    s_add_u32 m0, s38, 0
    s_nop 0
    buffer_load_dwordx4 v2, s[12:15], s31 offen offset:0 lds
    s_add_u32 s38, s65, s36
    s_add_u32 m0, s38, 1024
    s_nop 0
    buffer_load_dwordx4 v2, s[12:15], s33 offen offset:0 lds
    s_add_u32 s38, s65, s36
    s_add_u32 m0, s38, 0
    s_nop 0
    buffer_load_dwordx4 v2, s[12:15], s31 offen offset:2048 lds
    s_add_u32 s38, s65, s36
    s_add_u32 m0, s38, 1024
    s_nop 0
    buffer_load_dwordx4 v2, s[12:15], s33 offen offset:2048 lds
    s_add_u32 s31, s31, 4096
    s_add_u32 s33, s33, 4096
    s_add_u32 s38, s65, s36
    s_add_u32 m0, s38, 32768
    s_nop 0
    buffer_load_dwordx4 v2, s[12:15], s31 offen offset:0 lds
    s_add_u32 s38, s65, s36
    s_add_u32 m0, s38, 33792
    s_nop 0
    buffer_load_dwordx4 v2, s[12:15], s33 offen offset:0 lds
    s_add_u32 s38, s65, s36
    s_add_u32 m0, s38, 32768
    s_nop 0
    buffer_load_dwordx4 v2, s[12:15], s31 offen offset:2048 lds
    s_add_u32 s38, s65, s36
    s_add_u32 m0, s38, 33792
    s_nop 0
    buffer_load_dwordx4 v2, s[12:15], s33 offen offset:2048 lds
    s_add_u32 s31, s31, 4096
    s_add_u32 s33, s33, 4096
    v_fma_f32 v100, v80, v4, v100
    v_fma_f32 v101, v81, v4, v101
    v_fma_f32 v102, v82, v4, v102
    v_fma_f32 v103, v83, v4, v103
    v_fma_f32 v100, v88, v100, v5
    v_fma_f32 v101, v89, v101, v5
    v_fma_f32 v102, v90, v102, v5
    v_fma_f32 v103, v91, v103, v5
    v_mul_f32 v224, v100, v100
    v_mul_f32 v225, v101, v101
    v_mul_f32 v226, v102, v102
    v_mul_f32 v227, v103, v103
    v_fma_f32 v224, v224, v60, s44
    v_fma_f32 v225, v225, v60, s44
    v_fma_f32 v226, v226, v60, s44
    v_fma_f32 v227, v227, v60, s44
    v_mul_f32 v224, v224, v100
    v_mul_f32 v225, v225, v101
    v_mul_f32 v226, v226, v102
    v_mul_f32 v227, v227, v103
    v_exp_f32 v224, v224
    v_exp_f32 v225, v225
    v_exp_f32 v226, v226
    v_exp_f32 v227, v227
    v_add_f32 v224, 1.0, v224
    v_add_f32 v225, 1.0, v225
    v_add_f32 v226, 1.0, v226
    v_add_f32 v227, 1.0, v227
    v_rcp_f32 v224, v224
    v_rcp_f32 v225, v225
    v_rcp_f32 v226, v226
    v_rcp_f32 v227, v227
    v_mul_f32 v100, v100, v224
    v_mul_f32 v101, v101, v225
    v_mul_f32 v102, v102, v226
    v_mul_f32 v103, v103, v227
    v_mul_f32 v232, v100, v61
    v_mul_f32 v233, v101, v61
    v_mul_f32 v234, v102, v61
    v_mul_f32 v235, v103, v61
    v_mul_f32 v240, v232, v232
    v_mul_f32 v241, v233, v233
    v_mul_f32 v242, v234, v234
    v_mul_f32 v243, v235, v235
    v_fma_f32 v108, v96, v64, v108
    v_fma_f32 v109, v96, v65, v109
    v_fma_f32 v110, v96, v66, v110
    v_fma_f32 v111, v96, v67, v111
    v_fma_f32 v116, v96, v72, v116
    v_fma_f32 v117, v96, v73, v117
    v_fma_f32 v118, v96, v74, v118
    v_fma_f32 v119, v96, v75, v119
    v_fma_f32 v108, v97, v108, v68
    v_fma_f32 v109, v97, v109, v69
    v_fma_f32 v110, v97, v110, v70
    v_fma_f32 v111, v97, v111, v71
    v_fma_f32 v116, v97, v116, v76
    v_fma_f32 v117, v97, v117, v77
    v_fma_f32 v118, v97, v118, v78
    v_fma_f32 v119, v97, v119, v79
    s_waitcnt vmcnt(15)
    s_add_u32 s98, s98, 512
    s_cmp_eq_u32 s8, 0
    s_cbranch_scc1 TL_LF_16
    v_mov_b32 v58, 1
    s_mov_b64 exec, 1
    buffer_store_dword v58, off, s[12:15], s98
    s_mov_b64 exec, -1
TL_LF_16_R:
    s_add_u32 s28, s28, 512
    v_mul_f32 v224, v108, v108
    v_mul_f32 v225, v109, v109
    v_mul_f32 v226, v110, v110
    v_mul_f32 v227, v111, v111
    v_mul_f32 v228, v116, v116
    v_mul_f32 v229, v117, v117
    v_mul_f32 v230, v118, v118
    v_mul_f32 v231, v119, v119
    v_fma_f32 v224, v224, v60, s44
    v_fma_f32 v225, v225, v60, s44
    v_fma_f32 v226, v226, v60, s44
    v_fma_f32 v227, v227, v60, s44
    v_fma_f32 v228, v228, v60, s44
    v_fma_f32 v229, v229, v60, s44
    v_fma_f32 v230, v230, v60, s44
    v_fma_f32 v231, v231, v60, s44
    v_mul_f32 v224, v224, v108
    v_mul_f32 v225, v225, v109
    v_mul_f32 v226, v226, v110
    v_mul_f32 v227, v227, v111
    v_mul_f32 v228, v228, v116
    v_mul_f32 v229, v229, v117
    v_mul_f32 v230, v230, v118
    v_mul_f32 v231, v231, v119
    v_exp_f32 v224, v224
    v_exp_f32 v225, v225
    v_exp_f32 v226, v226
    v_exp_f32 v227, v227
    v_exp_f32 v228, v228
    v_exp_f32 v229, v229
    v_exp_f32 v230, v230
    v_exp_f32 v231, v231
    v_add_f32 v224, 1.0, v224
    v_add_f32 v225, 1.0, v225
    v_add_f32 v226, 1.0, v226
    v_add_f32 v227, 1.0, v227
    v_add_f32 v228, 1.0, v228
    v_add_f32 v229, 1.0, v229
    v_add_f32 v230, 1.0, v230
    v_add_f32 v231, 1.0, v231
    v_rcp_f32 v224, v224
    v_rcp_f32 v225, v225
    v_rcp_f32 v226, v226
    v_rcp_f32 v227, v227
    v_rcp_f32 v228, v228
    v_rcp_f32 v229, v229
    v_rcp_f32 v230, v230
    v_rcp_f32 v231, v231
    v_mul_f32 v108, v108, v224
    v_mul_f32 v109, v109, v225
    v_mul_f32 v110, v110, v226
    v_mul_f32 v111, v111, v227
    v_mul_f32 v116, v116, v228
    v_mul_f32 v117, v117, v229
    v_mul_f32 v118, v118, v230
    v_mul_f32 v119, v119, v231
    v_cvt_pk_bf16_f32 v224, v108, v109
    v_cvt_pk_bf16_f32 v225, v110, v111
    ds_write_b64 v29, v[224:225] offset:0
    v_cvt_pk_bf16_f32 v228, v116, v117
    v_cvt_pk_bf16_f32 v229, v118, v119
    ds_write_b64 v29, v[228:229] offset:32
    v_fma_f32 v104, v84, v4, v104
    v_fma_f32 v105, v85, v4, v105
    v_fma_f32 v106, v86, v4, v106
    v_fma_f32 v107, v87, v4, v107
    v_fma_f32 v104, v92, v104, v5
    v_fma_f32 v105, v93, v105, v5
    v_fma_f32 v106, v94, v106, v5
    v_fma_f32 v107, v95, v107, v5
    v_mul_f32 v224, v104, v104
    v_mul_f32 v225, v105, v105
    v_mul_f32 v226, v106, v106
    v_mul_f32 v227, v107, v107
    v_fma_f32 v224, v224, v60, s44
    v_fma_f32 v225, v225, v60, s44
    v_fma_f32 v226, v226, v60, s44
    v_fma_f32 v227, v227, v60, s44
    v_mul_f32 v224, v224, v104
    v_mul_f32 v225, v225, v105
    v_mul_f32 v226, v226, v106
    v_mul_f32 v227, v227, v107
    v_exp_f32 v224, v224
    v_exp_f32 v225, v225
    v_exp_f32 v226, v226
    v_exp_f32 v227, v227
    v_add_f32 v224, 1.0, v224
    v_add_f32 v225, 1.0, v225
    v_add_f32 v226, 1.0, v226
    v_add_f32 v227, 1.0, v227
    v_rcp_f32 v224, v224
    v_rcp_f32 v225, v225
    v_rcp_f32 v226, v226
    v_rcp_f32 v227, v227
    v_mul_f32 v104, v104, v224
    v_mul_f32 v105, v105, v225
    v_mul_f32 v106, v106, v226
    v_mul_f32 v107, v107, v227
    v_mul_f32 v236, v104, v61
    v_mul_f32 v237, v105, v61
    v_mul_f32 v238, v106, v61
    v_mul_f32 v239, v107, v61
    v_mul_f32 v244, v236, v236
    v_mul_f32 v245, v237, v237
    v_mul_f32 v246, v238, v238
    v_mul_f32 v247, v239, v239
    v_add_f32_dpp v248, v232, v232 row_ror:8 row_mask:0xf bank_mask:0x3
    v_add_f32_dpp v249, v233, v233 row_ror:8 row_mask:0xf bank_mask:0x3
    v_add_f32_dpp v250, v234, v234 row_ror:8 row_mask:0xf bank_mask:0x3
    v_add_f32_dpp v251, v235, v235 row_ror:8 row_mask:0xf bank_mask:0x3
    v_add_f32_dpp v252, v236, v236 row_ror:8 row_mask:0xf bank_mask:0x3
    v_add_f32_dpp v253, v237, v237 row_ror:8 row_mask:0xf bank_mask:0x3
    v_add_f32_dpp v254, v238, v238 row_ror:8 row_mask:0xf bank_mask:0x3
    v_add_f32_dpp v255, v239, v239 row_ror:8 row_mask:0xf bank_mask:0x3
    v_add_f32_dpp v248, v240, v240 row_ror:8 row_mask:0xf bank_mask:0xc
    v_add_f32_dpp v249, v241, v241 row_ror:8 row_mask:0xf bank_mask:0xc
    v_add_f32_dpp v250, v242, v242 row_ror:8 row_mask:0xf bank_mask:0xc
    v_add_f32_dpp v251, v243, v243 row_ror:8 row_mask:0xf bank_mask:0xc
    v_add_f32_dpp v252, v244, v244 row_ror:8 row_mask:0xf bank_mask:0xc
    v_add_f32_dpp v253, v245, v245 row_ror:8 row_mask:0xf bank_mask:0xc
    v_add_f32_dpp v254, v246, v246 row_ror:8 row_mask:0xf bank_mask:0xc
    v_add_f32_dpp v255, v247, v247 row_ror:8 row_mask:0xf bank_mask:0xc
    v_add_f32_dpp v232, v248, v248 row_half_mirror row_mask:0xf bank_mask:0x5
    v_add_f32_dpp v233, v249, v249 row_half_mirror row_mask:0xf bank_mask:0x5
    v_add_f32_dpp v234, v250, v250 row_half_mirror row_mask:0xf bank_mask:0x5
    v_add_f32_dpp v235, v251, v251 row_half_mirror row_mask:0xf bank_mask:0x5
    v_add_f32_dpp v232, v252, v252 row_half_mirror row_mask:0xf bank_mask:0xa
    v_add_f32_dpp v233, v253, v253 row_half_mirror row_mask:0xf bank_mask:0xa
    v_add_f32_dpp v234, v254, v254 row_half_mirror row_mask:0xf bank_mask:0xa
    v_add_f32_dpp v235, v255, v255 row_half_mirror row_mask:0xf bank_mask:0xa
    v_cndmask_b32_e64 v248, v232, v234, s[52:53]
    v_cndmask_b32_e64 v250, v234, v232, s[52:53]
    v_cndmask_b32_e64 v249, v233, v235, s[52:53]
    v_cndmask_b32_e64 v251, v235, v233, s[52:53]
    v_add_f32_dpp v232, v250, v248 quad_perm:[2,3,0,1] row_mask:0xf bank_mask:0xf
    s_nop 0
    v_add_f32_dpp v233, v251, v249 quad_perm:[2,3,0,1] row_mask:0xf bank_mask:0xf
    v_cndmask_b32_e64 v248, v232, v233, s[60:61]
    v_cndmask_b32_e64 v249, v233, v232, s[60:61]
    s_nop 1
    v_add_f32_dpp v232, v249, v248 quad_perm:[1,0,3,2] row_mask:0xf bank_mask:0xf
    ds_write_b32 v30, v232 offset:24576
    s_waitcnt lgkmcnt(0)
    s_barrier
    ds_read_b64 v[248:249], v23 offset:24576
    ds_read_b64 v[250:251], v23 offset:24832
    ds_read_b64 v[252:253], v23 offset:25088
    ds_read_b64 v[254:255], v23 offset:25344
    s_waitcnt lgkmcnt(0)
    v_add_f32 v248, v248, v250
    v_add_f32 v249, v249, v251
    v_add_f32 v252, v252, v254
    v_add_f32 v253, v253, v255
    v_add_f32 v248, v248, v252
    v_add_f32 v249, v249, v253
    v_or_b32 v249, 0x80000000, v249
    s_cmp_eq_u32 s8, 0
    s_cbranch_scc1 TL_LF_17
    s_mov_b64 exec, s[66:67]
    buffer_store_dwordx2 v[248:249], v27, s[12:15], s45 offen
    s_mov_b64 exec, -1
TL_LF_17_R:
    v_fma_f32 v112, v98, v64, v112
    v_fma_f32 v113, v98, v65, v113
    v_fma_f32 v114, v98, v66, v114
    v_fma_f32 v115, v98, v67, v115
    v_fma_f32 v120, v98, v72, v120
    v_fma_f32 v121, v98, v73, v121
    v_fma_f32 v122, v98, v74, v122
    v_fma_f32 v123, v98, v75, v123
    v_fma_f32 v112, v99, v112, v68
    v_fma_f32 v113, v99, v113, v69
    v_fma_f32 v114, v99, v114, v70
    v_fma_f32 v115, v99, v115, v71
    v_fma_f32 v120, v99, v120, v76
    v_fma_f32 v121, v99, v121, v77
    v_fma_f32 v122, v99, v122, v78
    v_fma_f32 v123, v99, v123, v79
    v_mul_f32 v224, v112, v112
    v_mul_f32 v225, v113, v113
    v_mul_f32 v226, v114, v114
    v_mul_f32 v227, v115, v115
    v_mul_f32 v228, v120, v120
    v_mul_f32 v229, v121, v121
    v_mul_f32 v230, v122, v122
    v_mul_f32 v231, v123, v123
    v_fma_f32 v224, v224, v60, s44
    v_fma_f32 v225, v225, v60, s44
    v_fma_f32 v226, v226, v60, s44
    v_fma_f32 v227, v227, v60, s44
    v_fma_f32 v228, v228, v60, s44
    v_fma_f32 v229, v229, v60, s44
    v_fma_f32 v230, v230, v60, s44
    v_fma_f32 v231, v231, v60, s44
    v_mul_f32 v224, v224, v112
    v_mul_f32 v225, v225, v113
    v_mul_f32 v226, v226, v114
    v_mul_f32 v227, v227, v115
    v_mul_f32 v228, v228, v120
    v_mul_f32 v229, v229, v121
    v_mul_f32 v230, v230, v122
    v_mul_f32 v231, v231, v123
    v_exp_f32 v224, v224
    v_exp_f32 v225, v225
    v_exp_f32 v226, v226
    v_exp_f32 v227, v227
    v_exp_f32 v228, v228
    v_exp_f32 v229, v229
    v_exp_f32 v230, v230
    v_exp_f32 v231, v231
    v_add_f32 v224, 1.0, v224
    v_add_f32 v225, 1.0, v225
    v_add_f32 v226, 1.0, v226
    v_add_f32 v227, 1.0, v227
    v_add_f32 v228, 1.0, v228
    v_add_f32 v229, 1.0, v229
    v_add_f32 v230, 1.0, v230
    v_add_f32 v231, 1.0, v231
    v_rcp_f32 v224, v224
    v_rcp_f32 v225, v225
    v_rcp_f32 v226, v226
    v_rcp_f32 v227, v227
    v_rcp_f32 v228, v228
    v_rcp_f32 v229, v229
    v_rcp_f32 v230, v230
    v_rcp_f32 v231, v231
    v_mul_f32 v112, v112, v224
    v_mul_f32 v113, v113, v225
    v_mul_f32 v114, v114, v226
    v_mul_f32 v115, v115, v227
    v_mul_f32 v120, v120, v228
    v_mul_f32 v121, v121, v229
    v_mul_f32 v122, v122, v230
    v_mul_f32 v123, v123, v231
    v_cvt_pk_bf16_f32 v224, v112, v113
    v_cvt_pk_bf16_f32 v225, v114, v115
    ds_write_b64 v29, v[224:225] offset:3200
    v_cvt_pk_bf16_f32 v228, v120, v121
    v_cvt_pk_bf16_f32 v229, v122, v123
    ds_write_b64 v29, v[228:229] offset:3232
    buffer_load_dword v57, v24, s[12:15], s28 offen sc1
    buffer_load_dwordx4 v[236:239], v31, s[12:15], s50 offen sc0 sc1
    buffer_load_dwordx4 v[240:243], v31, s[12:15], s50 offen offset:16 sc0 sc1
    s_waitcnt vmcnt(2)
    v_cmp_le_u32 vcc, 1, v57
    s_nop 0
    s_cmp_eq_u64 vcc, -1
    s_cbranch_scc0 TBX2H_S
TBX2H_R:
    s_add_u32 s38, s63, s36
    s_add_u32 m0, s38, 0
    s_nop 0
    buffer_load_dwordx4 v2, s[12:15], s29 offen offset:0 sc1 lds
    buffer_load_dwordx4 v2, s[12:15], s29 offen offset:1024 sc1 lds
    buffer_load_dwordx4 v2, s[12:15], s29 offen offset:2048 sc1 lds
    buffer_load_dwordx4 v2, s[12:15], s29 offen offset:3072 sc1 lds
    s_add_u32 s29, s29, 16384
    buffer_load_dwordx4 v[32:35], v19, s[12:15], s30 offen sc1
    buffer_load_dwordx4 v[36:39], v19, s[12:15], s30 offen offset:16 sc1
    s_add_u32 s30, s30, 16777216
    s_add_u32 m0, s38, 32768
    s_nop 0
    buffer_load_dwordx4 v2, s[12:15], s29 offen offset:0 sc1 lds
    buffer_load_dwordx4 v2, s[12:15], s29 offen offset:1024 sc1 lds
    buffer_load_dwordx4 v2, s[12:15], s29 offen offset:2048 sc1 lds
    buffer_load_dwordx4 v2, s[12:15], s29 offen offset:3072 sc1 lds
    s_add_u32 s29, s29, 16760832
    s_waitcnt vmcnt(10)
    v_and_b32 v57, v237, v239
    v_and_b32 v56, v241, v243
    v_and_b32 v57, v57, v56
    v_cmp_gt_i32 vcc, 0, v57
    s_nop 0
    s_cmp_eq_u64 vcc, -1
    s_cbranch_scc0 TBZL_S
TBZL_R:
    v_add_f32 v236, v236, v238
    v_add_f32 v237, v237, v239
    v_add_f32 v240, v240, v242
    v_add_f32 v241, v241, v243
    v_add_f32 v236, v236, v240
    v_add_f32 v237, v237, v241
    v_mov_b32 v238, v236
    v_mov_b32 v239, v237
    s_nop 0
    v_permlane32_swap_b32 v236, v238
    v_permlane32_swap_b32 v237, v239
    v_add_f32 v236, v236, v238
    v_add_f32 v237, v237, v239
    v_mul_f32 v236, 0xbabe82fa, v236
    v_mul_f32 v237, 0xbabe82fa, v237
    v_fma_f32 v237, -v236, v236, v237
    v_max_f32 v237, 0, v237
    v_add_f32 v237, 0x3727c5ac, v237
    v_rsq_f32 v237, v237
    s_nop 0
    v_mul_f32 v236, v236, v237
    ds_write_b32 v25, v236 offset:28672
    ds_write_b32 v25, v237 offset:28928
    s_waitcnt lgkmcnt(0)
    ds_read_b128 v[236:239], v28 offset:28672
    ds_read_b128 v[244:247], v28 offset:28928
    ds_read_b128 v[240:243], v28 offset:28736
    ds_read_b128 v[248:251], v28 offset:28992
    s_waitcnt lgkmcnt(0)
    v_fma_f32 v100, v100, v244, v236
    v_fma_f32 v101, v101, v245, v237
    v_fma_f32 v102, v102, v246, v238
    v_fma_f32 v103, v103, v247, v239
    v_fma_f32 v104, v104, v248, v240
    v_fma_f32 v105, v105, v249, v241
    v_fma_f32 v106, v106, v250, v242
    v_fma_f32 v107, v107, v251, v243
    v_cvt_pk_bf16_f32 v100, v100, v101
    v_cvt_pk_bf16_f32 v101, v102, v103
    v_cvt_pk_bf16_f32 v102, v104, v105
    v_cvt_pk_bf16_f32 v103, v106, v107
    buffer_store_dwordx4 v[100:103], v3, s[12:15], s54 offen sc1
    v_fma_f32 v108, v108, v244, v236
    v_fma_f32 v109, v109, v245, v237
    v_fma_f32 v110, v110, v246, v238
    v_fma_f32 v111, v111, v247, v239
    v_fma_f32 v112, v112, v248, v240
    v_fma_f32 v113, v113, v249, v241
    v_fma_f32 v114, v114, v250, v242
    v_fma_f32 v115, v115, v251, v243
    v_cvt_pk_bf16_f32 v108, v108, v109
    v_cvt_pk_bf16_f32 v109, v110, v111
    v_cvt_pk_bf16_f32 v110, v112, v113
    v_cvt_pk_bf16_f32 v111, v114, v115
    buffer_store_dwordx4 v[108:111], v0, s[12:15], s54 offen sc1
    s_waitcnt vmcnt(6)
    v_add_f32 v32, v32, v34
    v_add_f32 v33, v33, v35
    v_add_f32 v36, v36, v38
    v_add_f32 v37, v37, v39
    v_add_f32 v32, v32, v36
    v_add_f32 v33, v33, v37
    s_nop 0
    v_add_f32_dpp v34, v32, v32 quad_perm:[1,0,3,2] row_mask:0xf bank_mask:0xf
    v_add_f32_dpp v35, v33, v33 quad_perm:[1,0,3,2] row_mask:0xf bank_mask:0xf
    ds_write_b64 v22, v[34:35] offset:18432
    s_waitcnt vmcnt(2) lgkmcnt(0)
    s_barrier
    ds_read_b128 v[128:131], v17 offset:0
    ds_read_b128 v[132:135], v17 offset:1024
    ds_read_b128 v[136:139], v17 offset:2048
    ds_read_b128 v[140:143], v17 offset:3072
    s_waitcnt lgkmcnt(3)
    v_mfma_f32_16x16x32_bf16 v[212:215], v[128:131], a[0:3], 0
    ds_read_b64 v[32:33], v23 offset:18432
    ds_read_b64 v[34:35], v23 offset:18688
    ds_read_b64 v[36:37], v23 offset:18944
    v_mfma_f32_16x16x32_bf16 v[220:223], a[64:67], v[128:131], 0
    ds_read_b64 v[38:39], v23 offset:19200
    s_lshl_b32 s50, s46, 11
    s_add_u32 s50, s50, s80
    s_add_u32 s50, s50, 8192
    s_lshl_b32 s45, s43, 3
    v_mfma_f32_16x16x32_bf16 v[228:231], a[128:131], v[128:131], 0
    ds_read_b128 v[144:147], v17 offset:4096
    s_add_u32 s45, s45, s50
    s_waitcnt lgkmcnt(7)
    v_mfma_f32_16x16x32_bf16 v[212:215], v[132:135], a[4:7], v[212:215]
    v_mfma_f32_16x16x32_bf16 v[220:223], a[68:71], v[132:135], v[220:223]
    s_add_u32 s38, s64, s36
    s_add_u32 m0, s38, 0
    s_nop 0
    buffer_load_dwordx4 v2, s[12:15], s31 offen offset:0 lds
    v_mfma_f32_16x16x32_bf16 v[228:231], a[132:135], v[132:135], v[228:231]
    ds_read_b128 v[148:151], v17 offset:5120
    s_waitcnt lgkmcnt(7)
    v_mfma_f32_16x16x32_bf16 v[212:215], v[136:139], a[8:11], v[212:215]
    s_waitcnt lgkmcnt(2)
    v_add_f32 v32, v32, v34
    v_add_f32 v33, v33, v35
    v_mfma_f32_16x16x32_bf16 v[220:223], a[72:75], v[136:139], v[220:223]
    v_add_f32 v36, v36, v38
    v_add_f32 v37, v37, v39
    v_add_f32 v32, v32, v36
    v_mfma_f32_16x16x32_bf16 v[228:231], a[136:139], v[136:139], v[228:231]
    ds_read_b128 v[152:155], v17 offset:6144
    v_add_f32 v33, v33, v37
    v_mul_f32 v96, 0xbb000000, v32
    v_mfma_f32_16x16x32_bf16 v[212:215], v[140:143], a[12:15], v[212:215]
    v_mul_f32 v33, 0x3b000000, v33
    v_fma_f32 v33, -v96, v96, v33
    v_max_f32 v33, 0, v33
    v_mfma_f32_16x16x32_bf16 v[220:223], a[76:79], v[140:143], v[220:223]
    v_add_f32 v33, 0x3727c5ac, v33
    v_rsq_f32 v97, v33
    v_mfma_f32_16x16x32_bf16 v[228:231], a[140:143], v[140:143], v[228:231]
    ds_read_b128 v[156:159], v17 offset:7168
    ds_write_b32 v25, v96 offset:22528
    ds_write_b32 v25, v97 offset:22784
    s_waitcnt lgkmcnt(5)
    v_mfma_f32_16x16x32_bf16 v[212:215], v[144:147], a[16:19], v[212:215]
    v_mov_b32 v98, v96
    v_mov_b32 v99, v97
    v_mfma_f32_16x16x32_bf16 v[220:223], a[80:83], v[144:147], v[220:223]
    s_add_u32 s38, s64, s36
    s_add_u32 m0, s38, 1024
    s_nop 0
    buffer_load_dwordx4 v2, s[12:15], s33 offen offset:0 lds
    v_mfma_f32_16x16x32_bf16 v[228:231], a[144:147], v[144:147], v[228:231]
    ds_read_b128 v[160:163], v17 offset:8192
    s_waitcnt lgkmcnt(5)
    v_mfma_f32_16x16x32_bf16 v[212:215], v[148:151], a[20:23], v[212:215]
    s_add_u32 s38, s64, s36
    s_add_u32 m0, s38, 0
    s_nop 0
    buffer_load_dwordx4 v2, s[12:15], s31 offen offset:2048 lds
    v_mfma_f32_16x16x32_bf16 v[220:223], a[84:87], v[148:151], v[220:223]
    s_waitcnt lgkmcnt(1)
    ds_read_b128 v[80:83], v28 offset:22528
    ds_read_b128 v[88:91], v28 offset:22784
    v_mfma_f32_16x16x32_bf16 v[228:231], a[148:151], v[148:151], v[228:231]
    ds_read_b128 v[164:167], v17 offset:9216
    ds_read_b128 v[84:87], v28 offset:22592
    ds_read_b128 v[92:95], v28 offset:22848
    v_mfma_f32_16x16x32_bf16 v[212:215], v[152:155], a[24:27], v[212:215]
    v_permlane16_swap_b32 v96, v98
    v_permlane16_swap_b32 v97, v99
    v_mfma_f32_16x16x32_bf16 v[220:223], a[88:91], v[152:155], v[220:223]
    s_add_u32 s38, s64, s36
    s_add_u32 m0, s38, 1024
    s_nop 0
    buffer_load_dwordx4 v2, s[12:15], s33 offen offset:2048 lds
    s_add_u32 s31, s31, 4096
    s_add_u32 s33, s33, 4096
    v_mfma_f32_16x16x32_bf16 v[228:231], a[152:155], v[152:155], v[228:231]
    ds_read_b128 v[168:171], v17 offset:10240
    v_mfma_f32_16x16x32_bf16 v[212:215], v[156:159], a[28:31], v[212:215]
    s_add_u32 s38, s64, s36
    s_add_u32 m0, s38, 32768
    s_nop 0
    buffer_load_dwordx4 v2, s[12:15], s31 offen offset:0 lds
    v_mfma_f32_16x16x32_bf16 v[220:223], a[92:95], v[156:159], v[220:223]
    s_add_u32 s38, s64, s36
    s_add_u32 m0, s38, 33792
    s_nop 0
    buffer_load_dwordx4 v2, s[12:15], s33 offen offset:0 lds
    v_mfma_f32_16x16x32_bf16 v[228:231], a[156:159], v[156:159], v[228:231]
    ds_read_b128 v[172:175], v17 offset:11264
    s_waitcnt lgkmcnt(7)
    v_mfma_f32_16x16x32_bf16 v[212:215], v[160:163], a[32:35], v[212:215]
    s_add_u32 s38, s64, s36
    s_add_u32 m0, s38, 32768
    s_nop 0
    buffer_load_dwordx4 v2, s[12:15], s31 offen offset:2048 lds
    v_mfma_f32_16x16x32_bf16 v[220:223], a[96:99], v[160:163], v[220:223]
    s_add_u32 s38, s64, s36
    s_add_u32 m0, s38, 33792
    s_nop 0
    buffer_load_dwordx4 v2, s[12:15], s33 offen offset:2048 lds
    s_add_u32 s31, s31, 4096
    s_add_u32 s33, s33, 4096
    v_mfma_f32_16x16x32_bf16 v[228:231], a[160:163], v[160:163], v[228:231]
    ds_read_b128 v[176:179], v17 offset:12288
    s_waitcnt lgkmcnt(3)
    v_mfma_f32_16x16x32_bf16 v[212:215], v[164:167], a[36:39], v[212:215]
    v_mfma_f32_16x16x32_bf16 v[220:223], a[100:103], v[164:167], v[220:223]
    s_add_u32 s38, s62, s36
    s_add_u32 m0, s38, 0
    s_nop 0
    buffer_load_dwordx4 v2, s[12:15], s31 offen offset:0 lds
    v_mfma_f32_16x16x32_bf16 v[228:231], a[164:167], v[164:167], v[228:231]
    ds_read_b128 v[180:183], v17 offset:13312
    s_waitcnt lgkmcnt(3)
    v_mfma_f32_16x16x32_bf16 v[212:215], v[168:171], a[40:43], v[212:215]
    v_mfma_f32_16x16x32_bf16 v[220:223], a[104:107], v[168:171], v[220:223]
    s_add_u32 s38, s62, s36
    s_add_u32 m0, s38, 1024
    s_nop 0
    buffer_load_dwordx4 v2, s[12:15], s33 offen offset:0 lds
    v_mfma_f32_16x16x32_bf16 v[228:231], a[168:171], v[168:171], v[228:231]
    ds_read_b128 v[184:187], v17 offset:14336
    s_waitcnt lgkmcnt(3)
    v_mfma_f32_16x16x32_bf16 v[212:215], v[172:175], a[44:47], v[212:215]
    v_mfma_f32_16x16x32_bf16 v[220:223], a[108:111], v[172:175], v[220:223]
    s_add_u32 s38, s62, s36
    s_add_u32 m0, s38, 0
    s_nop 0
    buffer_load_dwordx4 v2, s[12:15], s31 offen offset:2048 lds
    v_mfma_f32_16x16x32_bf16 v[228:231], a[172:175], v[172:175], v[228:231]
    ds_read_b128 v[188:191], v17 offset:15360
    s_waitcnt lgkmcnt(3)
    v_mfma_f32_16x16x32_bf16 v[212:215], v[176:179], a[48:51], v[212:215]
    v_mfma_f32_16x16x32_bf16 v[220:223], a[112:115], v[176:179], v[220:223]
    s_add_u32 s38, s62, s36
    s_add_u32 m0, s38, 1024
    s_nop 0
    buffer_load_dwordx4 v2, s[12:15], s33 offen offset:2048 lds
    s_add_u32 s31, s31, 4096
    s_add_u32 s33, s33, 4096
    v_mfma_f32_16x16x32_bf16 v[228:231], a[176:179], v[176:179], v[228:231]
    ds_read_b128 v[128:131], v17 offset:32768
    s_waitcnt lgkmcnt(3)
    v_mfma_f32_16x16x32_bf16 v[212:215], v[180:183], a[52:55], v[212:215]
    ds_read_b128 v[132:135], v17 offset:33792
    v_mfma_f32_16x16x32_bf16 v[220:223], a[116:119], v[180:183], v[220:223]
    ds_read_b128 v[136:139], v17 offset:34816
    v_mfma_f32_16x16x32_bf16 v[228:231], a[180:183], v[180:183], v[228:231]
    ds_read_b128 v[140:143], v17 offset:35840
    s_waitcnt lgkmcnt(5)
    v_mfma_f32_16x16x32_bf16 v[212:215], v[184:187], a[56:59], v[212:215]
    ds_read_b128 v[144:147], v17 offset:36864
    v_mfma_f32_16x16x32_bf16 v[220:223], a[120:123], v[184:187], v[220:223]
    ds_read_b128 v[148:151], v17 offset:37888
    v_mfma_f32_16x16x32_bf16 v[228:231], a[184:187], v[184:187], v[228:231]
    ds_read_b128 v[152:155], v17 offset:38912
    s_waitcnt lgkmcnt(7)
    v_mfma_f32_16x16x32_bf16 v[212:215], v[188:191], a[60:63], v[212:215]
    ds_read_b128 v[156:159], v17 offset:39936
    v_mfma_f32_16x16x32_bf16 v[220:223], a[124:127], v[188:191], v[220:223]
    ds_read_b128 v[160:163], v17 offset:40960
    v_mfma_f32_16x16x32_bf16 v[228:231], a[188:191], v[188:191], v[228:231]
    ds_read_b128 v[164:167], v17 offset:41984
    s_waitcnt lgkmcnt(9)
    v_mfma_f32_16x16x32_bf16 v[216:219], v[128:131], a[0:3], 0
    ds_read_b128 v[168:171], v17 offset:43008
    s_waitcnt lgkmcnt(9)
    v_mfma_f32_16x16x32_bf16 v[216:219], v[132:135], a[4:7], v[216:219]
    ds_read_b128 v[172:175], v17 offset:44032
    v_fma_f32 v212, v80, v4, v212
    v_fma_f32 v213, v81, v4, v213
    s_waitcnt lgkmcnt(9)
    v_mfma_f32_16x16x32_bf16 v[216:219], v[136:139], a[8:11], v[216:219]
    ds_read_b128 v[176:179], v17 offset:45056
    v_fma_f32 v214, v82, v4, v214
    v_fma_f32 v215, v83, v4, v215
    s_waitcnt lgkmcnt(9)
    v_mfma_f32_16x16x32_bf16 v[216:219], v[140:143], a[12:15], v[216:219]
    ds_read_b128 v[180:183], v17 offset:46080
    v_fma_f32 v212, v88, v212, v5
    v_fma_f32 v213, v89, v213, v5
    s_waitcnt lgkmcnt(9)
    v_mfma_f32_16x16x32_bf16 v[216:219], v[144:147], a[16:19], v[216:219]
    ds_read_b128 v[184:187], v17 offset:47104
    v_fma_f32 v214, v90, v214, v5
    v_fma_f32 v215, v91, v215, v5
    s_waitcnt lgkmcnt(9)
    v_mfma_f32_16x16x32_bf16 v[216:219], v[148:151], a[20:23], v[216:219]
    ds_read_b128 v[188:191], v17 offset:48128
    v_mul_f32 v32, v212, v212
    v_mul_f32 v33, v213, v213
    s_waitcnt lgkmcnt(9)
    v_mfma_f32_16x16x32_bf16 v[216:219], v[152:155], a[24:27], v[216:219]
    s_add_u32 s38, s62, s36
    s_add_u32 m0, s38, 32768
    s_nop 0
    buffer_load_dwordx4 v2, s[12:15], s31 offen offset:0 lds
    s_waitcnt lgkmcnt(8)
    v_mfma_f32_16x16x32_bf16 v[216:219], v[156:159], a[28:31], v[216:219]
    s_add_u32 s38, s62, s36
    s_add_u32 m0, s38, 33792
    s_nop 0
    buffer_load_dwordx4 v2, s[12:15], s33 offen offset:0 lds
    s_waitcnt lgkmcnt(7)
    v_mfma_f32_16x16x32_bf16 v[216:219], v[160:163], a[32:35], v[216:219]
    s_add_u32 s38, s62, s36
    s_add_u32 m0, s38, 32768
    s_nop 0
    buffer_load_dwordx4 v2, s[12:15], s31 offen offset:2048 lds
    s_waitcnt lgkmcnt(6)
    v_mfma_f32_16x16x32_bf16 v[216:219], v[164:167], a[36:39], v[216:219]
    s_add_u32 s38, s62, s36
    s_add_u32 m0, s38, 33792
    s_nop 0
    buffer_load_dwordx4 v2, s[12:15], s33 offen offset:2048 lds
    s_add_u32 s31, s31, 4096
    s_add_u32 s33, s33, 4096
    s_waitcnt lgkmcnt(5)
    v_mfma_f32_16x16x32_bf16 v[216:219], v[168:171], a[40:43], v[216:219]
    v_mul_f32 v34, v214, v214
    v_mul_f32 v35, v215, v215
    v_fma_f32 v32, v32, v60, s44
    s_waitcnt lgkmcnt(4)
    v_mfma_f32_16x16x32_bf16 v[216:219], v[172:175], a[44:47], v[216:219]
    v_fma_f32 v33, v33, v60, s44
    v_fma_f32 v34, v34, v60, s44
    v_fma_f32 v35, v35, v60, s44
    s_waitcnt lgkmcnt(3)
    v_mfma_f32_16x16x32_bf16 v[216:219], v[176:179], a[48:51], v[216:219]
    s_waitcnt vmcnt(16)
    v_mul_f32 v32, v32, v212
    v_mul_f32 v33, v33, v213
    s_waitcnt lgkmcnt(2)
    v_mfma_f32_16x16x32_bf16 v[216:219], v[180:183], a[52:55], v[216:219]
    v_mov_b32 v58, 1
    s_mov_b64 exec, 1
    buffer_store_dword v58, off, s[12:15], s59 sc1
    s_mov_b64 exec, -1
    s_waitcnt lgkmcnt(1)
    v_mfma_f32_16x16x32_bf16 v[216:219], v[184:187], a[56:59], v[216:219]
    s_lshl_b32 s34, s43, 6
    s_add_u32 s34, s34, s71
    s_lshl_b32 s59, s34, 4
    s_mul_i32 s34, s34, 6144
    s_waitcnt lgkmcnt(0)
    v_mfma_f32_16x16x32_bf16 v[216:219], v[188:191], a[60:63], v[216:219]
    s_add_u32 s54, s34, 75497472
    s_lshl_b32 s34, s55, 2
    s_add_u32 s59, s59, s34
    s_add_u32 s59, s59, 434176
    v_mul_f32 v34, v34, v214
    v_mfma_f32_16x16x32_bf16 v[224:227], a[64:67], v[128:131], 0
    v_mul_f32 v35, v35, v215
    v_exp_f32 v32, v32
    v_mfma_f32_16x16x32_bf16 v[232:235], a[128:131], v[128:131], 0
    v_exp_f32 v33, v33
    v_fma_f32 v220, v96, v64, v220
    v_mfma_f32_16x16x32_bf16 v[224:227], a[68:71], v[132:135], v[224:227]
    v_exp_f32 v34, v34
    v_fma_f32 v221, v96, v65, v221
    v_mfma_f32_16x16x32_bf16 v[232:235], a[132:135], v[132:135], v[232:235]
    v_exp_f32 v35, v35
    v_add_f32 v32, 1.0, v32
    v_mfma_f32_16x16x32_bf16 v[224:227], a[72:75], v[136:139], v[224:227]
    v_add_f32 v33, 1.0, v33
    v_add_f32 v34, 1.0, v34
    v_add_f32 v35, 1.0, v35
    v_mfma_f32_16x16x32_bf16 v[232:235], a[136:139], v[136:139], v[232:235]
    v_rcp_f32 v32, v32
    v_fma_f32 v222, v96, v66, v222
    v_mfma_f32_16x16x32_bf16 v[224:227], a[76:79], v[140:143], v[224:227]
    v_rcp_f32 v33, v33
    v_fma_f32 v223, v96, v67, v223
    v_mfma_f32_16x16x32_bf16 v[232:235], a[140:143], v[140:143], v[232:235]
    v_rcp_f32 v34, v34
    v_fma_f32 v228, v96, v72, v228
    v_mfma_f32_16x16x32_bf16 v[224:227], a[80:83], v[144:147], v[224:227]
    v_rcp_f32 v35, v35
    v_mul_f32 v212, v212, v32
    v_mfma_f32_16x16x32_bf16 v[232:235], a[144:147], v[144:147], v[232:235]
    v_mul_f32 v213, v213, v33
    v_mul_f32 v214, v214, v34
    v_mul_f32 v215, v215, v35
    v_mfma_f32_16x16x32_bf16 v[224:227], a[84:87], v[148:151], v[224:227]
    v_mul_f32 v40, v212, v61
    v_mul_f32 v41, v213, v61
    v_mul_f32 v42, v214, v61
    v_mfma_f32_16x16x32_bf16 v[232:235], a[148:151], v[148:151], v[232:235]
    v_mul_f32 v43, v215, v61
    v_mul_f32 v48, v40, v40
    v_mul_f32 v49, v41, v41
    v_mfma_f32_16x16x32_bf16 v[224:227], a[88:91], v[152:155], v[224:227]
    v_mul_f32 v50, v42, v42
    v_mul_f32 v51, v43, v43
    v_fma_f32 v216, v84, v4, v216
    v_mfma_f32_16x16x32_bf16 v[232:235], a[152:155], v[152:155], v[232:235]
    v_fma_f32 v217, v85, v4, v217
    v_fma_f32 v218, v86, v4, v218
    v_fma_f32 v219, v87, v4, v219
    v_mfma_f32_16x16x32_bf16 v[224:227], a[92:95], v[156:159], v[224:227]
    v_fma_f32 v216, v92, v216, v5
    v_fma_f32 v217, v93, v217, v5
    v_fma_f32 v218, v94, v218, v5
    v_mfma_f32_16x16x32_bf16 v[232:235], a[156:159], v[156:159], v[232:235]
    v_fma_f32 v219, v95, v219, v5
    v_mul_f32 v32, v216, v216
    v_mul_f32 v33, v217, v217
    v_mfma_f32_16x16x32_bf16 v[224:227], a[96:99], v[160:163], v[224:227]
    v_mul_f32 v34, v218, v218
    v_mul_f32 v35, v219, v219
    v_fma_f32 v32, v32, v60, s44
    v_mfma_f32_16x16x32_bf16 v[232:235], a[160:163], v[160:163], v[232:235]
    v_fma_f32 v33, v33, v60, s44
    v_fma_f32 v34, v34, v60, s44
    v_fma_f32 v35, v35, v60, s44
    v_mfma_f32_16x16x32_bf16 v[224:227], a[100:103], v[164:167], v[224:227]
    v_mul_f32 v32, v32, v216
    v_mul_f32 v33, v33, v217
    v_mul_f32 v34, v34, v218
    v_mfma_f32_16x16x32_bf16 v[232:235], a[164:167], v[164:167], v[232:235]
    v_mul_f32 v35, v35, v219
    v_exp_f32 v32, v32
    v_mfma_f32_16x16x32_bf16 v[224:227], a[104:107], v[168:171], v[224:227]
    v_exp_f32 v33, v33
    v_fma_f32 v229, v96, v73, v229
    v_mfma_f32_16x16x32_bf16 v[232:235], a[168:171], v[168:171], v[232:235]
    v_exp_f32 v34, v34
    v_fma_f32 v230, v96, v74, v230
    v_mfma_f32_16x16x32_bf16 v[224:227], a[108:111], v[172:175], v[224:227]
    v_exp_f32 v35, v35
    v_add_f32 v32, 1.0, v32
    v_mfma_f32_16x16x32_bf16 v[232:235], a[172:175], v[172:175], v[232:235]
    v_add_f32 v33, 1.0, v33
    v_add_f32 v34, 1.0, v34
    v_add_f32 v35, 1.0, v35
    v_mfma_f32_16x16x32_bf16 v[224:227], a[112:115], v[176:179], v[224:227]
    v_rcp_f32 v32, v32
    v_fma_f32 v231, v96, v75, v231
    v_mfma_f32_16x16x32_bf16 v[232:235], a[176:179], v[176:179], v[232:235]
    v_rcp_f32 v33, v33
    v_fma_f32 v220, v97, v220, v68
    v_mfma_f32_16x16x32_bf16 v[224:227], a[116:119], v[180:183], v[224:227]
    v_rcp_f32 v34, v34
    v_fma_f32 v221, v97, v221, v69
    v_mfma_f32_16x16x32_bf16 v[232:235], a[180:183], v[180:183], v[232:235]
    v_rcp_f32 v35, v35
    v_mul_f32 v216, v216, v32
    v_mfma_f32_16x16x32_bf16 v[224:227], a[120:123], v[184:187], v[224:227]
    v_mul_f32 v217, v217, v33
    v_mul_f32 v218, v218, v34
    v_mul_f32 v219, v219, v35
    v_mfma_f32_16x16x32_bf16 v[232:235], a[184:187], v[184:187], v[232:235]
    v_mul_f32 v44, v216, v61
    v_mul_f32 v45, v217, v61
    v_mul_f32 v46, v218, v61
    v_mfma_f32_16x16x32_bf16 v[224:227], a[124:127], v[188:191], v[224:227]
    v_mul_f32 v47, v219, v61
    v_mul_f32 v52, v44, v44
    v_mul_f32 v53, v45, v45
    v_mfma_f32_16x16x32_bf16 v[232:235], a[188:191], v[188:191], v[232:235]
    v_mul_f32 v54, v46, v46
    v_mul_f32 v55, v47, v47
    v_add_f32_dpp v100, v40, v40 row_ror:8 row_mask:0xf bank_mask:0x3
    v_add_u32 v56, s36, v2
    v_add_u32 v59, s64, v56
    v_add_u32 v58, s62, v56
    v_add_u32 v56, s65, v56
    s_waitcnt vmcnt(1)
    ds_read_b128 a[0:3], v56 offset:0
    ds_read_b128 a[4:7], v56 offset:1024
    ds_read_b128 a[8:11], v56 offset:2048
    ds_read_b128 a[12:15], v56 offset:3072
    ds_read_b128 a[16:19], v56 offset:32768
    ds_read_b128 a[20:23], v56 offset:33792
    ds_read_b128 a[24:27], v56 offset:34816
    ds_read_b128 a[28:31], v56 offset:35840
    ds_read_b128 a[32:35], v59 offset:0
    ds_read_b128 a[36:39], v59 offset:1024
    ds_read_b128 a[40:43], v59 offset:2048
    ds_read_b128 a[44:47], v59 offset:3072
    ds_read_b128 a[48:51], v59 offset:32768
    ds_read_b128 a[52:55], v59 offset:33792
    ds_read_b128 a[56:59], v59 offset:34816
    ds_read_b128 a[60:63], v59 offset:35840
    ds_read_b128 a[64:67], v58 offset:0
    ds_read_b128 a[68:71], v58 offset:1024
    ds_read_b128 a[72:75], v58 offset:2048
    ds_read_b128 a[76:79], v58 offset:3072
    ds_read_b128 a[80:83], v58 offset:32768
    ds_read_b128 a[84:87], v58 offset:33792
    ds_read_b128 a[88:91], v58 offset:34816
    ds_read_b128 a[92:95], v58 offset:35840
    s_lshl_b32 s34, s43, 10
    s_lshl_b32 s38, s55, 7
    s_add_u32 s34, s34, s38
    s_add_u32 s28, s34, 434176
    v_lshlrev_b32 v18, 2, v20
    buffer_load_dword v57, v18, s[12:15], s28 offen sc1
    s_lshl_b32 s34, s3, 4
    v_xor_b32 v58, s34, v20
    v_lshlrev_b32 v16, 4, v58
    v_lshl_add_u32 v16, v21, 9, v16
    s_cmp_eq_u32 s43, 7
    s_cselect_b32 s34, 8, 24
    v_cmp_gt_u32 vcc, s34, v58
    v_mov_b32 v17, 1073741824
    s_nop 0
    v_cndmask_b32 v17, v17, v16, vcc
    s_lshl_b32 s34, s43, 7
    s_lshl_b32 s38, s55, 4
    s_add_u32 s34, s34, s38
    s_mul_i32 s34, s34, 3072
    s_add_u32 s29, s34, 75497472
    v_add_f32_dpp v101, v41, v41 row_ror:8 row_mask:0xf bank_mask:0x3
    v_add_f32_dpp v102, v42, v42 row_ror:8 row_mask:0xf bank_mask:0x3
    v_add_f32_dpp v103, v43, v43 row_ror:8 row_mask:0xf bank_mask:0x3
    v_add_f32_dpp v104, v44, v44 row_ror:8 row_mask:0xf bank_mask:0x3
    v_add_f32_dpp v105, v45, v45 row_ror:8 row_mask:0xf bank_mask:0x3
    v_add_f32_dpp v106, v46, v46 row_ror:8 row_mask:0xf bank_mask:0x3
    buffer_load_dwordx4 a[96:99], v2, s[12:15], s31 offen offset:0
    v_add_f32_dpp v107, v47, v47 row_ror:8 row_mask:0xf bank_mask:0x3
    v_add_f32_dpp v100, v48, v48 row_ror:8 row_mask:0xf bank_mask:0xc
    v_add_f32_dpp v101, v49, v49 row_ror:8 row_mask:0xf bank_mask:0xc
    v_add_f32_dpp v102, v50, v50 row_ror:8 row_mask:0xf bank_mask:0xc
    v_add_f32_dpp v103, v51, v51 row_ror:8 row_mask:0xf bank_mask:0xc
    v_add_f32_dpp v104, v52, v52 row_ror:8 row_mask:0xf bank_mask:0xc
    buffer_load_dwordx4 a[100:103], v2, s[12:15], s33 offen offset:0
    v_add_f32_dpp v105, v53, v53 row_ror:8 row_mask:0xf bank_mask:0xc
    v_add_f32_dpp v106, v54, v54 row_ror:8 row_mask:0xf bank_mask:0xc
    v_add_f32_dpp v107, v55, v55 row_ror:8 row_mask:0xf bank_mask:0xc
    v_add_f32_dpp v40, v100, v100 row_half_mirror row_mask:0xf bank_mask:0x5
    v_add_f32_dpp v41, v101, v101 row_half_mirror row_mask:0xf bank_mask:0x5
    v_add_f32_dpp v42, v102, v102 row_half_mirror row_mask:0xf bank_mask:0x5
    buffer_load_dwordx4 a[104:107], v2, s[12:15], s31 offen offset:2048
    v_add_f32_dpp v43, v103, v103 row_half_mirror row_mask:0xf bank_mask:0x5
    v_add_f32_dpp v40, v104, v104 row_half_mirror row_mask:0xf bank_mask:0xa
    v_add_f32_dpp v41, v105, v105 row_half_mirror row_mask:0xf bank_mask:0xa
    v_add_f32_dpp v42, v106, v106 row_half_mirror row_mask:0xf bank_mask:0xa
    v_add_f32_dpp v43, v107, v107 row_half_mirror row_mask:0xf bank_mask:0xa
    v_cndmask_b32_e64 v100, v40, v42, s[52:53]
    buffer_load_dwordx4 a[108:111], v2, s[12:15], s33 offen offset:2048
    s_add_u32 s31, s31, 4096
    s_add_u32 s33, s33, 4096
    v_cndmask_b32_e64 v102, v42, v40, s[52:53]
    v_cndmask_b32_e64 v101, v41, v43, s[52:53]
    v_cndmask_b32_e64 v103, v43, v41, s[52:53]
    v_add_f32_dpp v40, v102, v100 quad_perm:[2,3,0,1] row_mask:0xf bank_mask:0xf
    s_nop 0
    v_add_f32_dpp v41, v103, v101 quad_perm:[2,3,0,1] row_mask:0xf bank_mask:0xf
    v_cndmask_b32_e64 v100, v40, v41, s[60:61]
    buffer_load_dwordx4 a[112:115], v2, s[12:15], s31 offen offset:0
    v_cndmask_b32_e64 v101, v41, v40, s[60:61]
    s_nop 1
    v_add_f32_dpp v40, v101, v100 quad_perm:[1,0,3,2] row_mask:0xf bank_mask:0xf
    ds_write_b32 v30, v40 offset:26624
    buffer_load_dwordx4 a[116:119], v2, s[12:15], s33 offen offset:0
    buffer_load_dwordx4 a[120:123], v2, s[12:15], s31 offen offset:2048
    buffer_load_dwordx4 a[124:127], v2, s[12:15], s33 offen offset:2048
    s_add_u32 s31, s31, 4096
    s_add_u32 s33, s33, 4096
    buffer_load_dwordx4 a[128:131], v2, s[12:15], s31 offen offset:0
    buffer_load_dwordx4 a[132:135], v2, s[12:15], s33 offen offset:0
    buffer_load_dwordx4 a[136:139], v2, s[12:15], s31 offen offset:2048
    buffer_load_dwordx4 a[140:143], v2, s[12:15], s33 offen offset:2048
    s_add_u32 s31, s31, 4096
    s_add_u32 s33, s33, 4096
    buffer_load_dwordx4 a[144:147], v2, s[12:15], s31 offen offset:0
    buffer_load_dwordx4 a[148:151], v2, s[12:15], s33 offen offset:0
    buffer_load_dwordx4 a[152:155], v2, s[12:15], s31 offen offset:2048
    buffer_load_dwordx4 a[156:159], v2, s[12:15], s33 offen offset:2048
    s_add_u32 s31, s31, 4096
    s_add_u32 s33, s33, 4096
    s_waitcnt lgkmcnt(0)
    s_barrier
    ds_read_b64 v[100:101], v23 offset:26624
    ds_read_b64 v[102:103], v23 offset:26880
    ds_read_b64 v[104:105], v23 offset:27136
    ds_read_b64 v[106:107], v23 offset:27392
    s_waitcnt lgkmcnt(0)
    v_add_f32 v100, v100, v102
    v_add_f32 v101, v101, v103
    v_add_f32 v104, v104, v106
    v_add_f32 v105, v105, v107
    v_add_f32 v100, v100, v104
    v_add_f32 v101, v101, v105
    v_or_b32 v101, 0x80000000, v101
    s_cmp_eq_u32 s8, 0
    s_cbranch_scc1 TL_LF_18
    s_mov_b64 exec, s[66:67]
    buffer_store_dwordx2 v[100:101], v27, s[12:15], s45 offen
    s_mov_b64 exec, -1
TL_LF_18_R:
    s_waitcnt vmcnt(17)
    v_cmp_le_u32 vcc, 1, v57
    s_nop 0
    s_cmp_eq_u64 vcc, -1
    s_cbranch_scc0 TBFZL_S
TBFZL_R:
    buffer_load_dwordx4 v[128:131], v16, s[12:15], s29 offen offset:0
    buffer_load_dwordx4 v[132:135], v16, s[12:15], s29 offen offset:1024
    buffer_load_dwordx4 v[136:139], v17, s[12:15], s29 offen offset:2048
    s_add_u32 s29, s29, 3072
    buffer_load_dwordx4 v[140:143], v16, s[12:15], s29 offen offset:0
    buffer_load_dwordx4 v[144:147], v16, s[12:15], s29 offen offset:1024
    buffer_load_dwordx4 v[148:151], v17, s[12:15], s29 offen offset:2048
    s_add_u32 s29, s29, 3072
    v_fma_f32 v222, v97, v222, v70
    v_fma_f32 v223, v97, v223, v71
    v_fma_f32 v228, v97, v228, v76
    v_fma_f32 v229, v97, v229, v77
    v_fma_f32 v230, v97, v230, v78
    v_fma_f32 v231, v97, v231, v79
    v_mul_f32 v192, v220, v220
    v_mul_f32 v193, v221, v221
    v_mul_f32 v194, v222, v222
    v_mul_f32 v195, v223, v223
    v_mul_f32 v196, v228, v228
    v_mul_f32 v197, v229, v229
    v_mul_f32 v198, v230, v230
    v_mul_f32 v199, v231, v231
    v_fma_f32 v192, v192, v60, s44
    v_fma_f32 v193, v193, v60, s44
    v_fma_f32 v194, v194, v60, s44
    v_fma_f32 v195, v195, v60, s44
    v_fma_f32 v196, v196, v60, s44
    v_fma_f32 v197, v197, v60, s44
    v_fma_f32 v198, v198, v60, s44
    v_fma_f32 v199, v199, v60, s44
    v_mul_f32 v192, v192, v220
    v_mul_f32 v193, v193, v221
    v_mul_f32 v194, v194, v222
    v_mul_f32 v195, v195, v223
    v_mul_f32 v196, v196, v228
    v_mul_f32 v197, v197, v229
    v_mul_f32 v198, v198, v230
    v_mul_f32 v199, v199, v231
    v_exp_f32 v192, v192
    v_exp_f32 v193, v193
    v_exp_f32 v194, v194
    v_exp_f32 v195, v195
    v_exp_f32 v196, v196
    v_exp_f32 v197, v197
    v_exp_f32 v198, v198
    v_exp_f32 v199, v199
    v_add_f32 v192, 1.0, v192
    v_add_f32 v193, 1.0, v193
    v_add_f32 v194, 1.0, v194
    v_add_f32 v195, 1.0, v195
    v_add_f32 v196, 1.0, v196
    v_add_f32 v197, 1.0, v197
    v_add_f32 v198, 1.0, v198
    v_add_f32 v199, 1.0, v199
    v_rcp_f32 v192, v192
    v_rcp_f32 v193, v193
    v_rcp_f32 v194, v194
    v_rcp_f32 v195, v195
    v_rcp_f32 v196, v196
    v_rcp_f32 v197, v197
    v_rcp_f32 v198, v198
    v_rcp_f32 v199, v199
    v_mul_f32 v220, v220, v192
    v_mul_f32 v221, v221, v193
    v_mul_f32 v222, v222, v194
    v_mul_f32 v223, v223, v195
    v_mul_f32 v228, v228, v196
    v_mul_f32 v229, v229, v197
    v_mul_f32 v230, v230, v198
    v_mul_f32 v231, v231, v199
    v_cvt_pk_bf16_f32 v192, v220, v221
    v_cvt_pk_bf16_f32 v193, v222, v223
    ds_write_b64 v29, v[192:193] offset:6400
    v_cvt_pk_bf16_f32 v196, v228, v229
    v_cvt_pk_bf16_f32 v197, v230, v231
    ds_write_b64 v29, v[196:197] offset:6432
    v_fma_f32 v224, v98, v64, v224
    v_fma_f32 v225, v98, v65, v225
    v_fma_f32 v226, v98, v66, v226
    v_fma_f32 v227, v98, v67, v227
    v_fma_f32 v232, v98, v72, v232
    buffer_load_dwordx4 v[236:239], v31, s[12:15], s50 offen sc0 sc1
    buffer_load_dwordx4 v[240:243], v31, s[12:15], s50 offen offset:16 sc0 sc1
    buffer_load_dwordx4 v[152:155], v16, s[12:15], s29 offen offset:0
    buffer_load_dwordx4 v[156:159], v16, s[12:15], s29 offen offset:1024
    buffer_load_dwordx4 v[160:163], v17, s[12:15], s29 offen offset:2048
    s_add_u32 s29, s29, 3072
    buffer_load_dwordx4 v[164:167], v16, s[12:15], s29 offen offset:0
    buffer_load_dwordx4 v[168:171], v16, s[12:15], s29 offen offset:1024
    buffer_load_dwordx4 v[172:175], v17, s[12:15], s29 offen offset:2048
    s_add_u32 s29, s29, 3072
    buffer_load_dwordx4 v[176:179], v16, s[12:15], s29 offen offset:0
    buffer_load_dwordx4 v[180:183], v16, s[12:15], s29 offen offset:1024
    buffer_load_dwordx4 v[184:187], v17, s[12:15], s29 offen offset:2048
    s_add_u32 s29, s29, 3072
    v_fma_f32 v233, v98, v73, v233
    v_fma_f32 v234, v98, v74, v234
    v_fma_f32 v235, v98, v75, v235
    v_fma_f32 v224, v99, v224, v68
    v_fma_f32 v225, v99, v225, v69
    v_fma_f32 v226, v99, v226, v70
    v_fma_f32 v227, v99, v227, v71
    v_fma_f32 v232, v99, v232, v76
    v_fma_f32 v233, v99, v233, v77
    v_fma_f32 v234, v99, v234, v78
    v_fma_f32 v235, v99, v235, v79
    v_mul_f32 v192, v224, v224
    v_mul_f32 v193, v225, v225
    v_mul_f32 v194, v226, v226
    v_mul_f32 v195, v227, v227
    v_mul_f32 v196, v232, v232
    v_mul_f32 v197, v233, v233
    v_mul_f32 v198, v234, v234
    v_mul_f32 v199, v235, v235
    v_fma_f32 v192, v192, v60, s44
    v_fma_f32 v193, v193, v60, s44
    v_fma_f32 v194, v194, v60, s44
    v_fma_f32 v195, v195, v60, s44
    v_fma_f32 v196, v196, v60, s44
    v_fma_f32 v197, v197, v60, s44
    v_fma_f32 v198, v198, v60, s44
    v_fma_f32 v199, v199, v60, s44
    v_mul_f32 v192, v192, v224
    v_mul_f32 v193, v193, v225
    v_mul_f32 v194, v194, v226
    v_mul_f32 v195, v195, v227
    v_mul_f32 v196, v196, v232
    v_mul_f32 v197, v197, v233
    v_mul_f32 v198, v198, v234
    v_mul_f32 v199, v199, v235
    v_exp_f32 v192, v192
    v_exp_f32 v193, v193
    v_exp_f32 v194, v194
    v_exp_f32 v195, v195
    v_exp_f32 v196, v196
    v_exp_f32 v197, v197
    v_exp_f32 v198, v198
    v_exp_f32 v199, v199
    v_add_f32 v192, 1.0, v192
    v_add_f32 v193, 1.0, v193
    v_add_f32 v194, 1.0, v194
    v_add_f32 v195, 1.0, v195
    v_add_f32 v196, 1.0, v196
    v_add_f32 v197, 1.0, v197
    v_add_f32 v198, 1.0, v198
    v_add_f32 v199, 1.0, v199
    v_rcp_f32 v192, v192
    v_rcp_f32 v193, v193
    v_rcp_f32 v194, v194
    v_rcp_f32 v195, v195
    v_rcp_f32 v196, v196
    v_rcp_f32 v197, v197
    v_rcp_f32 v198, v198
    v_rcp_f32 v199, v199
    v_mul_f32 v224, v224, v192
    v_mul_f32 v225, v225, v193
    v_mul_f32 v226, v226, v194
    v_mul_f32 v227, v227, v195
    v_mul_f32 v232, v232, v196
    v_mul_f32 v233, v233, v197
    v_mul_f32 v234, v234, v198
    v_mul_f32 v235, v235, v199
    v_cvt_pk_bf16_f32 v192, v224, v225
    v_cvt_pk_bf16_f32 v193, v226, v227
    ds_write_b64 v29, v[192:193] offset:9600
    v_cvt_pk_bf16_f32 v196, v232, v233
    v_cvt_pk_bf16_f32 v197, v234, v235
    ds_write_b64 v29, v[196:197] offset:9632
    buffer_load_dwordx4 v[188:191], v16, s[12:15], s29 offen offset:0
    buffer_load_dwordx4 v[192:195], v16, s[12:15], s29 offen offset:1024
    buffer_load_dwordx4 v[196:199], v17, s[12:15], s29 offen offset:2048
    s_add_u32 s29, s29, 3072
    buffer_load_dwordx4 v[200:203], v16, s[12:15], s29 offen offset:0
    buffer_load_dwordx4 v[204:207], v16, s[12:15], s29 offen offset:1024
    buffer_load_dwordx4 v[208:211], v17, s[12:15], s29 offen offset:2048
    s_add_u32 s29, s29, 3072
    s_waitcnt lgkmcnt(0)
TL_S:
    s_nop 0
    s_waitcnt vmcnt(20)
    v_mfma_f32_32x32x16_bf16 v[32:47], v[128:131], a[192:195], 0
    s_add_u32 s28, s28, 512
    v_mfma_f32_32x32x16_bf16 v[80:95], v[128:131], a[196:199], 0
    s_waitcnt vmcnt(15)
    v_and_b32 v15, v237, v239
    v_and_b32 v11, v241, v243
    v_and_b32 v15, v15, v11
    v_cmp_gt_i32 vcc, 0, v15
    s_nop 0
    s_cmp_eq_u64 vcc, -1
    s_cbranch_scc0 TZH_S
TZH_R:
    v_mfma_f32_32x32x16_bf16 v[48:63], v[132:135], a[192:195], 0
    v_add_f32 v236, v236, v238
    v_add_f32 v237, v237, v239
    v_add_f32 v240, v240, v242
    v_add_f32 v241, v241, v243
    v_mfma_f32_32x32x16_bf16 v[96:111], v[132:135], a[196:199], 0
    v_add_f32 v236, v236, v240
    v_add_f32 v237, v237, v241
    v_mov_b32 v238, v236
    v_mov_b32 v239, v237
    s_nop 0
    v_permlane32_swap_b32 v236, v238
    v_mfma_f32_32x32x16_bf16 v[64:79], v[136:139], a[192:195], 0
    v_permlane32_swap_b32 v237, v239
    v_add_f32 v236, v236, v238
    v_add_f32 v237, v237, v239
    v_mul_f32 v236, 0xbabe82fa, v236
    v_mul_f32 v237, 0xbabe82fa, v237
    v_mfma_f32_32x32x16_bf16 v[112:127], v[136:139], a[196:199], 0
    v_fma_f32 v237, -v236, v236, v237
    v_max_f32 v237, 0, v237
    v_add_f32 v237, 0x3727c5ac, v237
    v_rsq_f32 v237, v237
    v_mfma_f32_32x32x16_bf16 v[32:47], v[140:143], a[200:203], v[32:47]
    buffer_load_dwordx4 v[128:131], v16, s[12:15], s29 offen offset:0
    v_mul_f32 v236, v236, v237
    ds_write_b32 v25, v236 offset:30720
    ds_write_b32 v25, v237 offset:30976
    v_mfma_f32_32x32x16_bf16 v[80:95], v[140:143], a[204:207], v[80:95]
    buffer_load_dwordx4 v[132:135], v16, s[12:15], s29 offen offset:1024
    s_waitcnt lgkmcnt(0)
    ds_read_b128 v[236:239], v28 offset:30720
    ds_read_b128 v[244:247], v28 offset:30976
    v_mfma_f32_32x32x16_bf16 v[48:63], v[144:147], a[200:203], v[48:63]
    buffer_load_dwordx4 v[136:139], v17, s[12:15], s29 offen offset:2048
    s_add_u32 s29, s29, 3072
    ds_read_b128 v[240:243], v28 offset:30784
    ds_read_b128 v[248:251], v28 offset:31040
    v_mfma_f32_32x32x16_bf16 v[96:111], v[144:147], a[204:207], v[96:111]
    s_waitcnt lgkmcnt(0)
    v_fma_f32 v212, v212, v244, v236
    v_fma_f32 v213, v213, v245, v237
    v_fma_f32 v214, v214, v246, v238
    v_fma_f32 v215, v215, v247, v239
    v_mfma_f32_32x32x16_bf16 v[64:79], v[148:151], a[200:203], v[64:79]
    v_fma_f32 v216, v216, v248, v240
    v_fma_f32 v217, v217, v249, v241
    v_fma_f32 v218, v218, v250, v242
    v_fma_f32 v219, v219, v251, v243
    v_cvt_pk_bf16_f32 v212, v212, v213
    v_mfma_f32_32x32x16_bf16 v[112:127], v[148:151], a[204:207], v[112:127]
    v_cvt_pk_bf16_f32 v213, v214, v215
    v_cvt_pk_bf16_f32 v214, v216, v217
    v_cvt_pk_bf16_f32 v215, v218, v219
    buffer_store_dwordx4 v[212:215], v3, s[12:15], s54 offen sc1
    s_waitcnt vmcnt(16)
    v_mfma_f32_32x32x16_bf16 v[32:47], v[152:155], a[208:211], v[32:47]
    buffer_load_dwordx4 v[140:143], v16, s[12:15], s29 offen offset:0
    v_fma_f32 v220, v220, v244, v236
    v_fma_f32 v221, v221, v245, v237
    v_fma_f32 v222, v222, v246, v238
    v_mfma_f32_32x32x16_bf16 v[80:95], v[152:155], a[212:215], v[80:95]
    buffer_load_dwordx4 v[144:147], v16, s[12:15], s29 offen offset:1024
    v_fma_f32 v223, v223, v247, v239
    v_fma_f32 v224, v224, v248, v240
    v_fma_f32 v225, v225, v249, v241
    v_mfma_f32_32x32x16_bf16 v[48:63], v[156:159], a[208:211], v[48:63]
    buffer_load_dwordx4 v[148:151], v17, s[12:15], s29 offen offset:2048
    s_add_u32 s29, s29, 3072
    v_fma_f32 v226, v226, v250, v242
    v_fma_f32 v227, v227, v251, v243
    v_mfma_f32_32x32x16_bf16 v[96:111], v[156:159], a[212:215], v[96:111]
    v_cvt_pk_bf16_f32 v220, v220, v221
    v_cvt_pk_bf16_f32 v221, v222, v223
    v_cvt_pk_bf16_f32 v222, v224, v225
    v_cvt_pk_bf16_f32 v223, v226, v227
    v_mfma_f32_32x32x16_bf16 v[64:79], v[160:163], a[208:211], v[64:79]
    buffer_store_dwordx4 v[220:223], v0, s[12:15], s54 offen sc1
    v_mfma_f32_32x32x16_bf16 v[112:127], v[160:163], a[212:215], v[112:127]
    s_waitcnt vmcnt(17)
    v_mfma_f32_32x32x16_bf16 v[32:47], v[164:167], a[216:219], v[32:47]
    buffer_load_dwordx4 v[152:155], v16, s[12:15], s29 offen offset:0
    v_mfma_f32_32x32x16_bf16 v[80:95], v[164:167], a[220:223], v[80:95]
    buffer_load_dwordx4 v[156:159], v16, s[12:15], s29 offen offset:1024
    v_mfma_f32_32x32x16_bf16 v[48:63], v[168:171], a[216:219], v[48:63]
    buffer_load_dwordx4 v[160:163], v17, s[12:15], s29 offen offset:2048
    s_add_u32 s29, s29, 3072
    v_mfma_f32_32x32x16_bf16 v[96:111], v[168:171], a[220:223], v[96:111]
    v_mfma_f32_32x32x16_bf16 v[64:79], v[172:175], a[216:219], v[64:79]
    v_mfma_f32_32x32x16_bf16 v[112:127], v[172:175], a[220:223], v[112:127]
    s_waitcnt vmcnt(17)
    v_mfma_f32_32x32x16_bf16 v[32:47], v[176:179], a[224:227], v[32:47]
    buffer_load_dwordx4 v[164:167], v16, s[12:15], s29 offen offset:0
    s_waitcnt vmcnt(4)
    v_mfma_f32_32x32x16_bf16 v[80:95], v[176:179], a[228:231], v[80:95]
    buffer_load_dwordx4 v[168:171], v16, s[12:15], s29 offen offset:1024
    v_mfma_f32_32x32x16_bf16 v[48:63], v[180:183], a[224:227], v[48:63]
    buffer_load_dwordx4 v[172:175], v17, s[12:15], s29 offen offset:2048
    s_add_u32 s29, s29, 3072
    v_mfma_f32_32x32x16_bf16 v[96:111], v[180:183], a[228:231], v[96:111]
    v_mov_b32 v14, 1
    s_mov_b64 exec, 1
    buffer_store_dword v14, off, s[12:15], s59 sc1
    s_mov_b64 exec, -1
    v_mfma_f32_32x32x16_bf16 v[64:79], v[184:187], a[224:227], v[64:79]
    v_mfma_f32_32x32x16_bf16 v[112:127], v[184:187], a[228:231], v[112:127]
    v_mfma_f32_32x32x16_bf16 v[32:47], v[188:191], a[232:235], v[32:47]
    buffer_load_dwordx4 v[176:179], v16, s[12:15], s29 offen offset:0
    v_mfma_f32_32x32x16_bf16 v[80:95], v[188:191], a[236:239], v[80:95]
    buffer_load_dwordx4 v[180:183], v16, s[12:15], s29 offen offset:1024
    v_mfma_f32_32x32x16_bf16 v[48:63], v[192:195], a[232:235], v[48:63]
    buffer_load_dwordx4 v[184:187], v17, s[12:15], s29 offen offset:2048
    s_add_u32 s29, s29, 3072
    v_mfma_f32_32x32x16_bf16 v[96:111], v[192:195], a[236:239], v[96:111]
    v_mfma_f32_32x32x16_bf16 v[64:79], v[196:199], a[232:235], v[64:79]
    v_mfma_f32_32x32x16_bf16 v[112:127], v[196:199], a[236:239], v[112:127]
    v_mfma_f32_32x32x16_bf16 v[32:47], v[200:203], a[240:243], v[32:47]
    buffer_load_dwordx4 v[188:191], v16, s[12:15], s29 offen offset:0
    v_mfma_f32_32x32x16_bf16 v[80:95], v[200:203], a[244:247], v[80:95]
    buffer_load_dwordx4 v[192:195], v16, s[12:15], s29 offen offset:1024
    v_mfma_f32_32x32x16_bf16 v[48:63], v[204:207], a[240:243], v[48:63]
    buffer_load_dwordx4 v[196:199], v17, s[12:15], s29 offen offset:2048
    s_add_u32 s29, s29, 3072
    v_mfma_f32_32x32x16_bf16 v[96:111], v[204:207], a[244:247], v[96:111]
    v_mfma_f32_32x32x16_bf16 v[64:79], v[208:211], a[240:243], v[64:79]
    buffer_load_dwordx4 a[160:163], v2, s[12:15], s31 offen offset:0
    buffer_load_dwordx4 a[164:167], v2, s[12:15], s33 offen offset:0
    v_mfma_f32_32x32x16_bf16 v[112:127], v[208:211], a[244:247], v[112:127]
    buffer_load_dwordx4 a[168:171], v2, s[12:15], s31 offen offset:2048
    buffer_load_dwordx4 a[172:175], v2, s[12:15], s33 offen offset:2048
    s_add_u32 s31, s31, 4096
    s_add_u32 s33, s33, 4096
    v_mfma_f32_32x32x16_bf16 v[32:47], v[128:131], a[248:251], v[32:47]
    buffer_load_dwordx4 v[200:203], v16, s[12:15], s29 offen offset:0
    buffer_load_dwordx4 a[176:179], v2, s[12:15], s31 offen offset:0
    v_mfma_f32_32x32x16_bf16 v[80:95], v[128:131], a[252:255], v[80:95]
    buffer_load_dwordx4 v[204:207], v16, s[12:15], s29 offen offset:1024
    buffer_load_dwordx4 a[180:183], v2, s[12:15], s33 offen offset:0
    v_mfma_f32_32x32x16_bf16 v[48:63], v[132:135], a[248:251], v[48:63]
    buffer_load_dwordx4 v[208:211], v17, s[12:15], s29 offen offset:2048
    s_add_u32 s29, s29, 3072
    buffer_load_dwordx4 a[184:187], v2, s[12:15], s31 offen offset:2048
    v_mfma_f32_32x32x16_bf16 v[96:111], v[132:135], a[252:255], v[96:111]
    buffer_load_dwordx4 a[188:191], v2, s[12:15], s33 offen offset:2048
    s_add_u32 s31, s31, 4096
    s_add_u32 s33, s33, 4096
    s_lshl_b32 s34, s43, 2
    s_add_u32 s34, s34, s55
    s_mul_i32 s34, s34, 24576
    s_add_u32 s34, s34, 106954752
    v_mfma_f32_32x32x16_bf16 v[64:79], v[136:139], a[248:251], v[64:79]
    s_lshl_b32 s38, s3, 10
    s_add_u32 s60, s34, s38
    s_xor_b32 s38, s38, 1024
    s_add_u32 s61, s34, s38
    v_mfma_f32_32x32x16_bf16 v[112:127], v[136:139], a[252:255], v[112:127]
    v_mfma_f32_32x32x16_bf16 v[32:47], v[140:143], a[0:3], v[32:47]
    buffer_load_dwordx4 v[128:131], v16, s[12:15], s29 offen offset:0
    v_mfma_f32_32x32x16_bf16 v[80:95], v[140:143], a[4:7], v[80:95]
    buffer_load_dwordx4 v[132:135], v16, s[12:15], s29 offen offset:1024
    v_mfma_f32_32x32x16_bf16 v[48:63], v[144:147], a[0:3], v[48:63]
    buffer_load_dwordx4 v[136:139], v17, s[12:15], s29 offen offset:2048
    s_add_u32 s29, s29, 3072
    v_mfma_f32_32x32x16_bf16 v[96:111], v[144:147], a[4:7], v[96:111]
    v_mfma_f32_32x32x16_bf16 v[64:79], v[148:151], a[0:3], v[64:79]
    v_mfma_f32_32x32x16_bf16 v[112:127], v[148:151], a[4:7], v[112:127]
    s_waitcnt vmcnt(24)
    v_mfma_f32_32x32x16_bf16 v[32:47], v[152:155], a[8:11], v[32:47]
    buffer_load_dwordx4 v[140:143], v16, s[12:15], s29 offen offset:0
    v_mfma_f32_32x32x16_bf16 v[80:95], v[152:155], a[12:15], v[80:95]
    buffer_load_dwordx4 v[144:147], v16, s[12:15], s29 offen offset:1024
    v_mfma_f32_32x32x16_bf16 v[48:63], v[156:159], a[8:11], v[48:63]
    buffer_load_dwordx4 v[148:151], v17, s[12:15], s29 offen offset:2048
    s_add_u32 s29, s29, 150528
    v_mfma_f32_32x32x16_bf16 v[96:111], v[156:159], a[12:15], v[96:111]
    v_mfma_f32_32x32x16_bf16 v[64:79], v[160:163], a[8:11], v[64:79]
    buffer_load_dwordx4 a[192:195], v2, s[12:15], s60 offen offset:0
    buffer_load_dwordx4 a[196:199], v2, s[12:15], s61 offen offset:0
    v_mfma_f32_32x32x16_bf16 v[112:127], v[160:163], a[12:15], v[112:127]
    buffer_load_dwordx4 a[200:203], v2, s[12:15], s60 offen offset:2048
    buffer_load_dwordx4 a[204:207], v2, s[12:15], s61 offen offset:2048
    s_add_u32 s60, s60, 4096
    s_add_u32 s61, s61, 4096
    s_waitcnt vmcnt(28)
    v_mfma_f32_32x32x16_bf16 v[32:47], v[164:167], a[16:19], v[32:47]
    buffer_load_dwordx4 a[208:211], v2, s[12:15], s60 offen offset:0
    buffer_load_dwordx4 a[212:215], v2, s[12:15], s61 offen offset:0
    v_mfma_f32_32x32x16_bf16 v[80:95], v[164:167], a[20:23], v[80:95]
    buffer_load_dwordx4 a[216:219], v2, s[12:15], s60 offen offset:2048
    buffer_load_dwordx4 a[220:223], v2, s[12:15], s61 offen offset:2048
    s_add_u32 s60, s60, 4096
    s_add_u32 s61, s61, 4096
    v_mfma_f32_32x32x16_bf16 v[48:63], v[168:171], a[16:19], v[48:63]
    v_mfma_f32_32x32x16_bf16 v[96:111], v[168:171], a[20:23], v[96:111]
    v_mfma_f32_32x32x16_bf16 v[64:79], v[172:175], a[16:19], v[64:79]
    v_mfma_f32_32x32x16_bf16 v[112:127], v[172:175], a[20:23], v[112:127]
    s_waitcnt vmcnt(28)
    v_mfma_f32_32x32x16_bf16 v[32:47], v[176:179], a[24:27], v[32:47]
    v_mfma_f32_32x32x16_bf16 v[80:95], v[176:179], a[28:31], v[80:95]
    v_mfma_f32_32x32x16_bf16 v[48:63], v[180:183], a[24:27], v[48:63]
    v_mfma_f32_32x32x16_bf16 v[96:111], v[180:183], a[28:31], v[96:111]
    v_mfma_f32_32x32x16_bf16 v[64:79], v[184:187], a[24:27], v[64:79]
    v_mfma_f32_32x32x16_bf16 v[112:127], v[184:187], a[28:31], v[112:127]
    s_waitcnt vmcnt(25)
    v_mfma_f32_32x32x16_bf16 v[32:47], v[188:191], a[32:35], v[32:47]
    v_mfma_f32_32x32x16_bf16 v[80:95], v[188:191], a[36:39], v[80:95]
    v_mfma_f32_32x32x16_bf16 v[48:63], v[192:195], a[32:35], v[48:63]
    s_cmp_lt_u32 s55, 2
    s_cselect_b32 s52, s70, s71
    s_lshr_b32 s53, s55, 1
    s_lshl_b32 s53, s53, 24
    s_xor_b32 s81, s53, 16777216
    s_add_u32 s53, s53, s49
    s_add_u32 s81, s81, s49
    s_lshl_b32 s34, s43, 1
    s_add_u32 s34, s34, s3
    s_lshl_b32 s35, s34, 7
    v_mfma_f32_32x32x16_bf16 v[96:111], v[192:195], a[36:39], v[96:111]
    s_add_u32 s35, s35, 10240
    s_lshl_b32 s37, s34, 11
    s_add_u32 s37, s37, s53
    s_add_u32 s37, s37, 196608
    v_lshlrev_b32 v4, 4, v21
    v_lshlrev_b32 v5, 1, v20
    s_lshl_b32 s38, s52, 6
    v_mfma_f32_32x32x16_bf16 v[64:79], v[196:199], a[32:35], v[64:79]
    buffer_load_ushort v252, v5, s[24:27], s38 offen
    v_mfma_f32_32x32x16_bf16 v[112:127], v[196:199], a[36:39], v[112:127]
    s_waitcnt vmcnt(17)
    v_mfma_f32_32x32x16_bf16 v[32:47], v[200:203], a[40:43], v[32:47]
    buffer_load_dword v15, v18, s[12:15], s28 offen sc1
    v_mfma_f32_32x32x16_bf16 v[80:95], v[200:203], a[44:47], v[80:95]
    v_mfma_f32_32x32x16_bf16 v[48:63], v[204:207], a[40:43], v[48:63]
    v_mfma_f32_32x32x16_bf16 v[96:111], v[204:207], a[44:47], v[96:111]
    v_mfma_f32_32x32x16_bf16 v[64:79], v[208:211], a[40:43], v[64:79]
    v_mfma_f32_32x32x16_bf16 v[112:127], v[208:211], a[44:47], v[112:127]
    s_waitcnt vmcnt(13)
    v_mfma_f32_32x32x16_bf16 v[32:47], v[128:131], a[48:51], v[32:47]
    v_mfma_f32_32x32x16_bf16 v[80:95], v[128:131], a[52:55], v[80:95]
    v_mfma_f32_32x32x16_bf16 v[48:63], v[132:135], a[48:51], v[48:63]
    v_mfma_f32_32x32x16_bf16 v[96:111], v[132:135], a[52:55], v[96:111]
    v_mfma_f32_32x32x16_bf16 v[64:79], v[136:139], a[48:51], v[64:79]
    v_mfma_f32_32x32x16_bf16 v[112:127], v[136:139], a[52:55], v[112:127]
    s_waitcnt vmcnt(10)
    v_mfma_f32_32x32x16_bf16 v[32:47], v[140:143], a[56:59], v[32:47]
    s_waitcnt vmcnt(0)
    v_cmp_le_u32 vcc, 1, v15
    s_nop 0
    s_cmp_eq_u64 vcc, -1
    s_cbranch_scc0 TFZH_S
TFZH_R:
    buffer_load_dwordx4 v[152:155], v16, s[12:15], s29 offen offset:0
    buffer_load_dwordx4 v[156:159], v16, s[12:15], s29 offen offset:1024
    buffer_load_dwordx4 v[160:163], v17, s[12:15], s29 offen offset:2048
    s_add_u32 s29, s29, 3072
    v_mfma_f32_32x32x16_bf16 v[80:95], v[140:143], a[60:63], v[80:95]
    buffer_load_dwordx4 v[164:167], v16, s[12:15], s29 offen offset:0
    buffer_load_dwordx4 v[168:171], v16, s[12:15], s29 offen offset:1024
    buffer_load_dwordx4 v[172:175], v17, s[12:15], s29 offen offset:2048
    s_add_u32 s29, s29, 3072
    v_mfma_f32_32x32x16_bf16 v[48:63], v[144:147], a[56:59], v[48:63]
    buffer_load_dwordx4 v[176:179], v16, s[12:15], s29 offen offset:0
    buffer_load_dwordx4 v[180:183], v16, s[12:15], s29 offen offset:1024
    buffer_load_dwordx4 v[184:187], v17, s[12:15], s29 offen offset:2048
    s_add_u32 s29, s29, 3072
    v_mfma_f32_32x32x16_bf16 v[96:111], v[144:147], a[60:63], v[96:111]
    buffer_load_dwordx4 v[188:191], v16, s[12:15], s29 offen offset:0
    buffer_load_dwordx4 v[192:195], v16, s[12:15], s29 offen offset:1024
    buffer_load_dwordx4 v[196:199], v17, s[12:15], s29 offen offset:2048
    s_add_u32 s29, s29, 3072
    v_mfma_f32_32x32x16_bf16 v[64:79], v[148:151], a[56:59], v[64:79]
    buffer_load_dwordx4 v[200:203], v16, s[12:15], s29 offen offset:0
    buffer_load_dwordx4 v[204:207], v16, s[12:15], s29 offen offset:1024
    buffer_load_dwordx4 v[208:211], v17, s[12:15], s29 offen offset:2048
    s_add_u32 s29, s29, 3072
    v_mfma_f32_32x32x16_bf16 v[112:127], v[148:151], a[60:63], v[112:127]
    buffer_load_dwordx4 v[128:131], v16, s[12:15], s29 offen offset:0
    buffer_load_dwordx4 v[132:135], v16, s[12:15], s29 offen offset:1024
    buffer_load_dwordx4 v[136:139], v17, s[12:15], s29 offen offset:2048
    s_add_u32 s29, s29, 3072
    s_waitcnt vmcnt(15)
    v_mfma_f32_32x32x16_bf16 v[32:47], v[152:155], a[64:67], v[32:47]
    buffer_load_dwordx4 v[140:143], v16, s[12:15], s29 offen offset:0
    buffer_load_dwordx4 v[144:147], v16, s[12:15], s29 offen offset:1024
    buffer_load_dwordx4 v[148:151], v17, s[12:15], s29 offen offset:2048
    s_add_u32 s29, s29, 3072
    v_mfma_f32_32x32x16_bf16 v[80:95], v[152:155], a[68:71], v[80:95]
    v_mfma_f32_32x32x16_bf16 v[48:63], v[156:159], a[64:67], v[48:63]
    v_mfma_f32_32x32x16_bf16 v[96:111], v[156:159], a[68:71], v[96:111]
    v_mfma_f32_32x32x16_bf16 v[64:79], v[160:163], a[64:67], v[64:79]
    v_mfma_f32_32x32x16_bf16 v[112:127], v[160:163], a[68:71], v[112:127]
    s_waitcnt vmcnt(15)
    v_mfma_f32_32x32x16_bf16 v[32:47], v[164:167], a[72:75], v[32:47]
    buffer_load_dwordx4 v[152:155], v16, s[12:15], s29 offen offset:0
    v_mfma_f32_32x32x16_bf16 v[80:95], v[164:167], a[76:79], v[80:95]
    buffer_load_dwordx4 v[156:159], v16, s[12:15], s29 offen offset:1024
    v_mfma_f32_32x32x16_bf16 v[48:63], v[168:171], a[72:75], v[48:63]
    buffer_load_dwordx4 v[160:163], v17, s[12:15], s29 offen offset:2048
    s_add_u32 s29, s29, 3072
    v_mfma_f32_32x32x16_bf16 v[96:111], v[168:171], a[76:79], v[96:111]
    v_mfma_f32_32x32x16_bf16 v[64:79], v[172:175], a[72:75], v[64:79]
    v_mfma_f32_32x32x16_bf16 v[112:127], v[172:175], a[76:79], v[112:127]
    s_waitcnt vmcnt(15)
    v_mfma_f32_32x32x16_bf16 v[32:47], v[176:179], a[80:83], v[32:47]
    buffer_load_dwordx4 v[164:167], v16, s[12:15], s29 offen offset:0
    v_mfma_f32_32x32x16_bf16 v[80:95], v[176:179], a[84:87], v[80:95]
    buffer_load_dwordx4 v[168:171], v16, s[12:15], s29 offen offset:1024
    v_mfma_f32_32x32x16_bf16 v[48:63], v[180:183], a[80:83], v[48:63]
    buffer_load_dwordx4 v[172:175], v17, s[12:15], s29 offen offset:2048
    s_add_u32 s29, s29, 3072
    v_mfma_f32_32x32x16_bf16 v[96:111], v[180:183], a[84:87], v[96:111]
    v_mfma_f32_32x32x16_bf16 v[64:79], v[184:187], a[80:83], v[64:79]
    v_mfma_f32_32x32x16_bf16 v[112:127], v[184:187], a[84:87], v[112:127]
    s_waitcnt vmcnt(15)
    v_mfma_f32_32x32x16_bf16 v[32:47], v[188:191], a[88:91], v[32:47]
    buffer_load_dwordx4 v[176:179], v16, s[12:15], s29 offen offset:0
    v_mfma_f32_32x32x16_bf16 v[80:95], v[188:191], a[92:95], v[80:95]
    buffer_load_dwordx4 v[180:183], v16, s[12:15], s29 offen offset:1024
    v_mfma_f32_32x32x16_bf16 v[48:63], v[192:195], a[88:91], v[48:63]
    buffer_load_dwordx4 v[184:187], v17, s[12:15], s29 offen offset:2048
    s_add_u32 s29, s29, 3072
    v_mfma_f32_32x32x16_bf16 v[96:111], v[192:195], a[92:95], v[96:111]
    v_mfma_f32_32x32x16_bf16 v[64:79], v[196:199], a[88:91], v[64:79]
    v_mfma_f32_32x32x16_bf16 v[112:127], v[196:199], a[92:95], v[112:127]
    s_waitcnt vmcnt(15)
    v_mfma_f32_32x32x16_bf16 v[32:47], v[200:203], a[96:99], v[32:47]
    buffer_load_dwordx4 v[188:191], v16, s[12:15], s29 offen offset:0
    v_mfma_f32_32x32x16_bf16 v[80:95], v[200:203], a[100:103], v[80:95]
    buffer_load_dwordx4 v[192:195], v16, s[12:15], s29 offen offset:1024
    v_mfma_f32_32x32x16_bf16 v[48:63], v[204:207], a[96:99], v[48:63]
    buffer_load_dwordx4 v[196:199], v17, s[12:15], s29 offen offset:2048
    s_add_u32 s29, s29, 3072
    v_mfma_f32_32x32x16_bf16 v[96:111], v[204:207], a[100:103], v[96:111]
    v_mfma_f32_32x32x16_bf16 v[64:79], v[208:211], a[96:99], v[64:79]
    v_mfma_f32_32x32x16_bf16 v[112:127], v[208:211], a[100:103], v[112:127]
    s_waitcnt vmcnt(15)
    v_mfma_f32_32x32x16_bf16 v[32:47], v[128:131], a[104:107], v[32:47]
    buffer_load_dwordx4 v[200:203], v16, s[12:15], s29 offen offset:0
    v_mfma_f32_32x32x16_bf16 v[80:95], v[128:131], a[108:111], v[80:95]
    buffer_load_dwordx4 v[204:207], v16, s[12:15], s29 offen offset:1024
    v_mfma_f32_32x32x16_bf16 v[48:63], v[132:135], a[104:107], v[48:63]
    buffer_load_dwordx4 v[208:211], v17, s[12:15], s29 offen offset:2048
    s_add_u32 s29, s29, 3072
    v_mfma_f32_32x32x16_bf16 v[96:111], v[132:135], a[108:111], v[96:111]
    v_mfma_f32_32x32x16_bf16 v[64:79], v[136:139], a[104:107], v[64:79]
    s_barrier
    v_mfma_f32_32x32x16_bf16 v[112:127], v[136:139], a[108:111], v[112:127]
    s_waitcnt vmcnt(15)
    v_mfma_f32_32x32x16_bf16 v[32:47], v[140:143], a[112:115], v[32:47]
    buffer_load_dwordx4 v[128:131], v16, s[12:15], s29 offen offset:0
    v_mfma_f32_32x32x16_bf16 v[80:95], v[140:143], a[116:119], v[80:95]
    buffer_load_dwordx4 v[132:135], v16, s[12:15], s29 offen offset:1024
    v_mfma_f32_32x32x16_bf16 v[48:63], v[144:147], a[112:115], v[48:63]
    buffer_load_dwordx4 v[136:139], v17, s[12:15], s29 offen offset:2048
    s_add_u32 s29, s29, 3072
    v_mfma_f32_32x32x16_bf16 v[96:111], v[144:147], a[116:119], v[96:111]
    v_mfma_f32_32x32x16_bf16 v[64:79], v[148:151], a[112:115], v[64:79]
    v_mfma_f32_32x32x16_bf16 v[112:127], v[148:151], a[116:119], v[112:127]
    s_waitcnt vmcnt(15)
    v_mfma_f32_32x32x16_bf16 v[32:47], v[152:155], a[120:123], v[32:47]
    buffer_load_dwordx4 v[140:143], v16, s[12:15], s29 offen offset:0
    v_mfma_f32_32x32x16_bf16 v[80:95], v[152:155], a[124:127], v[80:95]
    buffer_load_dwordx4 v[144:147], v16, s[12:15], s29 offen offset:1024
    v_mfma_f32_32x32x16_bf16 v[48:63], v[156:159], a[120:123], v[48:63]
    buffer_load_dwordx4 v[148:151], v17, s[12:15], s29 offen offset:2048
    s_add_u32 s29, s29, 3072
    v_mfma_f32_32x32x16_bf16 v[96:111], v[156:159], a[124:127], v[96:111]
    v_mfma_f32_32x32x16_bf16 v[64:79], v[160:163], a[120:123], v[64:79]
    v_mfma_f32_32x32x16_bf16 v[112:127], v[160:163], a[124:127], v[112:127]
    s_waitcnt vmcnt(15)
    v_mfma_f32_32x32x16_bf16 v[32:47], v[164:167], a[128:131], v[32:47]
    buffer_load_dwordx4 v[152:155], v16, s[12:15], s29 offen offset:0
    v_mfma_f32_32x32x16_bf16 v[80:95], v[164:167], a[132:135], v[80:95]
    buffer_load_dwordx4 v[156:159], v16, s[12:15], s29 offen offset:1024
    v_mfma_f32_32x32x16_bf16 v[48:63], v[168:171], a[128:131], v[48:63]
    buffer_load_dwordx4 v[160:163], v17, s[12:15], s29 offen offset:2048
    s_add_u32 s29, s29, 3072
    v_mfma_f32_32x32x16_bf16 v[96:111], v[168:171], a[132:135], v[96:111]
    v_mfma_f32_32x32x16_bf16 v[64:79], v[172:175], a[128:131], v[64:79]
    v_mfma_f32_32x32x16_bf16 v[112:127], v[172:175], a[132:135], v[112:127]
    s_waitcnt vmcnt(15)
    v_mfma_f32_32x32x16_bf16 v[32:47], v[176:179], a[136:139], v[32:47]
    buffer_load_dwordx4 v[164:167], v16, s[12:15], s29 offen offset:0
    v_mfma_f32_32x32x16_bf16 v[80:95], v[176:179], a[140:143], v[80:95]
    buffer_load_dwordx4 v[168:171], v16, s[12:15], s29 offen offset:1024
    v_mfma_f32_32x32x16_bf16 v[48:63], v[180:183], a[136:139], v[48:63]
    buffer_load_dwordx4 v[172:175], v17, s[12:15], s29 offen offset:2048
    s_add_u32 s29, s29, 3072
    v_mfma_f32_32x32x16_bf16 v[96:111], v[180:183], a[140:143], v[96:111]
    v_mfma_f32_32x32x16_bf16 v[64:79], v[184:187], a[136:139], v[64:79]
    v_mfma_f32_32x32x16_bf16 v[112:127], v[184:187], a[140:143], v[112:127]
    s_waitcnt vmcnt(15)
    v_mfma_f32_32x32x16_bf16 v[32:47], v[188:191], a[144:147], v[32:47]
    v_mfma_f32_32x32x16_bf16 v[80:95], v[188:191], a[148:151], v[80:95]
    v_mfma_f32_32x32x16_bf16 v[48:63], v[192:195], a[144:147], v[48:63]
    v_mfma_f32_32x32x16_bf16 v[96:111], v[192:195], a[148:151], v[96:111]
    v_mfma_f32_32x32x16_bf16 v[64:79], v[196:199], a[144:147], v[64:79]
    v_mfma_f32_32x32x16_bf16 v[112:127], v[196:199], a[148:151], v[112:127]
    s_waitcnt vmcnt(12)
    v_mfma_f32_32x32x16_bf16 v[32:47], v[200:203], a[152:155], v[32:47]
    buffer_load_dwordx4 v[212:215], v4, s[12:15], s35 offen offset:0
    buffer_load_dwordx4 v[216:219], v4, s[12:15], s35 offen offset:32
    v_mfma_f32_32x32x16_bf16 v[80:95], v[200:203], a[156:159], v[80:95]
    buffer_load_dwordx4 v[220:223], v4, s[12:15], s35 offen offset:64
    buffer_load_dwordx4 v[224:227], v4, s[12:15], s35 offen offset:96
    v_mfma_f32_32x32x16_bf16 v[48:63], v[204:207], a[152:155], v[48:63]
    buffer_load_dwordx4 v[228:231], v2, s[12:15], s37 offen offset:0 sc1
    buffer_load_dwordx4 v[232:235], v2, s[12:15], s37 offen offset:1024 sc1
    s_xor_b32 s34, s55, 1
    s_mul_i32 s34, s34, 18432
    v_mfma_f32_32x32x16_bf16 v[96:111], v[204:207], a[156:159], v[96:111]
    v_add_u32 v6, s34, v2
    s_xor_b32 s34, s55, 2
    s_mul_i32 s34, s34, 18432
    v_add_u32 v7, s34, v2
    s_xor_b32 s34, s55, 3
    s_mul_i32 s34, s34, 18432
    v_add_u32 v8, s34, v2
    v_mfma_f32_32x32x16_bf16 v[64:79], v[208:211], a[152:155], v[64:79]
    s_mul_i32 s34, s55, 18432
    v_add_u32 v9, s34, v2
    s_lshr_b32 s34, s55, 1
    s_lshl_b32 s34, s34, 5
    v_add_u32 v10, s34, v20
    v_mul_u32_u24 v10, 200, v10
    v_mfma_f32_32x32x16_bf16 v[112:127], v[208:211], a[156:159], v[112:127]
    v_lshl_add_u32 v10, v21, 3, v10
    s_lshl_b32 s34, s3, 5
    s_add_u32 s34, s34, 131072
    v_add_u32 v10, s34, v10
    s_mul_i32 s34, s43, 6144
    s_lshl_b32 s38, s3, 10
    s_add_u32 s34, s34, s38
    s_add_u32 s34, s34, s53
    s_waitcnt vmcnt(15)
    v_mfma_f32_32x32x16_bf16 v[32:47], v[128:131], a[160:163], v[32:47]
    s_add_u32 s28, s34, 262144
    s_add_u32 s29, s28, 4096
    s_lshl_b32 s34, s46, 7
    s_add_u32 s34, s34, s80
    s_add_u32 s34, s34, 19456
    s_lshl_b32 s30, s43, 4
    s_lshl_b32 s38, s55, 2
    s_add_u32 s30, s30, s38
    s_add_u32 s30, s30, s34
    s_lshl_b32 s38, s55, 5
    v_mfma_f32_32x32x16_bf16 v[80:95], v[128:131], a[164:167], v[80:95]
    s_add_u32 s31, s34, s38
    s_mul_i32 s34, s55, 12288
    s_add_u32 s34, s34, 262144
    s_add_u32 s32, s34, s53
    s_add_u32 s33, s34, s81
    v_lshlrev_b32 v252, 16, v252
    v_mfma_f32_32x32x16_bf16 v[48:63], v[132:135], a[160:163], v[48:63]
    v_mfma_f32_32x32x16_bf16 v[96:111], v[132:135], a[164:167], v[96:111]
    v_mfma_f32_32x32x16_bf16 v[64:79], v[136:139], a[160:163], v[64:79]
    v_mfma_f32_32x32x16_bf16 v[112:127], v[136:139], a[164:167], v[112:127]
    s_waitcnt vmcnt(12)
    v_mfma_f32_32x32x16_bf16 v[32:47], v[140:143], a[168:171], v[32:47]
    v_mfma_f32_32x32x16_bf16 v[80:95], v[140:143], a[172:175], v[80:95]
    v_mfma_f32_32x32x16_bf16 v[48:63], v[144:147], a[168:171], v[48:63]
    v_mfma_f32_32x32x16_bf16 v[96:111], v[144:147], a[172:175], v[96:111]
    v_mfma_f32_32x32x16_bf16 v[64:79], v[148:151], a[168:171], v[64:79]
    v_mfma_f32_32x32x16_bf16 v[112:127], v[148:151], a[172:175], v[112:127]
    s_waitcnt vmcnt(9)
    v_mfma_f32_32x32x16_bf16 v[32:47], v[152:155], a[176:179], v[32:47]
    v_mfma_f32_32x32x16_bf16 v[80:95], v[152:155], a[180:183], v[80:95]
    v_mfma_f32_32x32x16_bf16 v[48:63], v[156:159], a[176:179], v[48:63]
    v_mfma_f32_32x32x16_bf16 v[96:111], v[156:159], a[180:183], v[96:111]
    v_mfma_f32_32x32x16_bf16 v[64:79], v[160:163], a[176:179], v[64:79]
    v_mfma_f32_32x32x16_bf16 v[112:127], v[160:163], a[180:183], v[112:127]
    s_waitcnt vmcnt(6)
    v_mfma_f32_32x32x16_bf16 v[32:47], v[164:167], a[184:187], v[32:47]
    v_mfma_f32_32x32x16_bf16 v[80:95], v[164:167], a[188:191], v[80:95]
    v_mfma_f32_32x32x16_bf16 v[48:63], v[168:171], a[184:187], v[48:63]
    v_mfma_f32_32x32x16_bf16 v[96:111], v[168:171], a[188:191], v[96:111]
    v_mfma_f32_32x32x16_bf16 v[64:79], v[172:175], a[184:187], v[64:79]
    v_mfma_f32_32x32x16_bf16 v[112:127], v[172:175], a[188:191], v[112:127]
    s_nop 6
    ds_write_b128 v6, v[40:43] offset:0
    ds_write_b128 v6, v[44:47] offset:1024
    ds_write_b128 v6, v[56:59] offset:2048
    ds_write_b128 v6, v[60:63] offset:3072
    ds_write_b128 v6, v[72:75] offset:4096
    ds_write_b128 v6, v[76:79] offset:5120
    ds_write_b128 v7, v[80:83] offset:6144
    ds_write_b128 v7, v[84:87] offset:7168
    ds_write_b128 v7, v[96:99] offset:8192
    ds_write_b128 v7, v[100:103] offset:9216
    ds_write_b128 v7, v[112:115] offset:10240
    ds_write_b128 v7, v[116:119] offset:11264
    ds_write_b128 v8, v[88:91] offset:12288
    ds_write_b128 v8, v[92:95] offset:13312
    ds_write_b128 v8, v[104:107] offset:14336
    ds_write_b128 v8, v[108:111] offset:15360
    ds_write_b128 v8, v[120:123] offset:16384
    ds_write_b128 v8, v[124:127] offset:17408
    ds_read_b64 v[200:201], v10 offset:0
    ds_read_b64 v[202:203], v10 offset:16
    ds_read_b64 v[204:205], v10 offset:64
    ds_read_b64 v[206:207], v10 offset:80
    ds_read_b64 v[208:209], v10 offset:128
    ds_read_b64 v[210:211], v10 offset:144
    v_add_f32 v32, v32, v252
    buffer_load_dwordx4 a[224:227], v2, s[12:15], s60 offen offset:0
    v_add_f32 v33, v33, v252
    buffer_load_dwordx4 a[228:231], v2, s[12:15], s61 offen offset:0
    v_add_f32 v34, v34, v252
    buffer_load_dwordx4 a[232:235], v2, s[12:15], s60 offen offset:2048
    v_add_f32 v35, v35, v252
    buffer_load_dwordx4 a[236:239], v2, s[12:15], s61 offen offset:2048
    s_add_u32 s60, s60, 4096
    s_add_u32 s61, s61, 4096
    v_add_f32 v36, v36, v252
    buffer_load_dwordx4 a[240:243], v2, s[12:15], s60 offen offset:0
    v_add_f32 v37, v37, v252
    buffer_load_dwordx4 a[244:247], v2, s[12:15], s61 offen offset:0
    v_add_f32 v38, v38, v252
    buffer_load_dwordx4 a[248:251], v2, s[12:15], s60 offen offset:2048
    v_add_f32 v39, v39, v252
    buffer_load_dwordx4 a[252:255], v2, s[12:15], s61 offen offset:2048
    s_add_u32 s60, s60, 4096
    s_add_u32 s61, s61, 4096
    v_add_f32 v48, v48, v252
    v_add_f32 v49, v49, v252
    v_add_f32 v50, v50, v252
    v_add_f32 v51, v51, v252
    v_add_f32 v52, v52, v252
    v_add_f32 v53, v53, v252
    v_add_f32 v54, v54, v252
    v_add_f32 v55, v55, v252
    v_add_f32 v64, v64, v252
    v_add_f32 v65, v65, v252
    v_add_f32 v66, v66, v252
    v_add_f32 v67, v67, v252
    v_add_f32 v68, v68, v252
    v_add_f32 v69, v69, v252
    v_add_f32 v70, v70, v252
    v_add_f32 v71, v71, v252
    s_waitcnt lgkmcnt(0)
    s_barrier
    ds_read_b128 v[128:131], v9 offset:0
    ds_read_b128 v[132:135], v9 offset:1024
    ds_read_b128 v[136:139], v9 offset:6144
    ds_read_b128 v[140:143], v9 offset:7168
    ds_read_b128 v[144:147], v9 offset:12288
    ds_read_b128 v[148:151], v9 offset:13312
    ds_read_b128 v[152:155], v9 offset:2048
    ds_read_b128 v[156:159], v9 offset:3072
    ds_read_b128 v[160:163], v9 offset:8192
    ds_read_b128 v[164:167], v9 offset:9216
    ds_read_b128 v[168:171], v9 offset:14336
    ds_read_b128 v[172:175], v9 offset:15360
    ds_read_b128 v[176:179], v9 offset:4096
    ds_read_b128 v[180:183], v9 offset:5120
    ds_read_b128 v[184:187], v9 offset:10240
    ds_read_b128 v[188:191], v9 offset:11264
    ds_read_b128 v[192:195], v9 offset:16384
    ds_read_b128 v[196:199], v9 offset:17408
    v_lshlrev_b32 v40, 16, v200
    v_and_b32 v41, 0xffff0000, v200
    buffer_load_dwordx4 a[0:3], v2, s[12:15], s60 offen offset:0
    buffer_load_dwordx4 a[4:7], v2, s[12:15], s61 offen offset:0
    v_lshlrev_b32 v42, 16, v201
    v_and_b32 v43, 0xffff0000, v201
    buffer_load_dwordx4 a[8:11], v2, s[12:15], s60 offen offset:2048
    buffer_load_dwordx4 a[12:15], v2, s[12:15], s61 offen offset:2048
    s_add_u32 s60, s60, 4096
    s_add_u32 s61, s61, 4096
    v_lshlrev_b32 v44, 16, v202
    v_and_b32 v45, 0xffff0000, v202
    buffer_load_dwordx4 a[16:19], v2, s[12:15], s60 offen offset:0
    buffer_load_dwordx4 a[20:23], v2, s[12:15], s61 offen offset:0
    v_lshlrev_b32 v46, 16, v203
    v_and_b32 v47, 0xffff0000, v203
    buffer_load_dwordx4 a[24:27], v2, s[12:15], s60 offen offset:2048
    buffer_load_dwordx4 a[28:31], v2, s[12:15], s61 offen offset:2048
    s_add_u32 s60, s60, 4096
    s_add_u32 s61, s61, 4096
    v_lshlrev_b32 v56, 16, v204
    v_and_b32 v57, 0xffff0000, v204
    v_lshlrev_b32 v58, 16, v205
    v_and_b32 v59, 0xffff0000, v205
    v_lshlrev_b32 v60, 16, v206
    v_and_b32 v61, 0xffff0000, v206
    v_lshlrev_b32 v62, 16, v207
    v_and_b32 v63, 0xffff0000, v207
    v_lshlrev_b32 v72, 16, v208
    v_and_b32 v73, 0xffff0000, v208
    v_lshlrev_b32 v74, 16, v209
    v_and_b32 v75, 0xffff0000, v209
    v_lshlrev_b32 v76, 16, v210
    v_and_b32 v77, 0xffff0000, v210
    v_lshlrev_b32 v78, 16, v211
    v_and_b32 v79, 0xffff0000, v211
    s_waitcnt lgkmcnt(12)
    v_pk_add_f32 v[32:33], v[32:33], v[128:129]
    v_pk_add_f32 v[136:137], v[136:137], v[144:145]
    v_pk_add_f32 v[34:35], v[34:35], v[130:131]
    v_pk_add_f32 v[138:139], v[138:139], v[146:147]
    v_pk_add_f32 v[36:37], v[36:37], v[132:133]
    v_pk_add_f32 v[140:141], v[140:141], v[148:149]
    v_pk_add_f32 v[38:39], v[38:39], v[134:135]
    v_pk_add_f32 v[142:143], v[142:143], v[150:151]
    v_pk_add_f32 v[32:33], v[32:33], v[136:137]
    v_pk_add_f32 v[34:35], v[34:35], v[138:139]
    v_pk_add_f32 v[36:37], v[36:37], v[140:141]
    v_pk_add_f32 v[38:39], v[38:39], v[142:143]
    v_pk_mul_f32 v[32:33], v[32:33], v[40:41]
    v_pk_mul_f32 v[34:35], v[34:35], v[42:43]
    v_pk_mul_f32 v[36:37], v[36:37], v[44:45]
    v_pk_mul_f32 v[38:39], v[38:39], v[46:47]
    v_cvt_pk_bf16_f32 v128, v32, v33
    v_cvt_pk_bf16_f32 v129, v34, v35
    v_cvt_pk_bf16_f32 v130, v36, v37
    v_cvt_pk_bf16_f32 v131, v38, v39
    buffer_store_dwordx4 v[128:131], v2, s[12:15], s28 offen offset:0
    s_waitcnt lgkmcnt(6)
    v_pk_add_f32 v[48:49], v[48:49], v[152:153]
    v_pk_add_f32 v[160:161], v[160:161], v[168:169]
    v_pk_add_f32 v[50:51], v[50:51], v[154:155]
    v_pk_add_f32 v[162:163], v[162:163], v[170:171]
    v_pk_add_f32 v[52:53], v[52:53], v[156:157]
    v_pk_add_f32 v[164:165], v[164:165], v[172:173]
    v_pk_add_f32 v[54:55], v[54:55], v[158:159]
    v_pk_add_f32 v[166:167], v[166:167], v[174:175]
    v_pk_add_f32 v[48:49], v[48:49], v[160:161]
    v_pk_add_f32 v[50:51], v[50:51], v[162:163]
    v_pk_add_f32 v[52:53], v[52:53], v[164:165]
    v_pk_add_f32 v[54:55], v[54:55], v[166:167]
    v_pk_mul_f32 v[48:49], v[48:49], v[56:57]
    v_pk_mul_f32 v[50:51], v[50:51], v[58:59]
    v_pk_mul_f32 v[52:53], v[52:53], v[60:61]
    v_pk_mul_f32 v[54:55], v[54:55], v[62:63]
    v_cvt_pk_bf16_f32 v152, v48, v49
    v_cvt_pk_bf16_f32 v153, v50, v51
    v_cvt_pk_bf16_f32 v154, v52, v53
    v_cvt_pk_bf16_f32 v155, v54, v55
    buffer_store_dwordx4 v[152:155], v2, s[12:15], s28 offen offset:2048
    s_waitcnt lgkmcnt(0)
    v_pk_add_f32 v[64:65], v[64:65], v[176:177]
    v_pk_add_f32 v[184:185], v[184:185], v[192:193]
    v_pk_add_f32 v[66:67], v[66:67], v[178:179]
    v_pk_add_f32 v[186:187], v[186:187], v[194:195]
    v_pk_add_f32 v[68:69], v[68:69], v[180:181]
    v_pk_add_f32 v[188:189], v[188:189], v[196:197]
    v_pk_add_f32 v[70:71], v[70:71], v[182:183]
    v_pk_add_f32 v[190:191], v[190:191], v[198:199]
    v_pk_add_f32 v[64:65], v[64:65], v[184:185]
    v_pk_add_f32 v[66:67], v[66:67], v[186:187]
    v_pk_add_f32 v[68:69], v[68:69], v[188:189]
    v_pk_add_f32 v[70:71], v[70:71], v[190:191]
    v_pk_mul_f32 v[64:65], v[64:65], v[72:73]
    v_pk_mul_f32 v[66:67], v[66:67], v[74:75]
    v_pk_mul_f32 v[68:69], v[68:69], v[76:77]
    v_pk_mul_f32 v[70:71], v[70:71], v[78:79]
    v_cvt_pk_bf16_f32 v176, v64, v65
    v_cvt_pk_bf16_f32 v177, v66, v67
    v_cvt_pk_bf16_f32 v178, v68, v69
    v_cvt_pk_bf16_f32 v179, v70, v71
    buffer_store_dwordx4 v[176:179], v2, s[12:15], s29 offen
    s_waitcnt vmcnt(19)
    v_lshlrev_b32 v236, 16, v228
    v_and_b32 v237, 0xffff0000, v228
    v_lshlrev_b32 v238, 16, v229
    v_and_b32 v239, 0xffff0000, v229
    v_lshlrev_b32 v240, 16, v230
    v_and_b32 v241, 0xffff0000, v230
    v_lshlrev_b32 v242, 16, v231
    v_and_b32 v243, 0xffff0000, v231
    v_lshlrev_b32 v244, 16, v232
    v_and_b32 v245, 0xffff0000, v232
    v_lshlrev_b32 v246, 16, v233
    v_and_b32 v247, 0xffff0000, v233
    v_lshlrev_b32 v248, 16, v234
    v_and_b32 v249, 0xffff0000, v234
    v_lshlrev_b32 v250, 16, v235
    v_and_b32 v251, 0xffff0000, v235
    s_xor_b32 s39, s55, 1
    s_mul_i32 s39, s39, 12288
    s_add_u32 s39, s39, 73728
    v_add_u32 v6, s39, v2
    s_xor_b32 s39, s55, 2
    s_mul_i32 s39, s39, 12288
    s_add_u32 s39, s39, 73728
    v_add_u32 v7, s39, v2
    s_xor_b32 s39, s55, 3
    s_mul_i32 s39, s39, 12288
    s_add_u32 s39, s39, 73728
    v_add_u32 v8, s39, v2
    s_mul_i32 s39, s55, 12288
    s_add_u32 s39, s39, 73728
    v_add_u32 v9, s39, v2
    v_lshlrev_b32 v13, 10, v20
    v_lshl_add_u32 v13, v21, 4, v13
    s_lshl_b32 s34, s52, 15
    s_lshl_b32 s35, s43, 7
    s_add_u32 s34, s34, s35
    s_lshl_b32 s35, s3, 6
    s_add_u32 s34, s34, s35
    s_waitcnt vmcnt(0)
    s_cmp_eq_u32 s8, 0
    s_cbranch_scc1 TL_LF_19
    v_mov_b32 v14, 1
    s_mov_b64 exec, 1
    buffer_store_dword v14, off, s[12:15], s30
    s_mov_b64 exec, -1
TL_LF_19_R:
    s_mov_b32 s39, 0
TL_FY:
    s_nop 0
    buffer_load_dword v15, v24, s[12:15], s31 offen sc1
    s_add_u32 s39, s39, 1
    s_waitcnt vmcnt(0)
    v_cmp_ne_u32 vcc, 0, v15
    s_nop 0
    s_cmp_eq_u64 vcc, -1
    s_cbranch_scc1 TL_FYD
    s_cmp_lt_u32 s39, 32768
    s_cbranch_scc1 TL_FY
TL_FYD:
    s_nop 0
    buffer_load_dwordx4 v[128:131], v2, s[12:15], s32 offen offset:0 sc1
    buffer_load_dwordx4 v[132:135], v2, s[12:15], s33 offen offset:0 sc1
    buffer_load_dwordx4 v[136:139], v2, s[12:15], s32 offen offset:1024 sc1
    buffer_load_dwordx4 v[140:143], v2, s[12:15], s33 offen offset:1024 sc1
    buffer_load_dwordx4 v[144:147], v2, s[12:15], s32 offen offset:2048 sc1
    buffer_load_dwordx4 v[148:151], v2, s[12:15], s33 offen offset:2048 sc1
    buffer_load_dwordx4 v[152:155], v2, s[12:15], s32 offen offset:3072 sc1
    buffer_load_dwordx4 v[156:159], v2, s[12:15], s33 offen offset:3072 sc1
    s_add_u32 s32, s32, 4096
    s_add_u32 s33, s33, 4096
    buffer_load_dwordx4 v[160:163], v2, s[12:15], s32 offen offset:0 sc1
    buffer_load_dwordx4 v[164:167], v2, s[12:15], s33 offen offset:0 sc1
    buffer_load_dwordx4 v[168:171], v2, s[12:15], s32 offen offset:1024 sc1
    buffer_load_dwordx4 v[172:175], v2, s[12:15], s33 offen offset:1024 sc1
    buffer_load_dwordx4 v[176:179], v2, s[12:15], s32 offen offset:2048 sc1
    buffer_load_dwordx4 v[180:183], v2, s[12:15], s33 offen offset:2048 sc1
    buffer_load_dwordx4 v[184:187], v2, s[12:15], s32 offen offset:3072 sc1
    buffer_load_dwordx4 v[188:191], v2, s[12:15], s33 offen offset:3072 sc1
    s_add_u32 s32, s32, 4096
    s_add_u32 s33, s33, 4096
    buffer_load_dwordx4 v[192:195], v2, s[12:15], s32 offen offset:0 sc1
    buffer_load_dwordx4 v[196:199], v2, s[12:15], s33 offen offset:0 sc1
    buffer_load_dwordx4 v[32:35], v2, s[12:15], s32 offen offset:1024 sc1
    buffer_load_dwordx4 v[36:39], v2, s[12:15], s33 offen offset:1024 sc1
    buffer_load_dwordx4 v[40:43], v2, s[12:15], s32 offen offset:2048 sc1
    buffer_load_dwordx4 v[44:47], v2, s[12:15], s33 offen offset:2048 sc1
    buffer_load_dwordx4 v[48:51], v2, s[12:15], s32 offen offset:3072 sc1
    buffer_load_dwordx4 v[52:55], v2, s[12:15], s33 offen offset:3072 sc1
    s_waitcnt vmcnt(22)
    v_mfma_f32_32x32x16_bf16 v[112:127], a[196:199], v[132:135], 0
    v_mfma_f32_32x32x16_bf16 v[96:111], a[192:195], v[132:135], 0
    v_mfma_f32_32x32x16_bf16 v[80:95], a[196:199], v[128:131], 0
    v_mfma_f32_32x32x16_bf16 v[64:79], a[192:195], v[128:131], 0
    s_waitcnt vmcnt(20)
    v_mfma_f32_32x32x16_bf16 v[112:127], a[204:207], v[140:143], v[112:127]
    v_mfma_f32_32x32x16_bf16 v[96:111], a[200:203], v[140:143], v[96:111]
    v_mfma_f32_32x32x16_bf16 v[80:95], a[204:207], v[136:139], v[80:95]
    v_mfma_f32_32x32x16_bf16 v[64:79], a[200:203], v[136:139], v[64:79]
    s_waitcnt vmcnt(18)
    v_mfma_f32_32x32x16_bf16 v[112:127], a[212:215], v[148:151], v[112:127]
    v_mfma_f32_32x32x16_bf16 v[96:111], a[208:211], v[148:151], v[96:111]
    v_mfma_f32_32x32x16_bf16 v[80:95], a[212:215], v[144:147], v[80:95]
    v_mfma_f32_32x32x16_bf16 v[64:79], a[208:211], v[144:147], v[64:79]
    s_waitcnt vmcnt(16)
    v_mfma_f32_32x32x16_bf16 v[112:127], a[220:223], v[156:159], v[112:127]
    v_mfma_f32_32x32x16_bf16 v[96:111], a[216:219], v[156:159], v[96:111]
    v_mfma_f32_32x32x16_bf16 v[80:95], a[220:223], v[152:155], v[80:95]
    v_mfma_f32_32x32x16_bf16 v[64:79], a[216:219], v[152:155], v[64:79]
    s_waitcnt vmcnt(14)
    v_mfma_f32_32x32x16_bf16 v[112:127], a[228:231], v[164:167], v[112:127]
    v_mfma_f32_32x32x16_bf16 v[96:111], a[224:227], v[164:167], v[96:111]
    v_mfma_f32_32x32x16_bf16 v[80:95], a[228:231], v[160:163], v[80:95]
    v_mfma_f32_32x32x16_bf16 v[64:79], a[224:227], v[160:163], v[64:79]
    s_waitcnt vmcnt(12)
    v_mfma_f32_32x32x16_bf16 v[112:127], a[236:239], v[172:175], v[112:127]
    v_mfma_f32_32x32x16_bf16 v[96:111], a[232:235], v[172:175], v[96:111]
    v_mfma_f32_32x32x16_bf16 v[80:95], a[236:239], v[168:171], v[80:95]
    v_mfma_f32_32x32x16_bf16 v[64:79], a[232:235], v[168:171], v[64:79]
    s_waitcnt vmcnt(10)
    v_mfma_f32_32x32x16_bf16 v[112:127], a[244:247], v[180:183], v[112:127]
    v_mfma_f32_32x32x16_bf16 v[96:111], a[240:243], v[180:183], v[96:111]
    v_mfma_f32_32x32x16_bf16 v[80:95], a[244:247], v[176:179], v[80:95]
    v_mfma_f32_32x32x16_bf16 v[64:79], a[240:243], v[176:179], v[64:79]
    s_waitcnt vmcnt(8)
    v_mfma_f32_32x32x16_bf16 v[112:127], a[252:255], v[188:191], v[112:127]
    v_mfma_f32_32x32x16_bf16 v[96:111], a[248:251], v[188:191], v[96:111]
    v_mfma_f32_32x32x16_bf16 v[80:95], a[252:255], v[184:187], v[80:95]
    v_mfma_f32_32x32x16_bf16 v[64:79], a[248:251], v[184:187], v[64:79]
    s_waitcnt vmcnt(6)
    v_mfma_f32_32x32x16_bf16 v[112:127], a[4:7], v[196:199], v[112:127]
    v_mfma_f32_32x32x16_bf16 v[96:111], a[0:3], v[196:199], v[96:111]
    v_mfma_f32_32x32x16_bf16 v[80:95], a[4:7], v[192:195], v[80:95]
    v_mfma_f32_32x32x16_bf16 v[64:79], a[0:3], v[192:195], v[64:79]
    s_waitcnt vmcnt(4)
    v_mfma_f32_32x32x16_bf16 v[112:127], a[12:15], v[36:39], v[112:127]
    v_mfma_f32_32x32x16_bf16 v[96:111], a[8:11], v[36:39], v[96:111]
    v_mfma_f32_32x32x16_bf16 v[80:95], a[12:15], v[32:35], v[80:95]
    v_mfma_f32_32x32x16_bf16 v[64:79], a[8:11], v[32:35], v[64:79]
    s_waitcnt vmcnt(2)
    v_mfma_f32_32x32x16_bf16 v[112:127], a[20:23], v[44:47], v[112:127]
    v_mfma_f32_32x32x16_bf16 v[96:111], a[16:19], v[44:47], v[96:111]
    v_mfma_f32_32x32x16_bf16 v[80:95], a[20:23], v[40:43], v[80:95]
    v_mfma_f32_32x32x16_bf16 v[64:79], a[16:19], v[40:43], v[64:79]
    s_waitcnt vmcnt(0)
    v_mfma_f32_32x32x16_bf16 v[112:127], a[28:31], v[52:55], v[112:127]
    v_mfma_f32_32x32x16_bf16 v[96:111], a[24:27], v[52:55], v[96:111]
    v_mfma_f32_32x32x16_bf16 v[80:95], a[28:31], v[48:51], v[80:95]
    v_mfma_f32_32x32x16_bf16 v[64:79], a[24:27], v[48:51], v[64:79]
    s_nop 8
    ds_write_b128 v8, v[112:115] offset:8192
    ds_write_b128 v8, v[116:119] offset:9216
    ds_write_b128 v8, v[120:123] offset:10240
    ds_write_b128 v8, v[124:127] offset:11264
    ds_write_b128 v7, v[96:99] offset:4096
    ds_write_b128 v7, v[100:103] offset:5120
    ds_write_b128 v7, v[104:107] offset:6144
    ds_write_b128 v7, v[108:111] offset:7168
    ds_write_b128 v6, v[80:83] offset:0
    ds_write_b128 v6, v[84:87] offset:1024
    ds_write_b128 v6, v[88:91] offset:2048
    ds_write_b128 v6, v[92:95] offset:3072
    s_waitcnt lgkmcnt(0)
    s_barrier
    ds_read_b128 v[128:131], v9 offset:0
    ds_read_b128 v[144:147], v9 offset:4096
    ds_read_b128 v[160:163], v9 offset:8192
    ds_read_b128 v[132:135], v9 offset:1024
    ds_read_b128 v[148:151], v9 offset:5120
    ds_read_b128 v[164:167], v9 offset:9216
    ds_read_b128 v[136:139], v9 offset:2048
    ds_read_b128 v[152:155], v9 offset:6144
    ds_read_b128 v[168:171], v9 offset:10240
    ds_read_b128 v[140:143], v9 offset:3072
    ds_read_b128 v[156:159], v9 offset:7168
    ds_read_b128 v[172:175], v9 offset:11264
    s_waitcnt lgkmcnt(9)
    v_pk_add_f32 v[64:65], v[64:65], v[128:129]
    v_pk_add_f32 v[144:145], v[144:145], v[160:161]
    v_pk_add_f32 v[66:67], v[66:67], v[130:131]
    v_pk_add_f32 v[146:147], v[146:147], v[162:163]
    v_pk_add_f32 v[64:65], v[64:65], v[144:145]
    v_pk_add_f32 v[66:67], v[66:67], v[146:147]
    v_pk_fma_f32 v[64:65], v[64:65], v[212:213], v[236:237]
    v_pk_fma_f32 v[66:67], v[66:67], v[214:215], v[238:239]
    v_cvt_pk_bf16_f32 v176, v64, v65
    v_cvt_pk_bf16_f32 v177, v66, v67
    s_waitcnt lgkmcnt(6)
    v_pk_add_f32 v[68:69], v[68:69], v[132:133]
    v_pk_add_f32 v[148:149], v[148:149], v[164:165]
    v_pk_add_f32 v[70:71], v[70:71], v[134:135]
    v_pk_add_f32 v[150:151], v[150:151], v[166:167]
    v_pk_add_f32 v[68:69], v[68:69], v[148:149]
    v_pk_add_f32 v[70:71], v[70:71], v[150:151]
    v_pk_fma_f32 v[68:69], v[68:69], v[216:217], v[240:241]
    v_pk_fma_f32 v[70:71], v[70:71], v[218:219], v[242:243]
    v_cvt_pk_bf16_f32 v178, v68, v69
    v_cvt_pk_bf16_f32 v179, v70, v71
    s_nop 0
    v_permlane32_swap_b32 v176, v178
    v_permlane32_swap_b32 v177, v179
    buffer_store_dwordx4 v[176:179], v13, s[20:23], s34 offen offset:0
    s_waitcnt lgkmcnt(3)
    v_pk_add_f32 v[72:73], v[72:73], v[136:137]
    v_pk_add_f32 v[152:153], v[152:153], v[168:169]
    v_pk_add_f32 v[74:75], v[74:75], v[138:139]
    v_pk_add_f32 v[154:155], v[154:155], v[170:171]
    v_pk_add_f32 v[72:73], v[72:73], v[152:153]
    v_pk_add_f32 v[74:75], v[74:75], v[154:155]
    v_pk_fma_f32 v[72:73], v[72:73], v[220:221], v[244:245]
    v_pk_fma_f32 v[74:75], v[74:75], v[222:223], v[246:247]
    v_cvt_pk_bf16_f32 v180, v72, v73
    v_cvt_pk_bf16_f32 v181, v74, v75
    s_waitcnt lgkmcnt(0)
    v_pk_add_f32 v[76:77], v[76:77], v[140:141]
    v_pk_add_f32 v[156:157], v[156:157], v[172:173]
    v_pk_add_f32 v[78:79], v[78:79], v[142:143]
    v_pk_add_f32 v[158:159], v[158:159], v[174:175]
    v_pk_add_f32 v[76:77], v[76:77], v[156:157]
    v_pk_add_f32 v[78:79], v[78:79], v[158:159]
    v_pk_fma_f32 v[76:77], v[76:77], v[224:225], v[248:249]
    v_pk_fma_f32 v[78:79], v[78:79], v[226:227], v[250:251]
    v_cvt_pk_bf16_f32 v182, v76, v77
    v_cvt_pk_bf16_f32 v183, v78, v79
    s_nop 0
    v_permlane32_swap_b32 v180, v182
    v_permlane32_swap_b32 v181, v183
    buffer_store_dwordx4 v[180:183], v13, s[20:23], s34 offen offset:32
AT_END:
    s_nop 3
    s_endpgm
FR_AL:
    s_waitcnt vmcnt(0) lgkmcnt(0)
    s_cmp_lg_u32 s55, 0
    s_cbranch_scc1 FR_OB
    s_add_u32 s58, s58, 1
    s_cmp_ge_u32 s58, 64
    s_cbranch_scc1 FR_ON
    s_lshl_b32 s97, s5, 4
    s_lshl_b32 s11, 0xff, s59
    s_mov_b32 s39, 0
FR_A1:
    s_nop 0
    v_mov_b32 v60, 0
    s_mov_b64 exec, 1
    buffer_atomic_or v60, off, s[92:95], s97 sc0
    s_mov_b64 exec, -1
    s_add_u32 s39, s39, 1
    s_waitcnt vmcnt(0)
    v_readfirstlane_b32 s10, v60
    s_nop 0
    s_not_b32 s10, s10
    s_cbranch_scc0 FR_OV
    s_and_b32 s96, s10, s11
    s_cselect_b32 s10, s96, s10
    s_bcnt1_i32_b32 s96, s10
    s_cmp_eq_u32 s96, 1
    s_cbranch_scc1 FR_A2
    s_cmp_lt_u32 s39, 8
    s_cbranch_scc1 FR_A1
FR_A2:
    s_nop 0
    s_ff1_i32_b32 s98, s10
    s_lshl_b32 s98, s98, 3
    s_add_u32 s98, s98, s5
    s_branch FR_OW
FR_OV:
    s_mov_b32 s35, 1
    v_mov_b32 v60, 1
    v_lshlrev_b32 v58, 2, v1
    s_mov_b64 exec, 1
    buffer_atomic_add v60, off, s[92:95], 0 offset:132 sc0 sc1
    s_mov_b64 exec, -1
    s_mov_b32 s39, 0
FR_OL:
    s_nop 0
    buffer_load_dword v56, v58, s[92:95], 0 offen offset:128 sc0 sc1
    s_add_u32 s39, s39, 1
    s_waitcnt vmcnt(0)
    v_readlane_b32 s96, v56, 1
    v_readlane_b32 s97, v56, 8
    s_nop 0
    s_bcnt1_i32_b32 s97, s97
    s_add_u32 s96, s96, s97
    v_readlane_b32 s97, v56, 9
    s_nop 0
    s_bcnt1_i32_b32 s97, s97
    s_add_u32 s96, s96, s97
    v_readlane_b32 s97, v56, 10
    s_nop 0
    s_bcnt1_i32_b32 s97, s97
    s_add_u32 s96, s96, s97
    v_readlane_b32 s97, v56, 11
    s_nop 0
    s_bcnt1_i32_b32 s97, s97
    s_add_u32 s96, s96, s97
    v_readlane_b32 s97, v56, 12
    s_nop 0
    s_bcnt1_i32_b32 s97, s97
    s_add_u32 s96, s96, s97
    v_readlane_b32 s97, v56, 13
    s_nop 0
    s_bcnt1_i32_b32 s97, s97
    s_add_u32 s96, s96, s97
    v_readlane_b32 s97, v56, 14
    s_nop 0
    s_bcnt1_i32_b32 s97, s97
    s_add_u32 s96, s96, s97
    v_readlane_b32 s97, v56, 15
    s_nop 0
    s_bcnt1_i32_b32 s97, s97
    s_add_u32 s96, s96, s97
    s_cmp_eq_u32 s96, 256
    s_cbranch_scc1 FR_OK
    s_cmp_lt_u32 s39, 32768
    s_cbranch_scc1 FR_OL
FR_ON:
    s_nop 0
    s_mov_b32 s98, 0x00ffffff
    s_branch FR_OW
FR_OK:
    v_readfirstlane_b32 s97, v60
    s_mov_b32 s96, 0
FR_OY:
    s_nop 3
    s_add_u32 s10, s96, 8
    s_nop 3
    v_readlane_b32 s10, v56, s10
    s_nop 0
    s_not_b32 s10, s10
    s_bcnt1_i32_b32 s11, s10
    s_cmp_lt_u32 s97, s11
    s_cbranch_scc1 FR_OF
    s_sub_u32 s97, s97, s11
    s_add_u32 s96, s96, 1
    s_cmp_lt_u32 s96, 8
    s_cbranch_scc1 FR_OY
    s_branch FR_ON
FR_OF:
    s_ff1_i32_b32 s98, s10
    s_bitset0_b32 s10, s98
    s_sub_u32 s97, s97, 1
    s_cbranch_scc0 FR_OF
    s_lshl_b32 s98, s98, 3
    s_add_u32 s98, s98, s96
FR_OW:
    s_nop 0
    v_mov_b32 v60, s98
    ds_write_b32 v57, v60 offset:16
    s_waitcnt lgkmcnt(0)
FR_OB:
    s_nop 2
    s_barrier
    ds_read_b32 v60, v57 offset:16
    s_waitcnt lgkmcnt(0)
    v_readfirstlane_b32 s2, v60
    s_nop 0
    s_cmp_ge_u32 s2, 256
    s_cbranch_scc1 AT_END
    s_branch FR_RE
FR_CS:
    s_mov_b32 s39, 0
FR_CL:
    s_nop 0
    buffer_load_dwordx2 v[236:237], off, s[92:95], 0 offset:128 sc0 sc1
    s_add_u32 s39, s39, 1
    s_waitcnt vmcnt(0)
    v_cmp_eq_u32 vcc, 0x100, v236
    s_nop 0
    s_cmp_eq_u64 vcc, -1
    s_cbranch_scc1 FR_CR
    s_cmp_lt_u32 s39, 32768
    s_cbranch_scc1 FR_CL
    s_branch FR_CR
FR_H_S:
    s_mov_b32 s39, 0
FR_H_L:
    s_nop 0
    buffer_load_dwordx2 v[236:237], v61, s[72:75], s47 offen sc0 sc1
    s_add_u32 s39, s39, 1
    s_waitcnt vmcnt(0)
    v_min_u32 v236, v236, v237
    v_cmp_ne_u32 vcc, 0, v236
    s_nop 0
    s_cmp_eq_u64 vcc, -1
    s_cbranch_scc1 FR_H_R
    s_cmp_lt_u32 s39, 32768
    s_cbranch_scc1 FR_H_L
    s_branch FR_H_R
FR_K_S:
    s_mov_b32 s39, 0
FR_K_L:
    s_nop 0
    buffer_load_dword v63, v61, s[72:75], s46 offen sc1
    s_add_u32 s39, s39, 1
    s_waitcnt vmcnt(0)
    v_cmp_ne_u32 vcc, 0, v63
    s_nop 0
    s_cmp_eq_u64 vcc, -1
    s_cbranch_scc1 FR_K_R
    s_cmp_lt_u32 s39, 32768
    s_cbranch_scc1 FR_K_L
    s_branch FR_K_R
FR_LF_2:
    s_waitcnt vmcnt(0)
    buffer_wbl2 sc1
    s_waitcnt vmcnt(0)
    v_mov_b32 v60, 1
    s_mov_b64 exec, 1
    buffer_store_dword v60, off, s[72:75], s51 sc0 sc1
    s_mov_b64 exec, -1
    s_branch FR_LF_2_R
TL_C2S:
    s_mov_b32 s39, 0
TL_C2L:
    s_nop 0
    buffer_load_dword v59, off, s[4:7], 0 offset:192 sc0 sc1
    s_add_u32 s39, s39, 1
    s_waitcnt vmcnt(0)
    v_readfirstlane_b32 s45, v59
    s_nop 0
    s_cmp_eq_u32 s45, 256
    s_cbranch_scc1 TL_C2R
    s_cmp_lt_u32 s39, 32768
    s_cbranch_scc1 TL_C2L
    s_branch TL_C2R
TL_LF_8:
    s_waitcnt vmcnt(0)
    buffer_wbl2 sc1
    s_waitcnt vmcnt(0)
    v_mov_b32 v58, 1
    s_mov_b64 exec, 1
    buffer_store_dword v58, off, s[12:15], s78 sc0 sc1
    s_mov_b64 exec, -1
    s_branch TL_LF_8_R
TL_LF_9:
    s_waitcnt vmcnt(0)
    buffer_wbl2 sc1
    s_waitcnt vmcnt(0)
    v_mov_b32 v58, 1
    s_mov_b64 exec, 1
    buffer_store_dword v58, off, s[12:15], s78 sc0 sc1
    s_mov_b64 exec, -1
    s_branch TL_LF_9_R
TL_LATE:
    s_mov_b32 s39, 0
    v_and_b32 v56, 3, v1
    v_lshlrev_b32 v56, 2, v56
    s_waitcnt vmcnt(0)
    s_cmp_eq_u32 s8, 0
    s_cbranch_scc1 TL_LF_20
    v_mov_b32 v58, 1
    s_mov_b64 exec, 1
    buffer_store_dword v58, off, s[12:15], s99
    s_mov_b64 exec, -1
TL_LF_20_R:
TL_LATEL:
    s_nop 1
    v_cmp_ne_u32 vcc, 0, v57
    s_nop 0
    s_cmp_eq_u64 vcc, -1
    s_cbranch_scc1 TL_LATED
    buffer_load_dword v57, v56, s[12:15], s35 offen sc1
    s_add_u32 s39, s39, 1
    s_waitcnt vmcnt(0)
    s_cmp_lt_u32 s39, 32768
    s_cbranch_scc1 TL_LATEL
TL_LATED:
    s_nop 0
    s_mov_b32 s51, s59
    buffer_load_dwordx4 a[128:131], v2, s[12:15], s51 offen offset:2048
    buffer_load_dwordx4 a[132:135], v2, s[12:15], s51 offen offset:3072
    s_add_u32 s51, s51, 4096
    buffer_load_dwordx4 a[136:139], v2, s[12:15], s51 offen offset:2048
    buffer_load_dwordx4 a[140:143], v2, s[12:15], s51 offen offset:3072
    s_add_u32 s51, s51, 28672
    buffer_load_dwordx4 a[144:147], v2, s[12:15], s51 offen offset:2048
    buffer_load_dwordx4 a[148:151], v2, s[12:15], s51 offen offset:3072
    s_add_u32 s51, s51, 4096
    buffer_load_dwordx4 a[152:155], v2, s[12:15], s51 offen offset:2048
    buffer_load_dwordx4 a[156:159], v2, s[12:15], s51 offen offset:3072
    s_add_u32 s51, s51, 28672
    buffer_load_dwordx4 a[160:163], v2, s[12:15], s51 offen offset:0
    buffer_load_dwordx4 a[164:167], v2, s[12:15], s51 offen offset:1024
    s_add_u32 s51, s51, 4096
    buffer_load_dwordx4 a[168:171], v2, s[12:15], s51 offen offset:0
    buffer_load_dwordx4 a[172:175], v2, s[12:15], s51 offen offset:1024
    s_add_u32 s51, s51, 28672
    buffer_load_dwordx4 a[176:179], v2, s[12:15], s51 offen offset:0
    buffer_load_dwordx4 a[180:183], v2, s[12:15], s51 offen offset:1024
    s_add_u32 s51, s51, 4096
    buffer_load_dwordx4 a[184:187], v2, s[12:15], s51 offen offset:0
    buffer_load_dwordx4 a[188:191], v2, s[12:15], s51 offen offset:1024
    s_sub_u32 s51, s51, 102400
    buffer_load_dwordx4 a[192:195], v2, s[12:15], s51 offen offset:0
    buffer_load_dwordx4 a[196:199], v2, s[12:15], s51 offen offset:1024
    s_add_u32 s51, s51, 4096
    buffer_load_dwordx4 a[200:203], v2, s[12:15], s51 offen offset:0
    buffer_load_dwordx4 a[204:207], v2, s[12:15], s51 offen offset:1024
    s_add_u32 s51, s51, 28672
    buffer_load_dwordx4 a[208:211], v2, s[12:15], s51 offen offset:0
    buffer_load_dwordx4 a[212:215], v2, s[12:15], s51 offen offset:1024
    s_add_u32 s51, s51, 4096
    buffer_load_dwordx4 a[216:219], v2, s[12:15], s51 offen offset:0
    buffer_load_dwordx4 a[220:223], v2, s[12:15], s51 offen offset:1024
    s_add_u32 s51, s51, 28672
    buffer_load_dwordx4 a[224:227], v2, s[12:15], s51 offen offset:2048
    buffer_load_dwordx4 a[228:231], v2, s[12:15], s51 offen offset:3072
    s_add_u32 s51, s51, 4096
    buffer_load_dwordx4 a[232:235], v2, s[12:15], s51 offen offset:2048
    buffer_load_dwordx4 a[236:239], v2, s[12:15], s51 offen offset:3072
    s_add_u32 s51, s51, 28672
    buffer_load_dwordx4 a[240:243], v2, s[12:15], s51 offen offset:2048
    buffer_load_dwordx4 a[244:247], v2, s[12:15], s51 offen offset:3072
    s_add_u32 s51, s51, 4096
    buffer_load_dwordx4 a[248:251], v2, s[12:15], s51 offen offset:2048
    buffer_load_dwordx4 a[252:255], v2, s[12:15], s51 offen offset:3072
    s_waitcnt vmcnt(0)
    s_branch TL_LATER
TPH_S:
    s_mov_b32 s39, 0
TPH_L:
    s_nop 0
    buffer_load_dword v57, v24, s[12:15], s37 offen sc1
    s_add_u32 s39, s39, 1
    s_waitcnt vmcnt(0)
    v_cmp_le_u32 vcc, 1, v57
    s_nop 0
    s_cmp_eq_u64 vcc, -1
    s_cbranch_scc1 TPH_R
    s_cmp_lt_u32 s39, 32768
    s_cbranch_scc1 TPH_L
    s_branch TPH_R
TPD_S:
    s_mov_b32 s39, 0
TPD_L:
    s_nop 0
    buffer_load_dword v29, v28, s[12:15], s78 offen sc1
    s_add_u32 s39, s39, 1
    s_waitcnt vmcnt(0)
    v_cmp_le_u32 vcc, 1, v29
    s_nop 0
    s_cmp_eq_u64 vcc, -1
    s_cbranch_scc1 TPD_R
    s_cmp_lt_u32 s39, 32768
    s_cbranch_scc1 TPD_L
    s_branch TPD_R
TPX0_S:
    s_mov_b32 s39, 0
TPX0_L:
    s_nop 0
    buffer_load_dword v57, v24, s[12:15], s58 offen sc1
    s_add_u32 s39, s39, 1
    s_waitcnt vmcnt(0)
    v_cmp_le_u32 vcc, 1, v57
    s_nop 0
    s_cmp_eq_u64 vcc, -1
    s_cbranch_scc1 TPX0_R
    s_cmp_lt_u32 s39, 32768
    s_cbranch_scc1 TPX0_L
    s_branch TPX0_R
TL_LF_10:
    s_waitcnt vmcnt(0)
    buffer_wbl2 sc1
    s_waitcnt vmcnt(0)
    v_mov_b32 v58, 1
    s_mov_b64 exec, 1
    buffer_store_dword v58, off, s[12:15], s99 sc0 sc1
    s_mov_b64 exec, -1
    s_branch TL_LF_10_R
TZH_S:
    s_mov_b32 s39, 0
TZH_L:
    s_nop 0
    buffer_load_dwordx4 v[236:239], v31, s[12:15], s50 offen sc0 sc1
    buffer_load_dwordx4 v[240:243], v31, s[12:15], s50 offen offset:16 sc0 sc1
    s_add_u32 s39, s39, 1
    s_waitcnt vmcnt(0)
    v_and_b32 v15, v237, v239
    v_and_b32 v11, v241, v243
    v_and_b32 v15, v15, v11
    v_cmp_gt_i32 vcc, 0, v15
    s_nop 0
    s_cmp_eq_u64 vcc, -1
    s_cbranch_scc1 TZH_R
    s_cmp_lt_u32 s39, 32768
    s_cbranch_scc1 TZH_L
    s_branch TZH_R
TAX2L_S:
    s_mov_b32 s39, 0
TAX2L_L:
    s_nop 0
    buffer_load_dword v57, v24, s[12:15], s28 offen sc1
    s_add_u32 s39, s39, 1
    s_waitcnt vmcnt(0)
    v_cmp_le_u32 vcc, 1, v57
    s_nop 0
    s_cmp_eq_u64 vcc, -1
    s_cbranch_scc1 TAX2L_R
    s_cmp_lt_u32 s39, 32768
    s_cbranch_scc1 TAX2L_L
    s_branch TAX2L_R
TL_LF_11:
    s_waitcnt vmcnt(0)
    buffer_wbl2 sc1
    s_waitcnt vmcnt(0)
    v_mov_b32 v58, 1
    s_mov_b64 exec, 1
    buffer_store_dword v58, off, s[12:15], s98 sc0 sc1
    s_mov_b64 exec, -1
    s_branch TL_LF_11_R
TAPX1_S:
    s_mov_b32 s39, 0
TAPX1_L:
    s_nop 0
    buffer_load_dword v57, v24, s[12:15], s58 offen sc1
    s_add_u32 s39, s39, 1
    s_waitcnt vmcnt(0)
    v_cmp_le_u32 vcc, 2, v57
    s_nop 0
    s_cmp_eq_u64 vcc, -1
    s_cbranch_scc1 TAPX1_R
    s_cmp_lt_u32 s39, 32768
    s_cbranch_scc1 TAPX1_L
    s_branch TAPX1_R
TL_LF_12:
    s_waitcnt vmcnt(0)
    buffer_wbl2 sc1
    s_waitcnt vmcnt(0)
    v_mov_b32 v58, 1
    s_mov_b64 exec, 1
    buffer_store_dword v58, off, s[12:15], s98 sc0 sc1
    s_mov_b64 exec, -1
    s_branch TL_LF_12_R
TL_LF_13:
    s_waitcnt vmcnt(0)
    buffer_wbl2 sc1
    s_waitcnt vmcnt(0)
    s_mov_b64 exec, s[66:67]
    buffer_store_dwordx2 v[248:249], v27, s[12:15], s45 offen sc0 sc1
    s_mov_b64 exec, -1
    s_branch TL_LF_13_R
TAX2H_S:
    s_mov_b32 s39, 0
TAX2H_L:
    s_nop 0
    buffer_load_dword v57, v24, s[12:15], s28 offen sc1
    s_add_u32 s39, s39, 1
    s_waitcnt vmcnt(0)
    v_cmp_le_u32 vcc, 1, v57
    s_nop 0
    s_cmp_eq_u64 vcc, -1
    s_cbranch_scc1 TAX2H_R
    s_cmp_lt_u32 s39, 32768
    s_cbranch_scc1 TAX2H_L
    s_branch TAX2H_R
TAZL_S:
    s_mov_b32 s39, 0
TAZL_L:
    s_nop 0
    buffer_load_dwordx4 v[236:239], v31, s[12:15], s50 offen sc0 sc1
    buffer_load_dwordx4 v[240:243], v31, s[12:15], s50 offen offset:16 sc0 sc1
    s_add_u32 s39, s39, 1
    s_waitcnt vmcnt(0)
    v_and_b32 v57, v237, v239
    v_and_b32 v56, v241, v243
    v_and_b32 v57, v57, v56
    v_cmp_gt_i32 vcc, 0, v57
    s_nop 0
    s_cmp_eq_u64 vcc, -1
    s_cbranch_scc1 TAZL_R
    s_cmp_lt_u32 s39, 32768
    s_cbranch_scc1 TAZL_L
    s_branch TAZL_R
TAFZL_S:
    s_mov_b32 s39, 0
TAFZL_L:
    s_nop 0
    buffer_load_dword v57, v18, s[12:15], s28 offen sc1
    s_add_u32 s39, s39, 1
    s_waitcnt vmcnt(0)
    v_cmp_le_u32 vcc, 1, v57
    s_nop 0
    s_cmp_eq_u64 vcc, -1
    s_cbranch_scc1 TAFZL_R
    s_cmp_lt_u32 s39, 32768
    s_cbranch_scc1 TAFZL_L
    s_branch TAFZL_R
TL_LF_14:
    s_waitcnt vmcnt(0)
    buffer_wbl2 sc1
    s_waitcnt vmcnt(0)
    s_mov_b64 exec, s[66:67]
    buffer_store_dwordx2 v[100:101], v27, s[12:15], s45 offen sc0 sc1
    s_mov_b64 exec, -1
    s_branch TL_LF_14_R
TBX2L_S:
    s_mov_b32 s39, 0
TBX2L_L:
    s_nop 0
    buffer_load_dword v57, v24, s[12:15], s28 offen sc1
    s_add_u32 s39, s39, 1
    s_waitcnt vmcnt(0)
    v_cmp_le_u32 vcc, 1, v57
    s_nop 0
    s_cmp_eq_u64 vcc, -1
    s_cbranch_scc1 TBX2L_R
    s_cmp_lt_u32 s39, 32768
    s_cbranch_scc1 TBX2L_L
    s_branch TBX2L_R
TL_LF_15:
    s_waitcnt vmcnt(0)
    buffer_wbl2 sc1
    s_waitcnt vmcnt(0)
    v_mov_b32 v58, 1
    s_mov_b64 exec, 1
    buffer_store_dword v58, off, s[12:15], s98 sc0 sc1
    s_mov_b64 exec, -1
    s_branch TL_LF_15_R
TBPX1_S:
    s_mov_b32 s39, 0
TBPX1_L:
    s_nop 0
    buffer_load_dword v57, v24, s[12:15], s58 offen sc1
    s_add_u32 s39, s39, 1
    s_waitcnt vmcnt(0)
    v_cmp_le_u32 vcc, 2, v57
    s_nop 0
    s_cmp_eq_u64 vcc, -1
    s_cbranch_scc1 TBPX1_R
    s_cmp_lt_u32 s39, 32768
    s_cbranch_scc1 TBPX1_L
    s_branch TBPX1_R
TL_LF_16:
    s_waitcnt vmcnt(0)
    buffer_wbl2 sc1
    s_waitcnt vmcnt(0)
    v_mov_b32 v58, 1
    s_mov_b64 exec, 1
    buffer_store_dword v58, off, s[12:15], s98 sc0 sc1
    s_mov_b64 exec, -1
    s_branch TL_LF_16_R
TL_LF_17:
    s_waitcnt vmcnt(0)
    buffer_wbl2 sc1
    s_waitcnt vmcnt(0)
    s_mov_b64 exec, s[66:67]
    buffer_store_dwordx2 v[248:249], v27, s[12:15], s45 offen sc0 sc1
    s_mov_b64 exec, -1
    s_branch TL_LF_17_R
TBX2H_S:
    s_mov_b32 s39, 0
TBX2H_L:
    s_nop 0
    buffer_load_dword v57, v24, s[12:15], s28 offen sc1
    s_add_u32 s39, s39, 1
    s_waitcnt vmcnt(0)
    v_cmp_le_u32 vcc, 1, v57
    s_nop 0
    s_cmp_eq_u64 vcc, -1
    s_cbranch_scc1 TBX2H_R
    s_cmp_lt_u32 s39, 32768
    s_cbranch_scc1 TBX2H_L
    s_branch TBX2H_R
TBZL_S:
    s_mov_b32 s39, 0
TBZL_L:
    s_nop 0
    buffer_load_dwordx4 v[236:239], v31, s[12:15], s50 offen sc0 sc1
    buffer_load_dwordx4 v[240:243], v31, s[12:15], s50 offen offset:16 sc0 sc1
    s_add_u32 s39, s39, 1
    s_waitcnt vmcnt(0)
    v_and_b32 v57, v237, v239
    v_and_b32 v56, v241, v243
    v_and_b32 v57, v57, v56
    v_cmp_gt_i32 vcc, 0, v57
    s_nop 0
    s_cmp_eq_u64 vcc, -1
    s_cbranch_scc1 TBZL_R
    s_cmp_lt_u32 s39, 32768
    s_cbranch_scc1 TBZL_L
    s_branch TBZL_R
TBFZL_S:
    s_mov_b32 s39, 0
TBFZL_L:
    s_nop 0
    buffer_load_dword v57, v18, s[12:15], s28 offen sc1
    s_add_u32 s39, s39, 1
    s_waitcnt vmcnt(0)
    v_cmp_le_u32 vcc, 1, v57
    s_nop 0
    s_cmp_eq_u64 vcc, -1
    s_cbranch_scc1 TBFZL_R
    s_cmp_lt_u32 s39, 32768
    s_cbranch_scc1 TBFZL_L
    s_branch TBFZL_R
TL_LF_18:
    s_waitcnt vmcnt(0)
    buffer_wbl2 sc1
    s_waitcnt vmcnt(0)
    s_mov_b64 exec, s[66:67]
    buffer_store_dwordx2 v[100:101], v27, s[12:15], s45 offen sc0 sc1
    s_mov_b64 exec, -1
    s_branch TL_LF_18_R
TFZH_S:
    s_mov_b32 s39, 0
TFZH_L:
    s_nop 0
    buffer_load_dword v15, v18, s[12:15], s28 offen sc1
    s_add_u32 s39, s39, 1
    s_waitcnt vmcnt(0)
    v_cmp_le_u32 vcc, 1, v15
    s_nop 0
    s_cmp_eq_u64 vcc, -1
    s_cbranch_scc1 TFZH_R
    s_cmp_lt_u32 s39, 32768
    s_cbranch_scc1 TFZH_L
    s_branch TFZH_R
TL_LF_19:
    s_waitcnt vmcnt(0)
    buffer_wbl2 sc1
    s_waitcnt vmcnt(0)
    v_mov_b32 v14, 1
    s_mov_b64 exec, 1
    buffer_store_dword v14, off, s[12:15], s30 sc0 sc1
    s_mov_b64 exec, -1
    s_branch TL_LF_19_R
TL_LF_20:
    s_waitcnt vmcnt(0)
    buffer_wbl2 sc1
    s_waitcnt vmcnt(0)
    v_mov_b32 v58, 1
    s_mov_b64 exec, 1
    buffer_store_dword v58, off, s[12:15], s99 sc0 sc1
    s_mov_b64 exec, -1
    s_branch TL_LF_20_R
oproj_kernel:
win_kernel:
sp_kernel:
wout_kernel:
CODE_END:
    s_endpgm
.section .rodata,"a"
.p2align 6
.amdhsa_kernel attn_kernel
  .amdhsa_next_free_vgpr 512
  .amdhsa_next_free_sgpr 102
  .amdhsa_accum_offset 256
  .amdhsa_group_segment_fixed_size 0
  .amdhsa_kernarg_size 128
  .amdhsa_user_sgpr_count 2
  .amdhsa_user_sgpr_kernarg_segment_ptr 1
  .amdhsa_system_sgpr_workgroup_id_x 1
.end_amdhsa_kernel
```
